```python
import torch

def _softmax(x, axis=-1):
    return torch.softmax(x, dim=axis)
def _gelu(x):
    return torch.nn.functional.gelu(x, approximate="tanh")
def _silu(x):
    return torch.nn.functional.silu(x)
def _sigmoid(x):
    return torch.sigmoid(x)
def _layernorm(x, axis=-1, eps=1e-5):
    m = x.mean(dim=axis, keepdim=True)
    v = x.var(dim=axis, keepdim=True, unbiased=False)
    return (x - m) / torch.sqrt(v + eps)
def _scatter_add(tgt, idx, src, axis=0):
    return tgt.clone().index_add_(axis, idx, src)
def _segment_sum(src, seg, n):
    out = torch.zeros((n,) + src.shape[1:], dtype=src.dtype)
    return out.index_add_(0, seg, src)
def _pad(x, pw):
    flat = tuple(v for pair in reversed(pw) for v in pair)
    return torch.nn.functional.pad(x, flat)

kernel_name = 'standalone__gqa_softmax__near_ridge'

def setup_inputs():

    _w = (lambda a: (lambda t: t.to(torch.bfloat16) if t.is_floating_point() else t)(torch.as_tensor(a)))
    B, Hq, Hkv, Sq, Sk, D = 8, 16, 8, 368, 512, 256
    return {
        "q": _w((lambda *s: torch.randn(*s, dtype=torch.bfloat16) * 0.8)(B, Hq, Sq, D)),
        "k": _w((lambda *s: torch.randn(*s, dtype=torch.bfloat16) * 0.8)(B, Hkv, Sk, D)),
        "v": _w((lambda *s: torch.randn(*s, dtype=torch.bfloat16) * 0.05)(B, Hkv, Sk, D)),
    }

def reference(q, k, v):
    B, Hq, Sq, D = q.shape
    Hkv = k.shape[1]
    rep = Hq // Hkv
    k = (lambda x, n, axis: torch.repeat_interleave(x, n, dim=axis))(k, rep, axis=1)
    v = (lambda x, n, axis: torch.repeat_interleave(x, n, dim=axis))(v, rep, axis=1)
    scale = D ** -0.5
    scores = torch.einsum("bhqd,bhkd->bhqk", q, k) * scale
    p = _softmax(scores, axis=-1)
    return torch.einsum("bhqk,bhkd->bhqd", p, v)
```

```asm
; @launch grid=(256,1,1) block=(256,1,1) lds=163840
.amdgcn_target "amdgcn-amd-amdhsa--gfx950"
.text
.globl standalone__gqa_softmax__near_ridge_kernel
.p2align 8
.type standalone__gqa_softmax__near_ridge_kernel,@function
standalone__gqa_softmax__near_ridge_kernel:
    s_cmp_ge_u32 s2, 256
    s_cbranch_scc1 L_end
    s_load_dwordx4 s[4:7], s[0:1], 0
    s_load_dwordx4 s[8:11], s[0:1], 16
    v_lshrrev_b32 v1, 6, v0
    v_and_b32 v0, 63, v0
    v_readfirstlane_b32 s18, v1
    s_getpc_b64 s[52:53]
    s_and_b32 s52, s52, 0xfffff000
    v_and_b32 v112, 7, v0
    v_lshlrev_b32 v112, 12, v112
    v_mov_b32 v113, s53
    v_add_co_u32 v112, vcc, s52, v112
    s_nop 1
    v_addc_co_u32 v113, vcc, 0, v113, vcc
    global_load_dword a252, v[112:113], off
    s_and_b32 s14, s2, 7
    s_lshr_b32 s15, s2, 3
    s_lshl_b32 s14, s14, 3
    s_lshr_b32 s16, s15, 2
    s_add_u32 s14, s14, s16
    s_and_b32 s15, s15, 3
    s_mul_i32 s16, s14, 736
    s_mul_i32 s17, s15, 184
    s_add_u32 s16, s16, s17
    s_lshl_b32 s16, s16, 9
    s_lshl_b32 s17, s14, 18
    v_lshrrev_b32 v104, 3, v0
    v_and_b32 v105, 7, v0
    v_lshrrev_b32 v106, 4, v0
    v_lshlrev_b32 v107, 1, v106
    v_xor_b32 v107, v105, v107
    v_lshlrev_b32 v107, 4, v107
    v_lshl_add_u32 v1, v104, 9, v107
    v_xor_b32 v2, 16, v1
    v_add_u32 v2, 3072, v2
    v_add_u32 v3, 6144, v1
    v_add_u32 v4, 6144, v2
    v_add_u32 v18, 16384, v1
    v_add_u32 v19, 16384, v2
    s_mul_i32 s19, s18, 24576
    s_lshl_b32 s36, s18, 12
    s_mul_i32 s37, s18, 6144
    s_add_u32 s37, s37, 114688
    s_lshl_b32 s38, s18, 14
    s_lshl_b32 s100, s18, 11
    s_lshl_b32 s101, s18, 13
    s_waitcnt lgkmcnt(0)
    s_add_u32 s20, s4, s16
    s_addc_u32 s21, s5, 0
    s_add_u32 s20, s20, s19
    s_addc_u32 s21, s21, 0
    s_sub_u32 s22, 94208, s19
    s_mov_b32 s23, 0x20000
    s_add_u32 s24, s6, s17
    s_addc_u32 s25, s7, 0
    s_mov_b32 s26, 262144
    s_mov_b32 s27, 0x20000
    s_add_u32 m0, s100, 0
    s_add_u32 s48, s101, 0
    buffer_load_dwordx4 v1, s[24:27], s48 offen offset:0 nt lds
    buffer_load_dwordx4 v2, s[24:27], s48 offen offset:1024 nt lds
    s_add_u32 m0, s37, 0
    s_nop 0
    buffer_load_dwordx4 v1, s[20:23], 0 offen offset:0 nt lds
    buffer_load_dwordx4 v2, s[20:23], 0 offen offset:1024 nt lds
    s_add_u32 m0, s100, 8192
    s_add_u32 s48, s101, 32768
    buffer_load_dwordx4 v1, s[24:27], s48 offen offset:0 nt lds
    buffer_load_dwordx4 v2, s[24:27], s48 offen offset:1024 nt lds
    s_add_u32 m0, s37, 0
    s_nop 0
    buffer_load_dwordx4 v3, s[20:23], 0 offen offset:2048 nt lds
    buffer_load_dwordx4 v4, s[20:23], 0 offen offset:3072 nt lds
    s_add_u32 m0, s37, 4096
    s_nop 0
    buffer_load_dwordx4 v18, s[20:23], 0 offen offset:0 nt lds
    buffer_load_dwordx4 v19, s[20:23], 0 offen offset:1024 nt lds
    s_add_u32 m0, s36, 16384
    s_add_u32 s48, s38, 65536
    buffer_load_dwordx4 v1, s[24:27], s48 offen offset:0 nt lds
    buffer_load_dwordx4 v2, s[24:27], s48 offen offset:1024 nt lds
    buffer_load_dwordx4 v3, s[24:27], s48 offen offset:2048 nt lds
    buffer_load_dwordx4 v4, s[24:27], s48 offen offset:3072 nt lds
    s_lshr_b32 s49, s2, 3
    s_lshl_b32 s49, s49, 2
    s_add_u32 s49, s49, s18
    s_lshl_b32 s49, s49, 9
    s_lshr_b32 s49, s49, 1
    v_lshl_add_u32 v112, v0, 2, s49
    v_mov_b32 v113, s53
    v_add_co_u32 v112, vcc, s52, v112
    s_nop 1
    v_addc_co_u32 v113, vcc, 0, v113, vcc
    global_load_dword a252, v[112:113], off
    s_mov_b32 s40, 0
    s_mov_b32 s41, 128
    s_mov_b32 s42, 256
    s_mov_b32 s43, 384
    s_lshl_b32 s39, s15, 12
    s_add_u32 s39, s39, s38
    s_add_u32 s44, s39, 131328
    s_add_u32 s45, s39, 196864
    s_add_u32 s46, s39, 384
    s_add_u32 s47, s39, 65920
    s_add_u32 s56, s39, 131456
    s_add_u32 s57, s39, 196992
    s_add_u32 s28, s8, s17
    s_addc_u32 s29, s9, 0
    s_mov_b32 s30, 262144
    s_mov_b32 s31, 0x20000
    s_add_u32 s32, s10, s16
    s_addc_u32 s33, s11, 0
    s_mov_b32 s34, 94208
    s_mov_b32 s35, 0x20000
    s_mov_b32 s50, 1035512379
    s_mov_b32 s51, 1035512379
    s_lshl_b32 s92, s18, 2
    s_add_u32 s92, s92, 131072
    s_add_u32 s93, s36, 131072
    v_and_b32 v108, 15, v0
    v_and_b32 v109, 6, v108
    v_lshrrev_b32 v113, 3, v108
    v_or_b32 v109, v109, v113
    v_lshlrev_b32 v113, 1, v106
    v_xor_b32 v109, v109, v113
    v_lshlrev_b32 v109, 4, v109
    v_lshl_add_u32 v20, v108, 7, v109
    v_xor_b32 v21, 16, v20
    v_add_u32 v22, 65536, v20
    v_add_u32 v16, s37, v20
    v_add_u32 v23, 65536, v21
    v_add_u32 v17, s37, v21
    v_lshrrev_b32 v109, 2, v0
    v_lshlrev_b32 v113, 7, v109
    v_and_b32 v114, 6, v109
    v_lshrrev_b32 v109, 3, v109
    v_or_b32 v114, v114, v109
    v_bfe_u32 v109, v0, 1, 1
    v_xor_b32 v114, v114, v109
    v_lshlrev_b32 v114, 4, v114
    v_and_b32 v109, 1, v0
    v_lshlrev_b32 v109, 3, v109
    v_add3_u32 v5, v113, v114, v109
    v_add_u32 v5, 131072, v5
    v_xor_b32 v6, 32, v5
    v_xor_b32 v7, 64, v5
    v_xor_b32 v8, 96, v5
    v_and_b32 v109, 1, v106
    v_lshlrev_b32 v109, 5, v109
    v_lshrrev_b32 v113, 1, v106
    v_lshlrev_b32 v113, 4, v113
    v_lshl_add_u32 v114, v108, 9, s19
    v_add3_u32 v9, v114, v109, v113
    v_add_u32 v10, 8192, v9
    v_add_u32 v11, 16384, v9
    s_waitcnt vmcnt(11)
    ds_read_b128 a[184:187], v16 offset:0
    ds_read_b128 a[188:191], v17 offset:0
    s_barrier
    ds_read_b128 a[88:91], v20 offset:0
    ds_read_b128 a[92:95], v21 offset:0
    ds_read_b128 a[96:99], v20 offset:2048
    ds_read_b128 a[100:103], v21 offset:2048
    ds_read_b128 a[104:107], v20 offset:4096
    ds_read_b128 a[108:111], v21 offset:4096
    ds_read_b128 a[112:115], v20 offset:6144
    ds_read_b128 a[116:119], v21 offset:6144
    s_waitcnt lgkmcnt(6)
    v_mfma_f32_16x16x32_bf16 v[24:27], a[88:91], a[184:187], 0
    s_add_u32 m0, s36, 32768
    s_add_u32 s48, s38, 131072
    v_mfma_f32_16x16x32_bf16 v[24:27], a[92:95], a[188:191], v[24:27]
    s_waitcnt vmcnt(9)
    s_barrier
    s_waitcnt lgkmcnt(4)
    v_mfma_f32_16x16x32_bf16 v[28:31], a[96:99], a[184:187], 0
    ds_read_b128 a[120:123], v20 offset:8192
    ds_read_b128 a[124:127], v21 offset:8192
    v_mfma_f32_16x16x32_bf16 v[28:31], a[100:103], a[188:191], v[28:31]
    ds_read_b128 a[128:131], v20 offset:10240
    ds_read_b128 a[132:135], v21 offset:10240
    s_waitcnt lgkmcnt(6)
    v_mfma_f32_16x16x32_bf16 v[32:35], a[104:107], a[184:187], 0
    ds_read_b128 a[136:139], v20 offset:12288
    ds_read_b128 a[140:143], v21 offset:12288
    v_mfma_f32_16x16x32_bf16 v[32:35], a[108:111], a[188:191], v[32:35]
    ds_read_b128 a[144:147], v20 offset:14336
    ds_read_b128 a[148:151], v21 offset:14336
    s_waitcnt lgkmcnt(8)
    v_mfma_f32_16x16x32_bf16 v[36:39], a[112:115], a[184:187], 0
    buffer_load_dwordx4 v1, s[24:27], s48 offen offset:0 nt lds
    v_mfma_f32_16x16x32_bf16 v[36:39], a[116:119], a[188:191], v[36:39]
    s_waitcnt lgkmcnt(6)
    v_mfma_f32_16x16x32_bf16 v[40:43], a[120:123], a[184:187], 0
    v_mfma_f32_16x16x32_bf16 v[40:43], a[124:127], a[188:191], v[40:43]
    s_waitcnt vmcnt(8)
    ds_read_b128 a[192:195], v16 offset:2048
    ds_read_b128 a[196:199], v17 offset:2048
    s_waitcnt lgkmcnt(6)
    v_mfma_f32_16x16x32_bf16 v[44:47], a[128:131], a[184:187], 0
    buffer_load_dwordx4 v2, s[24:27], s48 offen offset:1024 nt lds
    v_mfma_f32_16x16x32_bf16 v[44:47], a[132:135], a[188:191], v[44:47]
    s_waitcnt lgkmcnt(4)
    v_mfma_f32_16x16x32_bf16 v[48:51], a[136:139], a[184:187], 0
    v_mfma_f32_16x16x32_bf16 v[48:51], a[140:143], a[188:191], v[48:51]
    s_waitcnt lgkmcnt(2)
    v_mfma_f32_16x16x32_bf16 v[52:55], a[144:147], a[184:187], 0
    buffer_load_dwordx4 v3, s[24:27], s48 offen offset:2048 nt lds
    v_mfma_f32_16x16x32_bf16 v[52:55], a[148:151], a[188:191], v[52:55]
    s_waitcnt lgkmcnt(0)
    v_mfma_f32_16x16x32_bf16 v[152:155], a[88:91], a[192:195], 0
    v_mfma_f32_16x16x32_bf16 v[152:155], a[92:95], a[196:199], v[152:155]
    v_mfma_f32_16x16x32_bf16 v[156:159], a[96:99], a[192:195], 0
    buffer_load_dwordx4 v4, s[24:27], s48 offen offset:3072 nt lds
    v_mfma_f32_16x16x32_bf16 v[156:159], a[100:103], a[196:199], v[156:159]
    v_mfma_f32_16x16x32_bf16 v[160:163], a[104:107], a[192:195], 0
    v_mfma_f32_16x16x32_bf16 v[160:163], a[108:111], a[196:199], v[160:163]
    v_mfma_f32_16x16x32_bf16 v[164:167], a[112:115], a[192:195], 0
    s_waitcnt vmcnt(9)
    ds_read_b128 a[200:203], v16 offset:4096
    ds_read_b128 a[204:207], v17 offset:4096
    v_mfma_f32_16x16x32_bf16 v[164:167], a[116:119], a[196:199], v[164:167]
    s_add_u32 m0, s37, 24576
    v_mfma_f32_16x16x32_bf16 v[168:171], a[120:123], a[192:195], 0
    buffer_load_dwordx4 v1, s[20:23], s41 offen offset:0 nt lds
    v_mfma_f32_16x16x32_bf16 v[168:171], a[124:127], a[196:199], v[168:171]
    v_mfma_f32_16x16x32_bf16 v[172:175], a[128:131], a[192:195], 0
    v_mfma_f32_16x16x32_bf16 v[172:175], a[132:135], a[196:199], v[172:175]
    v_mfma_f32_16x16x32_bf16 v[176:179], a[136:139], a[192:195], 0
    buffer_load_dwordx4 v2, s[20:23], s41 offen offset:1024 nt lds
    v_mfma_f32_16x16x32_bf16 v[176:179], a[140:143], a[196:199], v[176:179]
    v_mfma_f32_16x16x32_bf16 v[180:183], a[144:147], a[192:195], 0
    v_mfma_f32_16x16x32_bf16 v[180:183], a[148:151], a[196:199], v[180:183]
    s_waitcnt lgkmcnt(0)
    v_mfma_f32_16x16x32_bf16 a[24:27], a[88:91], a[200:203], 0
    s_add_u32 m0, s36, 49152
    s_add_u32 s48, s38, 196608
    v_mfma_f32_16x16x32_bf16 a[24:27], a[92:95], a[204:207], a[24:27]
    buffer_load_dwordx4 v1, s[24:27], s48 offen offset:0 nt lds
    v_mfma_f32_16x16x32_bf16 a[28:31], a[96:99], a[200:203], 0
    v_mfma_f32_16x16x32_bf16 a[28:31], a[100:103], a[204:207], a[28:31]
    v_mfma_f32_16x16x32_bf16 a[32:35], a[104:107], a[200:203], 0
    s_mov_b64 exec, 0
    s_cmp_eq_u32 s18, 0
    s_cbranch_scc1 L_pad0
    s_cmp_eq_u32 s18, 1
    s_cbranch_scc1 L_pad1
    s_cmp_eq_u32 s18, 2
    s_cbranch_scc1 L_pad2
    s_branch L_pad3
L_back1:
    s_mov_b64 exec, -1
    s_nop 3
    s_waitcnt vmcnt(8)
    s_barrier
    v_mfma_f32_16x16x32_bf16 a[32:35], a[108:111], a[204:207], a[32:35]
    ds_read_b128 a[152:155], v20 offset:16384
    buffer_load_dwordx4 v2, s[24:27], s48 offen offset:1024 nt lds
    v_mfma_f32_16x16x32_bf16 a[36:39], a[112:115], a[200:203], 0
    ds_read_b128 a[156:159], v21 offset:16384
    v_mfma_f32_16x16x32_bf16 a[36:39], a[116:119], a[204:207], a[36:39]
    v_mfma_f32_16x16x32_bf16 a[40:43], a[120:123], a[200:203], 0
    v_mfma_f32_16x16x32_bf16 a[40:43], a[124:127], a[204:207], a[40:43]
    buffer_load_dwordx4 v3, s[24:27], s48 offen offset:2048 nt lds
    v_mfma_f32_16x16x32_bf16 a[44:47], a[128:131], a[200:203], 0
    ds_read_b128 a[160:163], v20 offset:18432
    v_mfma_f32_16x16x32_bf16 a[44:47], a[132:135], a[204:207], a[44:47]
    ds_read_b128 a[164:167], v21 offset:18432
    v_mfma_f32_16x16x32_bf16 a[48:51], a[136:139], a[200:203], 0
    v_mfma_f32_16x16x32_bf16 a[48:51], a[140:143], a[204:207], a[48:51]
    buffer_load_dwordx4 v4, s[24:27], s48 offen offset:3072 nt lds
    v_mfma_f32_16x16x32_bf16 a[52:55], a[144:147], a[200:203], 0
    v_mfma_f32_16x16x32_bf16 a[52:55], a[148:151], a[204:207], a[52:55]
    s_waitcnt lgkmcnt(2)
    v_mfma_f32_16x16x32_bf16 v[56:59], a[152:155], a[184:187], 0
    ds_read_b128 a[168:171], v20 offset:20480
    v_mfma_f32_16x16x32_bf16 v[56:59], a[156:159], a[188:191], v[56:59]
    ds_read_b128 a[172:175], v21 offset:20480
    s_add_u32 m0, s37, 24576
    v_mfma_f32_16x16x32_bf16 v[184:187], a[152:155], a[192:195], 0
    buffer_load_dwordx4 v3, s[20:23], s41 offen offset:2048 nt lds
    v_mfma_f32_16x16x32_bf16 v[184:187], a[156:159], a[196:199], v[184:187]
    v_mfma_f32_16x16x32_bf16 a[56:59], a[152:155], a[200:203], 0
    v_mfma_f32_16x16x32_bf16 a[56:59], a[156:159], a[204:207], a[56:59]
    s_waitcnt lgkmcnt(2)
    v_mfma_f32_16x16x32_bf16 v[60:63], a[160:163], a[184:187], 0
    ds_read_b128 a[176:179], v20 offset:22528
    buffer_load_dwordx4 v4, s[20:23], s41 offen offset:3072 nt lds
    v_mfma_f32_16x16x32_bf16 v[60:63], a[164:167], a[188:191], v[60:63]
    ds_read_b128 a[180:183], v21 offset:22528
    v_mfma_f32_16x16x32_bf16 v[188:191], a[160:163], a[192:195], 0
    v_mfma_f32_16x16x32_bf16 v[188:191], a[164:167], a[196:199], v[188:191]
    v_mfma_f32_16x16x32_bf16 a[60:63], a[160:163], a[200:203], 0
    s_add_u32 m0, s37, 28672
    v_mfma_f32_16x16x32_bf16 a[60:63], a[164:167], a[204:207], a[60:63]
    buffer_load_dwordx4 v18, s[20:23], s41 offen offset:0 nt lds
    s_waitcnt lgkmcnt(2)
    v_mfma_f32_16x16x32_bf16 v[64:67], a[168:171], a[184:187], 0
    ds_read_b128 a[152:155], v20 offset:24576
    v_mfma_f32_16x16x32_bf16 v[64:67], a[172:175], a[188:191], v[64:67]
    ds_read_b128 a[156:159], v21 offset:24576
    v_mfma_f32_16x16x32_bf16 v[192:195], a[168:171], a[192:195], 0
    v_mfma_f32_16x16x32_bf16 v[192:195], a[172:175], a[196:199], v[192:195]
    buffer_load_dwordx4 v19, s[20:23], s41 offen offset:1024 nt lds
    v_mfma_f32_16x16x32_bf16 a[64:67], a[168:171], a[200:203], 0
    v_mfma_f32_16x16x32_bf16 a[64:67], a[172:175], a[204:207], a[64:67]
    s_waitcnt lgkmcnt(2)
    v_mfma_f32_16x16x32_bf16 v[68:71], a[176:179], a[184:187], 0
    ds_read_b128 a[160:163], v20 offset:26624
    v_mfma_f32_16x16x32_bf16 v[68:71], a[180:183], a[188:191], v[68:71]
    ds_read_b128 a[164:167], v21 offset:26624
    v_mfma_f32_16x16x32_bf16 v[196:199], a[176:179], a[192:195], 0
    v_mfma_f32_16x16x32_bf16 v[196:199], a[180:183], a[196:199], v[196:199]
    v_mfma_f32_16x16x32_bf16 a[68:71], a[176:179], a[200:203], 0
    s_add_u32 m0, s36, 65536
    s_add_u32 s48, s38, 128
    v_mfma_f32_16x16x32_bf16 a[68:71], a[180:183], a[204:207], a[68:71]
    buffer_load_dwordx4 v1, s[24:27], s48 offen offset:0 nt lds
    s_waitcnt lgkmcnt(2)
    v_mfma_f32_16x16x32_bf16 v[72:75], a[152:155], a[184:187], 0
    ds_read_b128 a[168:171], v20 offset:28672
    v_mfma_f32_16x16x32_bf16 v[72:75], a[156:159], a[188:191], v[72:75]
    ds_read_b128 a[172:175], v21 offset:28672
    v_mfma_f32_16x16x32_bf16 v[200:203], a[152:155], a[192:195], 0
    v_mfma_f32_16x16x32_bf16 v[200:203], a[156:159], a[196:199], v[200:203]
    v_mfma_f32_16x16x32_bf16 a[72:75], a[152:155], a[200:203], 0
    v_mfma_f32_16x16x32_bf16 a[72:75], a[156:159], a[204:207], a[72:75]
    s_waitcnt lgkmcnt(2)
    v_mfma_f32_16x16x32_bf16 v[76:79], a[160:163], a[184:187], 0
    ds_read_b128 a[176:179], v20 offset:30720
    buffer_load_dwordx4 v2, s[24:27], s48 offen offset:1024 nt lds
    v_mfma_f32_16x16x32_bf16 v[76:79], a[164:167], a[188:191], v[76:79]
    ds_read_b128 a[180:183], v21 offset:30720
    v_mfma_f32_16x16x32_bf16 v[204:207], a[160:163], a[192:195], 0
    v_mfma_f32_16x16x32_bf16 v[204:207], a[164:167], a[196:199], v[204:207]
    v_mfma_f32_16x16x32_bf16 a[76:79], a[160:163], a[200:203], 0
    v_mfma_f32_16x16x32_bf16 a[76:79], a[164:167], a[204:207], a[76:79]
    s_waitcnt lgkmcnt(2)
    v_mfma_f32_16x16x32_bf16 v[80:83], a[168:171], a[184:187], 0
    s_waitcnt vmcnt(12)
    s_barrier
    v_mfma_f32_16x16x32_bf16 v[80:83], a[172:175], a[188:191], v[80:83]
    ds_read_b128 a[152:155], v20 offset:32768
    buffer_load_dwordx4 v3, s[24:27], s48 offen offset:2048 nt lds
    v_mfma_f32_16x16x32_bf16 v[208:211], a[168:171], a[192:195], 0
    ds_read_b128 a[156:159], v21 offset:32768
    v_mfma_f32_16x16x32_bf16 v[208:211], a[172:175], a[196:199], v[208:211]
    v_mfma_f32_16x16x32_bf16 a[80:83], a[168:171], a[200:203], 0
    v_mfma_f32_16x16x32_bf16 a[80:83], a[172:175], a[204:207], a[80:83]
    s_waitcnt lgkmcnt(2)
    v_mfma_f32_16x16x32_bf16 v[84:87], a[176:179], a[184:187], 0
    ds_read_b128 a[160:163], v20 offset:34816
    v_mfma_f32_16x16x32_bf16 v[84:87], a[180:183], a[188:191], v[84:87]
    ds_read_b128 a[164:167], v21 offset:34816
    v_mfma_f32_16x16x32_bf16 v[212:215], a[176:179], a[192:195], 0
    buffer_load_dwordx4 v4, s[24:27], s48 offen offset:3072 nt lds
    v_mfma_f32_16x16x32_bf16 v[212:215], a[180:183], a[196:199], v[212:215]
    v_mfma_f32_16x16x32_bf16 a[84:87], a[176:179], a[200:203], 0
    v_mfma_f32_16x16x32_bf16 a[84:87], a[180:183], a[204:207], a[84:87]
    s_waitcnt lgkmcnt(2)
    v_mfma_f32_16x16x32_bf16 v[88:91], a[152:155], a[184:187], 0
    ds_read_b128 a[168:171], v20 offset:36864
    v_mfma_f32_16x16x32_bf16 v[88:91], a[156:159], a[188:191], v[88:91]
    ds_read_b128 a[172:175], v21 offset:36864
    v_mfma_f32_16x16x32_bf16 v[216:219], a[152:155], a[192:195], 0
    v_mfma_f32_16x16x32_bf16 v[216:219], a[156:159], a[196:199], v[216:219]
    s_add_u32 m0, s36, 81920
    s_add_u32 s48, s38, 65664
    v_mfma_f32_16x16x32_bf16 a[88:91], a[152:155], a[200:203], 0
    buffer_load_dwordx4 v1, s[24:27], s48 offen offset:0 nt lds
    v_mfma_f32_16x16x32_bf16 a[88:91], a[156:159], a[204:207], a[88:91]
    s_waitcnt lgkmcnt(2)
    v_mfma_f32_16x16x32_bf16 v[92:95], a[160:163], a[184:187], 0
    ds_read_b128 a[176:179], v20 offset:38912
    v_mfma_f32_16x16x32_bf16 v[92:95], a[164:167], a[188:191], v[92:95]
    ds_read_b128 a[180:183], v21 offset:38912
    v_mfma_f32_16x16x32_bf16 v[220:223], a[160:163], a[192:195], 0
    v_mfma_f32_16x16x32_bf16 v[220:223], a[164:167], a[196:199], v[220:223]
    v_mfma_f32_16x16x32_bf16 a[92:95], a[160:163], a[200:203], 0
    v_mfma_f32_16x16x32_bf16 a[92:95], a[164:167], a[204:207], a[92:95]
    buffer_load_dwordx4 v2, s[24:27], s48 offen offset:1024 nt lds
    s_waitcnt lgkmcnt(2)
    v_mfma_f32_16x16x32_bf16 v[96:99], a[168:171], a[184:187], 0
    ds_read_b128 a[152:155], v20 offset:40960
    v_mfma_f32_16x16x32_bf16 v[96:99], a[172:175], a[188:191], v[96:99]
    ds_read_b128 a[156:159], v21 offset:40960
    v_mfma_f32_16x16x32_bf16 v[224:227], a[168:171], a[192:195], 0
    v_mfma_f32_16x16x32_bf16 v[224:227], a[172:175], a[196:199], v[224:227]
    v_mfma_f32_16x16x32_bf16 a[96:99], a[168:171], a[200:203], 0
    v_mfma_f32_16x16x32_bf16 a[96:99], a[172:175], a[204:207], a[96:99]
    s_waitcnt lgkmcnt(2)
    v_mfma_f32_16x16x32_bf16 v[100:103], a[176:179], a[184:187], 0
    ds_read_b128 a[160:163], v20 offset:43008
    buffer_load_dwordx4 v3, s[24:27], s48 offen offset:2048 nt lds
    v_mfma_f32_16x16x32_bf16 v[100:103], a[180:183], a[188:191], v[100:103]
    ds_read_b128 a[164:167], v21 offset:43008
    v_mfma_f32_16x16x32_bf16 v[228:231], a[176:179], a[192:195], 0
    v_mfma_f32_16x16x32_bf16 v[228:231], a[180:183], a[196:199], v[228:231]
    v_mfma_f32_16x16x32_bf16 a[100:103], a[176:179], a[200:203], 0
    v_mfma_f32_16x16x32_bf16 a[100:103], a[180:183], a[204:207], a[100:103]
    s_waitcnt lgkmcnt(2)
    v_mfma_f32_16x16x32_bf16 v[104:107], a[152:155], a[184:187], 0
    ds_read_b128 a[168:171], v20 offset:45056
    v_mfma_f32_16x16x32_bf16 v[104:107], a[156:159], a[188:191], v[104:107]
    ds_read_b128 a[172:175], v21 offset:45056
    buffer_load_dwordx4 v4, s[24:27], s48 offen offset:3072 nt lds
    v_mfma_f32_16x16x32_bf16 v[232:235], a[152:155], a[192:195], 0
    v_mfma_f32_16x16x32_bf16 v[232:235], a[156:159], a[196:199], v[232:235]
    v_mfma_f32_16x16x32_bf16 a[104:107], a[152:155], a[200:203], 0
    v_mfma_f32_16x16x32_bf16 a[104:107], a[156:159], a[204:207], a[104:107]
    s_waitcnt lgkmcnt(2)
    v_mfma_f32_16x16x32_bf16 v[108:111], a[160:163], a[184:187], 0
    ds_read_b128 a[176:179], v20 offset:47104
    v_mfma_f32_16x16x32_bf16 v[108:111], a[164:167], a[188:191], v[108:111]
    ds_read_b128 a[180:183], v21 offset:47104
    v_mfma_f32_16x16x32_bf16 v[236:239], a[160:163], a[192:195], 0
    s_add_u32 m0, s37, 0
    v_mfma_f32_16x16x32_bf16 v[236:239], a[164:167], a[196:199], v[236:239]
    buffer_load_dwordx4 v1, s[20:23], s42 offen offset:0 nt lds
    v_mfma_f32_16x16x32_bf16 a[108:111], a[160:163], a[200:203], 0
    v_mfma_f32_16x16x32_bf16 a[108:111], a[164:167], a[204:207], a[108:111]
    s_waitcnt lgkmcnt(2)
    v_mfma_f32_16x16x32_bf16 v[112:115], a[168:171], a[184:187], 0
    s_waitcnt vmcnt(13)
    s_barrier
    v_mfma_f32_16x16x32_bf16 v[112:115], a[172:175], a[188:191], v[112:115]
    ds_read_b128 a[152:155], v20 offset:49152
    v_mfma_f32_16x16x32_bf16 v[240:243], a[168:171], a[192:195], 0
    ds_read_b128 a[156:159], v21 offset:49152
    v_mfma_f32_16x16x32_bf16 v[240:243], a[172:175], a[196:199], v[240:243]
    v_mfma_f32_16x16x32_bf16 a[112:115], a[168:171], a[200:203], 0
    buffer_load_dwordx4 v2, s[20:23], s42 offen offset:1024 nt lds
    v_mfma_f32_16x16x32_bf16 a[112:115], a[172:175], a[204:207], a[112:115]
    s_waitcnt lgkmcnt(2)
    v_mfma_f32_16x16x32_bf16 v[116:119], a[176:179], a[184:187], 0
    ds_read_b128 a[160:163], v20 offset:51200
    v_mfma_f32_16x16x32_bf16 v[116:119], a[180:183], a[188:191], v[116:119]
    ds_read_b128 a[164:167], v21 offset:51200
    v_mfma_f32_16x16x32_bf16 v[244:247], a[176:179], a[192:195], 0
    v_mfma_f32_16x16x32_bf16 v[244:247], a[180:183], a[196:199], v[244:247]
    v_mfma_f32_16x16x32_bf16 a[116:119], a[176:179], a[200:203], 0
    v_mfma_f32_16x16x32_bf16 a[116:119], a[180:183], a[204:207], a[116:119]
    s_add_u32 m0, s36, 98304
    s_waitcnt lgkmcnt(2)
    v_mfma_f32_16x16x32_bf16 v[120:123], a[152:155], a[184:187], 0
    ds_read_b128 a[168:171], v20 offset:53248
    s_add_u32 s48, s38, 131200
    v_mfma_f32_16x16x32_bf16 v[120:123], a[156:159], a[188:191], v[120:123]
    ds_read_b128 a[172:175], v21 offset:53248
    buffer_load_dwordx4 v1, s[24:27], s48 offen offset:0 nt lds
    v_mfma_f32_16x16x32_bf16 v[248:251], a[152:155], a[192:195], 0
    v_mfma_f32_16x16x32_bf16 v[248:251], a[156:159], a[196:199], v[248:251]
    s_waitcnt vmcnt(11)
    v_mfma_f32_16x16x32_bf16 a[120:123], a[152:155], a[200:203], 0
    v_mfma_f32_16x16x32_bf16 a[120:123], a[156:159], a[204:207], a[120:123]
    ds_read_b128 a[208:211], v16 offset:24576
    s_waitcnt lgkmcnt(3)
    v_mfma_f32_16x16x32_bf16 v[124:127], a[160:163], a[184:187], 0
    ds_read_b128 a[176:179], v20 offset:55296
    v_mfma_f32_16x16x32_bf16 v[124:127], a[164:167], a[188:191], v[124:127]
    ds_read_b128 a[180:183], v21 offset:55296
    ds_read_b128 a[212:215], v17 offset:24576
    v_mfma_f32_16x16x32_bf16 v[252:255], a[160:163], a[192:195], 0
    buffer_load_dwordx4 v2, s[24:27], s48 offen offset:1024 nt lds
    v_mfma_f32_16x16x32_bf16 v[252:255], a[164:167], a[196:199], v[252:255]
    ds_read_b128 a[216:219], v16 offset:26624
    v_mfma_f32_16x16x32_bf16 a[124:127], a[160:163], a[200:203], 0
    v_mfma_f32_16x16x32_bf16 a[124:127], a[164:167], a[204:207], a[124:127]
    ds_read_b128 a[220:223], v17 offset:26624
    s_waitcnt lgkmcnt(6)
    v_mfma_f32_16x16x32_bf16 v[128:131], a[168:171], a[184:187], 0
    ds_read_b128 a[152:155], v20 offset:57344
    v_mfma_f32_16x16x32_bf16 v[128:131], a[172:175], a[188:191], v[128:131]
    ds_read_b128 a[156:159], v21 offset:57344
    ds_read_b128 a[224:227], v16 offset:28672
    v_mfma_f32_16x16x32_bf16 a[0:3], a[168:171], a[192:195], 0
    v_mfma_f32_16x16x32_bf16 a[0:3], a[172:175], a[196:199], a[0:3]
    ds_read_b128 a[228:231], v17 offset:28672
    buffer_load_dwordx4 v3, s[24:27], s48 offen offset:2048 nt lds
    v_mfma_f32_16x16x32_bf16 a[128:131], a[168:171], a[200:203], 0
    v_mfma_f32_16x16x32_bf16 a[128:131], a[172:175], a[204:207], a[128:131]
    s_waitcnt lgkmcnt(7)
    v_mfma_f32_16x16x32_bf16 v[132:135], a[176:179], a[184:187], 0
    ds_read_b128 a[160:163], v20 offset:59392
    v_mfma_f32_16x16x32_bf16 v[132:135], a[180:183], a[188:191], v[132:135]
    ds_read_b128 a[164:167], v21 offset:59392
    v_mfma_f32_16x16x32_bf16 a[4:7], a[176:179], a[192:195], 0
L_pad0:
    s_cbranch_execz L_pad4
    v_mfma_f32_16x16x32_bf16 a[4:7], a[180:183], a[196:199], a[4:7]
    v_mfma_f32_16x16x32_bf16 a[132:135], a[176:179], a[200:203], 0
    buffer_load_dwordx4 v4, s[24:27], s48 offen offset:3072 nt lds
    v_mfma_f32_16x16x32_bf16 a[132:135], a[180:183], a[204:207], a[132:135]
    s_waitcnt lgkmcnt(4)
    v_mfma_f32_16x16x32_bf16 v[136:139], a[152:155], a[184:187], 0
    ds_read_b128 a[168:171], v20 offset:61440
    v_mfma_f32_16x16x32_bf16 v[136:139], a[156:159], a[188:191], v[136:139]
    ds_read_b128 a[172:175], v21 offset:61440
    v_mfma_f32_16x16x32_bf16 a[8:11], a[152:155], a[192:195], 0
    v_mfma_f32_16x16x32_bf16 a[8:11], a[156:159], a[196:199], a[8:11]
    v_mfma_f32_16x16x32_bf16 a[136:139], a[152:155], a[200:203], 0
    v_mfma_f32_16x16x32_bf16 a[136:139], a[156:159], a[204:207], a[136:139]
    s_add_u32 m0, s37, 0
    s_waitcnt lgkmcnt(2)
    v_mfma_f32_16x16x32_bf16 v[140:143], a[160:163], a[184:187], 0
    ds_read_b128 a[176:179], v20 offset:63488
    buffer_load_dwordx4 v3, s[20:23], s42 offen offset:2048 nt lds
    v_mfma_f32_16x16x32_bf16 v[140:143], a[164:167], a[188:191], v[140:143]
    ds_read_b128 a[180:183], v21 offset:63488
    v_mfma_f32_16x16x32_bf16 a[12:15], a[160:163], a[192:195], 0
    v_mfma_f32_16x16x32_bf16 a[12:15], a[164:167], a[196:199], a[12:15]
    v_mfma_f32_16x16x32_bf16 a[140:143], a[160:163], a[200:203], 0
    v_mfma_f32_16x16x32_bf16 a[140:143], a[164:167], a[204:207], a[140:143]
    s_waitcnt lgkmcnt(2)
    v_mfma_f32_16x16x32_bf16 v[144:147], a[168:171], a[184:187], 0
    s_waitcnt vmcnt(11)
    s_barrier
    v_mfma_f32_16x16x32_bf16 v[144:147], a[172:175], a[188:191], v[144:147]
    ds_read_b128 a[152:155], v22 offset:0
    buffer_load_dwordx4 v4, s[20:23], s42 offen offset:3072 nt lds
    v_mfma_f32_16x16x32_bf16 a[16:19], a[168:171], a[192:195], 0
    ds_read_b128 a[156:159], v23 offset:0
    v_mfma_f32_16x16x32_bf16 a[16:19], a[172:175], a[196:199], a[16:19]
    v_mfma_f32_16x16x32_bf16 a[144:147], a[168:171], a[200:203], 0
    v_mfma_f32_16x16x32_bf16 a[144:147], a[172:175], a[204:207], a[144:147]
    s_waitcnt lgkmcnt(2)
    v_mfma_f32_16x16x32_bf16 v[148:151], a[176:179], a[184:187], 0
    ds_read_b128 a[160:163], v22 offset:2048
    v_mfma_f32_16x16x32_bf16 v[148:151], a[180:183], a[188:191], v[148:151]
    ds_read_b128 a[164:167], v23 offset:2048
    v_mfma_f32_16x16x32_bf16 a[20:23], a[176:179], a[192:195], 0
    s_add_u32 m0, s36, 0
    s_add_u32 s48, s38, 196736
    v_mfma_f32_16x16x32_bf16 a[20:23], a[180:183], a[196:199], a[20:23]
    buffer_load_dwordx4 v1, s[24:27], s48 offen offset:0 nt lds
    v_mfma_f32_16x16x32_bf16 a[148:151], a[176:179], a[200:203], 0
    v_mfma_f32_16x16x32_bf16 a[148:151], a[180:183], a[204:207], a[148:151]
    s_waitcnt lgkmcnt(2)
    v_mfma_f32_16x16x32_bf16 v[24:27], a[152:155], a[208:211], v[24:27]
    ds_read_b128 a[168:171], v22 offset:4096
    v_mfma_f32_16x16x32_bf16 v[24:27], a[156:159], a[212:215], v[24:27]
    ds_read_b128 a[172:175], v23 offset:4096
    v_mfma_f32_16x16x32_bf16 v[152:155], a[152:155], a[216:219], v[152:155]
    v_mfma_f32_16x16x32_bf16 v[152:155], a[156:159], a[220:223], v[152:155]
    v_mfma_f32_16x16x32_bf16 a[24:27], a[152:155], a[224:227], a[24:27]
    buffer_load_dwordx4 v2, s[24:27], s48 offen offset:1024 nt lds
    v_mfma_f32_16x16x32_bf16 a[24:27], a[156:159], a[228:231], a[24:27]
    s_waitcnt lgkmcnt(2)
    v_mfma_f32_16x16x32_bf16 v[28:31], a[160:163], a[208:211], v[28:31]
    ds_read_b128 a[176:179], v22 offset:6144
    v_mfma_f32_16x16x32_bf16 v[28:31], a[164:167], a[212:215], v[28:31]
    ds_read_b128 a[180:183], v23 offset:6144
    v_mfma_f32_16x16x32_bf16 v[156:159], a[160:163], a[216:219], v[156:159]
    v_mfma_f32_16x16x32_bf16 v[156:159], a[164:167], a[220:223], v[156:159]
    v_mfma_f32_16x16x32_bf16 a[28:31], a[160:163], a[224:227], a[28:31]
    v_mfma_f32_16x16x32_bf16 a[28:31], a[164:167], a[228:231], a[28:31]
    buffer_load_dwordx4 v3, s[24:27], s48 offen offset:2048 nt lds
    s_waitcnt lgkmcnt(2)
    v_mfma_f32_16x16x32_bf16 v[32:35], a[168:171], a[208:211], v[32:35]
    ds_read_b128 a[152:155], v22 offset:8192
    v_mfma_f32_16x16x32_bf16 v[32:35], a[172:175], a[212:215], v[32:35]
    ds_read_b128 a[156:159], v23 offset:8192
    v_mfma_f32_16x16x32_bf16 v[160:163], a[168:171], a[216:219], v[160:163]
    v_mfma_f32_16x16x32_bf16 v[160:163], a[172:175], a[220:223], v[160:163]
    v_mfma_f32_16x16x32_bf16 a[32:35], a[168:171], a[224:227], a[32:35]
    v_mfma_f32_16x16x32_bf16 a[32:35], a[172:175], a[228:231], a[32:35]
    s_waitcnt lgkmcnt(2)
    v_mfma_f32_16x16x32_bf16 v[36:39], a[176:179], a[208:211], v[36:39]
    ds_read_b128 a[160:163], v22 offset:10240
    buffer_load_dwordx4 v4, s[24:27], s48 offen offset:3072 nt lds
    v_mfma_f32_16x16x32_bf16 v[36:39], a[180:183], a[212:215], v[36:39]
    ds_read_b128 a[164:167], v23 offset:10240
    v_mfma_f32_16x16x32_bf16 v[164:167], a[176:179], a[216:219], v[164:167]
    v_mfma_f32_16x16x32_bf16 v[164:167], a[180:183], a[220:223], v[164:167]
    v_mfma_f32_16x16x32_bf16 a[36:39], a[176:179], a[224:227], a[36:39]
    v_mfma_f32_16x16x32_bf16 a[36:39], a[180:183], a[228:231], a[36:39]
    s_waitcnt lgkmcnt(2)
    v_mfma_f32_16x16x32_bf16 v[40:43], a[152:155], a[208:211], v[40:43]
    ds_read_b128 a[168:171], v22 offset:12288
    v_mfma_f32_16x16x32_bf16 v[40:43], a[156:159], a[212:215], v[40:43]
    ds_read_b128 a[172:175], v23 offset:12288
    s_add_u32 m0, s37, 24576
    v_mfma_f32_16x16x32_bf16 v[168:171], a[152:155], a[216:219], v[168:171]
    buffer_load_dwordx4 v1, s[20:23], s43 offen offset:0 nt lds
    v_mfma_f32_16x16x32_bf16 v[168:171], a[156:159], a[220:223], v[168:171]
    v_mfma_f32_16x16x32_bf16 a[40:43], a[152:155], a[224:227], a[40:43]
    v_mfma_f32_16x16x32_bf16 a[40:43], a[156:159], a[228:231], a[40:43]
    s_waitcnt lgkmcnt(2)
    v_mfma_f32_16x16x32_bf16 v[44:47], a[160:163], a[208:211], v[44:47]
    ds_read_b128 a[176:179], v22 offset:14336
    v_mfma_f32_16x16x32_bf16 v[44:47], a[164:167], a[212:215], v[44:47]
    ds_read_b128 a[180:183], v23 offset:14336
    v_mfma_f32_16x16x32_bf16 v[172:175], a[160:163], a[216:219], v[172:175]
    v_mfma_f32_16x16x32_bf16 v[172:175], a[164:167], a[220:223], v[172:175]
    buffer_load_dwordx4 v2, s[20:23], s43 offen offset:1024 nt lds
    v_mfma_f32_16x16x32_bf16 a[44:47], a[160:163], a[224:227], a[44:47]
    v_mfma_f32_16x16x32_bf16 a[44:47], a[164:167], a[228:231], a[44:47]
    s_waitcnt lgkmcnt(2)
    v_mfma_f32_16x16x32_bf16 v[48:51], a[168:171], a[208:211], v[48:51]
    s_waitcnt vmcnt(14)
    s_barrier
    v_mfma_f32_16x16x32_bf16 v[48:51], a[172:175], a[212:215], v[48:51]
    ds_read_b128 a[152:155], v22 offset:16384
    v_mfma_f32_16x16x32_bf16 v[176:179], a[168:171], a[216:219], v[176:179]
    ds_read_b128 a[156:159], v23 offset:16384
    v_mfma_f32_16x16x32_bf16 v[176:179], a[172:175], a[220:223], v[176:179]
    v_mfma_f32_16x16x32_bf16 a[48:51], a[168:171], a[224:227], a[48:51]
    s_add_u32 m0, s37, 24576
    v_mfma_f32_16x16x32_bf16 a[48:51], a[172:175], a[228:231], a[48:51]
    buffer_load_dwordx4 v3, s[20:23], s43 offen offset:2048 nt lds
    s_waitcnt lgkmcnt(2)
    v_mfma_f32_16x16x32_bf16 v[52:55], a[176:179], a[208:211], v[52:55]
    ds_read_b128 a[160:163], v22 offset:18432
    v_mfma_f32_16x16x32_bf16 v[52:55], a[180:183], a[212:215], v[52:55]
    ds_read_b128 a[164:167], v23 offset:18432
    v_mfma_f32_16x16x32_bf16 v[180:183], a[176:179], a[216:219], v[180:183]
    v_mfma_f32_16x16x32_bf16 v[180:183], a[180:183], a[220:223], v[180:183]
    v_mfma_f32_16x16x32_bf16 a[52:55], a[176:179], a[224:227], a[52:55]
    v_mfma_f32_16x16x32_bf16 a[52:55], a[180:183], a[228:231], a[52:55]
    s_waitcnt lgkmcnt(2)
    v_mfma_f32_16x16x32_bf16 v[56:59], a[152:155], a[208:211], v[56:59]
    ds_read_b128 a[168:171], v22 offset:20480
    buffer_load_dwordx4 v4, s[20:23], s43 offen offset:3072 nt lds
    v_mfma_f32_16x16x32_bf16 v[56:59], a[156:159], a[212:215], v[56:59]
    ds_read_b128 a[172:175], v23 offset:20480
    v_mfma_f32_16x16x32_bf16 v[184:187], a[152:155], a[216:219], v[184:187]
    v_mfma_f32_16x16x32_bf16 v[184:187], a[156:159], a[220:223], v[184:187]
    v_mfma_f32_16x16x32_bf16 a[56:59], a[152:155], a[224:227], a[56:59]
    v_mfma_f32_16x16x32_bf16 a[56:59], a[156:159], a[228:231], a[56:59]
    s_waitcnt lgkmcnt(2)
    v_mfma_f32_16x16x32_bf16 v[60:63], a[160:163], a[208:211], v[60:63]
    ds_read_b128 a[176:179], v22 offset:22528
    v_mfma_f32_16x16x32_bf16 v[60:63], a[164:167], a[212:215], v[60:63]
    ds_read_b128 a[180:183], v23 offset:22528
    s_add_u32 m0, s100, 16384
    v_mfma_f32_16x16x32_bf16 v[188:191], a[160:163], a[216:219], v[188:191]
    s_add_u32 s48, s101, 256
    buffer_load_dwordx4 v1, s[24:27], s48 offen offset:0 nt lds
    v_mfma_f32_16x16x32_bf16 v[188:191], a[164:167], a[220:223], v[188:191]
    v_mfma_f32_16x16x32_bf16 a[60:63], a[160:163], a[224:227], a[60:63]
    v_mfma_f32_16x16x32_bf16 a[60:63], a[164:167], a[228:231], a[60:63]
    s_waitcnt lgkmcnt(2)
    v_mfma_f32_16x16x32_bf16 v[64:67], a[168:171], a[208:211], v[64:67]
    ds_read_b128 a[152:155], v22 offset:24576
    v_mfma_f32_16x16x32_bf16 v[64:67], a[172:175], a[212:215], v[64:67]
    ds_read_b128 a[156:159], v23 offset:24576
    v_mfma_f32_16x16x32_bf16 v[192:195], a[168:171], a[216:219], v[192:195]
    v_mfma_f32_16x16x32_bf16 v[192:195], a[172:175], a[220:223], v[192:195]
    buffer_load_dwordx4 v2, s[24:27], s48 offen offset:1024 nt lds
    v_mfma_f32_16x16x32_bf16 a[64:67], a[168:171], a[224:227], a[64:67]
    v_mfma_f32_16x16x32_bf16 a[64:67], a[172:175], a[228:231], a[64:67]
    s_waitcnt lgkmcnt(2)
    v_mfma_f32_16x16x32_bf16 v[68:71], a[176:179], a[208:211], v[68:71]
    ds_read_b128 a[160:163], v22 offset:26624
    v_mfma_f32_16x16x32_bf16 v[68:71], a[180:183], a[212:215], v[68:71]
    ds_read_b128 a[164:167], v23 offset:26624
    v_mfma_f32_16x16x32_bf16 v[196:199], a[176:179], a[216:219], v[196:199]
    v_mfma_f32_16x16x32_bf16 v[196:199], a[180:183], a[220:223], v[196:199]
    v_mfma_f32_16x16x32_bf16 a[68:71], a[176:179], a[224:227], a[68:71]
    s_add_u32 m0, s100, 24576
    s_add_u32 s48, s101, 384
    v_mfma_f32_16x16x32_bf16 a[68:71], a[180:183], a[228:231], a[68:71]
    buffer_load_dwordx4 v1, s[24:27], s48 offen offset:0 nt lds
    s_waitcnt lgkmcnt(2)
    v_mfma_f32_16x16x32_bf16 v[72:75], a[152:155], a[208:211], v[72:75]
    ds_read_b128 a[168:171], v22 offset:28672
    v_mfma_f32_16x16x32_bf16 v[72:75], a[156:159], a[212:215], v[72:75]
    ds_read_b128 a[172:175], v23 offset:28672
    v_mfma_f32_16x16x32_bf16 v[200:203], a[152:155], a[216:219], v[200:203]
    v_mfma_f32_16x16x32_bf16 v[200:203], a[156:159], a[220:223], v[200:203]
    v_mfma_f32_16x16x32_bf16 a[72:75], a[152:155], a[224:227], a[72:75]
    v_mfma_f32_16x16x32_bf16 a[72:75], a[156:159], a[228:231], a[72:75]
    s_waitcnt lgkmcnt(2)
    v_mfma_f32_16x16x32_bf16 v[76:79], a[160:163], a[208:211], v[76:79]
    ds_read_b128 a[176:179], v22 offset:30720
    buffer_load_dwordx4 v2, s[24:27], s48 offen offset:1024 nt lds
    v_mfma_f32_16x16x32_bf16 v[76:79], a[164:167], a[212:215], v[76:79]
    ds_read_b128 a[180:183], v23 offset:30720
    v_mfma_f32_16x16x32_bf16 v[204:207], a[160:163], a[216:219], v[204:207]
    v_mfma_f32_16x16x32_bf16 v[204:207], a[164:167], a[220:223], v[204:207]
    v_mfma_f32_16x16x32_bf16 a[76:79], a[160:163], a[224:227], a[76:79]
    v_mfma_f32_16x16x32_bf16 a[76:79], a[164:167], a[228:231], a[76:79]
    s_waitcnt lgkmcnt(2)
    v_mfma_f32_16x16x32_bf16 v[80:83], a[168:171], a[208:211], v[80:83]
    s_waitcnt vmcnt(14)
    s_barrier
    v_mfma_f32_16x16x32_bf16 v[80:83], a[172:175], a[212:215], v[80:83]
    ds_read_b128 a[152:155], v22 offset:32768
    s_add_u32 m0, s37, 4096
    v_mfma_f32_16x16x32_bf16 v[208:211], a[168:171], a[216:219], v[208:211]
    ds_read_b128 a[156:159], v23 offset:32768
    buffer_load_dwordx4 v18, s[20:23], s42 offen offset:0 nt lds
    v_mfma_f32_16x16x32_bf16 v[208:211], a[172:175], a[220:223], v[208:211]
    v_mfma_f32_16x16x32_bf16 a[80:83], a[168:171], a[224:227], a[80:83]
    v_mfma_f32_16x16x32_bf16 a[80:83], a[172:175], a[228:231], a[80:83]
    s_waitcnt lgkmcnt(2)
    v_mfma_f32_16x16x32_bf16 v[84:87], a[176:179], a[208:211], v[84:87]
    ds_read_b128 a[160:163], v22 offset:34816
    v_mfma_f32_16x16x32_bf16 v[84:87], a[180:183], a[212:215], v[84:87]
    ds_read_b128 a[164:167], v23 offset:34816
    v_mfma_f32_16x16x32_bf16 v[212:215], a[176:179], a[216:219], v[212:215]
    v_mfma_f32_16x16x32_bf16 v[212:215], a[180:183], a[220:223], v[212:215]
    buffer_load_dwordx4 v19, s[20:23], s42 offen offset:1024 nt lds
    v_mfma_f32_16x16x32_bf16 a[84:87], a[176:179], a[224:227], a[84:87]
    v_mfma_f32_16x16x32_bf16 a[84:87], a[180:183], a[228:231], a[84:87]
    s_waitcnt lgkmcnt(2)
    v_mfma_f32_16x16x32_bf16 v[88:91], a[152:155], a[208:211], v[88:91]
    ds_read_b128 a[168:171], v22 offset:36864
    v_mfma_f32_16x16x32_bf16 v[88:91], a[156:159], a[212:215], v[88:91]
    ds_read_b128 a[172:175], v23 offset:36864
    v_mfma_f32_16x16x32_bf16 v[216:219], a[152:155], a[216:219], v[216:219]
    v_mfma_f32_16x16x32_bf16 v[216:219], a[156:159], a[220:223], v[216:219]
    v_mfma_f32_16x16x32_bf16 a[88:91], a[152:155], a[224:227], a[88:91]
    s_add_u32 m0, s37, 28672
    v_mfma_f32_16x16x32_bf16 a[88:91], a[156:159], a[228:231], a[88:91]
    buffer_load_dwordx4 v18, s[20:23], s43 offen offset:0 nt lds
    s_waitcnt lgkmcnt(2)
    v_mfma_f32_16x16x32_bf16 v[92:95], a[160:163], a[208:211], v[92:95]
    ds_read_b128 a[176:179], v22 offset:38912
    v_mfma_f32_16x16x32_bf16 v[92:95], a[164:167], a[212:215], v[92:95]
    ds_read_b128 a[180:183], v23 offset:38912
    v_mfma_f32_16x16x32_bf16 v[220:223], a[160:163], a[216:219], v[220:223]
    v_mfma_f32_16x16x32_bf16 v[220:223], a[164:167], a[220:223], v[220:223]
    v_mfma_f32_16x16x32_bf16 a[92:95], a[160:163], a[224:227], a[92:95]
    v_mfma_f32_16x16x32_bf16 a[92:95], a[164:167], a[228:231], a[92:95]
    s_waitcnt lgkmcnt(2)
    v_mfma_f32_16x16x32_bf16 v[96:99], a[168:171], a[208:211], v[96:99]
    ds_read_b128 a[152:155], v22 offset:40960
    buffer_load_dwordx4 v19, s[20:23], s43 offen offset:1024 nt lds
    v_mfma_f32_16x16x32_bf16 v[96:99], a[172:175], a[212:215], v[96:99]
    ds_read_b128 a[156:159], v23 offset:40960
    v_mfma_f32_16x16x32_bf16 v[224:227], a[168:171], a[216:219], v[224:227]
    v_mfma_f32_16x16x32_bf16 v[224:227], a[172:175], a[220:223], v[224:227]
    v_mfma_f32_16x16x32_bf16 a[96:99], a[168:171], a[224:227], a[96:99]
    v_mfma_f32_16x16x32_bf16 a[96:99], a[172:175], a[228:231], a[96:99]
    s_waitcnt lgkmcnt(2)
    v_mfma_f32_16x16x32_bf16 v[100:103], a[176:179], a[208:211], v[100:103]
    ds_read_b128 a[160:163], v22 offset:43008
    v_mfma_f32_16x16x32_bf16 v[100:103], a[180:183], a[212:215], v[100:103]
    ds_read_b128 a[164:167], v23 offset:43008
    s_add_u32 m0, s100, 32768
    v_mfma_f32_16x16x32_bf16 v[228:231], a[176:179], a[216:219], v[228:231]
    s_add_u32 s48, s101, 33024
    buffer_load_dwordx4 v1, s[24:27], s48 offen offset:0 nt lds
    v_mfma_f32_16x16x32_bf16 v[228:231], a[180:183], a[220:223], v[228:231]
    v_mfma_f32_16x16x32_bf16 a[100:103], a[176:179], a[224:227], a[100:103]
    v_mfma_f32_16x16x32_bf16 a[100:103], a[180:183], a[228:231], a[100:103]
    s_waitcnt lgkmcnt(2)
    v_mfma_f32_16x16x32_bf16 v[104:107], a[152:155], a[208:211], v[104:107]
    ds_read_b128 a[168:171], v22 offset:45056
    v_mfma_f32_16x16x32_bf16 v[104:107], a[156:159], a[212:215], v[104:107]
    ds_read_b128 a[172:175], v23 offset:45056
    v_mfma_f32_16x16x32_bf16 v[232:235], a[152:155], a[216:219], v[232:235]
    v_mfma_f32_16x16x32_bf16 v[232:235], a[156:159], a[220:223], v[232:235]
    s_waitcnt vmcnt(17)
    buffer_load_dwordx4 v2, s[24:27], s48 offen offset:1024 nt lds
    v_mfma_f32_16x16x32_bf16 a[104:107], a[152:155], a[224:227], a[104:107]
    v_mfma_f32_16x16x32_bf16 a[104:107], a[156:159], a[228:231], a[104:107]
    ds_read_b128 a[184:187], v16 offset:0
    s_waitcnt lgkmcnt(3)
    v_mfma_f32_16x16x32_bf16 v[108:111], a[160:163], a[208:211], v[108:111]
    ds_read_b128 a[176:179], v22 offset:47104
    v_mfma_f32_16x16x32_bf16 v[108:111], a[164:167], a[212:215], v[108:111]
    ds_read_b128 a[180:183], v23 offset:47104
    ds_read_b128 a[188:191], v17 offset:0
    v_mfma_f32_16x16x32_bf16 v[236:239], a[160:163], a[216:219], v[236:239]
    v_mfma_f32_16x16x32_bf16 v[236:239], a[164:167], a[220:223], v[236:239]
    ds_read_b128 a[192:195], v16 offset:2048
    v_mfma_f32_16x16x32_bf16 a[108:111], a[160:163], a[224:227], a[108:111]
    s_add_u32 m0, s100, 40960
    s_add_u32 s48, s101, 33152
    v_mfma_f32_16x16x32_bf16 a[108:111], a[164:167], a[228:231], a[108:111]
    ds_read_b128 a[196:199], v17 offset:2048
    s_waitcnt lgkmcnt(6)
    v_mfma_f32_16x16x32_bf16 v[112:115], a[168:171], a[208:211], v[112:115]
    s_waitcnt vmcnt(14)
    s_barrier
    v_mfma_f32_16x16x32_bf16 v[112:115], a[172:175], a[212:215], v[112:115]
    ds_read_b128 a[152:155], v20 offset:0
    buffer_load_dwordx4 v1, s[24:27], s48 offen offset:0 nt lds
    v_mfma_f32_16x16x32_bf16 v[240:243], a[168:171], a[216:219], v[240:243]
    ds_read_b128 a[156:159], v21 offset:0
    v_mfma_f32_16x16x32_bf16 v[240:243], a[172:175], a[220:223], v[240:243]
    v_mfma_f32_16x16x32_bf16 a[112:115], a[168:171], a[224:227], a[112:115]
    v_mfma_f32_16x16x32_bf16 a[112:115], a[172:175], a[228:231], a[112:115]
    s_waitcnt lgkmcnt(5)
    v_mfma_f32_16x16x32_bf16 v[116:119], a[176:179], a[208:211], v[116:119]
    ds_read_b128 a[160:163], v20 offset:2048
    v_mfma_f32_16x16x32_bf16 v[116:119], a[180:183], a[212:215], v[116:119]
    ds_read_b128 a[164:167], v21 offset:2048
    v_mfma_f32_16x16x32_bf16 v[244:247], a[176:179], a[216:219], v[244:247]
    buffer_load_dwordx4 v2, s[24:27], s48 offen offset:1024 nt lds
    v_mfma_f32_16x16x32_bf16 v[244:247], a[180:183], a[220:223], v[244:247]
    v_mfma_f32_16x16x32_bf16 a[116:119], a[176:179], a[224:227], a[116:119]
    v_mfma_f32_16x16x32_bf16 a[116:119], a[180:183], a[228:231], a[116:119]
    s_waitcnt lgkmcnt(2)
    v_mfma_f32_16x16x32_bf16 v[120:123], a[152:155], a[208:211], v[120:123]
    ds_read_b128 a[168:171], v20 offset:4096
    v_mfma_f32_16x16x32_bf16 v[120:123], a[156:159], a[212:215], v[120:123]
    ds_read_b128 a[172:175], v21 offset:4096
    v_mfma_f32_16x16x32_bf16 v[248:251], a[152:155], a[216:219], v[248:251]
    v_mfma_f32_16x16x32_bf16 v[248:251], a[156:159], a[220:223], v[248:251]
    s_add_u32 m0, s100, 49152
    s_add_u32 s48, s101, 65792
    v_mfma_f32_16x16x32_bf16 a[120:123], a[152:155], a[224:227], a[120:123]
    buffer_load_dwordx4 v1, s[24:27], s48 offen offset:0 nt lds
    v_mfma_f32_16x16x32_bf16 a[120:123], a[156:159], a[228:231], a[120:123]
    s_waitcnt lgkmcnt(2)
    v_mfma_f32_16x16x32_bf16 v[124:127], a[160:163], a[208:211], v[124:127]
    ds_read_b128 a[176:179], v20 offset:6144
    v_mfma_f32_16x16x32_bf16 v[124:127], a[164:167], a[212:215], v[124:127]
    ds_read_b128 a[180:183], v21 offset:6144
    v_mfma_f32_16x16x32_bf16 v[252:255], a[160:163], a[216:219], v[252:255]
    v_mfma_f32_16x16x32_bf16 v[252:255], a[164:167], a[220:223], v[252:255]
    v_mfma_f32_16x16x32_bf16 a[124:127], a[160:163], a[224:227], a[124:127]
    v_mfma_f32_16x16x32_bf16 a[124:127], a[164:167], a[228:231], a[124:127]
    buffer_load_dwordx4 v2, s[24:27], s48 offen offset:1024 nt lds
    s_waitcnt lgkmcnt(2)
    v_mfma_f32_16x16x32_bf16 v[128:131], a[168:171], a[208:211], v[128:131]
    ds_read_b128 a[152:155], v20 offset:8192
    v_mfma_f32_16x16x32_bf16 v[128:131], a[172:175], a[212:215], v[128:131]
    ds_read_b128 a[156:159], v21 offset:8192
    v_mfma_f32_16x16x32_bf16 a[0:3], a[168:171], a[216:219], a[0:3]
    v_mfma_f32_16x16x32_bf16 a[0:3], a[172:175], a[220:223], a[0:3]
    v_mfma_f32_16x16x32_bf16 a[128:131], a[168:171], a[224:227], a[128:131]
    v_mfma_f32_16x16x32_bf16 a[128:131], a[172:175], a[228:231], a[128:131]
    s_waitcnt lgkmcnt(2)
    v_mfma_f32_16x16x32_bf16 v[132:135], a[176:179], a[208:211], v[132:135]
    ds_read_b128 a[160:163], v20 offset:10240
    s_add_u32 m0, s100, 57344
    v_mfma_f32_16x16x32_bf16 v[132:135], a[180:183], a[212:215], v[132:135]
    ds_read_b128 a[164:167], v21 offset:10240
    s_add_u32 s48, s101, 65920
    v_mfma_f32_16x16x32_bf16 a[4:7], a[176:179], a[216:219], a[4:7]
    buffer_load_dwordx4 v1, s[24:27], s48 offen offset:0 nt lds
    v_mfma_f32_16x16x32_bf16 a[4:7], a[180:183], a[220:223], a[4:7]
    v_mfma_f32_16x16x32_bf16 a[132:135], a[176:179], a[224:227], a[132:135]
    v_mfma_f32_16x16x32_bf16 a[132:135], a[180:183], a[228:231], a[132:135]
    s_waitcnt lgkmcnt(2)
    v_mfma_f32_16x16x32_bf16 v[136:139], a[152:155], a[208:211], v[136:139]
    ds_read_b128 a[168:171], v20 offset:12288
    v_mfma_f32_16x16x32_bf16 v[136:139], a[156:159], a[212:215], v[136:139]
    ds_read_b128 a[172:175], v21 offset:12288
    v_mfma_f32_16x16x32_bf16 a[8:11], a[152:155], a[216:219], a[8:11]
    v_mfma_f32_16x16x32_bf16 a[8:11], a[156:159], a[220:223], a[8:11]
    buffer_load_dwordx4 v2, s[24:27], s48 offen offset:1024 nt lds
    v_mfma_f32_16x16x32_bf16 a[136:139], a[152:155], a[224:227], a[136:139]
    v_mfma_f32_16x16x32_bf16 a[136:139], a[156:159], a[228:231], a[136:139]
    s_waitcnt lgkmcnt(2)
    v_mfma_f32_16x16x32_bf16 v[140:143], a[160:163], a[208:211], v[140:143]
    ds_read_b128 a[176:179], v20 offset:14336
    v_mfma_f32_16x16x32_bf16 v[140:143], a[164:167], a[212:215], v[140:143]
    ds_read_b128 a[180:183], v21 offset:14336
    v_mfma_f32_16x16x32_bf16 a[12:15], a[160:163], a[216:219], a[12:15]
    v_mfma_f32_16x16x32_bf16 a[12:15], a[164:167], a[220:223], a[12:15]
    v_mfma_f32_16x16x32_bf16 a[140:143], a[160:163], a[224:227], a[140:143]
    s_add_u32 m0, s100, 65536
    s_add_u32 s48, s101, 98560
    v_mfma_f32_16x16x32_bf16 a[140:143], a[164:167], a[228:231], a[140:143]
    buffer_load_dwordx4 v1, s[24:27], s48 offen offset:0 nt lds
    s_waitcnt lgkmcnt(2)
    v_mfma_f32_16x16x32_bf16 v[144:147], a[168:171], a[208:211], v[144:147]
    s_waitcnt vmcnt(13)
    s_barrier
    v_mfma_f32_16x16x32_bf16 v[144:147], a[172:175], a[212:215], v[144:147]
    ds_read_b128 a[152:155], v20 offset:16384
    v_mfma_f32_16x16x32_bf16 a[16:19], a[168:171], a[216:219], a[16:19]
    ds_read_b128 a[156:159], v21 offset:16384
    v_mfma_f32_16x16x32_bf16 a[16:19], a[172:175], a[220:223], a[16:19]
    ds_read_b128 a[160:163], v20 offset:24576
    v_mfma_f32_16x16x32_bf16 a[144:147], a[168:171], a[224:227], a[144:147]
    ds_read_b128 a[164:167], v21 offset:24576
    v_mfma_f32_16x16x32_bf16 a[144:147], a[172:175], a[228:231], a[144:147]
    s_waitcnt lgkmcnt(4)
    v_mfma_f32_16x16x32_bf16 v[148:151], a[176:179], a[208:211], v[148:151]
    buffer_load_dwordx4 v2, s[24:27], s48 offen offset:1024 nt lds
    v_mfma_f32_16x16x32_bf16 v[148:151], a[180:183], a[212:215], v[148:151]
    v_mfma_f32_16x16x32_bf16 a[20:23], a[176:179], a[216:219], a[20:23]
    ds_read_b128 a[208:211], v16 offset:24576
    ds_read_b128 a[212:215], v17 offset:24576
    v_mfma_f32_16x16x32_bf16 a[20:23], a[180:183], a[220:223], a[20:23]
    ds_read_b128 a[216:219], v16 offset:26624
    ds_read_b128 a[220:223], v17 offset:26624
    v_mfma_f32_16x16x32_bf16 a[148:151], a[176:179], a[224:227], a[148:151]
    v_mfma_f32_16x16x32_bf16 a[148:151], a[180:183], a[228:231], a[148:151]
    s_waitcnt lgkmcnt(4)
    v_mfma_f32_16x16x32_bf16 v[24:27], a[152:155], a[184:187], v[24:27]
    ds_read_b128 a[168:171], v20 offset:18432
    ds_read_b128 a[172:175], v21 offset:18432
    v_mfma_f32_16x16x32_bf16 v[24:27], a[156:159], a[188:191], v[24:27]
    ds_read_b128 a[176:179], v20 offset:26624
    ds_read_b128 a[180:183], v21 offset:26624
    v_mfma_f32_16x16x32_bf16 v[152:155], a[152:155], a[192:195], v[152:155]
    s_add_u32 m0, s100, 73728
    s_add_u32 s48, s101, 98688
    v_mfma_f32_16x16x32_bf16 v[152:155], a[156:159], a[196:199], v[152:155]
    buffer_load_dwordx4 v1, s[24:27], s48 offen offset:0 nt lds
    s_waitcnt lgkmcnt(4)
    v_mfma_f32_16x16x32_bf16 v[24:27], a[160:163], a[208:211], v[24:27]
    v_mfma_f32_16x16x32_bf16 v[24:27], a[164:167], a[212:215], v[24:27]
    v_mfma_f32_16x16x32_bf16 v[152:155], a[160:163], a[216:219], v[152:155]
    v_mfma_f32_16x16x32_bf16 v[152:155], a[164:167], a[220:223], v[152:155]
    s_waitcnt lgkmcnt(0)
    v_mfma_f32_16x16x32_bf16 v[28:31], a[168:171], a[184:187], v[28:31]
    ds_read_b128 a[152:155], v20 offset:20480
    ds_read_b128 a[156:159], v21 offset:20480
    v_mfma_f32_16x16x32_bf16 v[28:31], a[172:175], a[188:191], v[28:31]
    ds_read_b128 a[160:163], v20 offset:28672
    ds_read_b128 a[164:167], v21 offset:28672
    v_mfma_f32_16x16x32_bf16 v[28:31], a[176:179], a[208:211], v[28:31]
    buffer_load_dwordx4 v2, s[24:27], s48 offen offset:1024 nt lds
    v_mfma_f32_16x16x32_bf16 v[28:31], a[180:183], a[212:215], v[28:31]
    v_mfma_f32_16x16x32_bf16 v[156:159], a[168:171], a[192:195], v[156:159]
    v_mfma_f32_16x16x32_bf16 v[156:159], a[172:175], a[196:199], v[156:159]
    v_mfma_f32_16x16x32_bf16 v[156:159], a[176:179], a[216:219], v[156:159]
    v_mfma_f32_16x16x32_bf16 v[156:159], a[180:183], a[220:223], v[156:159]
    s_waitcnt lgkmcnt(0)
    v_mfma_f32_16x16x32_bf16 v[32:35], a[152:155], a[184:187], v[32:35]
    ds_read_b128 a[168:171], v20 offset:22528
    ds_read_b128 a[172:175], v21 offset:22528
    v_mfma_f32_16x16x32_bf16 v[32:35], a[156:159], a[188:191], v[32:35]
    ds_read_b128 a[176:179], v20 offset:30720
    ds_read_b128 a[180:183], v21 offset:30720
    v_mfma_f32_16x16x32_bf16 v[32:35], a[160:163], a[208:211], v[32:35]
    s_add_u32 m0, s100, 81920
    s_add_u32 s48, s101, 131328
    v_mfma_f32_16x16x32_bf16 v[32:35], a[164:167], a[212:215], v[32:35]
    buffer_load_dwordx4 v1, s[24:27], s48 offen offset:0 nt lds
    v_max3_f32 v12, v24, v25, v24
    v_mfma_f32_16x16x32_bf16 v[160:163], a[152:155], a[192:195], v[160:163]
    v_max3_f32 v12, v26, v27, v12
    v_max3_f32 v12, v28, v29, v12
    v_mfma_f32_16x16x32_bf16 v[160:163], a[156:159], a[196:199], v[160:163]
    v_max3_f32 v12, v30, v31, v12
    v_mov_b32 v13, v12
    v_mfma_f32_16x16x32_bf16 v[160:163], a[160:163], a[216:219], v[160:163]
    s_nop 0
    v_permlane32_swap_b32 v12, v13
    v_max_f32 v12, v12, v13
    v_mfma_f32_16x16x32_bf16 v[160:163], a[164:167], a[220:223], v[160:163]
    v_mov_b32 v13, v12
    s_waitcnt lgkmcnt(0)
    v_mfma_f32_16x16x32_bf16 v[36:39], a[168:171], a[184:187], v[36:39]
    s_waitcnt vmcnt(9)
    s_barrier
    v_mfma_f32_16x16x32_bf16 v[36:39], a[172:175], a[188:191], v[36:39]
    ds_read_b128 a[152:155], v20 offset:32768
    ds_read_b128 a[156:159], v21 offset:32768
    v_mfma_f32_16x16x32_bf16 v[36:39], a[176:179], a[208:211], v[36:39]
    ds_read_b128 a[160:163], v20 offset:40960
    ds_read_b128 a[164:167], v21 offset:40960
    v_mfma_f32_16x16x32_bf16 v[36:39], a[180:183], a[212:215], v[36:39]
    ds_read_b128 a[200:203], v16 offset:4096
    v_mfma_f32_16x16x32_bf16 v[164:167], a[168:171], a[192:195], v[164:167]
    ds_read_b128 a[204:207], v17 offset:4096
    ds_read_b128 a[224:227], v16 offset:28672
    v_mfma_f32_16x16x32_bf16 v[164:167], a[172:175], a[196:199], v[164:167]
    ds_read_b128 a[228:231], v17 offset:28672
    buffer_load_dwordx4 v2, s[24:27], s48 offen offset:1024 nt lds
    v_mfma_f32_16x16x32_bf16 v[164:167], a[176:179], a[216:219], v[164:167]
    v_permlane16_swap_b32 v12, v13
    v_max_f32 v12, v12, v13
    v_mfma_f32_16x16x32_bf16 v[164:167], a[180:183], a[220:223], v[164:167]
    v_mul_f32 v12, 3182996027, v12
    s_waitcnt lgkmcnt(4)
    v_mfma_f32_16x16x32_bf16 v[40:43], a[152:155], a[184:187], v[40:43]
    ds_read_b128 a[168:171], v20 offset:34816
    v_max3_f32 v14, v152, v153, v152
    v_mfma_f32_16x16x32_bf16 v[40:43], a[156:159], a[188:191], v[40:43]
    ds_read_b128 a[172:175], v21 offset:34816
    v_max3_f32 v14, v154, v155, v14
    v_mfma_f32_16x16x32_bf16 v[40:43], a[160:163], a[208:211], v[40:43]
    ds_read_b128 a[176:179], v20 offset:43008
    v_max3_f32 v14, v156, v157, v14
    v_mfma_f32_16x16x32_bf16 v[40:43], a[164:167], a[212:215], v[40:43]
    ds_read_b128 a[180:183], v21 offset:43008
    v_max3_f32 v14, v158, v159, v14
    v_mfma_f32_16x16x32_bf16 v[168:171], a[152:155], a[192:195], v[168:171]
    ds_read_b128 a[232:235], v20 offset:16384
    s_add_u32 m0, s100, 90112
    v_mfma_f32_16x16x32_bf16 v[168:171], a[156:159], a[196:199], v[168:171]
    ds_read_b128 a[236:239], v21 offset:16384
    s_add_u32 s48, s101, 131456
    v_mfma_f32_16x16x32_bf16 v[168:171], a[160:163], a[216:219], v[168:171]
    ds_read_b128 a[240:243], v20 offset:24576
    buffer_load_dwordx4 v1, s[24:27], s48 offen offset:0 nt lds
    v_mfma_f32_16x16x32_bf16 v[168:171], a[164:167], a[220:223], v[168:171]
    ds_read_b128 a[244:247], v21 offset:24576
    s_waitcnt lgkmcnt(8)
    v_mfma_f32_16x16x32_bf16 a[40:43], a[152:155], a[200:203], a[40:43]
    v_mov_b32 v13, v14
    v_fma_f32 v24, v24, s50, v12
    v_mfma_f32_16x16x32_bf16 a[40:43], a[156:159], a[204:207], a[40:43]
    v_permlane32_swap_b32 v14, v13
    v_max_f32 v14, v14, v13
    v_mfma_f32_16x16x32_bf16 a[40:43], a[160:163], a[224:227], a[40:43]
    v_mov_b32 v13, v14
    v_fma_f32 v25, v25, s50, v12
    v_mfma_f32_16x16x32_bf16 a[40:43], a[164:167], a[228:231], a[40:43]
    v_permlane16_swap_b32 v14, v13
    s_waitcnt lgkmcnt(0)
    v_mfma_f32_16x16x32_bf16 a[24:27], a[232:235], a[200:203], a[24:27]
    v_max_f32 v14, v14, v13
    v_mul_f32 v14, 3182996027, v14
    v_mfma_f32_16x16x32_bf16 a[24:27], a[236:239], a[204:207], a[24:27]
    buffer_load_dwordx4 v2, s[24:27], s48 offen offset:1024 nt lds
    v_fma_f32 v26, v26, s50, v12
    v_mfma_f32_16x16x32_bf16 a[24:27], a[240:243], a[224:227], a[24:27]
    v_exp_f32 v24, v24
    v_mfma_f32_16x16x32_bf16 a[24:27], a[244:247], a[228:231], a[24:27]
    v_fma_f32 v27, v27, s50, v12
    v_mfma_f32_16x16x32_bf16 v[44:47], a[168:171], a[184:187], v[44:47]
    ds_read_b128 a[152:155], v20 offset:36864
    v_fma_f32 v28, v28, s50, v12
    v_mfma_f32_16x16x32_bf16 v[44:47], a[172:175], a[188:191], v[44:47]
    ds_read_b128 a[156:159], v21 offset:36864
    v_fma_f32 v29, v29, s50, v12
    v_mfma_f32_16x16x32_bf16 v[44:47], a[176:179], a[208:211], v[44:47]
    ds_read_b128 a[160:163], v20 offset:45056
    v_fma_f32 v30, v30, s50, v12
    v_mfma_f32_16x16x32_bf16 v[44:47], a[180:183], a[212:215], v[44:47]
    ds_read_b128 a[164:167], v21 offset:45056
    v_fma_f32 v31, v31, s50, v12
    v_mfma_f32_16x16x32_bf16 v[172:175], a[168:171], a[192:195], v[172:175]
    ds_read_b128 a[232:235], v20 offset:18432
    s_add_u32 m0, s100, 98304
    v_mfma_f32_16x16x32_bf16 v[172:175], a[172:175], a[196:199], v[172:175]
    ds_read_b128 a[236:239], v21 offset:18432
    s_add_u32 s48, s101, 164096
    v_mfma_f32_16x16x32_bf16 v[172:175], a[176:179], a[216:219], v[172:175]
    ds_read_b128 a[240:243], v20 offset:26624
    buffer_load_dwordx4 v1, s[24:27], s48 offen offset:0 nt lds
    v_mfma_f32_16x16x32_bf16 v[172:175], a[180:183], a[220:223], v[172:175]
    ds_read_b128 a[244:247], v21 offset:26624
    v_fma_f32 v152, v152, s50, v14
    v_mfma_f32_16x16x32_bf16 a[44:47], a[168:171], a[200:203], a[44:47]
    v_exp_f32 v25, v25
L_pad1:
    s_cbranch_execz L_pad5
    v_mfma_f32_16x16x32_bf16 a[44:47], a[172:175], a[204:207], a[44:47]
    v_exp_f32 v26, v26
    v_mfma_f32_16x16x32_bf16 a[44:47], a[176:179], a[224:227], a[44:47]
    v_exp_f32 v27, v27
    v_mfma_f32_16x16x32_bf16 a[44:47], a[180:183], a[228:231], a[44:47]
    v_cvt_pk_bf16_f32 v24, v24, v25
    s_waitcnt lgkmcnt(0)
    v_mfma_f32_16x16x32_bf16 a[28:31], a[232:235], a[200:203], a[28:31]
    v_exp_f32 v28, v28
    v_mfma_f32_16x16x32_bf16 a[28:31], a[236:239], a[204:207], a[28:31]
    buffer_load_dwordx4 v2, s[24:27], s48 offen offset:1024 nt lds
    v_cvt_pk_bf16_f32 v25, v26, v27
    v_mfma_f32_16x16x32_bf16 a[28:31], a[240:243], a[224:227], a[28:31]
    v_exp_f32 v29, v29
    v_mfma_f32_16x16x32_bf16 a[28:31], a[244:247], a[228:231], a[28:31]
    v_cvt_pk_bf16_f32 v26, v28, v29
    v_mfma_f32_16x16x32_bf16 v[48:51], a[152:155], a[184:187], v[48:51]
    ds_read_b128 a[168:171], v20 offset:38912
    v_fma_f32 v153, v153, s50, v14
    v_mfma_f32_16x16x32_bf16 v[48:51], a[156:159], a[188:191], v[48:51]
    ds_read_b128 a[172:175], v21 offset:38912
    v_fma_f32 v154, v154, s50, v14
    v_mfma_f32_16x16x32_bf16 v[48:51], a[160:163], a[208:211], v[48:51]
    ds_read_b128 a[176:179], v20 offset:47104
    v_fma_f32 v155, v155, s50, v14
    v_mfma_f32_16x16x32_bf16 v[48:51], a[164:167], a[212:215], v[48:51]
    ds_read_b128 a[180:183], v21 offset:47104
    v_fma_f32 v156, v156, s50, v14
    v_mfma_f32_16x16x32_bf16 v[176:179], a[152:155], a[192:195], v[176:179]
    ds_read_b128 a[232:235], v20 offset:20480
    s_add_u32 m0, s100, 106496
    v_mfma_f32_16x16x32_bf16 v[176:179], a[156:159], a[196:199], v[176:179]
    ds_read_b128 a[236:239], v21 offset:20480
    s_add_u32 s48, s101, 164224
    v_mfma_f32_16x16x32_bf16 v[176:179], a[160:163], a[216:219], v[176:179]
    ds_read_b128 a[240:243], v20 offset:28672
    buffer_load_dwordx4 v1, s[24:27], s48 offen offset:0 nt lds
    v_mfma_f32_16x16x32_bf16 v[176:179], a[164:167], a[220:223], v[176:179]
    ds_read_b128 a[244:247], v21 offset:28672
    v_accvgpr_read_b32 v13, a24
    v_mfma_f32_16x16x32_bf16 a[48:51], a[152:155], a[200:203], a[48:51]
    v_accvgpr_read_b32 v15, a25
    v_max3_f32 v0, v13, v15, v13
    v_mfma_f32_16x16x32_bf16 a[48:51], a[156:159], a[204:207], a[48:51]
    v_accvgpr_read_b32 v13, a26
    v_accvgpr_read_b32 v15, a27
    v_mfma_f32_16x16x32_bf16 a[48:51], a[160:163], a[224:227], a[48:51]
    v_max3_f32 v0, v13, v15, v0
    v_accvgpr_read_b32 v13, a28
    v_mfma_f32_16x16x32_bf16 a[48:51], a[164:167], a[228:231], a[48:51]
    v_accvgpr_read_b32 v15, a29
    s_waitcnt lgkmcnt(0)
    v_mfma_f32_16x16x32_bf16 a[32:35], a[232:235], a[200:203], a[32:35]
    buffer_load_dwordx4 v2, s[24:27], s48 offen offset:1024 nt lds
    v_max3_f32 v0, v13, v15, v0
    v_mfma_f32_16x16x32_bf16 a[32:35], a[236:239], a[204:207], a[32:35]
    v_accvgpr_read_b32 v13, a30
    v_accvgpr_read_b32 v15, a31
    v_mfma_f32_16x16x32_bf16 a[32:35], a[240:243], a[224:227], a[32:35]
    v_max3_f32 v0, v13, v15, v0
    v_mov_b32 v13, v0
    v_mfma_f32_16x16x32_bf16 a[32:35], a[244:247], a[228:231], a[32:35]
    s_nop 0
    v_permlane32_swap_b32 v0, v13
    v_mfma_f32_16x16x32_bf16 v[52:55], a[168:171], a[184:187], v[52:55]
    s_waitcnt vmcnt(12)
    s_barrier
    v_mfma_f32_16x16x32_bf16 v[52:55], a[172:175], a[188:191], v[52:55]
    ds_read_b128 a[152:155], v20 offset:49152
    v_max_f32 v0, v0, v13
    v_mfma_f32_16x16x32_bf16 v[52:55], a[176:179], a[208:211], v[52:55]
    ds_read_b128 a[156:159], v21 offset:49152
    v_mov_b32 v13, v0
    v_mfma_f32_16x16x32_bf16 v[52:55], a[180:183], a[212:215], v[52:55]
    ds_read_b128 a[160:163], v20 offset:57344
    s_add_u32 m0, s100, 0
    v_mfma_f32_16x16x32_bf16 v[180:183], a[168:171], a[192:195], v[180:183]
    ds_read_b128 a[164:167], v21 offset:57344
    ds_read_b128 a[232:235], v20 offset:22528
    v_mfma_f32_16x16x32_bf16 v[180:183], a[172:175], a[196:199], v[180:183]
    ds_read_b128 a[236:239], v21 offset:22528
    s_add_u32 s48, s101, 196864
    v_mfma_f32_16x16x32_bf16 v[180:183], a[176:179], a[216:219], v[180:183]
    ds_read_b128 a[240:243], v20 offset:30720
    buffer_load_dwordx4 v1, s[24:27], s48 offen offset:0 nt lds
    v_mfma_f32_16x16x32_bf16 v[180:183], a[180:183], a[220:223], v[180:183]
    ds_read_b128 a[244:247], v21 offset:30720
    v_permlane16_swap_b32 v0, v13
    v_mfma_f32_16x16x32_bf16 a[52:55], a[168:171], a[200:203], a[52:55]
    v_max_f32 v0, v0, v13
    v_mul_f32 v0, 3182996027, v0
    v_mfma_f32_16x16x32_bf16 a[52:55], a[172:175], a[204:207], a[52:55]
    v_exp_f32 v30, v30
    v_mfma_f32_16x16x32_bf16 a[52:55], a[176:179], a[224:227], a[52:55]
    v_exp_f32 v31, v31
    v_mfma_f32_16x16x32_bf16 a[52:55], a[180:183], a[228:231], a[52:55]
    v_cvt_pk_bf16_f32 v27, v30, v31
    s_waitcnt lgkmcnt(0)
    v_mfma_f32_16x16x32_bf16 a[36:39], a[232:235], a[200:203], a[36:39]
    buffer_load_dwordx4 v2, s[24:27], s48 offen offset:1024 nt lds
    v_fma_f32 v157, v157, s50, v14
    v_mfma_f32_16x16x32_bf16 a[36:39], a[236:239], a[204:207], a[36:39]
    v_exp_f32 v152, v152
    v_mfma_f32_16x16x32_bf16 a[36:39], a[240:243], a[224:227], a[36:39]
    v_exp_f32 v153, v153
    v_mfma_f32_16x16x32_bf16 a[36:39], a[244:247], a[228:231], a[36:39]
    v_cvt_pk_bf16_f32 v152, v152, v153
    v_mfma_f32_16x16x32_bf16 v[56:59], a[152:155], a[184:187], v[56:59]
    ds_read_b128 a[168:171], v20 offset:51200
    v_fma_f32 v158, v158, s50, v14
    v_mfma_f32_16x16x32_bf16 v[56:59], a[156:159], a[188:191], v[56:59]
    ds_read_b128 a[172:175], v21 offset:51200
    v_fma_f32 v159, v159, s50, v14
    v_mfma_f32_16x16x32_bf16 v[56:59], a[160:163], a[208:211], v[56:59]
    ds_read_b128 a[176:179], v20 offset:59392
    v_fma_f32 v32, v32, s50, v12
    v_mfma_f32_16x16x32_bf16 v[56:59], a[164:167], a[212:215], v[56:59]
    ds_read_b128 a[180:183], v21 offset:59392
    s_add_u32 m0, s100, 8192
    v_mfma_f32_16x16x32_bf16 v[184:187], a[152:155], a[192:195], v[184:187]
    s_add_u32 s48, s101, 196992
    buffer_load_dwordx4 v1, s[24:27], s48 offen offset:0 nt lds
    v_mfma_f32_16x16x32_bf16 v[184:187], a[156:159], a[196:199], v[184:187]
    v_exp_f32 v154, v154
    v_mfma_f32_16x16x32_bf16 v[184:187], a[160:163], a[216:219], v[184:187]
    v_exp_f32 v155, v155
    v_mfma_f32_16x16x32_bf16 v[184:187], a[164:167], a[220:223], v[184:187]
    v_exp_f32 v156, v156
    v_mfma_f32_16x16x32_bf16 a[56:59], a[152:155], a[200:203], a[56:59]
    v_mov_b32 v13, 1065369472
    v_accvgpr_write_b32 a232, v13
    v_mfma_f32_16x16x32_bf16 a[56:59], a[156:159], a[204:207], a[56:59]
    v_accvgpr_write_b32 a233, v13
    v_accvgpr_write_b32 a234, v13
    v_mfma_f32_16x16x32_bf16 a[56:59], a[160:163], a[224:227], a[56:59]
    v_accvgpr_write_b32 a235, v13
    buffer_load_dwordx4 v2, s[24:27], s48 offen offset:1024 nt lds
    v_mfma_f32_16x16x32_bf16 a[56:59], a[164:167], a[228:231], a[56:59]
    v_cvt_pk_bf16_f32 v153, v154, v155
    s_waitcnt lgkmcnt(0)
    v_mfma_f32_16x16x32_bf16 v[60:63], a[168:171], a[184:187], v[60:63]
    ds_read_b128 a[152:155], v20 offset:53248
    v_fma_f32 v33, v33, s50, v12
    v_mfma_f32_16x16x32_bf16 v[60:63], a[172:175], a[188:191], v[60:63]
    ds_read_b128 a[156:159], v21 offset:53248
    v_fma_f32 v34, v34, s50, v12
    v_mfma_f32_16x16x32_bf16 v[60:63], a[176:179], a[208:211], v[60:63]
    ds_read_b128 a[160:163], v20 offset:61440
    v_fma_f32 v35, v35, s50, v12
    v_mfma_f32_16x16x32_bf16 v[60:63], a[180:183], a[212:215], v[60:63]
    ds_read_b128 a[164:167], v21 offset:61440
    v_fma_f32 v36, v36, s50, v12
    v_mfma_f32_16x16x32_bf16 v[188:191], a[168:171], a[192:195], v[188:191]
    v_exp_f32 v157, v157
    v_mfma_f32_16x16x32_bf16 v[188:191], a[172:175], a[196:199], v[188:191]
    v_exp_f32 v158, v158
    v_mfma_f32_16x16x32_bf16 v[188:191], a[176:179], a[216:219], v[188:191]
    v_exp_f32 v159, v159
    v_mfma_f32_16x16x32_bf16 v[188:191], a[180:183], a[220:223], v[188:191]
    v_exp_f32 v32, v32
    v_mfma_f32_16x16x32_bf16 a[60:63], a[168:171], a[200:203], a[60:63]
    v_exp_f32 v33, v33
    v_mfma_f32_16x16x32_bf16 a[60:63], a[172:175], a[204:207], a[60:63]
    v_exp_f32 v34, v34
    v_mfma_f32_16x16x32_bf16 a[60:63], a[176:179], a[224:227], a[60:63]
    v_exp_f32 v35, v35
    v_mfma_f32_16x16x32_bf16 a[60:63], a[180:183], a[228:231], a[60:63]
    v_cvt_pk_bf16_f32 v154, v156, v157
    s_waitcnt lgkmcnt(0)
    v_mfma_f32_16x16x32_bf16 v[64:67], a[152:155], a[184:187], v[64:67]
    ds_read_b128 a[168:171], v20 offset:55296
    v_cvt_pk_bf16_f32 v155, v158, v159
    v_mfma_f32_16x16x32_bf16 v[64:67], a[156:159], a[188:191], v[64:67]
    ds_read_b128 a[172:175], v21 offset:55296
    v_cvt_pk_bf16_f32 v32, v32, v33
    v_mfma_f32_16x16x32_bf16 v[64:67], a[160:163], a[208:211], v[64:67]
    ds_read_b128 a[176:179], v20 offset:63488
    v_cvt_pk_bf16_f32 v33, v34, v35
    v_mfma_f32_16x16x32_bf16 v[64:67], a[164:167], a[212:215], v[64:67]
    ds_read_b128 a[180:183], v21 offset:63488
    v_fma_f32 v37, v37, s50, v12
    v_mfma_f32_16x16x32_bf16 v[192:195], a[152:155], a[192:195], v[192:195]
    v_exp_f32 v36, v36
    v_mfma_f32_16x16x32_bf16 v[192:195], a[156:159], a[196:199], v[192:195]
    v_exp_f32 v37, v37
    v_mfma_f32_16x16x32_bf16 v[192:195], a[160:163], a[216:219], v[192:195]
    v_cvt_pk_bf16_f32 v34, v36, v37
    v_fma_f32 v38, v38, s50, v12
    v_mfma_f32_16x16x32_bf16 v[192:195], a[164:167], a[220:223], v[192:195]
    v_exp_f32 v38, v38
    v_mfma_f32_16x16x32_bf16 a[64:67], a[152:155], a[200:203], a[64:67]
    v_fma_f32 v39, v39, s50, v12
    v_fma_f32 v160, v160, s50, v14
    v_mfma_f32_16x16x32_bf16 a[64:67], a[156:159], a[204:207], a[64:67]
    v_exp_f32 v39, v39
    v_mfma_f32_16x16x32_bf16 a[64:67], a[160:163], a[224:227], a[64:67]
    v_exp_f32 v160, v160
    v_mfma_f32_16x16x32_bf16 a[64:67], a[164:167], a[228:231], a[64:67]
    v_cvt_pk_bf16_f32 v35, v38, v39
    s_waitcnt lgkmcnt(0)
    v_mfma_f32_16x16x32_bf16 v[68:71], a[168:171], a[184:187], v[68:71]
    s_waitcnt vmcnt(12)
    s_barrier
    v_mfma_f32_16x16x32_bf16 v[68:71], a[172:175], a[188:191], v[68:71]
    ds_read_b128 a[152:155], v22 offset:0
    s_add_u32 m0, s100, 16384
    v_mfma_f32_16x16x32_bf16 v[68:71], a[176:179], a[208:211], v[68:71]
    ds_read_b128 a[156:159], v23 offset:0
    s_add_u32 s48, s101, 229632
    v_mfma_f32_16x16x32_bf16 v[68:71], a[180:183], a[212:215], v[68:71]
    ds_read_b128 a[160:163], v22 offset:8192
    buffer_load_dwordx4 v1, s[24:27], s48 offen offset:0 nt lds
    v_mfma_f32_16x16x32_bf16 v[196:199], a[168:171], a[192:195], v[196:199]
    ds_read_b128 a[164:167], v23 offset:8192
    v_fma_f32 v161, v161, s50, v14
    v_mfma_f32_16x16x32_bf16 v[196:199], a[172:175], a[196:199], v[196:199]
    v_exp_f32 v161, v161
    v_mfma_f32_16x16x32_bf16 v[196:199], a[176:179], a[216:219], v[196:199]
    v_cvt_pk_bf16_f32 v160, v160, v161
    v_fma_f32 v162, v162, s50, v14
    v_mfma_f32_16x16x32_bf16 v[196:199], a[180:183], a[220:223], v[196:199]
    v_exp_f32 v162, v162
    v_mfma_f32_16x16x32_bf16 a[68:71], a[168:171], a[200:203], a[68:71]
    v_fma_f32 v163, v163, s50, v14
    v_fma_f32 v164, v164, s50, v14
    v_mfma_f32_16x16x32_bf16 a[68:71], a[172:175], a[204:207], a[68:71]
    buffer_load_dwordx4 v2, s[24:27], s48 offen offset:1024 nt lds
    v_fma_f32 v165, v165, s50, v14
    v_mfma_f32_16x16x32_bf16 a[68:71], a[176:179], a[224:227], a[68:71]
    v_exp_f32 v163, v163
    v_mfma_f32_16x16x32_bf16 a[68:71], a[180:183], a[228:231], a[68:71]
    v_cvt_pk_bf16_f32 v161, v162, v163
    s_waitcnt lgkmcnt(0)
    v_mfma_f32_16x16x32_bf16 v[72:75], a[152:155], a[184:187], v[72:75]
    ds_read_b128 a[168:171], v22 offset:2048
    v_fma_f32 v166, v166, s50, v14
    v_mfma_f32_16x16x32_bf16 v[72:75], a[156:159], a[188:191], v[72:75]
    ds_read_b128 a[172:175], v23 offset:2048
    v_fma_f32 v167, v167, s50, v14
    v_mfma_f32_16x16x32_bf16 v[72:75], a[160:163], a[208:211], v[72:75]
    ds_read_b128 a[176:179], v22 offset:10240
    v_fma_f32 v40, v40, s50, v12
    v_mfma_f32_16x16x32_bf16 v[72:75], a[164:167], a[212:215], v[72:75]
    ds_read_b128 a[180:183], v23 offset:10240
    v_fma_f32 v41, v41, s50, v12
    v_mfma_f32_16x16x32_bf16 v[200:203], a[152:155], a[192:195], v[200:203]
    s_add_u32 m0, s100, 24576
    s_add_u32 s48, s101, 229760
    v_mfma_f32_16x16x32_bf16 v[200:203], a[156:159], a[196:199], v[200:203]
    buffer_load_dwordx4 v1, s[24:27], s48 offen offset:0 nt lds
    v_fma_f32 v42, v42, s50, v12
    v_mfma_f32_16x16x32_bf16 v[200:203], a[160:163], a[216:219], v[200:203]
    v_exp_f32 v164, v164
    v_mfma_f32_16x16x32_bf16 v[200:203], a[164:167], a[220:223], v[200:203]
    v_exp_f32 v165, v165
    v_mfma_f32_16x16x32_bf16 a[72:75], a[152:155], a[200:203], a[72:75]
    v_exp_f32 v166, v166
    v_mfma_f32_16x16x32_bf16 a[72:75], a[156:159], a[204:207], a[72:75]
    v_exp_f32 v167, v167
    v_mfma_f32_16x16x32_bf16 a[72:75], a[160:163], a[224:227], a[72:75]
    v_exp_f32 v40, v40
    v_mfma_f32_16x16x32_bf16 a[72:75], a[164:167], a[228:231], a[72:75]
    buffer_load_dwordx4 v2, s[24:27], s48 offen offset:1024 nt lds
    s_waitcnt lgkmcnt(0)
    v_mfma_f32_16x16x32_bf16 v[76:79], a[168:171], a[184:187], v[76:79]
    ds_read_b128 a[152:155], v22 offset:4096
    v_cvt_pk_bf16_f32 v162, v164, v165
    v_mfma_f32_16x16x32_bf16 v[76:79], a[172:175], a[188:191], v[76:79]
    ds_read_b128 a[156:159], v23 offset:4096
    v_cvt_pk_bf16_f32 v163, v166, v167
    v_mfma_f32_16x16x32_bf16 v[76:79], a[176:179], a[208:211], v[76:79]
    ds_read_b128 a[160:163], v22 offset:12288
    v_fma_f32 v43, v43, s50, v12
    v_mfma_f32_16x16x32_bf16 v[76:79], a[180:183], a[212:215], v[76:79]
    ds_read_b128 a[164:167], v23 offset:12288
    v_fma_f32 v44, v44, s50, v12
    v_mfma_f32_16x16x32_bf16 v[204:207], a[168:171], a[192:195], v[204:207]
    v_exp_f32 v41, v41
    v_mfma_f32_16x16x32_bf16 v[204:207], a[172:175], a[196:199], v[204:207]
    v_exp_f32 v42, v42
    v_mfma_f32_16x16x32_bf16 v[204:207], a[176:179], a[216:219], v[204:207]
    s_add_u32 m0, s36, 131072
    s_add_u32 s48, s38, 0
    v_mfma_f32_16x16x32_bf16 v[204:207], a[180:183], a[220:223], v[204:207]
    buffer_load_dwordx4 v1, s[28:31], s48 offen offset:0 lds
    v_cvt_pk_bf16_f32 v40, v40, v41
    v_mfma_f32_16x16x32_bf16 a[76:79], a[168:171], a[200:203], a[76:79]
    v_exp_f32 v43, v43
    v_mfma_f32_16x16x32_bf16 a[76:79], a[172:175], a[204:207], a[76:79]
    v_exp_f32 v44, v44
    v_mfma_f32_16x16x32_bf16 a[76:79], a[176:179], a[224:227], a[76:79]
    v_cvt_pk_bf16_f32 v41, v42, v43
    v_fma_f32 v45, v45, s50, v12
    v_mfma_f32_16x16x32_bf16 a[76:79], a[180:183], a[228:231], a[76:79]
    v_fma_f32 v46, v46, s50, v12
    s_waitcnt lgkmcnt(0)
    v_mfma_f32_16x16x32_bf16 v[80:83], a[152:155], a[184:187], v[80:83]
    ds_read_b128 a[168:171], v22 offset:6144
    v_fma_f32 v47, v47, s50, v12
    v_mfma_f32_16x16x32_bf16 v[80:83], a[156:159], a[188:191], v[80:83]
    ds_read_b128 a[172:175], v23 offset:6144
    buffer_load_dwordx4 v2, s[28:31], s48 offen offset:1024 lds
    v_mfma_f32_16x16x32_bf16 v[80:83], a[160:163], a[208:211], v[80:83]
    ds_read_b128 a[176:179], v22 offset:14336
    v_fma_f32 v168, v168, s50, v14
    v_mfma_f32_16x16x32_bf16 v[80:83], a[164:167], a[212:215], v[80:83]
    ds_read_b128 a[180:183], v23 offset:14336
    v_fma_f32 v169, v169, s50, v14
    v_mfma_f32_16x16x32_bf16 v[208:211], a[152:155], a[192:195], v[208:211]
    v_exp_f32 v45, v45
    v_mfma_f32_16x16x32_bf16 v[208:211], a[156:159], a[196:199], v[208:211]
    v_exp_f32 v46, v46
    v_mfma_f32_16x16x32_bf16 v[208:211], a[160:163], a[216:219], v[208:211]
    v_exp_f32 v47, v47
    v_mfma_f32_16x16x32_bf16 v[208:211], a[164:167], a[220:223], v[208:211]
    v_exp_f32 v168, v168
    v_mfma_f32_16x16x32_bf16 a[80:83], a[152:155], a[200:203], a[80:83]
    buffer_load_dwordx4 v3, s[28:31], s48 offen offset:2048 lds
    v_cvt_pk_bf16_f32 v42, v44, v45
    v_mfma_f32_16x16x32_bf16 a[80:83], a[156:159], a[204:207], a[80:83]
    v_exp_f32 v169, v169
    v_mfma_f32_16x16x32_bf16 a[80:83], a[160:163], a[224:227], a[80:83]
    v_cvt_pk_bf16_f32 v43, v46, v47
    v_cvt_pk_bf16_f32 v168, v168, v169
    v_mfma_f32_16x16x32_bf16 a[80:83], a[164:167], a[228:231], a[80:83]
    v_fma_f32 v170, v170, s50, v14
    s_waitcnt lgkmcnt(0)
    v_mfma_f32_16x16x32_bf16 v[84:87], a[168:171], a[184:187], v[84:87]
    s_waitcnt vmcnt(15)
    s_barrier
    v_mfma_f32_16x16x32_bf16 v[84:87], a[172:175], a[188:191], v[84:87]
    ds_read_b128 a[152:155], v22 offset:16384
    v_fma_f32 v171, v171, s50, v14
    v_mfma_f32_16x16x32_bf16 v[84:87], a[176:179], a[208:211], v[84:87]
    ds_read_b128 a[156:159], v23 offset:16384
    buffer_load_dwordx4 v4, s[28:31], s48 offen offset:3072 lds
    v_mfma_f32_16x16x32_bf16 v[84:87], a[180:183], a[212:215], v[84:87]
    ds_read_b128 a[160:163], v22 offset:24576
    v_fma_f32 v172, v172, s50, v14
    v_mfma_f32_16x16x32_bf16 v[212:215], a[168:171], a[192:195], v[212:215]
    ds_read_b128 a[164:167], v23 offset:24576
    v_fma_f32 v173, v173, s50, v14
    v_mfma_f32_16x16x32_bf16 v[212:215], a[172:175], a[196:199], v[212:215]
    v_exp_f32 v170, v170
    v_mfma_f32_16x16x32_bf16 v[212:215], a[176:179], a[216:219], v[212:215]
    v_exp_f32 v171, v171
    v_mfma_f32_16x16x32_bf16 v[212:215], a[180:183], a[220:223], v[212:215]
    v_exp_f32 v172, v172
    v_mfma_f32_16x16x32_bf16 a[84:87], a[168:171], a[200:203], a[84:87]
    v_exp_f32 v173, v173
    v_mfma_f32_16x16x32_bf16 a[84:87], a[172:175], a[204:207], a[84:87]
    s_add_u32 m0, s36, 147456
    s_add_u32 s48, s38, 65536
    v_mfma_f32_16x16x32_bf16 a[84:87], a[176:179], a[224:227], a[84:87]
    buffer_load_dwordx4 v1, s[28:31], s48 offen offset:0 lds
    v_cvt_pk_bf16_f32 v169, v170, v171
    v_mfma_f32_16x16x32_bf16 a[84:87], a[180:183], a[228:231], a[84:87]
    v_cvt_pk_bf16_f32 v170, v172, v173
    s_waitcnt lgkmcnt(0)
    v_mfma_f32_16x16x32_bf16 v[88:91], a[152:155], a[184:187], v[88:91]
    ds_read_b128 a[168:171], v22 offset:18432
    v_fma_f32 v174, v174, s50, v14
    v_mfma_f32_16x16x32_bf16 v[88:91], a[156:159], a[188:191], v[88:91]
    ds_read_b128 a[172:175], v23 offset:18432
    v_fma_f32 v175, v175, s50, v14
    v_mfma_f32_16x16x32_bf16 v[88:91], a[160:163], a[208:211], v[88:91]
    ds_read_b128 a[176:179], v22 offset:26624
    v_fma_f32 v48, v48, s50, v12
    v_mfma_f32_16x16x32_bf16 v[88:91], a[164:167], a[212:215], v[88:91]
    ds_read_b128 a[180:183], v23 offset:26624
    v_fma_f32 v49, v49, s50, v12
    v_mfma_f32_16x16x32_bf16 v[216:219], a[152:155], a[192:195], v[216:219]
    buffer_load_dwordx4 v2, s[28:31], s48 offen offset:1024 lds
    v_fma_f32 v50, v50, s50, v12
    v_mfma_f32_16x16x32_bf16 v[216:219], a[156:159], a[196:199], v[216:219]
    v_exp_f32 v174, v174
    v_mfma_f32_16x16x32_bf16 v[216:219], a[160:163], a[216:219], v[216:219]
    v_exp_f32 v175, v175
    v_mfma_f32_16x16x32_bf16 v[216:219], a[164:167], a[220:223], v[216:219]
    v_exp_f32 v48, v48
    v_mfma_f32_16x16x32_bf16 a[88:91], a[152:155], a[200:203], a[88:91]
    v_exp_f32 v49, v49
    v_mfma_f32_16x16x32_bf16 a[88:91], a[156:159], a[204:207], a[88:91]
    v_exp_f32 v50, v50
    v_mfma_f32_16x16x32_bf16 a[88:91], a[160:163], a[224:227], a[88:91]
    v_cvt_pk_bf16_f32 v171, v174, v175
    v_cvt_pk_bf16_f32 v48, v48, v49
    v_mfma_f32_16x16x32_bf16 a[88:91], a[164:167], a[228:231], a[88:91]
    buffer_load_dwordx4 v3, s[28:31], s48 offen offset:2048 lds
    s_waitcnt lgkmcnt(0)
    v_mfma_f32_16x16x32_bf16 v[92:95], a[168:171], a[184:187], v[92:95]
    ds_read_b128 a[152:155], v22 offset:20480
    v_fma_f32 v51, v51, s50, v12
    v_mfma_f32_16x16x32_bf16 v[92:95], a[172:175], a[188:191], v[92:95]
    ds_read_b128 a[156:159], v23 offset:20480
    v_fma_f32 v52, v52, s50, v12
    v_mfma_f32_16x16x32_bf16 v[92:95], a[176:179], a[208:211], v[92:95]
    ds_read_b128 a[160:163], v22 offset:28672
    v_fma_f32 v53, v53, s50, v12
    v_mfma_f32_16x16x32_bf16 v[92:95], a[180:183], a[212:215], v[92:95]
    ds_read_b128 a[164:167], v23 offset:28672
    v_fma_f32 v54, v54, s50, v12
    v_mfma_f32_16x16x32_bf16 v[220:223], a[168:171], a[192:195], v[220:223]
    v_exp_f32 v51, v51
    v_mfma_f32_16x16x32_bf16 v[220:223], a[172:175], a[196:199], v[220:223]
    buffer_load_dwordx4 v4, s[28:31], s48 offen offset:3072 lds
    v_cvt_pk_bf16_f32 v49, v50, v51
    v_mfma_f32_16x16x32_bf16 v[220:223], a[176:179], a[216:219], v[220:223]
    v_exp_f32 v52, v52
    v_mfma_f32_16x16x32_bf16 v[220:223], a[180:183], a[220:223], v[220:223]
    v_exp_f32 v53, v53
    v_mfma_f32_16x16x32_bf16 a[92:95], a[168:171], a[200:203], a[92:95]
    v_exp_f32 v54, v54
    v_mfma_f32_16x16x32_bf16 a[92:95], a[172:175], a[204:207], a[92:95]
    v_cvt_pk_bf16_f32 v50, v52, v53
    v_fma_f32 v55, v55, s50, v12
    v_mfma_f32_16x16x32_bf16 a[92:95], a[176:179], a[224:227], a[92:95]
    v_exp_f32 v55, v55
    v_mfma_f32_16x16x32_bf16 a[92:95], a[180:183], a[228:231], a[92:95]
    v_cvt_pk_bf16_f32 v51, v54, v55
    s_waitcnt lgkmcnt(0)
    v_mfma_f32_16x16x32_bf16 v[96:99], a[152:155], a[184:187], v[96:99]
    ds_read_b128 a[168:171], v22 offset:22528
    s_add_u32 m0, s36, 32768
    v_mfma_f32_16x16x32_bf16 v[96:99], a[156:159], a[188:191], v[96:99]
    ds_read_b128 a[172:175], v23 offset:22528
    s_add_u32 s48, s38, 131072
    v_mfma_f32_16x16x32_bf16 v[96:99], a[160:163], a[208:211], v[96:99]
    ds_read_b128 a[176:179], v22 offset:30720
    buffer_load_dwordx4 v1, s[28:31], s48 offen offset:0 lds
    v_mfma_f32_16x16x32_bf16 v[96:99], a[164:167], a[212:215], v[96:99]
    ds_read_b128 a[180:183], v23 offset:30720
    v_fma_f32 v176, v176, s50, v14
    v_mfma_f32_16x16x32_bf16 v[224:227], a[152:155], a[192:195], v[224:227]
    v_exp_f32 v176, v176
    v_mfma_f32_16x16x32_bf16 v[224:227], a[156:159], a[196:199], v[224:227]
    v_fma_f32 v177, v177, s50, v14
    v_fma_f32 v178, v178, s50, v14
    v_mfma_f32_16x16x32_bf16 v[224:227], a[160:163], a[216:219], v[224:227]
    v_exp_f32 v177, v177
    v_mfma_f32_16x16x32_bf16 v[224:227], a[164:167], a[220:223], v[224:227]
    v_exp_f32 v178, v178
    v_mfma_f32_16x16x32_bf16 a[96:99], a[152:155], a[200:203], a[96:99]
    buffer_load_dwordx4 v2, s[28:31], s48 offen offset:1024 lds
    v_cvt_pk_bf16_f32 v176, v176, v177
    v_mfma_f32_16x16x32_bf16 a[96:99], a[156:159], a[204:207], a[96:99]
    v_fma_f32 v179, v179, s50, v14
    v_fma_f32 v180, v180, s50, v14
    v_mfma_f32_16x16x32_bf16 a[96:99], a[160:163], a[224:227], a[96:99]
    v_exp_f32 v179, v179
    v_mfma_f32_16x16x32_bf16 a[96:99], a[164:167], a[228:231], a[96:99]
    v_cvt_pk_bf16_f32 v177, v178, v179
    s_waitcnt lgkmcnt(0)
    v_mfma_f32_16x16x32_bf16 v[100:103], a[168:171], a[184:187], v[100:103]
    s_waitcnt vmcnt(18)
    s_barrier
    v_mfma_f32_16x16x32_bf16 v[100:103], a[172:175], a[188:191], v[100:103]
    ds_read_b128 a[152:155], v22 offset:32768
    v_fma_f32 v181, v181, s50, v14
    v_mfma_f32_16x16x32_bf16 v[100:103], a[176:179], a[208:211], v[100:103]
    ds_read_b128 a[156:159], v23 offset:32768
    v_fma_f32 v182, v182, s50, v14
    v_mfma_f32_16x16x32_bf16 v[100:103], a[180:183], a[212:215], v[100:103]
    ds_read_b128 a[160:163], v22 offset:40960
    buffer_load_dwordx4 v3, s[28:31], s48 offen offset:2048 lds
    v_mfma_f32_16x16x32_bf16 v[228:231], a[168:171], a[192:195], v[228:231]
    ds_read_b128 a[164:167], v23 offset:40960
    v_fma_f32 v183, v183, s50, v14
    v_mfma_f32_16x16x32_bf16 v[228:231], a[172:175], a[196:199], v[228:231]
    v_exp_f32 v180, v180
    v_mfma_f32_16x16x32_bf16 v[228:231], a[176:179], a[216:219], v[228:231]
    v_exp_f32 v181, v181
    v_mfma_f32_16x16x32_bf16 v[228:231], a[180:183], a[220:223], v[228:231]
    v_exp_f32 v182, v182
    v_mfma_f32_16x16x32_bf16 a[100:103], a[168:171], a[200:203], a[100:103]
    v_exp_f32 v183, v183
    v_mfma_f32_16x16x32_bf16 a[100:103], a[172:175], a[204:207], a[100:103]
    buffer_load_dwordx4 v4, s[28:31], s48 offen offset:3072 lds
    v_cvt_pk_bf16_f32 v178, v180, v181
    v_mfma_f32_16x16x32_bf16 a[100:103], a[176:179], a[224:227], a[100:103]
    v_cvt_pk_bf16_f32 v179, v182, v183
    v_fma_f32 v56, v56, s50, v12
    v_mfma_f32_16x16x32_bf16 a[100:103], a[180:183], a[228:231], a[100:103]
    v_fma_f32 v57, v57, s50, v12
    s_waitcnt lgkmcnt(0)
    v_mfma_f32_16x16x32_bf16 v[104:107], a[152:155], a[184:187], v[104:107]
    ds_read_b128 a[168:171], v22 offset:34816
    v_fma_f32 v58, v58, s50, v12
    v_mfma_f32_16x16x32_bf16 v[104:107], a[156:159], a[188:191], v[104:107]
    ds_read_b128 a[172:175], v23 offset:34816
    v_fma_f32 v59, v59, s50, v12
    v_mfma_f32_16x16x32_bf16 v[104:107], a[160:163], a[208:211], v[104:107]
    ds_read_b128 a[176:179], v22 offset:43008
    v_fma_f32 v60, v60, s50, v12
    v_mfma_f32_16x16x32_bf16 v[104:107], a[164:167], a[212:215], v[104:107]
    ds_read_b128 a[180:183], v23 offset:43008
    v_fma_f32 v61, v61, s50, v12
    v_mfma_f32_16x16x32_bf16 v[232:235], a[152:155], a[192:195], v[232:235]
    s_add_u32 m0, s36, 114688
    s_add_u32 s48, s38, 131200
    v_mfma_f32_16x16x32_bf16 v[232:235], a[156:159], a[196:199], v[232:235]
    buffer_load_dwordx4 v1, s[28:31], s48 offen offset:0 lds
    v_fma_f32 v62, v62, s50, v12
    v_mfma_f32_16x16x32_bf16 v[232:235], a[160:163], a[216:219], v[232:235]
    v_exp_f32 v56, v56
    v_mfma_f32_16x16x32_bf16 v[232:235], a[164:167], a[220:223], v[232:235]
    v_exp_f32 v57, v57
    v_mfma_f32_16x16x32_bf16 a[104:107], a[152:155], a[200:203], a[104:107]
    v_exp_f32 v58, v58
    v_mfma_f32_16x16x32_bf16 a[104:107], a[156:159], a[204:207], a[104:107]
    v_exp_f32 v59, v59
    v_mfma_f32_16x16x32_bf16 a[104:107], a[160:163], a[224:227], a[104:107]
    v_exp_f32 v60, v60
    v_mfma_f32_16x16x32_bf16 a[104:107], a[164:167], a[228:231], a[104:107]
    buffer_load_dwordx4 v2, s[28:31], s48 offen offset:1024 lds
    s_waitcnt lgkmcnt(0)
    v_mfma_f32_16x16x32_bf16 v[108:111], a[168:171], a[184:187], v[108:111]
    ds_read_b128 a[152:155], v22 offset:36864
    v_cvt_pk_bf16_f32 v56, v56, v57
    v_mfma_f32_16x16x32_bf16 v[108:111], a[172:175], a[188:191], v[108:111]
    ds_read_b128 a[156:159], v23 offset:36864
    v_cvt_pk_bf16_f32 v57, v58, v59
    v_mfma_f32_16x16x32_bf16 v[108:111], a[176:179], a[208:211], v[108:111]
    ds_read_b128 a[160:163], v22 offset:45056
    v_fma_f32 v63, v63, s50, v12
    v_mfma_f32_16x16x32_bf16 v[108:111], a[180:183], a[212:215], v[108:111]
    ds_read_b128 a[164:167], v23 offset:45056
    v_fma_f32 v184, v184, s50, v14
    v_mfma_f32_16x16x32_bf16 v[236:239], a[168:171], a[192:195], v[236:239]
    v_exp_f32 v61, v61
    v_mfma_f32_16x16x32_bf16 v[236:239], a[172:175], a[196:199], v[236:239]
    v_exp_f32 v62, v62
    v_mfma_f32_16x16x32_bf16 v[236:239], a[176:179], a[216:219], v[236:239]
    buffer_load_dwordx4 v3, s[28:31], s48 offen offset:2048 lds
    v_cvt_pk_bf16_f32 v58, v60, v61
    v_mfma_f32_16x16x32_bf16 v[236:239], a[180:183], a[220:223], v[236:239]
    v_exp_f32 v63, v63
    v_mfma_f32_16x16x32_bf16 a[108:111], a[168:171], a[200:203], a[108:111]
    v_exp_f32 v184, v184
    v_mfma_f32_16x16x32_bf16 a[108:111], a[172:175], a[204:207], a[108:111]
    v_cvt_pk_bf16_f32 v59, v62, v63
    v_fma_f32 v185, v185, s50, v14
    v_mfma_f32_16x16x32_bf16 a[108:111], a[176:179], a[224:227], a[108:111]
    v_exp_f32 v185, v185
    v_mfma_f32_16x16x32_bf16 a[108:111], a[180:183], a[228:231], a[108:111]
    v_cvt_pk_bf16_f32 v184, v184, v185
    s_waitcnt lgkmcnt(0)
    v_mfma_f32_16x16x32_bf16 v[112:115], a[152:155], a[184:187], v[112:115]
    ds_read_b128 a[168:171], v22 offset:38912
    buffer_load_dwordx4 v4, s[28:31], s48 offen offset:3072 lds
    v_mfma_f32_16x16x32_bf16 v[112:115], a[156:159], a[188:191], v[112:115]
    ds_read_b128 a[172:175], v23 offset:38912
    v_fma_f32 v186, v186, s50, v14
    v_mfma_f32_16x16x32_bf16 v[112:115], a[160:163], a[208:211], v[112:115]
    ds_read_b128 a[176:179], v22 offset:47104
    v_fma_f32 v187, v187, s50, v14
    v_mfma_f32_16x16x32_bf16 v[112:115], a[164:167], a[212:215], v[112:115]
    ds_read_b128 a[180:183], v23 offset:47104
    v_fma_f32 v188, v188, s50, v14
    v_mfma_f32_16x16x32_bf16 v[240:243], a[152:155], a[192:195], v[240:243]
    v_exp_f32 v186, v186
    v_mfma_f32_16x16x32_bf16 v[240:243], a[156:159], a[196:199], v[240:243]
    v_exp_f32 v187, v187
    v_mfma_f32_16x16x32_bf16 v[240:243], a[160:163], a[216:219], v[240:243]
    v_exp_f32 v188, v188
    v_mfma_f32_16x16x32_bf16 v[240:243], a[164:167], a[220:223], v[240:243]
L_pad2:
    s_cbranch_execz L_pad6
    s_add_u32 m0, s36, 49152
    s_add_u32 s48, s38, 196608
    v_mfma_f32_16x16x32_bf16 a[112:115], a[152:155], a[200:203], a[112:115]
    buffer_load_dwordx4 v1, s[28:31], s48 offen offset:0 lds
    v_cvt_pk_bf16_f32 v185, v186, v187
    v_mfma_f32_16x16x32_bf16 a[112:115], a[156:159], a[204:207], a[112:115]
    v_fma_f32 v189, v189, s50, v14
    v_fma_f32 v190, v190, s50, v14
    v_mfma_f32_16x16x32_bf16 a[112:115], a[160:163], a[224:227], a[112:115]
    v_exp_f32 v189, v189
    v_mfma_f32_16x16x32_bf16 a[112:115], a[164:167], a[228:231], a[112:115]
    v_cvt_pk_bf16_f32 v186, v188, v189
    s_waitcnt lgkmcnt(0)
    v_mfma_f32_16x16x32_bf16 v[116:119], a[168:171], a[184:187], v[116:119]
    s_waitcnt vmcnt(21)
    s_barrier
    v_mfma_f32_16x16x32_bf16 v[116:119], a[172:175], a[188:191], v[116:119]
    ds_read_b128 a[152:155], v20 offset:0
    v_fma_f32 v191, v191, s50, v14
    v_mfma_f32_16x16x32_bf16 v[116:119], a[176:179], a[208:211], v[116:119]
    ds_read_b128 a[156:159], v21 offset:0
    buffer_load_dwordx4 v2, s[28:31], s48 offen offset:1024 lds
    v_mfma_f32_16x16x32_bf16 v[116:119], a[180:183], a[212:215], v[116:119]
    ds_read_b128 a[160:163], v20 offset:8192
    v_fma_f32 v64, v64, s50, v12
    v_mfma_f32_16x16x32_bf16 v[244:247], a[168:171], a[192:195], v[244:247]
    ds_read_b128 a[164:167], v21 offset:8192
    v_fma_f32 v65, v65, s50, v12
    v_mfma_f32_16x16x32_bf16 v[244:247], a[172:175], a[196:199], v[244:247]
    v_exp_f32 v190, v190
    v_mfma_f32_16x16x32_bf16 v[244:247], a[176:179], a[216:219], v[244:247]
    v_exp_f32 v191, v191
    v_mfma_f32_16x16x32_bf16 v[244:247], a[180:183], a[220:223], v[244:247]
    v_exp_f32 v64, v64
    v_mfma_f32_16x16x32_bf16 a[116:119], a[168:171], a[200:203], a[116:119]
    v_exp_f32 v65, v65
    v_mfma_f32_16x16x32_bf16 a[116:119], a[172:175], a[204:207], a[116:119]
    buffer_load_dwordx4 v3, s[28:31], s48 offen offset:2048 lds
    v_cvt_pk_bf16_f32 v187, v190, v191
    v_mfma_f32_16x16x32_bf16 a[116:119], a[176:179], a[224:227], a[116:119]
    v_cvt_pk_bf16_f32 v64, v64, v65
    v_fma_f32 v66, v66, s50, v12
    v_mfma_f32_16x16x32_bf16 a[116:119], a[180:183], a[228:231], a[116:119]
    v_fma_f32 v67, v67, s50, v12
    s_waitcnt lgkmcnt(0)
    v_mfma_f32_16x16x32_bf16 v[120:123], a[152:155], a[184:187], v[120:123]
    ds_read_b128 a[168:171], v20 offset:2048
    v_fma_f32 v68, v68, s50, v12
    v_mfma_f32_16x16x32_bf16 v[120:123], a[156:159], a[188:191], v[120:123]
    ds_read_b128 a[172:175], v21 offset:2048
    v_fma_f32 v69, v69, s50, v12
    v_mfma_f32_16x16x32_bf16 v[120:123], a[160:163], a[208:211], v[120:123]
    ds_read_b128 a[176:179], v20 offset:10240
    v_fma_f32 v70, v70, s50, v12
    v_mfma_f32_16x16x32_bf16 v[120:123], a[164:167], a[212:215], v[120:123]
    ds_read_b128 a[180:183], v21 offset:10240
    buffer_load_dwordx4 v4, s[28:31], s48 offen offset:3072 lds
    v_mfma_f32_16x16x32_bf16 v[248:251], a[152:155], a[192:195], v[248:251]
    v_exp_f32 v66, v66
    v_mfma_f32_16x16x32_bf16 v[248:251], a[156:159], a[196:199], v[248:251]
    v_exp_f32 v67, v67
    v_mfma_f32_16x16x32_bf16 v[248:251], a[160:163], a[216:219], v[248:251]
    v_exp_f32 v68, v68
    v_mfma_f32_16x16x32_bf16 v[248:251], a[164:167], a[220:223], v[248:251]
    v_exp_f32 v69, v69
    v_mfma_f32_16x16x32_bf16 a[120:123], a[152:155], a[200:203], a[120:123]
    v_exp_f32 v70, v70
    v_mfma_f32_16x16x32_bf16 a[120:123], a[156:159], a[204:207], a[120:123]
    v_cvt_pk_bf16_f32 v65, v66, v67
    v_cvt_pk_bf16_f32 v66, v68, v69
    v_mfma_f32_16x16x32_bf16 a[120:123], a[160:163], a[224:227], a[120:123]
    s_add_u32 m0, s36, 65536
    s_add_u32 s48, s38, 128
    v_mfma_f32_16x16x32_bf16 a[120:123], a[164:167], a[228:231], a[120:123]
    buffer_load_dwordx4 v1, s[28:31], s48 offen offset:0 lds
    s_waitcnt lgkmcnt(0)
    v_mfma_f32_16x16x32_bf16 v[124:127], a[168:171], a[184:187], v[124:127]
    ds_read_b128 a[152:155], v20 offset:4096
    v_fma_f32 v71, v71, s50, v12
    v_mfma_f32_16x16x32_bf16 v[124:127], a[172:175], a[188:191], v[124:127]
    ds_read_b128 a[156:159], v21 offset:4096
    v_fma_f32 v192, v192, s50, v14
    v_mfma_f32_16x16x32_bf16 v[124:127], a[176:179], a[208:211], v[124:127]
    ds_read_b128 a[160:163], v20 offset:12288
    v_fma_f32 v193, v193, s50, v14
    v_mfma_f32_16x16x32_bf16 v[124:127], a[180:183], a[212:215], v[124:127]
    ds_read_b128 a[164:167], v21 offset:12288
    v_fma_f32 v194, v194, s50, v14
    v_mfma_f32_16x16x32_bf16 v[252:255], a[168:171], a[192:195], v[252:255]
    v_exp_f32 v71, v71
    v_mfma_f32_16x16x32_bf16 v[252:255], a[172:175], a[196:199], v[252:255]
    buffer_load_dwordx4 v2, s[28:31], s48 offen offset:1024 lds
    v_cvt_pk_bf16_f32 v67, v70, v71
    v_mfma_f32_16x16x32_bf16 v[252:255], a[176:179], a[216:219], v[252:255]
    v_exp_f32 v192, v192
    v_mfma_f32_16x16x32_bf16 v[252:255], a[180:183], a[220:223], v[252:255]
    v_exp_f32 v193, v193
    v_mfma_f32_16x16x32_bf16 a[124:127], a[168:171], a[200:203], a[124:127]
    v_exp_f32 v194, v194
    v_mfma_f32_16x16x32_bf16 a[124:127], a[172:175], a[204:207], a[124:127]
    v_cvt_pk_bf16_f32 v192, v192, v193
    v_fma_f32 v195, v195, s50, v14
    v_mfma_f32_16x16x32_bf16 a[124:127], a[176:179], a[224:227], a[124:127]
    v_exp_f32 v195, v195
    v_mfma_f32_16x16x32_bf16 a[124:127], a[180:183], a[228:231], a[124:127]
    v_cvt_pk_bf16_f32 v193, v194, v195
    s_waitcnt lgkmcnt(0)
    v_mfma_f32_16x16x32_bf16 v[128:131], a[152:155], a[184:187], v[128:131]
    ds_read_b128 a[168:171], v20 offset:6144
    buffer_load_dwordx4 v3, s[28:31], s48 offen offset:2048 lds
    v_mfma_f32_16x16x32_bf16 v[128:131], a[156:159], a[188:191], v[128:131]
    ds_read_b128 a[172:175], v21 offset:6144
    v_fma_f32 v196, v196, s50, v14
    v_mfma_f32_16x16x32_bf16 v[128:131], a[160:163], a[208:211], v[128:131]
    ds_read_b128 a[176:179], v20 offset:14336
    v_fma_f32 v197, v197, s50, v14
    v_mfma_f32_16x16x32_bf16 v[128:131], a[164:167], a[212:215], v[128:131]
    ds_read_b128 a[180:183], v21 offset:14336
    v_fma_f32 v198, v198, s50, v14
    v_mfma_f32_16x16x32_bf16 a[0:3], a[152:155], a[192:195], a[0:3]
    v_exp_f32 v196, v196
    v_mfma_f32_16x16x32_bf16 a[0:3], a[156:159], a[196:199], a[0:3]
    v_exp_f32 v197, v197
    v_mfma_f32_16x16x32_bf16 a[0:3], a[160:163], a[216:219], a[0:3]
    buffer_load_dwordx4 v4, s[28:31], s48 offen offset:3072 lds
    v_cvt_pk_bf16_f32 v194, v196, v197
    v_mfma_f32_16x16x32_bf16 a[0:3], a[164:167], a[220:223], a[0:3]
    v_exp_f32 v198, v198
    v_mfma_f32_16x16x32_bf16 a[128:131], a[152:155], a[200:203], a[128:131]
    v_fma_f32 v199, v199, s50, v14
    v_fma_f32 v72, v72, s50, v12
    v_mfma_f32_16x16x32_bf16 a[128:131], a[156:159], a[204:207], a[128:131]
    v_exp_f32 v199, v199
    v_mfma_f32_16x16x32_bf16 a[128:131], a[160:163], a[224:227], a[128:131]
    v_exp_f32 v72, v72
    v_mfma_f32_16x16x32_bf16 a[128:131], a[164:167], a[228:231], a[128:131]
    v_cvt_pk_bf16_f32 v195, v198, v199
    s_waitcnt lgkmcnt(0)
    v_mfma_f32_16x16x32_bf16 v[132:135], a[168:171], a[184:187], v[132:135]
    s_waitcnt vmcnt(24)
    s_barrier
    v_mfma_f32_16x16x32_bf16 v[132:135], a[172:175], a[188:191], v[132:135]
    ds_read_b128 a[152:155], v20 offset:16384
    s_add_u32 m0, s36, 81920
    v_mfma_f32_16x16x32_bf16 v[132:135], a[176:179], a[208:211], v[132:135]
    ds_read_b128 a[156:159], v21 offset:16384
    s_add_u32 s48, s38, 65664
    v_mfma_f32_16x16x32_bf16 v[132:135], a[180:183], a[212:215], v[132:135]
    ds_read_b128 a[160:163], v20 offset:24576
    buffer_load_dwordx4 v1, s[28:31], s48 offen offset:0 lds
    v_mfma_f32_16x16x32_bf16 a[4:7], a[168:171], a[192:195], a[4:7]
    ds_read_b128 a[164:167], v21 offset:24576
    v_fma_f32 v73, v73, s50, v12
    v_mfma_f32_16x16x32_bf16 a[4:7], a[172:175], a[196:199], a[4:7]
    v_exp_f32 v73, v73
    v_mfma_f32_16x16x32_bf16 a[4:7], a[176:179], a[216:219], a[4:7]
    v_cvt_pk_bf16_f32 v72, v72, v73
    v_fma_f32 v74, v74, s50, v12
    v_mfma_f32_16x16x32_bf16 a[4:7], a[180:183], a[220:223], a[4:7]
    v_exp_f32 v74, v74
    v_mfma_f32_16x16x32_bf16 a[132:135], a[168:171], a[200:203], a[132:135]
    v_fma_f32 v75, v75, s50, v12
    v_fma_f32 v76, v76, s50, v12
    v_mfma_f32_16x16x32_bf16 a[132:135], a[172:175], a[204:207], a[132:135]
    buffer_load_dwordx4 v2, s[28:31], s48 offen offset:1024 lds
    v_fma_f32 v77, v77, s50, v12
    v_mfma_f32_16x16x32_bf16 a[132:135], a[176:179], a[224:227], a[132:135]
    v_exp_f32 v75, v75
    v_mfma_f32_16x16x32_bf16 a[132:135], a[180:183], a[228:231], a[132:135]
    v_cvt_pk_bf16_f32 v73, v74, v75
    s_waitcnt lgkmcnt(0)
    v_mfma_f32_16x16x32_bf16 v[136:139], a[152:155], a[184:187], v[136:139]
    ds_read_b128 a[168:171], v20 offset:18432
    v_fma_f32 v78, v78, s50, v12
    v_mfma_f32_16x16x32_bf16 v[136:139], a[156:159], a[188:191], v[136:139]
    ds_read_b128 a[172:175], v21 offset:18432
    v_fma_f32 v79, v79, s50, v12
    v_mfma_f32_16x16x32_bf16 v[136:139], a[160:163], a[208:211], v[136:139]
    ds_read_b128 a[176:179], v20 offset:26624
    v_fma_f32 v200, v200, s50, v14
    v_mfma_f32_16x16x32_bf16 v[136:139], a[164:167], a[212:215], v[136:139]
    ds_read_b128 a[180:183], v21 offset:26624
    v_fma_f32 v201, v201, s50, v14
    v_mfma_f32_16x16x32_bf16 a[8:11], a[152:155], a[192:195], a[8:11]
    buffer_load_dwordx4 v3, s[28:31], s48 offen offset:2048 lds
    v_fma_f32 v202, v202, s50, v14
    v_mfma_f32_16x16x32_bf16 a[8:11], a[156:159], a[196:199], a[8:11]
    v_exp_f32 v76, v76
    v_mfma_f32_16x16x32_bf16 a[8:11], a[160:163], a[216:219], a[8:11]
    v_exp_f32 v77, v77
    v_mfma_f32_16x16x32_bf16 a[8:11], a[164:167], a[220:223], a[8:11]
    v_exp_f32 v78, v78
    v_mfma_f32_16x16x32_bf16 a[136:139], a[152:155], a[200:203], a[136:139]
    v_exp_f32 v79, v79
    v_mfma_f32_16x16x32_bf16 a[136:139], a[156:159], a[204:207], a[136:139]
    v_exp_f32 v200, v200
    v_mfma_f32_16x16x32_bf16 a[136:139], a[160:163], a[224:227], a[136:139]
    buffer_load_dwordx4 v4, s[28:31], s48 offen offset:3072 lds
    v_cvt_pk_bf16_f32 v74, v76, v77
    v_mfma_f32_16x16x32_bf16 a[136:139], a[164:167], a[228:231], a[136:139]
    v_cvt_pk_bf16_f32 v75, v78, v79
    s_waitcnt lgkmcnt(0)
    v_mfma_f32_16x16x32_bf16 v[140:143], a[168:171], a[184:187], v[140:143]
    ds_read_b128 a[152:155], v20 offset:20480
    v_fma_f32 v203, v203, s50, v14
    v_mfma_f32_16x16x32_bf16 v[140:143], a[172:175], a[188:191], v[140:143]
    ds_read_b128 a[156:159], v21 offset:20480
    v_fma_f32 v204, v204, s50, v14
    v_mfma_f32_16x16x32_bf16 v[140:143], a[176:179], a[208:211], v[140:143]
    ds_read_b128 a[160:163], v20 offset:28672
    v_fma_f32 v205, v205, s50, v14
    v_mfma_f32_16x16x32_bf16 v[140:143], a[180:183], a[212:215], v[140:143]
    ds_read_b128 a[164:167], v21 offset:28672
    v_fma_f32 v206, v206, s50, v14
    v_mfma_f32_16x16x32_bf16 a[12:15], a[168:171], a[192:195], a[12:15]
    v_exp_f32 v201, v201
    v_mfma_f32_16x16x32_bf16 a[12:15], a[172:175], a[196:199], a[12:15]
    s_add_u32 m0, s36, 98304
    s_add_u32 s48, s38, 196736
    v_mfma_f32_16x16x32_bf16 a[12:15], a[176:179], a[216:219], a[12:15]
    buffer_load_dwordx4 v1, s[28:31], s48 offen offset:0 lds
    v_cvt_pk_bf16_f32 v200, v200, v201
    v_mfma_f32_16x16x32_bf16 a[12:15], a[180:183], a[220:223], a[12:15]
    v_exp_f32 v202, v202
    v_mfma_f32_16x16x32_bf16 a[140:143], a[168:171], a[200:203], a[140:143]
    v_exp_f32 v203, v203
    v_mfma_f32_16x16x32_bf16 a[140:143], a[172:175], a[204:207], a[140:143]
    v_exp_f32 v204, v204
    v_mfma_f32_16x16x32_bf16 a[140:143], a[176:179], a[224:227], a[140:143]
    v_exp_f32 v205, v205
    v_mfma_f32_16x16x32_bf16 a[140:143], a[180:183], a[228:231], a[140:143]
    v_cvt_pk_bf16_f32 v201, v202, v203
    s_waitcnt lgkmcnt(0)
    v_mfma_f32_16x16x32_bf16 v[144:147], a[152:155], a[184:187], v[144:147]
    ds_read_b128 a[168:171], v20 offset:22528
    buffer_load_dwordx4 v2, s[28:31], s48 offen offset:1024 lds
    v_mfma_f32_16x16x32_bf16 v[144:147], a[156:159], a[188:191], v[144:147]
    ds_read_b128 a[172:175], v21 offset:22528
    v_cvt_pk_bf16_f32 v202, v204, v205
    v_mfma_f32_16x16x32_bf16 v[144:147], a[160:163], a[208:211], v[144:147]
    ds_read_b128 a[176:179], v20 offset:30720
    v_fma_f32 v207, v207, s50, v14
    v_mfma_f32_16x16x32_bf16 v[144:147], a[164:167], a[212:215], v[144:147]
    ds_read_b128 a[180:183], v21 offset:30720
    v_fma_f32 v80, v80, s50, v12
    v_mfma_f32_16x16x32_bf16 a[16:19], a[152:155], a[192:195], a[16:19]
    v_exp_f32 v206, v206
    v_mfma_f32_16x16x32_bf16 a[16:19], a[156:159], a[196:199], a[16:19]
    v_exp_f32 v207, v207
    v_mfma_f32_16x16x32_bf16 a[16:19], a[160:163], a[216:219], a[16:19]
    v_exp_f32 v80, v80
    v_mfma_f32_16x16x32_bf16 a[16:19], a[164:167], a[220:223], a[16:19]
    buffer_load_dwordx4 v3, s[28:31], s48 offen offset:2048 lds
    v_cvt_pk_bf16_f32 v203, v206, v207
    v_mfma_f32_16x16x32_bf16 a[144:147], a[152:155], a[200:203], a[144:147]
    v_fma_f32 v81, v81, s50, v12
    v_fma_f32 v82, v82, s50, v12
    v_mfma_f32_16x16x32_bf16 a[144:147], a[156:159], a[204:207], a[144:147]
    v_exp_f32 v81, v81
    v_mfma_f32_16x16x32_bf16 a[144:147], a[160:163], a[224:227], a[144:147]
    v_exp_f32 v82, v82
    v_mfma_f32_16x16x32_bf16 a[144:147], a[164:167], a[228:231], a[144:147]
    v_cvt_pk_bf16_f32 v80, v80, v81
    s_waitcnt lgkmcnt(0)
    v_mfma_f32_16x16x32_bf16 v[148:151], a[168:171], a[184:187], v[148:151]
    v_fma_f32 v83, v83, s50, v12
    v_fma_f32 v84, v84, s50, v12
    v_mfma_f32_16x16x32_bf16 v[148:151], a[172:175], a[188:191], v[148:151]
    buffer_load_dwordx4 v4, s[28:31], s48 offen offset:3072 lds
    v_fma_f32 v85, v85, s50, v12
    v_mfma_f32_16x16x32_bf16 v[148:151], a[176:179], a[208:211], v[148:151]
    v_exp_f32 v83, v83
    v_mfma_f32_16x16x32_bf16 v[148:151], a[180:183], a[212:215], v[148:151]
    v_exp_f32 v84, v84
    v_mfma_f32_16x16x32_bf16 a[20:23], a[168:171], a[192:195], a[20:23]
    v_exp_f32 v85, v85
    v_mfma_f32_16x16x32_bf16 a[20:23], a[172:175], a[196:199], a[20:23]
    v_cvt_pk_bf16_f32 v81, v82, v83
    v_cvt_pk_bf16_f32 v82, v84, v85
    v_mfma_f32_16x16x32_bf16 a[20:23], a[176:179], a[216:219], a[20:23]
    v_fma_f32 v86, v86, s50, v12
    v_fma_f32 v87, v87, s50, v12
    v_mfma_f32_16x16x32_bf16 a[20:23], a[180:183], a[220:223], a[20:23]
    v_exp_f32 v86, v86
    v_mfma_f32_16x16x32_bf16 a[148:151], a[168:171], a[200:203], a[148:151]
    v_exp_f32 v87, v87
    v_mfma_f32_16x16x32_bf16 a[148:151], a[172:175], a[204:207], a[148:151]
    v_cvt_pk_bf16_f32 v83, v86, v87
    v_fma_f32 v208, v208, s50, v14
    v_mfma_f32_16x16x32_bf16 a[148:151], a[176:179], a[224:227], a[148:151]
    v_exp_f32 v208, v208
    v_mfma_f32_16x16x32_bf16 a[148:151], a[180:183], a[228:231], a[148:151]
    v_fma_f32 v209, v209, s50, v14
    v_fma_f32 v210, v210, s50, v14
    v_fma_f32 v211, v211, s50, v14
    v_fma_f32 v212, v212, s50, v14
    v_fma_f32 v213, v213, s50, v14
    v_fma_f32 v214, v214, s50, v14
    v_fma_f32 v215, v215, s50, v14
    v_exp_f32 v209, v209
    v_exp_f32 v210, v210
    v_exp_f32 v211, v211
    v_exp_f32 v212, v212
    v_exp_f32 v213, v213
    v_exp_f32 v214, v214
    v_exp_f32 v215, v215
    v_cvt_pk_bf16_f32 v208, v208, v209
    v_cvt_pk_bf16_f32 v209, v210, v211
    v_cvt_pk_bf16_f32 v210, v212, v213
    v_cvt_pk_bf16_f32 v211, v214, v215
    v_pk_fma_f32 v[88:89], v[88:89], s[50:51], v[12:13] op_sel_hi:[1,1,0]
    v_pk_fma_f32 v[90:91], v[90:91], s[50:51], v[12:13] op_sel_hi:[1,1,0]
    v_pk_fma_f32 v[92:93], v[92:93], s[50:51], v[12:13] op_sel_hi:[1,1,0]
    v_pk_fma_f32 v[94:95], v[94:95], s[50:51], v[12:13] op_sel_hi:[1,1,0]
    v_exp_f32 v88, v88
    v_exp_f32 v89, v89
    v_mfma_f32_16x16x32_bf16 a[236:239], a[232:235], v[24:27], 0
    v_accvgpr_read_b32 v16, a0
    v_accvgpr_read_b32 v17, a1
    v_exp_f32 v90, v90
    v_exp_f32 v91, v91
    v_mfma_f32_16x16x32_bf16 a[240:243], a[232:235], v[152:155], 0
    v_accvgpr_read_b32 v18, a2
    v_accvgpr_read_b32 v19, a3
    v_exp_f32 v92, v92
    v_exp_f32 v93, v93
    v_accvgpr_read_b32 v20, a4
    v_accvgpr_read_b32 v21, a5
    v_exp_f32 v94, v94
    v_exp_f32 v95, v95
    v_accvgpr_read_b32 v22, a6
    v_accvgpr_read_b32 v23, a7
    v_pk_fma_f32 v[96:97], v[96:97], s[50:51], v[12:13] op_sel_hi:[1,1,0]
    v_pk_fma_f32 v[98:99], v[98:99], s[50:51], v[12:13] op_sel_hi:[1,1,0]
    v_pk_fma_f32 v[100:101], v[100:101], s[50:51], v[12:13] op_sel_hi:[1,1,0]
    v_pk_fma_f32 v[102:103], v[102:103], s[50:51], v[12:13] op_sel_hi:[1,1,0]
    v_exp_f32 v96, v96
    v_exp_f32 v97, v97
    v_mfma_f32_16x16x32_bf16 a[236:239], a[232:235], v[32:35], a[236:239]
    s_waitcnt vmcnt(24)
    s_barrier
    v_cvt_pk_bf16_f32 v88, v88, v89
    v_cvt_pk_bf16_f32 v89, v90, v91
    v_exp_f32 v98, v98
    v_exp_f32 v99, v99
    v_mfma_f32_16x16x32_bf16 a[240:243], a[232:235], v[160:163], a[240:243]
    v_cvt_pk_bf16_f32 v90, v92, v93
    v_cvt_pk_bf16_f32 v91, v94, v95
    v_accvgpr_read_b32 v28, a8
    v_accvgpr_read_b32 v29, a9
    v_exp_f32 v100, v100
    v_exp_f32 v101, v101
    v_accvgpr_read_b32 v30, a10
    v_accvgpr_read_b32 v31, a11
    v_accvgpr_read_b32 v156, a12
    v_accvgpr_read_b32 v157, a13
    v_exp_f32 v102, v102
    v_exp_f32 v103, v103
    v_accvgpr_read_b32 v158, a14
    v_accvgpr_read_b32 v159, a15
    v_pk_fma_f32 v[104:105], v[104:105], s[50:51], v[12:13] op_sel_hi:[1,1,0]
    v_pk_fma_f32 v[106:107], v[106:107], s[50:51], v[12:13] op_sel_hi:[1,1,0]
    v_pk_fma_f32 v[108:109], v[108:109], s[50:51], v[12:13] op_sel_hi:[1,1,0]
    v_pk_fma_f32 v[110:111], v[110:111], s[50:51], v[12:13] op_sel_hi:[1,1,0]
    v_exp_f32 v104, v104
    v_exp_f32 v105, v105
    v_mfma_f32_16x16x32_bf16 a[236:239], a[232:235], v[40:43], a[236:239]
    s_add_u32 m0, s36, 0
    s_add_u32 s48, s38, 256
    buffer_load_dwordx4 v1, s[28:31], s48 offen offset:0 lds
    v_cvt_pk_bf16_f32 v96, v96, v97
    v_exp_f32 v106, v106
    v_exp_f32 v107, v107
    v_mfma_f32_16x16x32_bf16 a[240:243], a[232:235], v[168:171], a[240:243]
    v_cvt_pk_bf16_f32 v97, v98, v99
    v_cvt_pk_bf16_f32 v98, v100, v101
    v_cvt_pk_bf16_f32 v99, v102, v103
    v_accvgpr_read_b32 v36, a16
    v_exp_f32 v108, v108
    v_exp_f32 v109, v109
    v_accvgpr_read_b32 v37, a17
    v_accvgpr_read_b32 v38, a18
    v_accvgpr_read_b32 v39, a19
    v_accvgpr_read_b32 v164, a20
    v_exp_f32 v110, v110
    v_exp_f32 v111, v111
    v_accvgpr_read_b32 v165, a21
    v_accvgpr_read_b32 v166, a22
    v_accvgpr_read_b32 v167, a23
    v_pk_fma_f32 v[112:113], v[112:113], s[50:51], v[12:13] op_sel_hi:[1,1,0]
    v_pk_fma_f32 v[114:115], v[114:115], s[50:51], v[12:13] op_sel_hi:[1,1,0]
    v_pk_fma_f32 v[116:117], v[116:117], s[50:51], v[12:13] op_sel_hi:[1,1,0]
    v_pk_fma_f32 v[118:119], v[118:119], s[50:51], v[12:13] op_sel_hi:[1,1,0]
    v_exp_f32 v112, v112
    v_exp_f32 v113, v113
    v_mfma_f32_16x16x32_bf16 a[236:239], a[232:235], v[48:51], a[236:239]
    buffer_load_dwordx4 v2, s[28:31], s48 offen offset:1024 lds
    v_cvt_pk_bf16_f32 v104, v104, v105
    v_cvt_pk_bf16_f32 v105, v106, v107
    v_cvt_pk_bf16_f32 v106, v108, v109
    v_exp_f32 v114, v114
    v_exp_f32 v115, v115
    v_mfma_f32_16x16x32_bf16 a[240:243], a[232:235], v[176:179], a[240:243]
    v_cvt_pk_bf16_f32 v107, v110, v111
    v_accvgpr_read_b32 v44, a24
    v_accvgpr_read_b32 v45, a25
    v_accvgpr_read_b32 v46, a26
    v_exp_f32 v116, v116
    v_exp_f32 v117, v117
    v_accvgpr_read_b32 v47, a27
    v_accvgpr_read_b32 v172, a28
    v_accvgpr_read_b32 v173, a29
    v_accvgpr_read_b32 v174, a30
    v_exp_f32 v118, v118
    v_exp_f32 v119, v119
    v_accvgpr_read_b32 v175, a31
    v_pk_fma_f32 v[120:121], v[120:121], s[50:51], v[12:13] op_sel_hi:[1,1,0]
    v_pk_fma_f32 v[122:123], v[122:123], s[50:51], v[12:13] op_sel_hi:[1,1,0]
    v_pk_fma_f32 v[124:125], v[124:125], s[50:51], v[12:13] op_sel_hi:[1,1,0]
    v_pk_fma_f32 v[126:127], v[126:127], s[50:51], v[12:13] op_sel_hi:[1,1,0]
    v_exp_f32 v120, v120
    v_exp_f32 v121, v121
    v_mfma_f32_16x16x32_bf16 a[236:239], a[232:235], v[56:59], a[236:239]
    buffer_load_dwordx4 v3, s[28:31], s48 offen offset:2048 lds
    v_cvt_pk_bf16_f32 v112, v112, v113
    v_cvt_pk_bf16_f32 v113, v114, v115
    v_cvt_pk_bf16_f32 v114, v116, v117
    v_exp_f32 v122, v122
    v_exp_f32 v123, v123
    v_mfma_f32_16x16x32_bf16 a[240:243], a[232:235], v[184:187], a[240:243]
    v_cvt_pk_bf16_f32 v115, v118, v119
    v_accvgpr_read_b32 v52, a32
    v_accvgpr_read_b32 v53, a33
    v_accvgpr_read_b32 v54, a34
    v_exp_f32 v124, v124
    v_exp_f32 v125, v125
    v_accvgpr_read_b32 v55, a35
    v_accvgpr_read_b32 v180, a36
    v_accvgpr_read_b32 v181, a37
    v_accvgpr_read_b32 v182, a38
    v_exp_f32 v126, v126
    v_exp_f32 v127, v127
    v_accvgpr_read_b32 v183, a39
    v_pk_fma_f32 v[128:129], v[128:129], s[50:51], v[12:13] op_sel_hi:[1,1,0]
    v_pk_fma_f32 v[130:131], v[130:131], s[50:51], v[12:13] op_sel_hi:[1,1,0]
    v_pk_fma_f32 v[132:133], v[132:133], s[50:51], v[12:13] op_sel_hi:[1,1,0]
    v_pk_fma_f32 v[134:135], v[134:135], s[50:51], v[12:13] op_sel_hi:[1,1,0]
    v_exp_f32 v128, v128
    v_exp_f32 v129, v129
    v_mfma_f32_16x16x32_bf16 a[236:239], a[232:235], v[64:67], a[236:239]
    buffer_load_dwordx4 v4, s[28:31], s48 offen offset:3072 lds
    v_cvt_pk_bf16_f32 v120, v120, v121
    v_cvt_pk_bf16_f32 v121, v122, v123
    v_cvt_pk_bf16_f32 v122, v124, v125
    v_exp_f32 v130, v130
    v_exp_f32 v131, v131
    v_mfma_f32_16x16x32_bf16 a[240:243], a[232:235], v[192:195], a[240:243]
    v_cvt_pk_bf16_f32 v123, v126, v127
    v_accvgpr_read_b32 v60, a40
    v_accvgpr_read_b32 v61, a41
    v_accvgpr_read_b32 v62, a42
    v_exp_f32 v132, v132
    v_exp_f32 v133, v133
    v_accvgpr_read_b32 v63, a43
    v_accvgpr_read_b32 v188, a44
    v_accvgpr_read_b32 v189, a45
    v_accvgpr_read_b32 v190, a46
    v_exp_f32 v134, v134
    v_exp_f32 v135, v135
    v_accvgpr_read_b32 v191, a47
    v_pk_fma_f32 v[136:137], v[136:137], s[50:51], v[12:13] op_sel_hi:[1,1,0]
    v_pk_fma_f32 v[138:139], v[138:139], s[50:51], v[12:13] op_sel_hi:[1,1,0]
    v_pk_fma_f32 v[140:141], v[140:141], s[50:51], v[12:13] op_sel_hi:[1,1,0]
    v_pk_fma_f32 v[142:143], v[142:143], s[50:51], v[12:13] op_sel_hi:[1,1,0]
    v_exp_f32 v136, v136
    v_exp_f32 v137, v137
    v_mfma_f32_16x16x32_bf16 a[236:239], a[232:235], v[72:75], a[236:239]
    s_add_u32 m0, s36, 16384
    s_add_u32 s48, s38, 65792
    buffer_load_dwordx4 v1, s[28:31], s48 offen offset:0 lds
    v_cvt_pk_bf16_f32 v128, v128, v129
    v_exp_f32 v138, v138
    v_exp_f32 v139, v139
    v_mfma_f32_16x16x32_bf16 a[240:243], a[232:235], v[200:203], a[240:243]
    v_cvt_pk_bf16_f32 v129, v130, v131
    v_cvt_pk_bf16_f32 v130, v132, v133
    v_cvt_pk_bf16_f32 v131, v134, v135
    v_accvgpr_read_b32 v68, a48
    v_exp_f32 v140, v140
    v_exp_f32 v141, v141
    v_accvgpr_read_b32 v69, a49
    v_accvgpr_read_b32 v70, a50
    v_accvgpr_read_b32 v71, a51
    v_accvgpr_read_b32 v196, a52
    v_exp_f32 v142, v142
    v_exp_f32 v143, v143
    v_accvgpr_read_b32 v197, a53
    v_accvgpr_read_b32 v198, a54
    v_accvgpr_read_b32 v199, a55
    v_pk_fma_f32 v[144:145], v[144:145], s[50:51], v[12:13] op_sel_hi:[1,1,0]
    v_pk_fma_f32 v[146:147], v[146:147], s[50:51], v[12:13] op_sel_hi:[1,1,0]
    v_pk_fma_f32 v[148:149], v[148:149], s[50:51], v[12:13] op_sel_hi:[1,1,0]
    v_pk_fma_f32 v[150:151], v[150:151], s[50:51], v[12:13] op_sel_hi:[1,1,0]
    v_exp_f32 v144, v144
    v_exp_f32 v145, v145
    v_mfma_f32_16x16x32_bf16 a[236:239], a[232:235], v[80:83], a[236:239]
    buffer_load_dwordx4 v2, s[28:31], s48 offen offset:1024 lds
    v_cvt_pk_bf16_f32 v136, v136, v137
    v_cvt_pk_bf16_f32 v137, v138, v139
    v_cvt_pk_bf16_f32 v138, v140, v141
    v_exp_f32 v146, v146
    v_exp_f32 v147, v147
    v_mfma_f32_16x16x32_bf16 a[240:243], a[232:235], v[208:211], a[240:243]
    v_cvt_pk_bf16_f32 v139, v142, v143
    v_accvgpr_read_b32 v76, a56
    v_accvgpr_read_b32 v77, a57
    v_accvgpr_read_b32 v78, a58
    v_exp_f32 v148, v148
    v_exp_f32 v149, v149
    v_accvgpr_read_b32 v79, a59
    v_accvgpr_read_b32 v204, a60
    v_accvgpr_read_b32 v205, a61
    v_accvgpr_read_b32 v206, a62
    v_exp_f32 v150, v150
    v_exp_f32 v151, v151
    v_accvgpr_read_b32 v207, a63
    v_pk_fma_f32 v[216:217], v[216:217], s[50:51], v[14:15] op_sel_hi:[1,1,0]
    v_pk_fma_f32 v[218:219], v[218:219], s[50:51], v[14:15] op_sel_hi:[1,1,0]
    v_pk_fma_f32 v[220:221], v[220:221], s[50:51], v[14:15] op_sel_hi:[1,1,0]
    v_pk_fma_f32 v[222:223], v[222:223], s[50:51], v[14:15] op_sel_hi:[1,1,0]
    v_exp_f32 v216, v216
    v_exp_f32 v217, v217
    v_mfma_f32_16x16x32_bf16 a[236:239], a[232:235], v[88:91], a[236:239]
    buffer_load_dwordx4 v3, s[28:31], s48 offen offset:2048 lds
    v_cvt_pk_bf16_f32 v144, v144, v145
    v_cvt_pk_bf16_f32 v145, v146, v147
    v_cvt_pk_bf16_f32 v146, v148, v149
    v_exp_f32 v218, v218
    v_exp_f32 v219, v219
    v_mfma_f32_16x16x32_bf16 a[236:239], a[232:235], v[96:99], a[236:239]
    v_cvt_pk_bf16_f32 v147, v150, v151
    v_accvgpr_read_b32 v84, a64
    v_accvgpr_read_b32 v85, a65
    v_accvgpr_read_b32 v86, a66
    v_exp_f32 v220, v220
    v_exp_f32 v221, v221
    v_accvgpr_read_b32 v87, a67
    v_accvgpr_read_b32 v212, a68
    v_accvgpr_read_b32 v213, a69
    v_accvgpr_read_b32 v214, a70
    v_exp_f32 v222, v222
    v_exp_f32 v223, v223
    v_accvgpr_read_b32 v215, a71
    v_pk_fma_f32 v[224:225], v[224:225], s[50:51], v[14:15] op_sel_hi:[1,1,0]
    v_pk_fma_f32 v[226:227], v[226:227], s[50:51], v[14:15] op_sel_hi:[1,1,0]
    v_pk_fma_f32 v[228:229], v[228:229], s[50:51], v[14:15] op_sel_hi:[1,1,0]
    v_pk_fma_f32 v[230:231], v[230:231], s[50:51], v[14:15] op_sel_hi:[1,1,0]
    v_exp_f32 v224, v224
    v_exp_f32 v225, v225
    v_mfma_f32_16x16x32_bf16 a[236:239], a[232:235], v[104:107], a[236:239]
    buffer_load_dwordx4 v4, s[28:31], s48 offen offset:3072 lds
    v_cvt_pk_bf16_f32 v216, v216, v217
    v_cvt_pk_bf16_f32 v217, v218, v219
    v_cvt_pk_bf16_f32 v218, v220, v221
    v_exp_f32 v226, v226
    v_exp_f32 v227, v227
    v_mfma_f32_16x16x32_bf16 a[236:239], a[232:235], v[112:115], a[236:239]
    v_cvt_pk_bf16_f32 v219, v222, v223
    v_accvgpr_read_b32 v92, a72
    v_accvgpr_read_b32 v93, a73
    v_accvgpr_read_b32 v94, a74
    v_exp_f32 v228, v228
    v_exp_f32 v229, v229
    v_accvgpr_read_b32 v95, a75
    v_accvgpr_read_b32 v100, a76
    v_accvgpr_read_b32 v101, a77
    v_accvgpr_read_b32 v102, a78
    v_exp_f32 v230, v230
    v_exp_f32 v231, v231
    v_accvgpr_read_b32 v103, a79
    v_pk_fma_f32 v[232:233], v[232:233], s[50:51], v[14:15] op_sel_hi:[1,1,0]
    v_pk_fma_f32 v[234:235], v[234:235], s[50:51], v[14:15] op_sel_hi:[1,1,0]
    v_pk_fma_f32 v[236:237], v[236:237], s[50:51], v[14:15] op_sel_hi:[1,1,0]
    v_pk_fma_f32 v[238:239], v[238:239], s[50:51], v[14:15] op_sel_hi:[1,1,0]
    v_exp_f32 v232, v232
    v_exp_f32 v233, v233
L_pad3:
    s_cbranch_execz L_back1
    v_mfma_f32_16x16x32_bf16 a[236:239], a[232:235], v[120:123], a[236:239]
    buffer_load_dwordx4 a[252:255], v1, s[28:31], s44 offen offset:0
    v_cvt_pk_bf16_f32 v224, v224, v225
    v_cvt_pk_bf16_f32 v225, v226, v227
    v_cvt_pk_bf16_f32 v226, v228, v229
    v_exp_f32 v234, v234
    v_exp_f32 v235, v235
    v_mfma_f32_16x16x32_bf16 a[236:239], a[232:235], v[128:131], a[236:239]
    v_cvt_pk_bf16_f32 v227, v230, v231
    v_accvgpr_read_b32 v108, a80
    v_accvgpr_read_b32 v109, a81
    v_accvgpr_read_b32 v110, a82
    v_exp_f32 v236, v236
    v_exp_f32 v237, v237
    v_accvgpr_read_b32 v111, a83
    v_accvgpr_read_b32 v116, a84
    v_accvgpr_read_b32 v117, a85
    v_accvgpr_read_b32 v118, a86
    v_exp_f32 v238, v238
    v_exp_f32 v239, v239
    v_accvgpr_read_b32 v119, a87
    v_pk_fma_f32 v[240:241], v[240:241], s[50:51], v[14:15] op_sel_hi:[1,1,0]
    v_pk_fma_f32 v[242:243], v[242:243], s[50:51], v[14:15] op_sel_hi:[1,1,0]
    v_pk_fma_f32 v[244:245], v[244:245], s[50:51], v[14:15] op_sel_hi:[1,1,0]
    v_pk_fma_f32 v[246:247], v[246:247], s[50:51], v[14:15] op_sel_hi:[1,1,0]
    v_exp_f32 v240, v240
    v_exp_f32 v241, v241
    v_mfma_f32_16x16x32_bf16 a[236:239], a[232:235], v[136:139], a[236:239]
    buffer_load_dwordx4 a[252:255], v1, s[28:31], s45 offen offset:0
    v_cvt_pk_bf16_f32 v232, v232, v233
    v_cvt_pk_bf16_f32 v233, v234, v235
    v_cvt_pk_bf16_f32 v234, v236, v237
    v_exp_f32 v242, v242
    v_exp_f32 v243, v243
    v_mfma_f32_16x16x32_bf16 a[236:239], a[232:235], v[144:147], a[236:239]
    v_cvt_pk_bf16_f32 v235, v238, v239
    v_accvgpr_read_b32 v124, a88
    v_accvgpr_read_b32 v125, a89
    v_accvgpr_read_b32 v126, a90
    v_exp_f32 v244, v244
    v_exp_f32 v245, v245
    v_accvgpr_read_b32 v127, a91
    v_accvgpr_read_b32 v132, a92
    v_accvgpr_read_b32 v133, a93
    v_accvgpr_read_b32 v134, a94
    v_exp_f32 v246, v246
    v_exp_f32 v247, v247
    v_accvgpr_read_b32 v135, a95
    v_pk_fma_f32 v[248:249], v[248:249], s[50:51], v[14:15] op_sel_hi:[1,1,0]
    v_pk_fma_f32 v[250:251], v[250:251], s[50:51], v[14:15] op_sel_hi:[1,1,0]
    v_pk_fma_f32 v[252:253], v[252:253], s[50:51], v[14:15] op_sel_hi:[1,1,0]
    v_pk_fma_f32 v[254:255], v[254:255], s[50:51], v[14:15] op_sel_hi:[1,1,0]
    v_exp_f32 v248, v248
    v_exp_f32 v249, v249
    v_mfma_f32_16x16x32_bf16 a[240:243], a[232:235], v[216:219], a[240:243]
    buffer_load_dwordx4 a[252:255], v1, s[28:31], s46 offen offset:0
    v_cvt_pk_bf16_f32 v240, v240, v241
    v_cvt_pk_bf16_f32 v241, v242, v243
    v_cvt_pk_bf16_f32 v242, v244, v245
    v_exp_f32 v250, v250
    v_exp_f32 v251, v251
    v_mfma_f32_16x16x32_bf16 a[240:243], a[232:235], v[224:227], a[240:243]
    v_cvt_pk_bf16_f32 v243, v246, v247
    v_accvgpr_read_b32 v140, a96
    v_accvgpr_read_b32 v141, a97
    v_accvgpr_read_b32 v142, a98
    v_exp_f32 v252, v252
    v_exp_f32 v253, v253
    v_accvgpr_read_b32 v143, a99
    v_accvgpr_read_b32 v148, a100
    v_accvgpr_read_b32 v149, a101
    v_accvgpr_read_b32 v150, a102
    v_exp_f32 v254, v254
    v_exp_f32 v255, v255
    v_accvgpr_read_b32 v151, a103
    v_pk_fma_f32 v[16:17], v[16:17], s[50:51], v[14:15] op_sel_hi:[1,1,0]
    v_pk_fma_f32 v[18:19], v[18:19], s[50:51], v[14:15] op_sel_hi:[1,1,0]
    v_pk_fma_f32 v[20:21], v[20:21], s[50:51], v[14:15] op_sel_hi:[1,1,0]
    v_pk_fma_f32 v[22:23], v[22:23], s[50:51], v[14:15] op_sel_hi:[1,1,0]
    v_exp_f32 v16, v16
    v_exp_f32 v17, v17
    v_mfma_f32_16x16x32_bf16 a[240:243], a[232:235], v[232:235], a[240:243]
    buffer_load_dwordx4 a[252:255], v1, s[28:31], s47 offen offset:0
    v_cvt_pk_bf16_f32 v248, v248, v249
    v_cvt_pk_bf16_f32 v249, v250, v251
    v_cvt_pk_bf16_f32 v250, v252, v253
    v_exp_f32 v18, v18
    v_exp_f32 v19, v19
    v_mfma_f32_16x16x32_bf16 a[240:243], a[232:235], v[240:243], a[240:243]
    v_cvt_pk_bf16_f32 v251, v254, v255
    v_accvgpr_read_b32 v220, a104
    v_accvgpr_read_b32 v221, a105
    v_accvgpr_read_b32 v222, a106
    v_exp_f32 v20, v20
    v_exp_f32 v21, v21
    v_accvgpr_read_b32 v223, a107
    v_accvgpr_read_b32 v228, a108
    v_accvgpr_read_b32 v229, a109
    v_accvgpr_read_b32 v230, a110
    v_exp_f32 v22, v22
    v_exp_f32 v23, v23
    v_accvgpr_read_b32 v231, a111
    v_pk_fma_f32 v[28:29], v[28:29], s[50:51], v[14:15] op_sel_hi:[1,1,0]
    v_pk_fma_f32 v[30:31], v[30:31], s[50:51], v[14:15] op_sel_hi:[1,1,0]
    v_pk_fma_f32 v[156:157], v[156:157], s[50:51], v[14:15] op_sel_hi:[1,1,0]
    v_pk_fma_f32 v[158:159], v[158:159], s[50:51], v[14:15] op_sel_hi:[1,1,0]
    v_exp_f32 v28, v28
    v_exp_f32 v29, v29
    v_mfma_f32_16x16x32_bf16 a[240:243], a[232:235], v[248:251], a[240:243]
    buffer_load_dwordx4 a[252:255], v1, s[28:31], s56 offen offset:0
    v_cvt_pk_bf16_f32 v16, v16, v17
    v_cvt_pk_bf16_f32 v17, v18, v19
    v_cvt_pk_bf16_f32 v18, v20, v21
    v_exp_f32 v30, v30
    v_exp_f32 v31, v31
    v_cvt_pk_bf16_f32 v19, v22, v23
    v_accvgpr_read_b32 v236, a112
    v_accvgpr_read_b32 v237, a113
    v_accvgpr_read_b32 v238, a114
    v_exp_f32 v156, v156
    v_exp_f32 v157, v157
    v_accvgpr_read_b32 v239, a115
    v_accvgpr_read_b32 v244, a116
    v_accvgpr_read_b32 v245, a117
    v_accvgpr_read_b32 v246, a118
    v_exp_f32 v158, v158
    v_exp_f32 v159, v159
    v_accvgpr_read_b32 v247, a119
    v_pk_fma_f32 v[36:37], v[36:37], s[50:51], v[14:15] op_sel_hi:[1,1,0]
    v_pk_fma_f32 v[38:39], v[38:39], s[50:51], v[14:15] op_sel_hi:[1,1,0]
    v_pk_fma_f32 v[164:165], v[164:165], s[50:51], v[14:15] op_sel_hi:[1,1,0]
    v_pk_fma_f32 v[166:167], v[166:167], s[50:51], v[14:15] op_sel_hi:[1,1,0]
    v_exp_f32 v36, v36
    v_exp_f32 v37, v37
    v_mfma_f32_16x16x32_bf16 a[240:243], a[232:235], v[16:19], a[240:243]
    buffer_load_dwordx4 a[252:255], v1, s[28:31], s57 offen offset:0
    v_cvt_pk_bf16_f32 v28, v28, v29
    v_cvt_pk_bf16_f32 v29, v30, v31
    v_cvt_pk_bf16_f32 v30, v156, v157
    v_exp_f32 v38, v38
    v_exp_f32 v39, v39
    v_cvt_pk_bf16_f32 v31, v158, v159
    v_accvgpr_read_b32 v252, a120
    v_accvgpr_read_b32 v253, a121
    v_accvgpr_read_b32 v254, a122
    v_exp_f32 v164, v164
    v_exp_f32 v165, v165
    v_accvgpr_read_b32 v255, a123
    v_accvgpr_read_b32 v20, a124
    v_accvgpr_read_b32 v21, a125
    v_accvgpr_read_b32 v22, a126
    v_exp_f32 v166, v166
    v_exp_f32 v167, v167
    v_accvgpr_read_b32 v23, a127
    v_pk_fma_f32 v[44:45], v[44:45], s[50:51], v[0:1] op_sel_hi:[1,1,0]
    v_pk_fma_f32 v[46:47], v[46:47], s[50:51], v[0:1] op_sel_hi:[1,1,0]
    v_pk_fma_f32 v[172:173], v[172:173], s[50:51], v[0:1] op_sel_hi:[1,1,0]
    v_pk_fma_f32 v[174:175], v[174:175], s[50:51], v[0:1] op_sel_hi:[1,1,0]
    v_exp_f32 v44, v44
    v_exp_f32 v45, v45
    v_mfma_f32_16x16x32_bf16 a[240:243], a[232:235], v[28:31], a[240:243]
    v_cvt_pk_bf16_f32 v36, v36, v37
    v_cvt_pk_bf16_f32 v37, v38, v39
    v_cvt_pk_bf16_f32 v38, v164, v165
    v_cvt_pk_bf16_f32 v39, v166, v167
    v_exp_f32 v46, v46
    v_exp_f32 v47, v47
    v_accvgpr_read_b32 v156, a128
    v_accvgpr_read_b32 v157, a129
    v_accvgpr_read_b32 v158, a130
    v_accvgpr_read_b32 v159, a131
    v_exp_f32 v172, v172
    v_exp_f32 v173, v173
    v_accvgpr_read_b32 v164, a132
    v_accvgpr_read_b32 v165, a133
    v_accvgpr_read_b32 v166, a134
    v_accvgpr_read_b32 v167, a135
    v_exp_f32 v174, v174
    v_exp_f32 v175, v175
    v_pk_fma_f32 v[52:53], v[52:53], s[50:51], v[0:1] op_sel_hi:[1,1,0]
    v_pk_fma_f32 v[54:55], v[54:55], s[50:51], v[0:1] op_sel_hi:[1,1,0]
    v_pk_fma_f32 v[180:181], v[180:181], s[50:51], v[0:1] op_sel_hi:[1,1,0]
    v_pk_fma_f32 v[182:183], v[182:183], s[50:51], v[0:1] op_sel_hi:[1,1,0]
    v_exp_f32 v52, v52
    v_exp_f32 v53, v53
    v_mfma_f32_16x16x32_bf16 a[240:243], a[232:235], v[36:39], a[240:243]
    v_cvt_pk_bf16_f32 v44, v44, v45
    v_cvt_pk_bf16_f32 v45, v46, v47
    v_exp_f32 v54, v54
    v_exp_f32 v55, v55
    v_cvt_pk_bf16_f32 v46, v172, v173
    v_cvt_pk_bf16_f32 v47, v174, v175
    v_exp_f32 v180, v180
    v_exp_f32 v181, v181
    v_exp_f32 v182, v182
    v_exp_f32 v183, v183
    v_pk_fma_f32 v[60:61], v[60:61], s[50:51], v[0:1] op_sel_hi:[1,1,0]
    v_pk_fma_f32 v[62:63], v[62:63], s[50:51], v[0:1] op_sel_hi:[1,1,0]
    v_pk_fma_f32 v[188:189], v[188:189], s[50:51], v[0:1] op_sel_hi:[1,1,0]
    v_pk_fma_f32 v[190:191], v[190:191], s[50:51], v[0:1] op_sel_hi:[1,1,0]
    v_exp_f32 v60, v60
    v_exp_f32 v61, v61
    v_mfma_f32_16x16x32_bf16 a[244:247], a[232:235], v[44:47], 0
    v_cvt_pk_bf16_f32 v52, v52, v53
    v_cvt_pk_bf16_f32 v53, v54, v55
    v_cvt_pk_bf16_f32 v54, v180, v181
    v_cvt_pk_bf16_f32 v55, v182, v183
    v_exp_f32 v62, v62
    v_exp_f32 v63, v63
    v_accvgpr_read_b32 v172, a136
    v_accvgpr_read_b32 v173, a137
    v_accvgpr_read_b32 v174, a138
    v_accvgpr_read_b32 v175, a139
    v_exp_f32 v188, v188
    v_exp_f32 v189, v189
    v_accvgpr_read_b32 v180, a140
    v_accvgpr_read_b32 v181, a141
    v_accvgpr_read_b32 v182, a142
    v_accvgpr_read_b32 v183, a143
    v_exp_f32 v190, v190
    v_exp_f32 v191, v191
    v_pk_fma_f32 v[68:69], v[68:69], s[50:51], v[0:1] op_sel_hi:[1,1,0]
    v_pk_fma_f32 v[70:71], v[70:71], s[50:51], v[0:1] op_sel_hi:[1,1,0]
    v_pk_fma_f32 v[196:197], v[196:197], s[50:51], v[0:1] op_sel_hi:[1,1,0]
    v_pk_fma_f32 v[198:199], v[198:199], s[50:51], v[0:1] op_sel_hi:[1,1,0]
    v_exp_f32 v68, v68
    v_exp_f32 v69, v69
    v_mfma_f32_16x16x32_bf16 a[244:247], a[232:235], v[52:55], a[244:247]
    v_cvt_pk_bf16_f32 v60, v60, v61
    v_cvt_pk_bf16_f32 v61, v62, v63
    v_exp_f32 v70, v70
    v_exp_f32 v71, v71
    v_cvt_pk_bf16_f32 v62, v188, v189
    v_cvt_pk_bf16_f32 v63, v190, v191
    v_exp_f32 v196, v196
    v_exp_f32 v197, v197
    v_exp_f32 v198, v198
    v_exp_f32 v199, v199
    v_pk_fma_f32 v[76:77], v[76:77], s[50:51], v[0:1] op_sel_hi:[1,1,0]
    v_pk_fma_f32 v[78:79], v[78:79], s[50:51], v[0:1] op_sel_hi:[1,1,0]
    v_pk_fma_f32 v[204:205], v[204:205], s[50:51], v[0:1] op_sel_hi:[1,1,0]
    v_pk_fma_f32 v[206:207], v[206:207], s[50:51], v[0:1] op_sel_hi:[1,1,0]
    v_exp_f32 v76, v76
    v_exp_f32 v77, v77
    v_mfma_f32_16x16x32_bf16 a[244:247], a[232:235], v[60:63], a[244:247]
    v_cvt_pk_bf16_f32 v68, v68, v69
    v_cvt_pk_bf16_f32 v69, v70, v71
    v_cvt_pk_bf16_f32 v70, v196, v197
    v_cvt_pk_bf16_f32 v71, v198, v199
    v_exp_f32 v78, v78
    v_exp_f32 v79, v79
    v_accvgpr_read_b32 v188, a144
    v_accvgpr_read_b32 v189, a145
    v_accvgpr_read_b32 v190, a146
    v_accvgpr_read_b32 v191, a147
    v_exp_f32 v204, v204
    v_exp_f32 v205, v205
    v_accvgpr_read_b32 v196, a148
    v_accvgpr_read_b32 v197, a149
    v_accvgpr_read_b32 v198, a150
    v_accvgpr_read_b32 v199, a151
    v_exp_f32 v206, v206
    v_exp_f32 v207, v207
    v_pk_fma_f32 v[84:85], v[84:85], s[50:51], v[0:1] op_sel_hi:[1,1,0]
    v_pk_fma_f32 v[86:87], v[86:87], s[50:51], v[0:1] op_sel_hi:[1,1,0]
    v_pk_fma_f32 v[212:213], v[212:213], s[50:51], v[0:1] op_sel_hi:[1,1,0]
    v_pk_fma_f32 v[214:215], v[214:215], s[50:51], v[0:1] op_sel_hi:[1,1,0]
    v_exp_f32 v84, v84
    v_exp_f32 v85, v85
    v_mfma_f32_16x16x32_bf16 a[244:247], a[232:235], v[68:71], a[244:247]
    v_cvt_pk_bf16_f32 v76, v76, v77
    v_cvt_pk_bf16_f32 v77, v78, v79
    v_exp_f32 v86, v86
    v_exp_f32 v87, v87
    v_cvt_pk_bf16_f32 v78, v204, v205
    v_cvt_pk_bf16_f32 v79, v206, v207
    v_exp_f32 v212, v212
    v_exp_f32 v213, v213
    v_exp_f32 v214, v214
    v_exp_f32 v215, v215
    v_pk_fma_f32 v[92:93], v[92:93], s[50:51], v[0:1] op_sel_hi:[1,1,0]
    v_pk_fma_f32 v[94:95], v[94:95], s[50:51], v[0:1] op_sel_hi:[1,1,0]
    v_pk_fma_f32 v[100:101], v[100:101], s[50:51], v[0:1] op_sel_hi:[1,1,0]
    v_pk_fma_f32 v[102:103], v[102:103], s[50:51], v[0:1] op_sel_hi:[1,1,0]
    v_exp_f32 v92, v92
    v_exp_f32 v93, v93
    v_mfma_f32_16x16x32_bf16 a[244:247], a[232:235], v[76:79], a[244:247]
    v_cvt_pk_bf16_f32 v84, v84, v85
    v_cvt_pk_bf16_f32 v85, v86, v87
    v_exp_f32 v94, v94
    v_exp_f32 v95, v95
    v_cvt_pk_bf16_f32 v86, v212, v213
    v_cvt_pk_bf16_f32 v87, v214, v215
    v_exp_f32 v100, v100
    v_exp_f32 v101, v101
    v_exp_f32 v102, v102
    v_exp_f32 v103, v103
    v_pk_fma_f32 v[108:109], v[108:109], s[50:51], v[0:1] op_sel_hi:[1,1,0]
    v_pk_fma_f32 v[110:111], v[110:111], s[50:51], v[0:1] op_sel_hi:[1,1,0]
    v_pk_fma_f32 v[116:117], v[116:117], s[50:51], v[0:1] op_sel_hi:[1,1,0]
    v_pk_fma_f32 v[118:119], v[118:119], s[50:51], v[0:1] op_sel_hi:[1,1,0]
    v_exp_f32 v108, v108
    v_exp_f32 v109, v109
    v_mfma_f32_16x16x32_bf16 a[244:247], a[232:235], v[84:87], a[244:247]
    v_cvt_pk_bf16_f32 v92, v92, v93
    v_cvt_pk_bf16_f32 v93, v94, v95
    v_exp_f32 v110, v110
    v_exp_f32 v111, v111
    v_cvt_pk_bf16_f32 v94, v100, v101
    v_cvt_pk_bf16_f32 v95, v102, v103
    v_exp_f32 v116, v116
    v_exp_f32 v117, v117
    v_exp_f32 v118, v118
    v_exp_f32 v119, v119
    v_pk_fma_f32 v[124:125], v[124:125], s[50:51], v[0:1] op_sel_hi:[1,1,0]
    v_pk_fma_f32 v[126:127], v[126:127], s[50:51], v[0:1] op_sel_hi:[1,1,0]
    v_pk_fma_f32 v[132:133], v[132:133], s[50:51], v[0:1] op_sel_hi:[1,1,0]
    v_pk_fma_f32 v[134:135], v[134:135], s[50:51], v[0:1] op_sel_hi:[1,1,0]
    v_exp_f32 v124, v124
    v_exp_f32 v125, v125
    v_mfma_f32_16x16x32_bf16 a[244:247], a[232:235], v[92:95], a[244:247]
    v_cvt_pk_bf16_f32 v108, v108, v109
    v_cvt_pk_bf16_f32 v109, v110, v111
    v_exp_f32 v126, v126
    v_exp_f32 v127, v127
    v_cvt_pk_bf16_f32 v110, v116, v117
    v_cvt_pk_bf16_f32 v111, v118, v119
    v_exp_f32 v132, v132
    v_exp_f32 v133, v133
    v_exp_f32 v134, v134
    v_exp_f32 v135, v135
    v_pk_fma_f32 v[140:141], v[140:141], s[50:51], v[0:1] op_sel_hi:[1,1,0]
    v_pk_fma_f32 v[142:143], v[142:143], s[50:51], v[0:1] op_sel_hi:[1,1,0]
    v_pk_fma_f32 v[148:149], v[148:149], s[50:51], v[0:1] op_sel_hi:[1,1,0]
    v_pk_fma_f32 v[150:151], v[150:151], s[50:51], v[0:1] op_sel_hi:[1,1,0]
    v_exp_f32 v140, v140
    v_exp_f32 v141, v141
    v_mfma_f32_16x16x32_bf16 a[244:247], a[232:235], v[108:111], a[244:247]
    v_cvt_pk_bf16_f32 v124, v124, v125
    v_cvt_pk_bf16_f32 v125, v126, v127
    v_exp_f32 v142, v142
    v_exp_f32 v143, v143
    v_cvt_pk_bf16_f32 v126, v132, v133
    v_cvt_pk_bf16_f32 v127, v134, v135
    v_exp_f32 v148, v148
    v_exp_f32 v149, v149
    ds_read_b64_tr_b16 a[152:153], v5 offset:0
    ds_read_b64_tr_b16 a[154:155], v5 offset:2048
    v_exp_f32 v150, v150
    v_exp_f32 v151, v151
    ds_read_b64_tr_b16 a[156:157], v5 offset:4096
    ds_read_b64_tr_b16 a[158:159], v5 offset:6144
    v_pk_fma_f32 v[220:221], v[220:221], s[50:51], v[0:1] op_sel_hi:[1,1,0]
    v_pk_fma_f32 v[222:223], v[222:223], s[50:51], v[0:1] op_sel_hi:[1,1,0]
    v_pk_fma_f32 v[228:229], v[228:229], s[50:51], v[0:1] op_sel_hi:[1,1,0]
    v_pk_fma_f32 v[230:231], v[230:231], s[50:51], v[0:1] op_sel_hi:[1,1,0]
    v_exp_f32 v220, v220
    v_exp_f32 v221, v221
    v_mfma_f32_16x16x32_bf16 a[244:247], a[232:235], v[124:127], a[244:247]
    v_cvt_pk_bf16_f32 v140, v140, v141
    v_cvt_pk_bf16_f32 v141, v142, v143
    v_exp_f32 v222, v222
    v_exp_f32 v223, v223
    v_cvt_pk_bf16_f32 v142, v148, v149
    v_cvt_pk_bf16_f32 v143, v150, v151
    v_exp_f32 v228, v228
    v_exp_f32 v229, v229
    ds_read_b64_tr_b16 a[160:161], v5 offset:8192
    ds_read_b64_tr_b16 a[162:163], v5 offset:10240
    v_exp_f32 v230, v230
    v_exp_f32 v231, v231
    ds_read_b64_tr_b16 a[164:165], v5 offset:12288
    ds_read_b64_tr_b16 a[166:167], v5 offset:14336
    v_pk_fma_f32 v[236:237], v[236:237], s[50:51], v[0:1] op_sel_hi:[1,1,0]
    v_pk_fma_f32 v[238:239], v[238:239], s[50:51], v[0:1] op_sel_hi:[1,1,0]
    v_pk_fma_f32 v[244:245], v[244:245], s[50:51], v[0:1] op_sel_hi:[1,1,0]
    v_pk_fma_f32 v[246:247], v[246:247], s[50:51], v[0:1] op_sel_hi:[1,1,0]
    v_exp_f32 v236, v236
    v_exp_f32 v237, v237
    v_mfma_f32_16x16x32_bf16 a[244:247], a[232:235], v[140:143], a[244:247]
    v_cvt_pk_bf16_f32 v220, v220, v221
    v_cvt_pk_bf16_f32 v221, v222, v223
    v_exp_f32 v238, v238
    v_exp_f32 v239, v239
    v_cvt_pk_bf16_f32 v222, v228, v229
    v_cvt_pk_bf16_f32 v223, v230, v231
    v_exp_f32 v244, v244
    v_exp_f32 v245, v245
    v_exp_f32 v246, v246
    v_exp_f32 v247, v247
    v_cvt_pk_bf16_f32 v236, v236, v237
    v_cvt_pk_bf16_f32 v237, v238, v239
    v_cvt_pk_bf16_f32 v238, v244, v245
    v_cvt_pk_bf16_f32 v239, v246, v247
    v_pk_fma_f32 v[252:253], v[252:253], s[50:51], v[0:1] op_sel_hi:[1,1,0]
    v_pk_fma_f32 v[254:255], v[254:255], s[50:51], v[0:1] op_sel_hi:[1,1,0]
    v_pk_fma_f32 v[20:21], v[20:21], s[50:51], v[0:1] op_sel_hi:[1,1,0]
    v_pk_fma_f32 v[22:23], v[22:23], s[50:51], v[0:1] op_sel_hi:[1,1,0]
    v_pk_fma_f32 v[156:157], v[156:157], s[50:51], v[0:1] op_sel_hi:[1,1,0]
    v_pk_fma_f32 v[158:159], v[158:159], s[50:51], v[0:1] op_sel_hi:[1,1,0]
    v_pk_fma_f32 v[164:165], v[164:165], s[50:51], v[0:1] op_sel_hi:[1,1,0]
    v_pk_fma_f32 v[166:167], v[166:167], s[50:51], v[0:1] op_sel_hi:[1,1,0]
    v_pk_fma_f32 v[172:173], v[172:173], s[50:51], v[0:1] op_sel_hi:[1,1,0]
    v_pk_fma_f32 v[174:175], v[174:175], s[50:51], v[0:1] op_sel_hi:[1,1,0]
    v_pk_fma_f32 v[180:181], v[180:181], s[50:51], v[0:1] op_sel_hi:[1,1,0]
    v_pk_fma_f32 v[182:183], v[182:183], s[50:51], v[0:1] op_sel_hi:[1,1,0]
    v_pk_fma_f32 v[188:189], v[188:189], s[50:51], v[0:1] op_sel_hi:[1,1,0]
    v_pk_fma_f32 v[190:191], v[190:191], s[50:51], v[0:1] op_sel_hi:[1,1,0]
    v_pk_fma_f32 v[196:197], v[196:197], s[50:51], v[0:1] op_sel_hi:[1,1,0]
    v_pk_fma_f32 v[198:199], v[198:199], s[50:51], v[0:1] op_sel_hi:[1,1,0]
    ds_read_b64_tr_b16 a[168:169], v5 offset:16384
    ds_read_b64_tr_b16 a[170:171], v5 offset:18432
    ds_read_b64_tr_b16 a[172:173], v5 offset:20480
    ds_read_b64_tr_b16 a[174:175], v5 offset:22528
    s_waitcnt lgkmcnt(4)
    v_mfma_f32_16x16x32_bf16 v[204:207], a[152:155], v[24:27], 0
    ds_read_b64_tr_b16 a[176:177], v5 offset:24576
    ds_read_b64_tr_b16 a[178:179], v5 offset:26624
    v_mfma_f32_16x16x32_bf16 v[204:207], a[156:159], v[32:35], v[204:207]
    ds_read_b64_tr_b16 a[180:181], v5 offset:28672
    ds_read_b64_tr_b16 a[182:183], v5 offset:30720
    v_mfma_f32_16x16x32_bf16 v[204:207], a[160:163], v[40:43], v[204:207]
    ds_read_b64_tr_b16 a[184:185], v6 offset:0
    ds_read_b64_tr_b16 a[186:187], v6 offset:2048
    v_mfma_f32_16x16x32_bf16 v[204:207], a[164:167], v[48:51], v[204:207]
    s_waitcnt lgkmcnt(2)
    v_mfma_f32_16x16x32_bf16 v[204:207], a[168:171], v[56:59], v[204:207]
    ds_read_b64_tr_b16 a[188:189], v6 offset:4096
    ds_read_b64_tr_b16 a[190:191], v6 offset:6144
    v_mfma_f32_16x16x32_bf16 v[204:207], a[172:175], v[64:67], v[204:207]
    v_mfma_f32_16x16x32_bf16 a[244:247], a[232:235], v[220:223], a[244:247]
    v_mfma_f32_16x16x32_bf16 v[204:207], a[176:179], v[72:75], v[204:207]
    ds_read_b64_tr_b16 a[192:193], v6 offset:8192
    ds_read_b64_tr_b16 a[194:195], v6 offset:10240
    v_mfma_f32_16x16x32_bf16 v[204:207], a[180:183], v[80:83], v[204:207]
    v_mfma_f32_16x16x32_bf16 a[244:247], a[232:235], v[236:239], a[244:247]
    v_mfma_f32_16x16x32_bf16 v[212:215], a[152:155], v[152:155], 0
    ds_read_b64_tr_b16 a[196:197], v6 offset:12288
    ds_read_b64_tr_b16 a[198:199], v6 offset:14336
    v_add_u32 v5, 4294836224, v5
    v_mfma_f32_16x16x32_bf16 v[212:215], a[156:159], v[160:163], v[212:215]
    v_exp_f32 v252, v252
    v_mfma_f32_16x16x32_bf16 v[212:215], a[160:163], v[168:171], v[212:215]
    ds_read_b64_tr_b16 a[200:201], v6 offset:16384
    ds_read_b64_tr_b16 a[202:203], v6 offset:18432
    v_mfma_f32_16x16x32_bf16 v[212:215], a[164:167], v[176:179], v[212:215]
    v_exp_f32 v253, v253
    v_mfma_f32_16x16x32_bf16 v[212:215], a[168:171], v[184:187], v[212:215]
    ds_read_b64_tr_b16 a[204:205], v6 offset:20480
    ds_read_b64_tr_b16 a[206:207], v6 offset:22528
    v_mfma_f32_16x16x32_bf16 v[212:215], a[172:175], v[192:195], v[212:215]
    v_exp_f32 v254, v254
    v_mfma_f32_16x16x32_bf16 v[212:215], a[176:179], v[200:203], v[212:215]
    ds_read_b64_tr_b16 a[208:209], v6 offset:24576
    ds_read_b64_tr_b16 a[210:211], v6 offset:26624
    v_mfma_f32_16x16x32_bf16 v[212:215], a[180:183], v[208:211], v[212:215]
    v_exp_f32 v255, v255
    v_mfma_f32_16x16x32_bf16 v[100:103], a[152:155], v[44:47], 0
    ds_read_b64_tr_b16 a[212:213], v6 offset:28672
    ds_read_b64_tr_b16 a[214:215], v6 offset:30720
    v_mfma_f32_16x16x32_bf16 v[100:103], a[156:159], v[52:55], v[100:103]
    v_exp_f32 v20, v20
    v_mfma_f32_16x16x32_bf16 v[100:103], a[160:163], v[60:63], v[100:103]
    v_exp_f32 v21, v21
    v_mfma_f32_16x16x32_bf16 v[100:103], a[164:167], v[68:71], v[100:103]
    v_exp_f32 v22, v22
    v_mfma_f32_16x16x32_bf16 v[100:103], a[168:171], v[76:79], v[100:103]
    v_exp_f32 v23, v23
    v_mfma_f32_16x16x32_bf16 v[100:103], a[172:175], v[84:87], v[100:103]
    v_cvt_pk_bf16_f32 v252, v252, v253
    v_cvt_pk_bf16_f32 v253, v254, v255
    v_mfma_f32_16x16x32_bf16 v[100:103], a[176:179], v[92:95], v[100:103]
    v_exp_f32 v156, v156
    v_mfma_f32_16x16x32_bf16 v[100:103], a[180:183], v[108:111], v[100:103]
    v_cvt_pk_bf16_f32 v254, v20, v21
    s_waitcnt lgkmcnt(8)
    v_mfma_f32_16x16x32_bf16 v[116:119], a[184:187], v[24:27], 0
    ds_read_b64_tr_b16 a[152:153], v7 offset:0
    ds_read_b64_tr_b16 a[154:155], v7 offset:2048
    v_mfma_f32_16x16x32_bf16 v[116:119], a[188:191], v[32:35], v[116:119]
    v_add_u32 v6, 4294836224, v6
    v_cvt_pk_bf16_f32 v255, v22, v23
    v_mfma_f32_16x16x32_bf16 v[116:119], a[192:195], v[40:43], v[116:119]
    ds_read_b64_tr_b16 a[156:157], v7 offset:4096
    ds_read_b64_tr_b16 a[158:159], v7 offset:6144
    v_mfma_f32_16x16x32_bf16 v[116:119], a[196:199], v[48:51], v[116:119]
    v_mfma_f32_16x16x32_bf16 a[244:247], a[232:235], v[252:255], a[244:247]
    s_waitcnt lgkmcnt(4)
    v_mfma_f32_16x16x32_bf16 v[116:119], a[200:203], v[56:59], v[116:119]
    ds_read_b64_tr_b16 a[160:161], v7 offset:8192
    ds_read_b64_tr_b16 a[162:163], v7 offset:10240
    v_mfma_f32_16x16x32_bf16 v[116:119], a[204:207], v[64:67], v[116:119]
    v_exp_f32 v157, v157
    v_mfma_f32_16x16x32_bf16 v[116:119], a[208:211], v[72:75], v[116:119]
    ds_read_b64_tr_b16 a[164:165], v7 offset:12288
    ds_read_b64_tr_b16 a[166:167], v7 offset:14336
    v_mfma_f32_16x16x32_bf16 v[116:119], a[212:215], v[80:83], v[116:119]
    v_exp_f32 v158, v158
    v_mfma_f32_16x16x32_bf16 v[132:135], a[184:187], v[152:155], 0
    ds_read_b64_tr_b16 a[168:169], v7 offset:16384
    ds_read_b64_tr_b16 a[170:171], v7 offset:18432
    v_mfma_f32_16x16x32_bf16 v[132:135], a[188:191], v[160:163], v[132:135]
    v_exp_f32 v159, v159
    v_mfma_f32_16x16x32_bf16 v[132:135], a[192:195], v[168:171], v[132:135]
    ds_read_b64_tr_b16 a[172:173], v7 offset:20480
    ds_read_b64_tr_b16 a[174:175], v7 offset:22528
    v_mfma_f32_16x16x32_bf16 v[132:135], a[196:199], v[176:179], v[132:135]
    v_exp_f32 v164, v164
    v_mfma_f32_16x16x32_bf16 v[132:135], a[200:203], v[184:187], v[132:135]
    ds_read_b64_tr_b16 a[176:177], v7 offset:24576
    ds_read_b64_tr_b16 a[178:179], v7 offset:26624
    v_mfma_f32_16x16x32_bf16 v[132:135], a[204:207], v[192:195], v[132:135]
    v_exp_f32 v165, v165
    v_mfma_f32_16x16x32_bf16 v[132:135], a[208:211], v[200:203], v[132:135]
    ds_read_b64_tr_b16 a[180:181], v7 offset:28672
    ds_read_b64_tr_b16 a[182:183], v7 offset:30720
    v_mfma_f32_16x16x32_bf16 v[132:135], a[212:215], v[208:211], v[132:135]
    v_exp_f32 v166, v166
    v_mfma_f32_16x16x32_bf16 v[148:151], a[184:187], v[44:47], 0
    v_exp_f32 v167, v167
    v_mfma_f32_16x16x32_bf16 v[148:151], a[188:191], v[52:55], v[148:151]
    v_cvt_pk_bf16_f32 v156, v156, v157
    v_cvt_pk_bf16_f32 v157, v158, v159
    v_mfma_f32_16x16x32_bf16 v[148:151], a[192:195], v[60:63], v[148:151]
    v_exp_f32 v172, v172
    v_mfma_f32_16x16x32_bf16 v[148:151], a[196:199], v[68:71], v[148:151]
    v_exp_f32 v173, v173
    v_mfma_f32_16x16x32_bf16 v[148:151], a[200:203], v[76:79], v[148:151]
    v_exp_f32 v174, v174
    v_mfma_f32_16x16x32_bf16 v[148:151], a[204:207], v[84:87], v[148:151]
    v_exp_f32 v175, v175
    v_mfma_f32_16x16x32_bf16 v[148:151], a[208:211], v[92:95], v[148:151]
    v_cvt_pk_bf16_f32 v158, v164, v165
    v_cvt_pk_bf16_f32 v159, v166, v167
    v_mfma_f32_16x16x32_bf16 v[148:151], a[212:215], v[108:111], v[148:151]
    v_add_u32 v7, 4294836224, v7
    s_waitcnt lgkmcnt(8)
    v_mfma_f32_16x16x32_bf16 v[228:231], a[152:155], v[24:27], 0
    ds_read_b64_tr_b16 a[184:185], v8 offset:0
    ds_read_b64_tr_b16 a[186:187], v8 offset:2048
    v_mfma_f32_16x16x32_bf16 a[244:247], a[232:235], v[156:159], a[244:247]
    v_mfma_f32_16x16x32_bf16 v[228:231], a[156:159], v[32:35], v[228:231]
    v_exp_f32 v180, v180
    v_mfma_f32_16x16x32_bf16 v[228:231], a[160:163], v[40:43], v[228:231]
    ds_read_b64_tr_b16 a[188:189], v8 offset:4096
    ds_read_b64_tr_b16 a[190:191], v8 offset:6144
    v_mfma_f32_16x16x32_bf16 v[228:231], a[164:167], v[48:51], v[228:231]
    v_cvt_pk_bf16_f32 v172, v172, v173
    s_waitcnt lgkmcnt(4)
    v_mfma_f32_16x16x32_bf16 v[228:231], a[168:171], v[56:59], v[228:231]
    ds_read_b64_tr_b16 a[192:193], v8 offset:8192
    ds_read_b64_tr_b16 a[194:195], v8 offset:10240
    v_mfma_f32_16x16x32_bf16 v[228:231], a[172:175], v[64:67], v[228:231]
    v_exp_f32 v181, v181
    v_mfma_f32_16x16x32_bf16 v[228:231], a[176:179], v[72:75], v[228:231]
    ds_read_b64_tr_b16 a[196:197], v8 offset:12288
    ds_read_b64_tr_b16 a[198:199], v8 offset:14336
    v_mfma_f32_16x16x32_bf16 v[228:231], a[180:183], v[80:83], v[228:231]
    v_exp_f32 v182, v182
    v_mfma_f32_16x16x32_bf16 v[244:247], a[152:155], v[152:155], 0
    ds_read_b64_tr_b16 a[200:201], v8 offset:16384
    ds_read_b64_tr_b16 a[202:203], v8 offset:18432
    v_mfma_f32_16x16x32_bf16 v[244:247], a[156:159], v[160:163], v[244:247]
    v_exp_f32 v183, v183
    v_mfma_f32_16x16x32_bf16 v[244:247], a[160:163], v[168:171], v[244:247]
    ds_read_b64_tr_b16 a[204:205], v8 offset:20480
    ds_read_b64_tr_b16 a[206:207], v8 offset:22528
    v_mfma_f32_16x16x32_bf16 v[244:247], a[164:167], v[176:179], v[244:247]
    v_exp_f32 v188, v188
    v_mfma_f32_16x16x32_bf16 v[244:247], a[168:171], v[184:187], v[244:247]
    ds_read_b64_tr_b16 a[208:209], v8 offset:24576
    ds_read_b64_tr_b16 a[210:211], v8 offset:26624
    v_mfma_f32_16x16x32_bf16 v[244:247], a[172:175], v[192:195], v[244:247]
    v_exp_f32 v189, v189
    v_mfma_f32_16x16x32_bf16 v[244:247], a[176:179], v[200:203], v[244:247]
    ds_read_b64_tr_b16 a[212:213], v8 offset:28672
    ds_read_b64_tr_b16 a[214:215], v8 offset:30720
    v_mfma_f32_16x16x32_bf16 v[244:247], a[180:183], v[208:211], v[244:247]
    v_cvt_pk_bf16_f32 v173, v174, v175
    v_cvt_pk_bf16_f32 v174, v180, v181
    v_mfma_f32_16x16x32_bf16 v[20:23], a[152:155], v[44:47], 0
    v_exp_f32 v190, v190
    v_mfma_f32_16x16x32_bf16 v[20:23], a[156:159], v[52:55], v[20:23]
    v_exp_f32 v191, v191
    v_mfma_f32_16x16x32_bf16 v[20:23], a[160:163], v[60:63], v[20:23]
    v_exp_f32 v196, v196
    v_mfma_f32_16x16x32_bf16 v[20:23], a[164:167], v[68:71], v[20:23]
    v_exp_f32 v197, v197
    v_mfma_f32_16x16x32_bf16 v[20:23], a[168:171], v[76:79], v[20:23]
    v_cvt_pk_bf16_f32 v175, v182, v183
    v_cvt_pk_bf16_f32 v188, v188, v189
    v_mfma_f32_16x16x32_bf16 v[20:23], a[172:175], v[84:87], v[20:23]
    v_exp_f32 v198, v198
    v_mfma_f32_16x16x32_bf16 v[20:23], a[176:179], v[92:95], v[20:23]
    v_exp_f32 v199, v199
    v_mfma_f32_16x16x32_bf16 a[244:247], a[232:235], v[172:175], a[244:247]
    v_mfma_f32_16x16x32_bf16 v[20:23], a[180:183], v[108:111], v[20:23]
    v_add_u32 v8, 4294836224, v8
    s_waitcnt lgkmcnt(8)
    v_mfma_f32_16x16x32_bf16 v[164:167], a[184:187], v[24:27], 0
    s_waitcnt vmcnt(26)
    s_barrier
    v_mfma_f32_16x16x32_bf16 v[164:167], a[188:191], v[32:35], v[164:167]
L_pad4:
    s_cbranch_execz L_back1
    ds_read_b64_tr_b16 a[152:153], v5 offset:32768
    ds_read_b64_tr_b16 a[154:155], v5 offset:34816
    v_mfma_f32_16x16x32_bf16 v[164:167], a[192:195], v[40:43], v[164:167]
    v_cvt_pk_bf16_f32 v189, v190, v191
    v_cvt_pk_bf16_f32 v190, v196, v197
    v_mfma_f32_16x16x32_bf16 v[164:167], a[196:199], v[48:51], v[164:167]
    ds_read_b64_tr_b16 a[156:157], v5 offset:36864
    ds_read_b64_tr_b16 a[158:159], v5 offset:38912
    s_waitcnt lgkmcnt(4)
    v_mfma_f32_16x16x32_bf16 v[164:167], a[200:203], v[56:59], v[164:167]
    v_cvt_pk_bf16_f32 v191, v198, v199
    v_mfma_f32_16x16x32_bf16 v[164:167], a[204:207], v[64:67], v[164:167]
    ds_read_b64_tr_b16 a[160:161], v5 offset:40960
    ds_read_b64_tr_b16 a[162:163], v5 offset:43008
    v_mfma_f32_16x16x32_bf16 v[164:167], a[208:211], v[72:75], v[164:167]
    v_mfma_f32_16x16x32_bf16 a[244:247], a[232:235], v[188:191], a[244:247]
    v_mfma_f32_16x16x32_bf16 v[164:167], a[212:215], v[80:83], v[164:167]
    ds_read_b64_tr_b16 a[164:165], v5 offset:45056
    ds_read_b64_tr_b16 a[166:167], v5 offset:47104
    v_mfma_f32_16x16x32_bf16 v[180:183], a[184:187], v[152:155], 0
    v_mfma_f32_16x16x32_bf16 v[180:183], a[188:191], v[160:163], v[180:183]
    ds_read_b64_tr_b16 a[168:169], v5 offset:49152
    ds_read_b64_tr_b16 a[170:171], v5 offset:51200
    v_mfma_f32_16x16x32_bf16 v[180:183], a[192:195], v[168:171], v[180:183]
    v_mfma_f32_16x16x32_bf16 v[180:183], a[196:199], v[176:179], v[180:183]
    ds_read_b64_tr_b16 a[172:173], v5 offset:53248
    ds_read_b64_tr_b16 a[174:175], v5 offset:55296
    v_mfma_f32_16x16x32_bf16 v[180:183], a[200:203], v[184:187], v[180:183]
    v_accvgpr_read_b32 v12, a236
    v_accvgpr_read_b32 v13, a240
    v_mfma_f32_16x16x32_bf16 v[180:183], a[204:207], v[192:195], v[180:183]
    ds_read_b64_tr_b16 a[176:177], v5 offset:57344
    ds_read_b64_tr_b16 a[178:179], v5 offset:59392
    v_mfma_f32_16x16x32_bf16 v[180:183], a[208:211], v[200:203], v[180:183]
    v_accvgpr_read_b32 v14, a244
    v_add_f32 v0, v12, v13
    v_add_f32 v0, v0, v14
    v_mfma_f32_16x16x32_bf16 v[180:183], a[212:215], v[208:211], v[180:183]
    ds_read_b64_tr_b16 a[180:181], v5 offset:61440
    ds_read_b64_tr_b16 a[182:183], v5 offset:63488
    v_mfma_f32_16x16x32_bf16 v[196:199], a[184:187], v[44:47], 0
    v_rcp_f32 v12, v12
    v_mfma_f32_16x16x32_bf16 v[196:199], a[188:191], v[52:55], v[196:199]
    v_rcp_f32 v13, v13
    v_mfma_f32_16x16x32_bf16 v[196:199], a[192:195], v[60:63], v[196:199]
    v_rcp_f32 v14, v14
    v_mfma_f32_16x16x32_bf16 v[196:199], a[196:199], v[68:71], v[196:199]
    v_mov_b32 v15, 1400897536
    v_cmp_nlt_f32 vcc, v0, v15
    v_mfma_f32_16x16x32_bf16 v[196:199], a[200:203], v[76:79], v[196:199]
    v_mbcnt_lo_u32_b32 v15, -1, 0
    v_and_b32 v15, 3, v15
    v_mfma_f32_16x16x32_bf16 v[196:199], a[204:207], v[84:87], v[196:199]
    s_cmp_lg_u64 vcc, 0
    s_cselect_b32 s94, 1, 0
    v_mfma_f32_16x16x32_bf16 v[196:199], a[208:211], v[92:95], v[196:199]
    v_mov_b32 v0, s94
    v_lshl_add_u32 v15, v15, 12, s92
    v_mfma_f32_16x16x32_bf16 v[196:199], a[212:215], v[108:111], v[196:199]
    ds_write_b32 v15, v0 offset:0
    s_waitcnt lgkmcnt(9)
    v_mfma_f32_16x16x32_bf16 v[204:207], a[152:155], v[88:91], v[204:207]
    ds_read_b64_tr_b16 a[184:185], v6 offset:32768
    v_add_u32 v5, 65536, v5
    v_mfma_f32_16x16x32_bf16 v[204:207], a[156:159], v[96:99], v[204:207]
    ds_read_b64_tr_b16 a[186:187], v6 offset:34816
    v_mbcnt_lo_u32_b32 v15, -1, 0
    v_mfma_f32_16x16x32_bf16 v[204:207], a[160:163], v[104:107], v[204:207]
    ds_read_b64_tr_b16 a[188:189], v6 offset:36864
    v_and_b32 v15, 3, v15
    v_mfma_f32_16x16x32_bf16 v[204:207], a[164:167], v[112:115], v[204:207]
    ds_read_b64_tr_b16 a[190:191], v6 offset:38912
    s_waitcnt lgkmcnt(5)
    v_mfma_f32_16x16x32_bf16 v[204:207], a[168:171], v[120:123], v[204:207]
    ds_read_b64_tr_b16 a[192:193], v6 offset:40960
    v_lshl_add_u32 v15, v15, 2, s93
    v_mfma_f32_16x16x32_bf16 v[204:207], a[172:175], v[128:131], v[204:207]
    ds_read_b64_tr_b16 a[194:195], v6 offset:43008
    v_mfma_f32_16x16x32_bf16 v[204:207], a[176:179], v[136:139], v[204:207]
    ds_read_b64_tr_b16 a[196:197], v6 offset:45056
    v_mfma_f32_16x16x32_bf16 v[204:207], a[180:183], v[144:147], v[204:207]
    ds_read_b64_tr_b16 a[198:199], v6 offset:47104
    v_mfma_f32_16x16x32_bf16 v[212:215], a[152:155], v[216:219], v[212:215]
    ds_read_b64_tr_b16 a[200:201], v6 offset:49152
    v_mfma_f32_16x16x32_bf16 v[212:215], a[156:159], v[224:227], v[212:215]
    ds_read_b64_tr_b16 a[202:203], v6 offset:51200
    v_mfma_f32_16x16x32_bf16 v[212:215], a[160:163], v[232:235], v[212:215]
    ds_read_b64_tr_b16 a[204:205], v6 offset:53248
    v_mfma_f32_16x16x32_bf16 v[212:215], a[164:167], v[240:243], v[212:215]
    ds_read_b64_tr_b16 a[206:207], v6 offset:55296
    v_mfma_f32_16x16x32_bf16 v[212:215], a[168:171], v[248:251], v[212:215]
    ds_read_b64_tr_b16 a[208:209], v6 offset:57344
    v_mul_f32 v204, v12, v204
    v_mfma_f32_16x16x32_bf16 v[212:215], a[172:175], v[16:19], v[212:215]
    ds_read_b64_tr_b16 a[210:211], v6 offset:59392
    v_mul_f32 v205, v12, v205
    v_mfma_f32_16x16x32_bf16 v[212:215], a[176:179], v[28:31], v[212:215]
    ds_read_b64_tr_b16 a[212:213], v6 offset:61440
    v_mul_f32 v206, v12, v206
    v_mfma_f32_16x16x32_bf16 v[212:215], a[180:183], v[36:39], v[212:215]
    ds_read_b64_tr_b16 a[214:215], v6 offset:63488
    v_mul_f32 v207, v12, v207
    v_mfma_f32_16x16x32_bf16 v[100:103], a[152:155], v[124:127], v[100:103]
    v_cvt_pk_bf16_f32 v204, v204, v205
    v_cvt_pk_bf16_f32 v205, v206, v207
    v_mfma_f32_16x16x32_bf16 v[100:103], a[156:159], v[140:143], v[100:103]
    v_mfma_f32_16x16x32_bf16 v[100:103], a[160:163], v[220:223], v[100:103]
    v_mfma_f32_16x16x32_bf16 v[100:103], a[164:167], v[236:239], v[100:103]
    v_mfma_f32_16x16x32_bf16 v[100:103], a[168:171], v[252:255], v[100:103]
    v_mul_f32 v212, v13, v212
    v_mul_f32 v213, v13, v213
    v_mfma_f32_16x16x32_bf16 v[100:103], a[172:175], v[156:159], v[100:103]
    v_mul_f32 v214, v13, v214
    v_mul_f32 v215, v13, v215
    v_mfma_f32_16x16x32_bf16 v[100:103], a[176:179], v[172:175], v[100:103]
    v_cvt_pk_bf16_f32 v212, v212, v213
    v_cvt_pk_bf16_f32 v213, v214, v215
    v_mfma_f32_16x16x32_bf16 v[100:103], a[180:183], v[188:191], v[100:103]
    s_waitcnt lgkmcnt(8)
    v_mfma_f32_16x16x32_bf16 v[116:119], a[184:187], v[88:91], v[116:119]
    ds_read_b64_tr_b16 a[152:153], v7 offset:32768
    v_add_u32 v6, 65536, v6
    v_mfma_f32_16x16x32_bf16 v[116:119], a[188:191], v[96:99], v[116:119]
    ds_read_b64_tr_b16 a[154:155], v7 offset:34816
    v_mfma_f32_16x16x32_bf16 v[116:119], a[192:195], v[104:107], v[116:119]
    ds_read_b64_tr_b16 a[156:157], v7 offset:36864
    v_mfma_f32_16x16x32_bf16 v[116:119], a[196:199], v[112:115], v[116:119]
    ds_read_b64_tr_b16 a[158:159], v7 offset:38912
    s_waitcnt lgkmcnt(4)
    v_mfma_f32_16x16x32_bf16 v[116:119], a[200:203], v[120:123], v[116:119]
    ds_read_b64_tr_b16 a[160:161], v7 offset:40960
    v_mul_f32 v100, v14, v100
    v_mfma_f32_16x16x32_bf16 v[116:119], a[204:207], v[128:131], v[116:119]
    ds_read_b64_tr_b16 a[162:163], v7 offset:43008
    v_mul_f32 v101, v14, v101
    v_mfma_f32_16x16x32_bf16 v[116:119], a[208:211], v[136:139], v[116:119]
    ds_read_b64_tr_b16 a[164:165], v7 offset:45056
    v_mul_f32 v102, v14, v102
    v_mfma_f32_16x16x32_bf16 v[116:119], a[212:215], v[144:147], v[116:119]
    ds_read_b64_tr_b16 a[166:167], v7 offset:47104
    v_mul_f32 v103, v14, v103
    v_mfma_f32_16x16x32_bf16 v[132:135], a[184:187], v[216:219], v[132:135]
    ds_read_b64_tr_b16 a[168:169], v7 offset:49152
    v_cvt_pk_bf16_f32 v100, v100, v101
    v_mfma_f32_16x16x32_bf16 v[132:135], a[188:191], v[224:227], v[132:135]
    ds_read_b64_tr_b16 a[170:171], v7 offset:51200
    v_cvt_pk_bf16_f32 v101, v102, v103
    v_mfma_f32_16x16x32_bf16 v[132:135], a[192:195], v[232:235], v[132:135]
    ds_read_b64_tr_b16 a[172:173], v7 offset:53248
    v_mfma_f32_16x16x32_bf16 v[132:135], a[196:199], v[240:243], v[132:135]
    ds_read_b64_tr_b16 a[174:175], v7 offset:55296
    v_mfma_f32_16x16x32_bf16 v[132:135], a[200:203], v[248:251], v[132:135]
    ds_read_b64_tr_b16 a[176:177], v7 offset:57344
    v_mul_f32 v116, v12, v116
    v_mfma_f32_16x16x32_bf16 v[132:135], a[204:207], v[16:19], v[132:135]
    ds_read_b64_tr_b16 a[178:179], v7 offset:59392
    v_mul_f32 v117, v12, v117
    v_mfma_f32_16x16x32_bf16 v[132:135], a[208:211], v[28:31], v[132:135]
    ds_read_b64_tr_b16 a[180:181], v7 offset:61440
    v_mul_f32 v118, v12, v118
    v_mfma_f32_16x16x32_bf16 v[132:135], a[212:215], v[36:39], v[132:135]
    ds_read_b64_tr_b16 a[182:183], v7 offset:63488
    v_mul_f32 v119, v12, v119
    v_mfma_f32_16x16x32_bf16 v[148:151], a[184:187], v[124:127], v[148:151]
    v_cvt_pk_bf16_f32 v206, v116, v117
    v_cvt_pk_bf16_f32 v207, v118, v119
    v_mfma_f32_16x16x32_bf16 v[148:151], a[188:191], v[140:143], v[148:151]
    v_permlane16_swap_b32 v204, v206
    v_permlane16_swap_b32 v205, v207
    v_mfma_f32_16x16x32_bf16 v[148:151], a[192:195], v[220:223], v[148:151]
    buffer_store_dwordx4 v[204:207], v9, s[32:35], s40 offen offset:0 sc1 nt
    v_mfma_f32_16x16x32_bf16 v[148:151], a[196:199], v[236:239], v[148:151]
    v_mfma_f32_16x16x32_bf16 v[148:151], a[200:203], v[252:255], v[148:151]
    v_mul_f32 v132, v13, v132
    v_mul_f32 v133, v13, v133
    v_mfma_f32_16x16x32_bf16 v[148:151], a[204:207], v[156:159], v[148:151]
    v_mul_f32 v134, v13, v134
    v_mul_f32 v135, v13, v135
    v_mfma_f32_16x16x32_bf16 v[148:151], a[208:211], v[172:175], v[148:151]
    v_cvt_pk_bf16_f32 v214, v132, v133
    v_cvt_pk_bf16_f32 v215, v134, v135
    v_mfma_f32_16x16x32_bf16 v[148:151], a[212:215], v[188:191], v[148:151]
    v_permlane16_swap_b32 v212, v214
    s_waitcnt lgkmcnt(8)
    v_mfma_f32_16x16x32_bf16 v[228:231], a[152:155], v[88:91], v[228:231]
    ds_read_b64_tr_b16 a[184:185], v8 offset:32768
    v_add_u32 v7, 65536, v7
    v_mfma_f32_16x16x32_bf16 v[228:231], a[156:159], v[96:99], v[228:231]
    ds_read_b64_tr_b16 a[186:187], v8 offset:34816
    v_permlane16_swap_b32 v213, v215
    v_mfma_f32_16x16x32_bf16 v[228:231], a[160:163], v[104:107], v[228:231]
    ds_read_b64_tr_b16 a[188:189], v8 offset:36864
    v_mfma_f32_16x16x32_bf16 v[228:231], a[164:167], v[112:115], v[228:231]
    ds_read_b64_tr_b16 a[190:191], v8 offset:38912
    s_waitcnt lgkmcnt(4)
    v_mfma_f32_16x16x32_bf16 v[228:231], a[168:171], v[120:123], v[228:231]
    ds_read_b64_tr_b16 a[192:193], v8 offset:40960
    v_mfma_f32_16x16x32_bf16 v[228:231], a[172:175], v[128:131], v[228:231]
    ds_read_b64_tr_b16 a[194:195], v8 offset:43008
    v_mfma_f32_16x16x32_bf16 v[228:231], a[176:179], v[136:139], v[228:231]
    ds_read_b64_tr_b16 a[196:197], v8 offset:45056
    v_mfma_f32_16x16x32_bf16 v[228:231], a[180:183], v[144:147], v[228:231]
    ds_read_b64_tr_b16 a[198:199], v8 offset:47104
    v_mfma_f32_16x16x32_bf16 v[244:247], a[152:155], v[216:219], v[244:247]
    ds_read_b64_tr_b16 a[200:201], v8 offset:49152
    v_mfma_f32_16x16x32_bf16 v[244:247], a[156:159], v[224:227], v[244:247]
    ds_read_b64_tr_b16 a[202:203], v8 offset:51200
    v_mfma_f32_16x16x32_bf16 v[244:247], a[160:163], v[232:235], v[244:247]
    ds_read_b64_tr_b16 a[204:205], v8 offset:53248
    v_mfma_f32_16x16x32_bf16 v[244:247], a[164:167], v[240:243], v[244:247]
    ds_read_b64_tr_b16 a[206:207], v8 offset:55296
    v_mfma_f32_16x16x32_bf16 v[244:247], a[168:171], v[248:251], v[244:247]
    ds_read_b64_tr_b16 a[208:209], v8 offset:57344
    v_mfma_f32_16x16x32_bf16 v[244:247], a[172:175], v[16:19], v[244:247]
    ds_read_b64_tr_b16 a[210:211], v8 offset:59392
    v_mfma_f32_16x16x32_bf16 v[244:247], a[176:179], v[28:31], v[244:247]
    ds_read_b64_tr_b16 a[212:213], v8 offset:61440
    v_mfma_f32_16x16x32_bf16 v[244:247], a[180:183], v[36:39], v[244:247]
    ds_read_b64_tr_b16 a[214:215], v8 offset:63488
    v_mfma_f32_16x16x32_bf16 v[20:23], a[152:155], v[124:127], v[20:23]
    buffer_store_dwordx4 v[212:215], v10, s[32:35], s40 offen offset:0 sc1 nt
    v_mfma_f32_16x16x32_bf16 v[20:23], a[156:159], v[140:143], v[20:23]
    v_mul_f32 v148, v14, v148
    v_mul_f32 v149, v14, v149
    v_mfma_f32_16x16x32_bf16 v[20:23], a[160:163], v[220:223], v[20:23]
    v_mul_f32 v150, v14, v150
    v_mul_f32 v151, v14, v151
    v_mfma_f32_16x16x32_bf16 v[20:23], a[164:167], v[236:239], v[20:23]
    v_cvt_pk_bf16_f32 v102, v148, v149
    v_cvt_pk_bf16_f32 v103, v150, v151
    v_mfma_f32_16x16x32_bf16 v[20:23], a[168:171], v[252:255], v[20:23]
    v_permlane16_swap_b32 v100, v102
    v_permlane16_swap_b32 v101, v103
    v_mfma_f32_16x16x32_bf16 v[20:23], a[172:175], v[156:159], v[20:23]
    buffer_store_dwordx4 v[100:103], v11, s[32:35], s40 offen offset:0 sc1 nt
    v_mfma_f32_16x16x32_bf16 v[20:23], a[176:179], v[172:175], v[20:23]
    v_mul_f32 v228, v12, v228
    v_mul_f32 v229, v12, v229
    v_mfma_f32_16x16x32_bf16 v[20:23], a[180:183], v[188:191], v[20:23]
    v_mul_f32 v230, v12, v230
    s_waitcnt lgkmcnt(8)
    v_mfma_f32_16x16x32_bf16 v[164:167], a[184:187], v[88:91], v[164:167]
    s_waitcnt vmcnt(21)
    s_barrier
    v_mfma_f32_16x16x32_bf16 v[164:167], a[188:191], v[96:99], v[164:167]
    ds_read_b64_tr_b16 a[152:153], v5 offset:0
    v_add_u32 v8, 65536, v8
    ds_read_b32 v0, v15 offset:0
    v_mfma_f32_16x16x32_bf16 v[164:167], a[192:195], v[104:107], v[164:167]
    ds_read_b64_tr_b16 a[154:155], v5 offset:2048
    v_mul_f32 v231, v12, v231
    v_mfma_f32_16x16x32_bf16 v[164:167], a[196:199], v[112:115], v[164:167]
    ds_read_b64_tr_b16 a[156:157], v5 offset:4096
    s_waitcnt lgkmcnt(4)
    v_mfma_f32_16x16x32_bf16 v[164:167], a[200:203], v[120:123], v[164:167]
    ds_read_b64_tr_b16 a[158:159], v5 offset:6144
    v_cvt_pk_bf16_f32 v228, v228, v229
    v_mfma_f32_16x16x32_bf16 v[164:167], a[204:207], v[128:131], v[164:167]
    ds_read_b64_tr_b16 a[160:161], v5 offset:8192
    v_cvt_pk_bf16_f32 v229, v230, v231
    v_mfma_f32_16x16x32_bf16 v[164:167], a[208:211], v[136:139], v[164:167]
    ds_read_b64_tr_b16 a[162:163], v5 offset:10240
    v_mul_f32 v244, v13, v244
    v_mfma_f32_16x16x32_bf16 v[164:167], a[212:215], v[144:147], v[164:167]
    ds_read_b64_tr_b16 a[164:165], v5 offset:12288
    v_mul_f32 v245, v13, v245
    v_mfma_f32_16x16x32_bf16 v[180:183], a[184:187], v[216:219], v[180:183]
    ds_read_b64_tr_b16 a[166:167], v5 offset:14336
    s_waitcnt lgkmcnt(7)
    v_cmp_ne_u32 vcc, 0, v0
    v_mfma_f32_16x16x32_bf16 v[180:183], a[188:191], v[224:227], v[180:183]
    ds_read_b64_tr_b16 a[168:169], v5 offset:16384
    v_mul_f32 v246, v13, v246
    v_mfma_f32_16x16x32_bf16 v[180:183], a[192:195], v[232:235], v[180:183]
    ds_read_b64_tr_b16 a[170:171], v5 offset:18432
    v_mul_f32 v247, v13, v247
    v_mfma_f32_16x16x32_bf16 v[180:183], a[196:199], v[240:243], v[180:183]
    ds_read_b64_tr_b16 a[172:173], v5 offset:20480
    s_cmp_lg_u64 vcc, 0
    s_cbranch_scc1 L_fallback
    v_mfma_f32_16x16x32_bf16 v[180:183], a[200:203], v[248:251], v[180:183]
    ds_read_b64_tr_b16 a[174:175], v5 offset:22528
    s_add_u32 m0, s36, 131072
    v_mfma_f32_16x16x32_bf16 v[180:183], a[204:207], v[16:19], v[180:183]
    ds_read_b64_tr_b16 a[176:177], v5 offset:24576
    s_add_u32 s48, s38, 131328
    v_mfma_f32_16x16x32_bf16 v[180:183], a[208:211], v[28:31], v[180:183]
    ds_read_b64_tr_b16 a[178:179], v5 offset:26624
    buffer_load_dwordx4 v1, s[28:31], s48 offen offset:0 lds
    v_mfma_f32_16x16x32_bf16 v[180:183], a[212:215], v[36:39], v[180:183]
    ds_read_b64_tr_b16 a[180:181], v5 offset:28672
    v_cvt_pk_bf16_f32 v244, v244, v245
    v_mfma_f32_16x16x32_bf16 v[196:199], a[184:187], v[124:127], v[196:199]
    ds_read_b64_tr_b16 a[182:183], v5 offset:30720
    v_cvt_pk_bf16_f32 v245, v246, v247
    v_mfma_f32_16x16x32_bf16 v[196:199], a[188:191], v[140:143], v[196:199]
    v_mul_f32 v20, v14, v20
    v_mul_f32 v21, v14, v21
    v_mfma_f32_16x16x32_bf16 v[196:199], a[192:195], v[220:223], v[196:199]
    v_mul_f32 v22, v14, v22
    v_mul_f32 v23, v14, v23
    v_mfma_f32_16x16x32_bf16 v[196:199], a[196:199], v[236:239], v[196:199]
    v_cvt_pk_bf16_f32 v20, v20, v21
    v_cvt_pk_bf16_f32 v21, v22, v23
    v_mfma_f32_16x16x32_bf16 v[196:199], a[200:203], v[252:255], v[196:199]
    v_mul_f32 v164, v12, v164
    v_mul_f32 v165, v12, v165
    v_mfma_f32_16x16x32_bf16 v[196:199], a[204:207], v[156:159], v[196:199]
    v_mul_f32 v166, v12, v166
    v_mul_f32 v167, v12, v167
    v_mfma_f32_16x16x32_bf16 v[196:199], a[208:211], v[172:175], v[196:199]
    v_cvt_pk_bf16_f32 v230, v164, v165
    v_cvt_pk_bf16_f32 v231, v166, v167
    v_mfma_f32_16x16x32_bf16 v[196:199], a[212:215], v[188:191], v[196:199]
    v_permlane16_swap_b32 v228, v230
    s_waitcnt lgkmcnt(8)
    v_mfma_f32_16x16x32_bf16 v[204:207], a[152:155], v[24:27], 0
    ds_read_b64_tr_b16 a[184:185], v6 offset:0
    buffer_load_dwordx4 v2, s[28:31], s48 offen offset:1024 lds
    v_mfma_f32_16x16x32_bf16 v[204:207], a[156:159], v[32:35], v[204:207]
    ds_read_b64_tr_b16 a[186:187], v6 offset:2048
    v_permlane16_swap_b32 v229, v231
    v_mfma_f32_16x16x32_bf16 v[204:207], a[160:163], v[40:43], v[204:207]
    ds_read_b64_tr_b16 a[188:189], v6 offset:4096
    v_mfma_f32_16x16x32_bf16 v[204:207], a[164:167], v[48:51], v[204:207]
    ds_read_b64_tr_b16 a[190:191], v6 offset:6144
    s_waitcnt lgkmcnt(4)
    v_mfma_f32_16x16x32_bf16 v[204:207], a[168:171], v[56:59], v[204:207]
    ds_read_b64_tr_b16 a[192:193], v6 offset:8192
    v_mfma_f32_16x16x32_bf16 v[204:207], a[172:175], v[64:67], v[204:207]
    ds_read_b64_tr_b16 a[194:195], v6 offset:10240
    v_mfma_f32_16x16x32_bf16 v[204:207], a[176:179], v[72:75], v[204:207]
    ds_read_b64_tr_b16 a[196:197], v6 offset:12288
    v_mfma_f32_16x16x32_bf16 v[204:207], a[180:183], v[80:83], v[204:207]
    ds_read_b64_tr_b16 a[198:199], v6 offset:14336
    v_mfma_f32_16x16x32_bf16 v[212:215], a[152:155], v[152:155], 0
    ds_read_b64_tr_b16 a[200:201], v6 offset:16384
    v_mfma_f32_16x16x32_bf16 v[212:215], a[156:159], v[160:163], v[212:215]
    ds_read_b64_tr_b16 a[202:203], v6 offset:18432
    v_mfma_f32_16x16x32_bf16 v[212:215], a[160:163], v[168:171], v[212:215]
    ds_read_b64_tr_b16 a[204:205], v6 offset:20480
    buffer_load_dwordx4 v3, s[28:31], s48 offen offset:2048 lds
    v_mfma_f32_16x16x32_bf16 v[212:215], a[164:167], v[176:179], v[212:215]
    ds_read_b64_tr_b16 a[206:207], v6 offset:22528
    v_mfma_f32_16x16x32_bf16 v[212:215], a[168:171], v[184:187], v[212:215]
    ds_read_b64_tr_b16 a[208:209], v6 offset:24576
    v_mfma_f32_16x16x32_bf16 v[212:215], a[172:175], v[192:195], v[212:215]
    ds_read_b64_tr_b16 a[210:211], v6 offset:26624
    v_mfma_f32_16x16x32_bf16 v[212:215], a[176:179], v[200:203], v[212:215]
    ds_read_b64_tr_b16 a[212:213], v6 offset:28672
    v_mfma_f32_16x16x32_bf16 v[212:215], a[180:183], v[208:211], v[212:215]
    ds_read_b64_tr_b16 a[214:215], v6 offset:30720
    v_mfma_f32_16x16x32_bf16 v[100:103], a[152:155], v[44:47], 0
    buffer_store_dwordx4 v[228:231], v9, s[32:35], s40 offen offset:64 sc1 nt
    v_mfma_f32_16x16x32_bf16 v[100:103], a[156:159], v[52:55], v[100:103]
    v_mul_f32 v180, v13, v180
    v_mul_f32 v181, v13, v181
    v_mfma_f32_16x16x32_bf16 v[100:103], a[160:163], v[60:63], v[100:103]
    v_mul_f32 v182, v13, v182
    v_mul_f32 v183, v13, v183
    v_mfma_f32_16x16x32_bf16 v[100:103], a[164:167], v[68:71], v[100:103]
    v_cvt_pk_bf16_f32 v246, v180, v181
    v_cvt_pk_bf16_f32 v247, v182, v183
    v_mfma_f32_16x16x32_bf16 v[100:103], a[168:171], v[76:79], v[100:103]
    buffer_load_dwordx4 v4, s[28:31], s48 offen offset:3072 lds
    v_permlane16_swap_b32 v244, v246
    v_mfma_f32_16x16x32_bf16 v[100:103], a[172:175], v[84:87], v[100:103]
    v_permlane16_swap_b32 v245, v247
    v_mfma_f32_16x16x32_bf16 v[100:103], a[176:179], v[92:95], v[100:103]
    buffer_store_dwordx4 v[244:247], v10, s[32:35], s40 offen offset:64 sc1 nt
    v_mfma_f32_16x16x32_bf16 v[100:103], a[180:183], v[108:111], v[100:103]
    v_mul_f32 v196, v14, v196
    s_waitcnt lgkmcnt(8)
    v_mfma_f32_16x16x32_bf16 v[116:119], a[184:187], v[24:27], 0
    ds_read_b64_tr_b16 a[152:153], v7 offset:0
    v_mul_f32 v197, v14, v197
    v_mfma_f32_16x16x32_bf16 v[116:119], a[188:191], v[32:35], v[116:119]
    ds_read_b64_tr_b16 a[154:155], v7 offset:2048
    v_mul_f32 v198, v14, v198
    v_mfma_f32_16x16x32_bf16 v[116:119], a[192:195], v[40:43], v[116:119]
    ds_read_b64_tr_b16 a[156:157], v7 offset:4096
    v_mul_f32 v199, v14, v199
    v_mfma_f32_16x16x32_bf16 v[116:119], a[196:199], v[48:51], v[116:119]
    ds_read_b64_tr_b16 a[158:159], v7 offset:6144
    s_waitcnt lgkmcnt(4)
    v_mfma_f32_16x16x32_bf16 v[116:119], a[200:203], v[56:59], v[116:119]
    ds_read_b64_tr_b16 a[160:161], v7 offset:8192
    v_cvt_pk_bf16_f32 v22, v196, v197
    v_mfma_f32_16x16x32_bf16 v[116:119], a[204:207], v[64:67], v[116:119]
    ds_read_b64_tr_b16 a[162:163], v7 offset:10240
    v_cvt_pk_bf16_f32 v23, v198, v199
    v_mfma_f32_16x16x32_bf16 v[116:119], a[208:211], v[72:75], v[116:119]
    ds_read_b64_tr_b16 a[164:165], v7 offset:12288
    s_add_u32 m0, s36, 147456
    v_mfma_f32_16x16x32_bf16 v[116:119], a[212:215], v[80:83], v[116:119]
    ds_read_b64_tr_b16 a[166:167], v7 offset:14336
    s_add_u32 s48, s38, 196864
    v_mfma_f32_16x16x32_bf16 v[132:135], a[184:187], v[152:155], 0
    ds_read_b64_tr_b16 a[168:169], v7 offset:16384
    buffer_load_dwordx4 v1, s[28:31], s48 offen offset:0 lds
    v_mfma_f32_16x16x32_bf16 v[132:135], a[188:191], v[160:163], v[132:135]
    ds_read_b64_tr_b16 a[170:171], v7 offset:18432
    v_permlane16_swap_b32 v20, v22
    v_mfma_f32_16x16x32_bf16 v[132:135], a[192:195], v[168:171], v[132:135]
    ds_read_b64_tr_b16 a[172:173], v7 offset:20480
    v_permlane16_swap_b32 v21, v23
    v_mfma_f32_16x16x32_bf16 v[132:135], a[196:199], v[176:179], v[132:135]
    ds_read_b64_tr_b16 a[174:175], v7 offset:22528
    v_mfma_f32_16x16x32_bf16 v[132:135], a[200:203], v[184:187], v[132:135]
    ds_read_b64_tr_b16 a[176:177], v7 offset:24576
    v_mfma_f32_16x16x32_bf16 v[132:135], a[204:207], v[192:195], v[132:135]
    ds_read_b64_tr_b16 a[178:179], v7 offset:26624
    v_mfma_f32_16x16x32_bf16 v[132:135], a[208:211], v[200:203], v[132:135]
    ds_read_b64_tr_b16 a[180:181], v7 offset:28672
    v_mfma_f32_16x16x32_bf16 v[132:135], a[212:215], v[208:211], v[132:135]
    ds_read_b64_tr_b16 a[182:183], v7 offset:30720
    v_mfma_f32_16x16x32_bf16 v[148:151], a[184:187], v[44:47], 0
    buffer_store_dwordx4 v[20:23], v11, s[32:35], s40 offen offset:64 sc1 nt
    v_mfma_f32_16x16x32_bf16 v[148:151], a[188:191], v[52:55], v[148:151]
    v_mfma_f32_16x16x32_bf16 v[148:151], a[192:195], v[60:63], v[148:151]
    buffer_load_dwordx4 v2, s[28:31], s48 offen offset:1024 lds
    v_mfma_f32_16x16x32_bf16 v[148:151], a[196:199], v[68:71], v[148:151]
    v_mfma_f32_16x16x32_bf16 v[148:151], a[200:203], v[76:79], v[148:151]
    v_mfma_f32_16x16x32_bf16 v[148:151], a[204:207], v[84:87], v[148:151]
    v_mfma_f32_16x16x32_bf16 v[148:151], a[208:211], v[92:95], v[148:151]
    v_mfma_f32_16x16x32_bf16 v[148:151], a[212:215], v[108:111], v[148:151]
    s_waitcnt lgkmcnt(8)
    v_mfma_f32_16x16x32_bf16 v[228:231], a[152:155], v[24:27], 0
    ds_read_b64_tr_b16 a[184:185], v8 offset:0
    v_mfma_f32_16x16x32_bf16 v[228:231], a[156:159], v[32:35], v[228:231]
    ds_read_b64_tr_b16 a[186:187], v8 offset:2048
    v_mfma_f32_16x16x32_bf16 v[228:231], a[160:163], v[40:43], v[228:231]
    ds_read_b64_tr_b16 a[188:189], v8 offset:4096
    v_mfma_f32_16x16x32_bf16 v[228:231], a[164:167], v[48:51], v[228:231]
    ds_read_b64_tr_b16 a[190:191], v8 offset:6144
    s_waitcnt lgkmcnt(4)
    v_mfma_f32_16x16x32_bf16 v[228:231], a[168:171], v[56:59], v[228:231]
    ds_read_b64_tr_b16 a[192:193], v8 offset:8192
    buffer_load_dwordx4 v3, s[28:31], s48 offen offset:2048 lds
    v_mfma_f32_16x16x32_bf16 v[228:231], a[172:175], v[64:67], v[228:231]
    ds_read_b64_tr_b16 a[194:195], v8 offset:10240
    v_mfma_f32_16x16x32_bf16 v[228:231], a[176:179], v[72:75], v[228:231]
    ds_read_b64_tr_b16 a[196:197], v8 offset:12288
    v_mfma_f32_16x16x32_bf16 v[228:231], a[180:183], v[80:83], v[228:231]
    ds_read_b64_tr_b16 a[198:199], v8 offset:14336
    v_mfma_f32_16x16x32_bf16 v[244:247], a[152:155], v[152:155], 0
    ds_read_b64_tr_b16 a[200:201], v8 offset:16384
    v_mfma_f32_16x16x32_bf16 v[244:247], a[156:159], v[160:163], v[244:247]
    ds_read_b64_tr_b16 a[202:203], v8 offset:18432
    v_mfma_f32_16x16x32_bf16 v[244:247], a[160:163], v[168:171], v[244:247]
    ds_read_b64_tr_b16 a[204:205], v8 offset:20480
    v_mfma_f32_16x16x32_bf16 v[244:247], a[164:167], v[176:179], v[244:247]
    ds_read_b64_tr_b16 a[206:207], v8 offset:22528
    v_mfma_f32_16x16x32_bf16 v[244:247], a[168:171], v[184:187], v[244:247]
    ds_read_b64_tr_b16 a[208:209], v8 offset:24576
    v_mfma_f32_16x16x32_bf16 v[244:247], a[172:175], v[192:195], v[244:247]
    ds_read_b64_tr_b16 a[210:211], v8 offset:26624
    v_mfma_f32_16x16x32_bf16 v[244:247], a[176:179], v[200:203], v[244:247]
    ds_read_b64_tr_b16 a[212:213], v8 offset:28672
    buffer_load_dwordx4 v4, s[28:31], s48 offen offset:3072 lds
    v_mfma_f32_16x16x32_bf16 v[244:247], a[180:183], v[208:211], v[244:247]
    ds_read_b64_tr_b16 a[214:215], v8 offset:30720
    v_mfma_f32_16x16x32_bf16 v[20:23], a[152:155], v[44:47], 0
    v_mfma_f32_16x16x32_bf16 v[20:23], a[156:159], v[52:55], v[20:23]
    v_mfma_f32_16x16x32_bf16 v[20:23], a[160:163], v[60:63], v[20:23]
    v_mfma_f32_16x16x32_bf16 v[20:23], a[164:167], v[68:71], v[20:23]
    v_mfma_f32_16x16x32_bf16 v[20:23], a[168:171], v[76:79], v[20:23]
    v_mfma_f32_16x16x32_bf16 v[20:23], a[172:175], v[84:87], v[20:23]
    v_mfma_f32_16x16x32_bf16 v[20:23], a[176:179], v[92:95], v[20:23]
    v_mfma_f32_16x16x32_bf16 v[20:23], a[180:183], v[108:111], v[20:23]
    s_waitcnt lgkmcnt(8)
    v_mfma_f32_16x16x32_bf16 v[164:167], a[184:187], v[24:27], 0
    s_waitcnt vmcnt(28)
    s_barrier
    v_mfma_f32_16x16x32_bf16 v[164:167], a[188:191], v[32:35], v[164:167]
    ds_read_b64_tr_b16 a[152:153], v5 offset:49152
    s_add_u32 m0, s36, 32768
    v_mfma_f32_16x16x32_bf16 v[164:167], a[192:195], v[40:43], v[164:167]
    ds_read_b64_tr_b16 a[154:155], v5 offset:51200
    s_add_u32 s48, s38, 384
    v_mfma_f32_16x16x32_bf16 v[164:167], a[196:199], v[48:51], v[164:167]
    ds_read_b64_tr_b16 a[156:157], v5 offset:53248
    s_waitcnt lgkmcnt(3)
    v_mfma_f32_16x16x32_bf16 v[164:167], a[200:203], v[56:59], v[164:167]
    ds_read_b64_tr_b16 a[158:159], v5 offset:55296
    buffer_load_dwordx4 v1, s[28:31], s48 offen offset:0 lds
    v_mfma_f32_16x16x32_bf16 v[164:167], a[204:207], v[64:67], v[164:167]
    ds_read_b64_tr_b16 a[160:161], v5 offset:57344
    v_mfma_f32_16x16x32_bf16 v[164:167], a[208:211], v[72:75], v[164:167]
    ds_read_b64_tr_b16 a[162:163], v5 offset:59392
    v_mfma_f32_16x16x32_bf16 v[164:167], a[212:215], v[80:83], v[164:167]
    ds_read_b64_tr_b16 a[164:165], v5 offset:61440
    v_mfma_f32_16x16x32_bf16 v[180:183], a[184:187], v[152:155], 0
    ds_read_b64_tr_b16 a[166:167], v5 offset:63488
    v_mfma_f32_16x16x32_bf16 v[180:183], a[188:191], v[160:163], v[180:183]
    ds_read_b64_tr_b16 a[168:169], v5 offset:32768
    v_mfma_f32_16x16x32_bf16 v[180:183], a[192:195], v[168:171], v[180:183]
    ds_read_b64_tr_b16 a[170:171], v5 offset:34816
    v_mfma_f32_16x16x32_bf16 v[180:183], a[196:199], v[176:179], v[180:183]
    ds_read_b64_tr_b16 a[172:173], v5 offset:36864
    v_mfma_f32_16x16x32_bf16 v[180:183], a[200:203], v[184:187], v[180:183]
    ds_read_b64_tr_b16 a[174:175], v5 offset:38912
    v_mfma_f32_16x16x32_bf16 v[180:183], a[204:207], v[192:195], v[180:183]
    ds_read_b64_tr_b16 a[176:177], v5 offset:40960
    v_mfma_f32_16x16x32_bf16 v[180:183], a[208:211], v[200:203], v[180:183]
    ds_read_b64_tr_b16 a[178:179], v5 offset:43008
    buffer_load_dwordx4 v2, s[28:31], s48 offen offset:1024 lds
    v_mfma_f32_16x16x32_bf16 v[180:183], a[212:215], v[208:211], v[180:183]
    ds_read_b64_tr_b16 a[180:181], v5 offset:45056
    v_mfma_f32_16x16x32_bf16 v[196:199], a[184:187], v[44:47], 0
    ds_read_b64_tr_b16 a[182:183], v5 offset:47104
    v_mfma_f32_16x16x32_bf16 v[196:199], a[188:191], v[52:55], v[196:199]
    v_mfma_f32_16x16x32_bf16 v[196:199], a[192:195], v[60:63], v[196:199]
    v_mfma_f32_16x16x32_bf16 v[196:199], a[196:199], v[68:71], v[196:199]
    v_mfma_f32_16x16x32_bf16 v[196:199], a[200:203], v[76:79], v[196:199]
    v_mfma_f32_16x16x32_bf16 v[196:199], a[204:207], v[84:87], v[196:199]
    v_mfma_f32_16x16x32_bf16 v[196:199], a[208:211], v[92:95], v[196:199]
    v_mfma_f32_16x16x32_bf16 v[196:199], a[212:215], v[108:111], v[196:199]
    s_waitcnt lgkmcnt(8)
    v_mfma_f32_16x16x32_bf16 v[204:207], a[152:155], v[88:91], v[204:207]
    ds_read_b64_tr_b16 a[184:185], v6 offset:49152
    buffer_load_dwordx4 v3, s[28:31], s48 offen offset:2048 lds
    v_mfma_f32_16x16x32_bf16 v[204:207], a[156:159], v[96:99], v[204:207]
    ds_read_b64_tr_b16 a[186:187], v6 offset:51200
    v_add_u32 v5, 4294901760, v5
    v_mfma_f32_16x16x32_bf16 v[204:207], a[160:163], v[104:107], v[204:207]
    ds_read_b64_tr_b16 a[188:189], v6 offset:53248
    v_mfma_f32_16x16x32_bf16 v[204:207], a[164:167], v[112:115], v[204:207]
    ds_read_b64_tr_b16 a[190:191], v6 offset:55296
    s_waitcnt lgkmcnt(4)
    v_mfma_f32_16x16x32_bf16 v[204:207], a[168:171], v[120:123], v[204:207]
    ds_read_b64_tr_b16 a[192:193], v6 offset:57344
    v_mfma_f32_16x16x32_bf16 v[204:207], a[172:175], v[128:131], v[204:207]
    ds_read_b64_tr_b16 a[194:195], v6 offset:59392
    v_mfma_f32_16x16x32_bf16 v[204:207], a[176:179], v[136:139], v[204:207]
    ds_read_b64_tr_b16 a[196:197], v6 offset:61440
    v_mfma_f32_16x16x32_bf16 v[204:207], a[180:183], v[144:147], v[204:207]
    ds_read_b64_tr_b16 a[198:199], v6 offset:63488
    v_mfma_f32_16x16x32_bf16 v[212:215], a[152:155], v[216:219], v[212:215]
    ds_read_b64_tr_b16 a[200:201], v6 offset:32768
    v_mfma_f32_16x16x32_bf16 v[212:215], a[156:159], v[224:227], v[212:215]
    ds_read_b64_tr_b16 a[202:203], v6 offset:34816
    v_mfma_f32_16x16x32_bf16 v[212:215], a[160:163], v[232:235], v[212:215]
    ds_read_b64_tr_b16 a[204:205], v6 offset:36864
    buffer_load_dwordx4 v4, s[28:31], s48 offen offset:3072 lds
    v_mfma_f32_16x16x32_bf16 v[212:215], a[164:167], v[240:243], v[212:215]
    ds_read_b64_tr_b16 a[206:207], v6 offset:38912
    v_mfma_f32_16x16x32_bf16 v[212:215], a[168:171], v[248:251], v[212:215]
    ds_read_b64_tr_b16 a[208:209], v6 offset:40960
    v_mul_f32 v204, v12, v204
    v_mfma_f32_16x16x32_bf16 v[212:215], a[172:175], v[16:19], v[212:215]
    ds_read_b64_tr_b16 a[210:211], v6 offset:43008
    v_mul_f32 v205, v12, v205
    v_mfma_f32_16x16x32_bf16 v[212:215], a[176:179], v[28:31], v[212:215]
    ds_read_b64_tr_b16 a[212:213], v6 offset:45056
    v_mul_f32 v206, v12, v206
    v_mfma_f32_16x16x32_bf16 v[212:215], a[180:183], v[36:39], v[212:215]
    ds_read_b64_tr_b16 a[214:215], v6 offset:47104
    v_mul_f32 v207, v12, v207
    v_mfma_f32_16x16x32_bf16 v[100:103], a[152:155], v[124:127], v[100:103]
    v_cvt_pk_bf16_f32 v204, v204, v205
    v_cvt_pk_bf16_f32 v205, v206, v207
    v_mfma_f32_16x16x32_bf16 v[100:103], a[156:159], v[140:143], v[100:103]
L_pad5:
    s_cbranch_execz L_back1
    v_mfma_f32_16x16x32_bf16 v[100:103], a[160:163], v[220:223], v[100:103]
    v_mfma_f32_16x16x32_bf16 v[100:103], a[164:167], v[236:239], v[100:103]
    v_mfma_f32_16x16x32_bf16 v[100:103], a[168:171], v[252:255], v[100:103]
    s_add_u32 m0, s36, 49152
    s_add_u32 s48, s38, 65920
    v_mfma_f32_16x16x32_bf16 v[100:103], a[172:175], v[156:159], v[100:103]
    buffer_load_dwordx4 v1, s[28:31], s48 offen offset:0 lds
    v_mul_f32 v212, v13, v212
    v_mfma_f32_16x16x32_bf16 v[100:103], a[176:179], v[172:175], v[100:103]
    v_mul_f32 v213, v13, v213
    v_mul_f32 v214, v13, v214
    v_mfma_f32_16x16x32_bf16 v[100:103], a[180:183], v[188:191], v[100:103]
    v_mul_f32 v215, v13, v215
    s_waitcnt lgkmcnt(8)
    v_mfma_f32_16x16x32_bf16 v[116:119], a[184:187], v[88:91], v[116:119]
    ds_read_b64_tr_b16 a[152:153], v7 offset:49152
    v_add_u32 v6, 4294901760, v6
    v_mfma_f32_16x16x32_bf16 v[116:119], a[188:191], v[96:99], v[116:119]
    ds_read_b64_tr_b16 a[154:155], v7 offset:51200
    v_cvt_pk_bf16_f32 v212, v212, v213
    v_mfma_f32_16x16x32_bf16 v[116:119], a[192:195], v[104:107], v[116:119]
    ds_read_b64_tr_b16 a[156:157], v7 offset:53248
    v_cvt_pk_bf16_f32 v213, v214, v215
    v_mfma_f32_16x16x32_bf16 v[116:119], a[196:199], v[112:115], v[116:119]
    ds_read_b64_tr_b16 a[158:159], v7 offset:55296
    s_waitcnt lgkmcnt(4)
    v_mfma_f32_16x16x32_bf16 v[116:119], a[200:203], v[120:123], v[116:119]
    ds_read_b64_tr_b16 a[160:161], v7 offset:57344
    v_mul_f32 v100, v14, v100
    v_mfma_f32_16x16x32_bf16 v[116:119], a[204:207], v[128:131], v[116:119]
    ds_read_b64_tr_b16 a[162:163], v7 offset:59392
    v_mul_f32 v101, v14, v101
    v_mfma_f32_16x16x32_bf16 v[116:119], a[208:211], v[136:139], v[116:119]
    ds_read_b64_tr_b16 a[164:165], v7 offset:61440
    v_mul_f32 v102, v14, v102
    v_mfma_f32_16x16x32_bf16 v[116:119], a[212:215], v[144:147], v[116:119]
    ds_read_b64_tr_b16 a[166:167], v7 offset:63488
    buffer_load_dwordx4 v2, s[28:31], s48 offen offset:1024 lds
    v_mfma_f32_16x16x32_bf16 v[132:135], a[184:187], v[216:219], v[132:135]
    ds_read_b64_tr_b16 a[168:169], v7 offset:32768
    v_mul_f32 v103, v14, v103
    v_mfma_f32_16x16x32_bf16 v[132:135], a[188:191], v[224:227], v[132:135]
    ds_read_b64_tr_b16 a[170:171], v7 offset:34816
    v_cvt_pk_bf16_f32 v100, v100, v101
    v_mfma_f32_16x16x32_bf16 v[132:135], a[192:195], v[232:235], v[132:135]
    ds_read_b64_tr_b16 a[172:173], v7 offset:36864
    v_cvt_pk_bf16_f32 v101, v102, v103
    v_mfma_f32_16x16x32_bf16 v[132:135], a[196:199], v[240:243], v[132:135]
    ds_read_b64_tr_b16 a[174:175], v7 offset:38912
    v_mfma_f32_16x16x32_bf16 v[132:135], a[200:203], v[248:251], v[132:135]
    ds_read_b64_tr_b16 a[176:177], v7 offset:40960
    v_mul_f32 v116, v12, v116
    v_mfma_f32_16x16x32_bf16 v[132:135], a[204:207], v[16:19], v[132:135]
    ds_read_b64_tr_b16 a[178:179], v7 offset:43008
    v_mul_f32 v117, v12, v117
    v_mfma_f32_16x16x32_bf16 v[132:135], a[208:211], v[28:31], v[132:135]
    ds_read_b64_tr_b16 a[180:181], v7 offset:45056
    v_mul_f32 v118, v12, v118
    v_mfma_f32_16x16x32_bf16 v[132:135], a[212:215], v[36:39], v[132:135]
    ds_read_b64_tr_b16 a[182:183], v7 offset:47104
    v_mul_f32 v119, v12, v119
    v_mfma_f32_16x16x32_bf16 v[148:151], a[184:187], v[124:127], v[148:151]
    v_cvt_pk_bf16_f32 v206, v116, v117
    v_cvt_pk_bf16_f32 v207, v118, v119
    v_mfma_f32_16x16x32_bf16 v[148:151], a[188:191], v[140:143], v[148:151]
    buffer_load_dwordx4 v3, s[28:31], s48 offen offset:2048 lds
    v_permlane16_swap_b32 v204, v206
    v_mfma_f32_16x16x32_bf16 v[148:151], a[192:195], v[220:223], v[148:151]
    v_permlane16_swap_b32 v205, v207
    v_mfma_f32_16x16x32_bf16 v[148:151], a[196:199], v[236:239], v[148:151]
    buffer_store_dwordx4 v[204:207], v9, s[32:35], s41 offen offset:0 sc1 nt
    v_mfma_f32_16x16x32_bf16 v[148:151], a[200:203], v[252:255], v[148:151]
    v_mul_f32 v132, v13, v132
    v_mul_f32 v133, v13, v133
    v_mfma_f32_16x16x32_bf16 v[148:151], a[204:207], v[156:159], v[148:151]
    v_mul_f32 v134, v13, v134
    v_mul_f32 v135, v13, v135
    v_mfma_f32_16x16x32_bf16 v[148:151], a[208:211], v[172:175], v[148:151]
    v_cvt_pk_bf16_f32 v214, v132, v133
    v_cvt_pk_bf16_f32 v215, v134, v135
    v_mfma_f32_16x16x32_bf16 v[148:151], a[212:215], v[188:191], v[148:151]
    v_permlane16_swap_b32 v212, v214
    s_waitcnt lgkmcnt(8)
    v_mfma_f32_16x16x32_bf16 v[228:231], a[152:155], v[88:91], v[228:231]
    ds_read_b64_tr_b16 a[184:185], v8 offset:49152
    v_add_u32 v7, 4294901760, v7
    v_mfma_f32_16x16x32_bf16 v[228:231], a[156:159], v[96:99], v[228:231]
    ds_read_b64_tr_b16 a[186:187], v8 offset:51200
    v_permlane16_swap_b32 v213, v215
    v_mfma_f32_16x16x32_bf16 v[228:231], a[160:163], v[104:107], v[228:231]
    ds_read_b64_tr_b16 a[188:189], v8 offset:53248
    v_mfma_f32_16x16x32_bf16 v[228:231], a[164:167], v[112:115], v[228:231]
    ds_read_b64_tr_b16 a[190:191], v8 offset:55296
    s_waitcnt lgkmcnt(4)
    v_mfma_f32_16x16x32_bf16 v[228:231], a[168:171], v[120:123], v[228:231]
    ds_read_b64_tr_b16 a[192:193], v8 offset:57344
    buffer_load_dwordx4 v4, s[28:31], s48 offen offset:3072 lds
    v_mfma_f32_16x16x32_bf16 v[228:231], a[172:175], v[128:131], v[228:231]
    ds_read_b64_tr_b16 a[194:195], v8 offset:59392
    v_mfma_f32_16x16x32_bf16 v[228:231], a[176:179], v[136:139], v[228:231]
    ds_read_b64_tr_b16 a[196:197], v8 offset:61440
    v_mfma_f32_16x16x32_bf16 v[228:231], a[180:183], v[144:147], v[228:231]
    ds_read_b64_tr_b16 a[198:199], v8 offset:63488
    v_mfma_f32_16x16x32_bf16 v[244:247], a[152:155], v[216:219], v[244:247]
    ds_read_b64_tr_b16 a[200:201], v8 offset:32768
    v_mfma_f32_16x16x32_bf16 v[244:247], a[156:159], v[224:227], v[244:247]
    ds_read_b64_tr_b16 a[202:203], v8 offset:34816
    v_mfma_f32_16x16x32_bf16 v[244:247], a[160:163], v[232:235], v[244:247]
    ds_read_b64_tr_b16 a[204:205], v8 offset:36864
    v_mfma_f32_16x16x32_bf16 v[244:247], a[164:167], v[240:243], v[244:247]
    ds_read_b64_tr_b16 a[206:207], v8 offset:38912
    v_mfma_f32_16x16x32_bf16 v[244:247], a[168:171], v[248:251], v[244:247]
    ds_read_b64_tr_b16 a[208:209], v8 offset:40960
    v_mfma_f32_16x16x32_bf16 v[244:247], a[172:175], v[16:19], v[244:247]
    ds_read_b64_tr_b16 a[210:211], v8 offset:43008
    v_mfma_f32_16x16x32_bf16 v[244:247], a[176:179], v[28:31], v[244:247]
    ds_read_b64_tr_b16 a[212:213], v8 offset:45056
    v_mfma_f32_16x16x32_bf16 v[244:247], a[180:183], v[36:39], v[244:247]
    ds_read_b64_tr_b16 a[214:215], v8 offset:47104
    v_mfma_f32_16x16x32_bf16 v[20:23], a[152:155], v[124:127], v[20:23]
    buffer_store_dwordx4 v[212:215], v10, s[32:35], s41 offen offset:0 sc1 nt
    v_mfma_f32_16x16x32_bf16 v[20:23], a[156:159], v[140:143], v[20:23]
    v_mul_f32 v148, v14, v148
    v_mul_f32 v149, v14, v149
    v_mfma_f32_16x16x32_bf16 v[20:23], a[160:163], v[220:223], v[20:23]
    v_mul_f32 v150, v14, v150
    v_mul_f32 v151, v14, v151
    v_mfma_f32_16x16x32_bf16 v[20:23], a[164:167], v[236:239], v[20:23]
    v_cvt_pk_bf16_f32 v102, v148, v149
    v_cvt_pk_bf16_f32 v103, v150, v151
    v_mfma_f32_16x16x32_bf16 v[20:23], a[168:171], v[252:255], v[20:23]
    v_permlane16_swap_b32 v100, v102
    v_permlane16_swap_b32 v101, v103
    v_mfma_f32_16x16x32_bf16 v[20:23], a[172:175], v[156:159], v[20:23]
    buffer_store_dwordx4 v[100:103], v11, s[32:35], s41 offen offset:0 sc1 nt
    v_mfma_f32_16x16x32_bf16 v[20:23], a[176:179], v[172:175], v[20:23]
    v_mul_f32 v228, v12, v228
    v_mul_f32 v229, v12, v229
    v_mfma_f32_16x16x32_bf16 v[20:23], a[180:183], v[188:191], v[20:23]
    v_mul_f32 v230, v12, v230
    s_waitcnt lgkmcnt(8)
    v_mfma_f32_16x16x32_bf16 v[164:167], a[184:187], v[88:91], v[164:167]
    s_waitcnt vmcnt(31)
    s_barrier
    v_add_u32 v8, 4294901760, v8
    v_mfma_f32_16x16x32_bf16 v[164:167], a[188:191], v[96:99], v[164:167]
    ds_read_b64_tr_b16 a[152:153], v5 offset:0
    s_add_u32 m0, s36, 65536
    v_mfma_f32_16x16x32_bf16 v[164:167], a[192:195], v[104:107], v[164:167]
    ds_read_b64_tr_b16 a[154:155], v5 offset:2048
    s_add_u32 s48, s38, 131456
    v_mfma_f32_16x16x32_bf16 v[164:167], a[196:199], v[112:115], v[164:167]
    ds_read_b64_tr_b16 a[156:157], v5 offset:4096
    s_waitcnt lgkmcnt(3)
    v_mfma_f32_16x16x32_bf16 v[164:167], a[200:203], v[120:123], v[164:167]
    ds_read_b64_tr_b16 a[158:159], v5 offset:6144
    buffer_load_dwordx4 v1, s[28:31], s48 offen offset:0 lds
    v_mfma_f32_16x16x32_bf16 v[164:167], a[204:207], v[128:131], v[164:167]
    ds_read_b64_tr_b16 a[160:161], v5 offset:8192
    v_mul_f32 v231, v12, v231
    v_mfma_f32_16x16x32_bf16 v[164:167], a[208:211], v[136:139], v[164:167]
    ds_read_b64_tr_b16 a[162:163], v5 offset:10240
    v_cvt_pk_bf16_f32 v228, v228, v229
    v_mfma_f32_16x16x32_bf16 v[164:167], a[212:215], v[144:147], v[164:167]
    ds_read_b64_tr_b16 a[164:165], v5 offset:12288
    v_cvt_pk_bf16_f32 v229, v230, v231
    v_mfma_f32_16x16x32_bf16 v[180:183], a[184:187], v[216:219], v[180:183]
    ds_read_b64_tr_b16 a[166:167], v5 offset:14336
    v_mul_f32 v244, v13, v244
    v_mfma_f32_16x16x32_bf16 v[180:183], a[188:191], v[224:227], v[180:183]
    ds_read_b64_tr_b16 a[168:169], v5 offset:16384
    v_mul_f32 v245, v13, v245
    v_mfma_f32_16x16x32_bf16 v[180:183], a[192:195], v[232:235], v[180:183]
    ds_read_b64_tr_b16 a[170:171], v5 offset:18432
    v_mul_f32 v246, v13, v246
    v_mfma_f32_16x16x32_bf16 v[180:183], a[196:199], v[240:243], v[180:183]
    ds_read_b64_tr_b16 a[172:173], v5 offset:20480
    v_mul_f32 v247, v13, v247
    v_mfma_f32_16x16x32_bf16 v[180:183], a[200:203], v[248:251], v[180:183]
    ds_read_b64_tr_b16 a[174:175], v5 offset:22528
    v_cvt_pk_bf16_f32 v244, v244, v245
    v_mfma_f32_16x16x32_bf16 v[180:183], a[204:207], v[16:19], v[180:183]
    ds_read_b64_tr_b16 a[176:177], v5 offset:24576
    v_cvt_pk_bf16_f32 v245, v246, v247
    v_mfma_f32_16x16x32_bf16 v[180:183], a[208:211], v[28:31], v[180:183]
    ds_read_b64_tr_b16 a[178:179], v5 offset:26624
    buffer_load_dwordx4 v2, s[28:31], s48 offen offset:1024 lds
    v_mfma_f32_16x16x32_bf16 v[180:183], a[212:215], v[36:39], v[180:183]
    ds_read_b64_tr_b16 a[180:181], v5 offset:28672
    v_mul_f32 v20, v14, v20
    v_mfma_f32_16x16x32_bf16 v[196:199], a[184:187], v[124:127], v[196:199]
    ds_read_b64_tr_b16 a[182:183], v5 offset:30720
    v_mul_f32 v21, v14, v21
    v_mfma_f32_16x16x32_bf16 v[196:199], a[188:191], v[140:143], v[196:199]
    v_mul_f32 v22, v14, v22
    v_mul_f32 v23, v14, v23
    v_mfma_f32_16x16x32_bf16 v[196:199], a[192:195], v[220:223], v[196:199]
    v_cvt_pk_bf16_f32 v20, v20, v21
    v_cvt_pk_bf16_f32 v21, v22, v23
    v_mfma_f32_16x16x32_bf16 v[196:199], a[196:199], v[236:239], v[196:199]
    v_mul_f32 v164, v12, v164
    v_mul_f32 v165, v12, v165
    v_mfma_f32_16x16x32_bf16 v[196:199], a[200:203], v[252:255], v[196:199]
    v_mul_f32 v166, v12, v166
    v_mul_f32 v167, v12, v167
    v_mfma_f32_16x16x32_bf16 v[196:199], a[204:207], v[156:159], v[196:199]
    v_cvt_pk_bf16_f32 v230, v164, v165
    v_cvt_pk_bf16_f32 v231, v166, v167
    v_mfma_f32_16x16x32_bf16 v[196:199], a[208:211], v[172:175], v[196:199]
    v_permlane16_swap_b32 v228, v230
    v_permlane16_swap_b32 v229, v231
    v_mfma_f32_16x16x32_bf16 v[196:199], a[212:215], v[188:191], v[196:199]
    s_waitcnt lgkmcnt(8)
    v_mfma_f32_16x16x32_bf16 v[204:207], a[152:155], v[24:27], 0
    ds_read_b64_tr_b16 a[184:185], v6 offset:0
    buffer_load_dwordx4 v3, s[28:31], s48 offen offset:2048 lds
    v_mfma_f32_16x16x32_bf16 v[204:207], a[156:159], v[32:35], v[204:207]
    ds_read_b64_tr_b16 a[186:187], v6 offset:2048
    v_add_u32 v5, 131072, v5
    v_mfma_f32_16x16x32_bf16 v[204:207], a[160:163], v[40:43], v[204:207]
    ds_read_b64_tr_b16 a[188:189], v6 offset:4096
    v_mfma_f32_16x16x32_bf16 v[204:207], a[164:167], v[48:51], v[204:207]
    ds_read_b64_tr_b16 a[190:191], v6 offset:6144
    s_waitcnt lgkmcnt(4)
    v_mfma_f32_16x16x32_bf16 v[204:207], a[168:171], v[56:59], v[204:207]
    ds_read_b64_tr_b16 a[192:193], v6 offset:8192
    v_mfma_f32_16x16x32_bf16 v[204:207], a[172:175], v[64:67], v[204:207]
    ds_read_b64_tr_b16 a[194:195], v6 offset:10240
    v_mfma_f32_16x16x32_bf16 v[204:207], a[176:179], v[72:75], v[204:207]
    ds_read_b64_tr_b16 a[196:197], v6 offset:12288
    v_mfma_f32_16x16x32_bf16 v[204:207], a[180:183], v[80:83], v[204:207]
    ds_read_b64_tr_b16 a[198:199], v6 offset:14336
    v_mfma_f32_16x16x32_bf16 v[212:215], a[152:155], v[152:155], 0
    ds_read_b64_tr_b16 a[200:201], v6 offset:16384
    v_mfma_f32_16x16x32_bf16 v[212:215], a[156:159], v[160:163], v[212:215]
    ds_read_b64_tr_b16 a[202:203], v6 offset:18432
    v_mfma_f32_16x16x32_bf16 v[212:215], a[160:163], v[168:171], v[212:215]
    ds_read_b64_tr_b16 a[204:205], v6 offset:20480
    buffer_load_dwordx4 v4, s[28:31], s48 offen offset:3072 lds
    v_mfma_f32_16x16x32_bf16 v[212:215], a[164:167], v[176:179], v[212:215]
    ds_read_b64_tr_b16 a[206:207], v6 offset:22528
    v_mfma_f32_16x16x32_bf16 v[212:215], a[168:171], v[184:187], v[212:215]
    ds_read_b64_tr_b16 a[208:209], v6 offset:24576
    v_mfma_f32_16x16x32_bf16 v[212:215], a[172:175], v[192:195], v[212:215]
    ds_read_b64_tr_b16 a[210:211], v6 offset:26624
    v_mfma_f32_16x16x32_bf16 v[212:215], a[176:179], v[200:203], v[212:215]
    ds_read_b64_tr_b16 a[212:213], v6 offset:28672
    v_mfma_f32_16x16x32_bf16 v[212:215], a[180:183], v[208:211], v[212:215]
    ds_read_b64_tr_b16 a[214:215], v6 offset:30720
    v_mfma_f32_16x16x32_bf16 v[100:103], a[152:155], v[44:47], 0
    buffer_store_dwordx4 v[228:231], v9, s[32:35], s41 offen offset:64 sc1 nt
    v_mfma_f32_16x16x32_bf16 v[100:103], a[156:159], v[52:55], v[100:103]
    v_mul_f32 v180, v13, v180
    v_mul_f32 v181, v13, v181
    v_mfma_f32_16x16x32_bf16 v[100:103], a[160:163], v[60:63], v[100:103]
    v_mul_f32 v182, v13, v182
    v_mul_f32 v183, v13, v183
    v_mfma_f32_16x16x32_bf16 v[100:103], a[164:167], v[68:71], v[100:103]
    v_cvt_pk_bf16_f32 v246, v180, v181
    v_cvt_pk_bf16_f32 v247, v182, v183
    v_mfma_f32_16x16x32_bf16 v[100:103], a[168:171], v[76:79], v[100:103]
    s_add_u32 m0, s36, 81920
    s_add_u32 s48, s38, 196992
    v_mfma_f32_16x16x32_bf16 v[100:103], a[172:175], v[84:87], v[100:103]
    buffer_load_dwordx4 v1, s[28:31], s48 offen offset:0 lds
    v_permlane16_swap_b32 v244, v246
    v_mfma_f32_16x16x32_bf16 v[100:103], a[176:179], v[92:95], v[100:103]
    v_permlane16_swap_b32 v245, v247
    v_mfma_f32_16x16x32_bf16 v[100:103], a[180:183], v[108:111], v[100:103]
    s_waitcnt lgkmcnt(8)
    v_mfma_f32_16x16x32_bf16 v[116:119], a[184:187], v[24:27], 0
    ds_read_b64_tr_b16 a[152:153], v7 offset:0
    v_add_u32 v6, 131072, v6
    v_mfma_f32_16x16x32_bf16 v[116:119], a[188:191], v[32:35], v[116:119]
    ds_read_b64_tr_b16 a[154:155], v7 offset:2048
    v_mfma_f32_16x16x32_bf16 v[116:119], a[192:195], v[40:43], v[116:119]
    ds_read_b64_tr_b16 a[156:157], v7 offset:4096
    v_mfma_f32_16x16x32_bf16 v[116:119], a[196:199], v[48:51], v[116:119]
    ds_read_b64_tr_b16 a[158:159], v7 offset:6144
    s_waitcnt lgkmcnt(4)
    v_mfma_f32_16x16x32_bf16 v[116:119], a[200:203], v[56:59], v[116:119]
    ds_read_b64_tr_b16 a[160:161], v7 offset:8192
    v_mfma_f32_16x16x32_bf16 v[116:119], a[204:207], v[64:67], v[116:119]
    ds_read_b64_tr_b16 a[162:163], v7 offset:10240
    v_mfma_f32_16x16x32_bf16 v[116:119], a[208:211], v[72:75], v[116:119]
    ds_read_b64_tr_b16 a[164:165], v7 offset:12288
    v_mfma_f32_16x16x32_bf16 v[116:119], a[212:215], v[80:83], v[116:119]
    ds_read_b64_tr_b16 a[166:167], v7 offset:14336
    buffer_load_dwordx4 v2, s[28:31], s48 offen offset:1024 lds
    v_mfma_f32_16x16x32_bf16 v[132:135], a[184:187], v[152:155], 0
    ds_read_b64_tr_b16 a[168:169], v7 offset:16384
    v_mfma_f32_16x16x32_bf16 v[132:135], a[188:191], v[160:163], v[132:135]
    ds_read_b64_tr_b16 a[170:171], v7 offset:18432
    v_mfma_f32_16x16x32_bf16 v[132:135], a[192:195], v[168:171], v[132:135]
    ds_read_b64_tr_b16 a[172:173], v7 offset:20480
    v_mfma_f32_16x16x32_bf16 v[132:135], a[196:199], v[176:179], v[132:135]
    ds_read_b64_tr_b16 a[174:175], v7 offset:22528
    v_mfma_f32_16x16x32_bf16 v[132:135], a[200:203], v[184:187], v[132:135]
    ds_read_b64_tr_b16 a[176:177], v7 offset:24576
    v_mfma_f32_16x16x32_bf16 v[132:135], a[204:207], v[192:195], v[132:135]
    ds_read_b64_tr_b16 a[178:179], v7 offset:26624
    v_mfma_f32_16x16x32_bf16 v[132:135], a[208:211], v[200:203], v[132:135]
    ds_read_b64_tr_b16 a[180:181], v7 offset:28672
    v_mfma_f32_16x16x32_bf16 v[132:135], a[212:215], v[208:211], v[132:135]
    ds_read_b64_tr_b16 a[182:183], v7 offset:30720
    v_mfma_f32_16x16x32_bf16 v[148:151], a[184:187], v[44:47], 0
    buffer_store_dwordx4 v[244:247], v10, s[32:35], s41 offen offset:64 sc1 nt
    v_mfma_f32_16x16x32_bf16 v[148:151], a[188:191], v[52:55], v[148:151]
    buffer_load_dwordx4 v3, s[28:31], s48 offen offset:2048 lds
    v_mul_f32 v196, v14, v196
    v_mfma_f32_16x16x32_bf16 v[148:151], a[192:195], v[60:63], v[148:151]
    v_mul_f32 v197, v14, v197
    v_mul_f32 v198, v14, v198
    v_mfma_f32_16x16x32_bf16 v[148:151], a[196:199], v[68:71], v[148:151]
    v_mul_f32 v199, v14, v199
    v_cvt_pk_bf16_f32 v22, v196, v197
    v_mfma_f32_16x16x32_bf16 v[148:151], a[200:203], v[76:79], v[148:151]
    v_cvt_pk_bf16_f32 v23, v198, v199
    v_mfma_f32_16x16x32_bf16 v[148:151], a[204:207], v[84:87], v[148:151]
    v_permlane16_swap_b32 v20, v22
    v_permlane16_swap_b32 v21, v23
    v_mfma_f32_16x16x32_bf16 v[148:151], a[208:211], v[92:95], v[148:151]
    buffer_store_dwordx4 v[20:23], v11, s[32:35], s41 offen offset:64 sc1 nt
    v_mfma_f32_16x16x32_bf16 v[148:151], a[212:215], v[108:111], v[148:151]
    s_waitcnt lgkmcnt(8)
    v_mfma_f32_16x16x32_bf16 v[228:231], a[152:155], v[24:27], 0
    ds_read_b64_tr_b16 a[184:185], v8 offset:0
    v_add_u32 v7, 131072, v7
    v_mfma_f32_16x16x32_bf16 v[228:231], a[156:159], v[32:35], v[228:231]
    ds_read_b64_tr_b16 a[186:187], v8 offset:2048
    v_mfma_f32_16x16x32_bf16 v[228:231], a[160:163], v[40:43], v[228:231]
    ds_read_b64_tr_b16 a[188:189], v8 offset:4096
    v_mfma_f32_16x16x32_bf16 v[228:231], a[164:167], v[48:51], v[228:231]
    ds_read_b64_tr_b16 a[190:191], v8 offset:6144
    s_waitcnt lgkmcnt(4)
    v_mfma_f32_16x16x32_bf16 v[228:231], a[168:171], v[56:59], v[228:231]
    ds_read_b64_tr_b16 a[192:193], v8 offset:8192
    buffer_load_dwordx4 v4, s[28:31], s48 offen offset:3072 lds
    v_mfma_f32_16x16x32_bf16 v[228:231], a[172:175], v[64:67], v[228:231]
    ds_read_b64_tr_b16 a[194:195], v8 offset:10240
    v_mfma_f32_16x16x32_bf16 v[228:231], a[176:179], v[72:75], v[228:231]
    ds_read_b64_tr_b16 a[196:197], v8 offset:12288
    v_mfma_f32_16x16x32_bf16 v[228:231], a[180:183], v[80:83], v[228:231]
    ds_read_b64_tr_b16 a[198:199], v8 offset:14336
    v_mfma_f32_16x16x32_bf16 v[244:247], a[152:155], v[152:155], 0
    ds_read_b64_tr_b16 a[200:201], v8 offset:16384
    v_mfma_f32_16x16x32_bf16 v[244:247], a[156:159], v[160:163], v[244:247]
    ds_read_b64_tr_b16 a[202:203], v8 offset:18432
    v_mfma_f32_16x16x32_bf16 v[244:247], a[160:163], v[168:171], v[244:247]
    ds_read_b64_tr_b16 a[204:205], v8 offset:20480
    v_mfma_f32_16x16x32_bf16 v[244:247], a[164:167], v[176:179], v[244:247]
    ds_read_b64_tr_b16 a[206:207], v8 offset:22528
    v_mfma_f32_16x16x32_bf16 v[244:247], a[168:171], v[184:187], v[244:247]
    ds_read_b64_tr_b16 a[208:209], v8 offset:24576
    v_mfma_f32_16x16x32_bf16 v[244:247], a[172:175], v[192:195], v[244:247]
    ds_read_b64_tr_b16 a[210:211], v8 offset:26624
    v_mfma_f32_16x16x32_bf16 v[244:247], a[176:179], v[200:203], v[244:247]
    ds_read_b64_tr_b16 a[212:213], v8 offset:28672
    v_mfma_f32_16x16x32_bf16 v[244:247], a[180:183], v[208:211], v[244:247]
    ds_read_b64_tr_b16 a[214:215], v8 offset:30720
    v_mfma_f32_16x16x32_bf16 v[20:23], a[152:155], v[44:47], 0
    v_mfma_f32_16x16x32_bf16 v[20:23], a[156:159], v[52:55], v[20:23]
    v_mfma_f32_16x16x32_bf16 v[20:23], a[160:163], v[60:63], v[20:23]
    v_mfma_f32_16x16x32_bf16 v[20:23], a[164:167], v[68:71], v[20:23]
    v_mfma_f32_16x16x32_bf16 v[20:23], a[168:171], v[76:79], v[20:23]
    v_mfma_f32_16x16x32_bf16 v[20:23], a[172:175], v[84:87], v[20:23]
    v_mfma_f32_16x16x32_bf16 v[20:23], a[176:179], v[92:95], v[20:23]
    v_mfma_f32_16x16x32_bf16 v[20:23], a[180:183], v[108:111], v[20:23]
    s_waitcnt lgkmcnt(8)
    v_mfma_f32_16x16x32_bf16 v[164:167], a[184:187], v[24:27], 0
    s_waitcnt vmcnt(22)
    s_barrier
    v_add_u32 v8, 131072, v8
    v_mfma_f32_16x16x32_bf16 v[164:167], a[188:191], v[32:35], v[164:167]
    ds_read_b64_tr_b16 a[152:153], v5 offset:0
    v_mfma_f32_16x16x32_bf16 v[164:167], a[192:195], v[40:43], v[164:167]
    ds_read_b64_tr_b16 a[154:155], v5 offset:2048
    v_mfma_f32_16x16x32_bf16 v[164:167], a[196:199], v[48:51], v[164:167]
    ds_read_b64_tr_b16 a[156:157], v5 offset:4096
    s_waitcnt lgkmcnt(3)
    v_mfma_f32_16x16x32_bf16 v[164:167], a[200:203], v[56:59], v[164:167]
    ds_read_b64_tr_b16 a[158:159], v5 offset:6144
    v_mfma_f32_16x16x32_bf16 v[164:167], a[204:207], v[64:67], v[164:167]
    ds_read_b64_tr_b16 a[160:161], v5 offset:8192
    v_mfma_f32_16x16x32_bf16 v[164:167], a[208:211], v[72:75], v[164:167]
    ds_read_b64_tr_b16 a[162:163], v5 offset:10240
    v_mfma_f32_16x16x32_bf16 v[164:167], a[212:215], v[80:83], v[164:167]
    ds_read_b64_tr_b16 a[164:165], v5 offset:12288
    v_mfma_f32_16x16x32_bf16 v[180:183], a[184:187], v[152:155], 0
    ds_read_b64_tr_b16 a[166:167], v5 offset:14336
    v_mfma_f32_16x16x32_bf16 v[180:183], a[188:191], v[160:163], v[180:183]
    ds_read_b64_tr_b16 a[168:169], v5 offset:16384
    v_mfma_f32_16x16x32_bf16 v[180:183], a[192:195], v[168:171], v[180:183]
    ds_read_b64_tr_b16 a[170:171], v5 offset:18432
    v_mfma_f32_16x16x32_bf16 v[180:183], a[196:199], v[176:179], v[180:183]
    ds_read_b64_tr_b16 a[172:173], v5 offset:20480
    v_mfma_f32_16x16x32_bf16 v[180:183], a[200:203], v[184:187], v[180:183]
    ds_read_b64_tr_b16 a[174:175], v5 offset:22528
    v_mfma_f32_16x16x32_bf16 v[180:183], a[204:207], v[192:195], v[180:183]
    ds_read_b64_tr_b16 a[176:177], v5 offset:24576
    v_mfma_f32_16x16x32_bf16 v[180:183], a[208:211], v[200:203], v[180:183]
    ds_read_b64_tr_b16 a[178:179], v5 offset:26624
    v_mfma_f32_16x16x32_bf16 v[180:183], a[212:215], v[208:211], v[180:183]
    ds_read_b64_tr_b16 a[180:181], v5 offset:28672
    v_mfma_f32_16x16x32_bf16 v[196:199], a[184:187], v[44:47], 0
    ds_read_b64_tr_b16 a[182:183], v5 offset:30720
    v_mfma_f32_16x16x32_bf16 v[196:199], a[188:191], v[52:55], v[196:199]
    v_mfma_f32_16x16x32_bf16 v[196:199], a[192:195], v[60:63], v[196:199]
    v_mfma_f32_16x16x32_bf16 v[196:199], a[196:199], v[68:71], v[196:199]
    v_mfma_f32_16x16x32_bf16 v[196:199], a[200:203], v[76:79], v[196:199]
    v_mfma_f32_16x16x32_bf16 v[196:199], a[204:207], v[84:87], v[196:199]
    v_mfma_f32_16x16x32_bf16 v[196:199], a[208:211], v[92:95], v[196:199]
    v_mfma_f32_16x16x32_bf16 v[196:199], a[212:215], v[108:111], v[196:199]
    s_waitcnt lgkmcnt(8)
    v_mfma_f32_16x16x32_bf16 v[204:207], a[152:155], v[88:91], v[204:207]
    ds_read_b64_tr_b16 a[184:185], v6 offset:0
    v_mfma_f32_16x16x32_bf16 v[204:207], a[156:159], v[96:99], v[204:207]
    ds_read_b64_tr_b16 a[186:187], v6 offset:2048
    v_add_u32 v5, 4294836224, v5
    v_mfma_f32_16x16x32_bf16 v[204:207], a[160:163], v[104:107], v[204:207]
    ds_read_b64_tr_b16 a[188:189], v6 offset:4096
    v_mfma_f32_16x16x32_bf16 v[204:207], a[164:167], v[112:115], v[204:207]
    ds_read_b64_tr_b16 a[190:191], v6 offset:6144
    s_waitcnt lgkmcnt(4)
    v_mfma_f32_16x16x32_bf16 v[204:207], a[168:171], v[120:123], v[204:207]
    ds_read_b64_tr_b16 a[192:193], v6 offset:8192
    v_mfma_f32_16x16x32_bf16 v[204:207], a[172:175], v[128:131], v[204:207]
    ds_read_b64_tr_b16 a[194:195], v6 offset:10240
    v_mfma_f32_16x16x32_bf16 v[204:207], a[176:179], v[136:139], v[204:207]
    ds_read_b64_tr_b16 a[196:197], v6 offset:12288
    v_mfma_f32_16x16x32_bf16 v[204:207], a[180:183], v[144:147], v[204:207]
    ds_read_b64_tr_b16 a[198:199], v6 offset:14336
    v_mfma_f32_16x16x32_bf16 v[212:215], a[152:155], v[216:219], v[212:215]
    ds_read_b64_tr_b16 a[200:201], v6 offset:16384
    v_mfma_f32_16x16x32_bf16 v[212:215], a[156:159], v[224:227], v[212:215]
    ds_read_b64_tr_b16 a[202:203], v6 offset:18432
    v_mfma_f32_16x16x32_bf16 v[212:215], a[160:163], v[232:235], v[212:215]
    ds_read_b64_tr_b16 a[204:205], v6 offset:20480
    v_mfma_f32_16x16x32_bf16 v[212:215], a[164:167], v[240:243], v[212:215]
    ds_read_b64_tr_b16 a[206:207], v6 offset:22528
    v_mfma_f32_16x16x32_bf16 v[212:215], a[168:171], v[248:251], v[212:215]
    ds_read_b64_tr_b16 a[208:209], v6 offset:24576
    v_mul_f32 v204, v12, v204
    v_mfma_f32_16x16x32_bf16 v[212:215], a[172:175], v[16:19], v[212:215]
    ds_read_b64_tr_b16 a[210:211], v6 offset:26624
    v_mul_f32 v205, v12, v205
    v_mfma_f32_16x16x32_bf16 v[212:215], a[176:179], v[28:31], v[212:215]
    ds_read_b64_tr_b16 a[212:213], v6 offset:28672
    v_mul_f32 v206, v12, v206
    v_mfma_f32_16x16x32_bf16 v[212:215], a[180:183], v[36:39], v[212:215]
    ds_read_b64_tr_b16 a[214:215], v6 offset:30720
    v_mul_f32 v207, v12, v207
    v_mfma_f32_16x16x32_bf16 v[100:103], a[152:155], v[124:127], v[100:103]
    v_cvt_pk_bf16_f32 v204, v204, v205
    v_cvt_pk_bf16_f32 v205, v206, v207
    v_mfma_f32_16x16x32_bf16 v[100:103], a[156:159], v[140:143], v[100:103]
    v_mfma_f32_16x16x32_bf16 v[100:103], a[160:163], v[220:223], v[100:103]
    v_mfma_f32_16x16x32_bf16 v[100:103], a[164:167], v[236:239], v[100:103]
    v_mfma_f32_16x16x32_bf16 v[100:103], a[168:171], v[252:255], v[100:103]
    v_mul_f32 v212, v13, v212
    v_mul_f32 v213, v13, v213
    v_mfma_f32_16x16x32_bf16 v[100:103], a[172:175], v[156:159], v[100:103]
    v_mul_f32 v214, v13, v214
    v_mul_f32 v215, v13, v215
    v_mfma_f32_16x16x32_bf16 v[100:103], a[176:179], v[172:175], v[100:103]
    v_cvt_pk_bf16_f32 v212, v212, v213
    v_cvt_pk_bf16_f32 v213, v214, v215
    v_mfma_f32_16x16x32_bf16 v[100:103], a[180:183], v[188:191], v[100:103]
    s_waitcnt lgkmcnt(8)
    v_mfma_f32_16x16x32_bf16 v[116:119], a[184:187], v[88:91], v[116:119]
    ds_read_b64_tr_b16 a[152:153], v7 offset:0
    v_add_u32 v6, 4294836224, v6
    v_mfma_f32_16x16x32_bf16 v[116:119], a[188:191], v[96:99], v[116:119]
    ds_read_b64_tr_b16 a[154:155], v7 offset:2048
    v_mfma_f32_16x16x32_bf16 v[116:119], a[192:195], v[104:107], v[116:119]
    ds_read_b64_tr_b16 a[156:157], v7 offset:4096
    v_mfma_f32_16x16x32_bf16 v[116:119], a[196:199], v[112:115], v[116:119]
    ds_read_b64_tr_b16 a[158:159], v7 offset:6144
    s_waitcnt lgkmcnt(4)
    v_mfma_f32_16x16x32_bf16 v[116:119], a[200:203], v[120:123], v[116:119]
    ds_read_b64_tr_b16 a[160:161], v7 offset:8192
    v_mul_f32 v100, v14, v100
    v_mfma_f32_16x16x32_bf16 v[116:119], a[204:207], v[128:131], v[116:119]
    ds_read_b64_tr_b16 a[162:163], v7 offset:10240
    v_mul_f32 v101, v14, v101
    v_mfma_f32_16x16x32_bf16 v[116:119], a[208:211], v[136:139], v[116:119]
    ds_read_b64_tr_b16 a[164:165], v7 offset:12288
    v_mul_f32 v102, v14, v102
    v_mfma_f32_16x16x32_bf16 v[116:119], a[212:215], v[144:147], v[116:119]
    ds_read_b64_tr_b16 a[166:167], v7 offset:14336
    v_mul_f32 v103, v14, v103
    v_mfma_f32_16x16x32_bf16 v[132:135], a[184:187], v[216:219], v[132:135]
    ds_read_b64_tr_b16 a[168:169], v7 offset:16384
    v_cvt_pk_bf16_f32 v100, v100, v101
    v_mfma_f32_16x16x32_bf16 v[132:135], a[188:191], v[224:227], v[132:135]
    ds_read_b64_tr_b16 a[170:171], v7 offset:18432
    v_cvt_pk_bf16_f32 v101, v102, v103
    v_mfma_f32_16x16x32_bf16 v[132:135], a[192:195], v[232:235], v[132:135]
    ds_read_b64_tr_b16 a[172:173], v7 offset:20480
    v_mfma_f32_16x16x32_bf16 v[132:135], a[196:199], v[240:243], v[132:135]
    ds_read_b64_tr_b16 a[174:175], v7 offset:22528
    v_mfma_f32_16x16x32_bf16 v[132:135], a[200:203], v[248:251], v[132:135]
    ds_read_b64_tr_b16 a[176:177], v7 offset:24576
    v_mul_f32 v116, v12, v116
    v_mfma_f32_16x16x32_bf16 v[132:135], a[204:207], v[16:19], v[132:135]
    ds_read_b64_tr_b16 a[178:179], v7 offset:26624
    v_mul_f32 v117, v12, v117
    v_mfma_f32_16x16x32_bf16 v[132:135], a[208:211], v[28:31], v[132:135]
    ds_read_b64_tr_b16 a[180:181], v7 offset:28672
    v_mul_f32 v118, v12, v118
    v_mfma_f32_16x16x32_bf16 v[132:135], a[212:215], v[36:39], v[132:135]
    ds_read_b64_tr_b16 a[182:183], v7 offset:30720
    v_mul_f32 v119, v12, v119
    v_mfma_f32_16x16x32_bf16 v[148:151], a[184:187], v[124:127], v[148:151]
    v_cvt_pk_bf16_f32 v206, v116, v117
    v_cvt_pk_bf16_f32 v207, v118, v119
    v_mfma_f32_16x16x32_bf16 v[148:151], a[188:191], v[140:143], v[148:151]
    v_permlane16_swap_b32 v204, v206
    v_permlane16_swap_b32 v205, v207
    v_mfma_f32_16x16x32_bf16 v[148:151], a[192:195], v[220:223], v[148:151]
    buffer_store_dwordx4 v[204:207], v9, s[32:35], s42 offen offset:0 sc1 nt
    v_mfma_f32_16x16x32_bf16 v[148:151], a[196:199], v[236:239], v[148:151]
    v_mfma_f32_16x16x32_bf16 v[148:151], a[200:203], v[252:255], v[148:151]
    v_mul_f32 v132, v13, v132
    v_mul_f32 v133, v13, v133
    v_mfma_f32_16x16x32_bf16 v[148:151], a[204:207], v[156:159], v[148:151]
    v_mul_f32 v134, v13, v134
    v_mul_f32 v135, v13, v135
    v_mfma_f32_16x16x32_bf16 v[148:151], a[208:211], v[172:175], v[148:151]
    v_cvt_pk_bf16_f32 v214, v132, v133
    v_cvt_pk_bf16_f32 v215, v134, v135
    v_mfma_f32_16x16x32_bf16 v[148:151], a[212:215], v[188:191], v[148:151]
    v_permlane16_swap_b32 v212, v214
    s_waitcnt lgkmcnt(8)
    v_mfma_f32_16x16x32_bf16 v[228:231], a[152:155], v[88:91], v[228:231]
    ds_read_b64_tr_b16 a[184:185], v8 offset:0
    v_add_u32 v7, 4294836224, v7
    v_mfma_f32_16x16x32_bf16 v[228:231], a[156:159], v[96:99], v[228:231]
    ds_read_b64_tr_b16 a[186:187], v8 offset:2048
    v_permlane16_swap_b32 v213, v215
    v_mfma_f32_16x16x32_bf16 v[228:231], a[160:163], v[104:107], v[228:231]
    ds_read_b64_tr_b16 a[188:189], v8 offset:4096
    v_mfma_f32_16x16x32_bf16 v[228:231], a[164:167], v[112:115], v[228:231]
    ds_read_b64_tr_b16 a[190:191], v8 offset:6144
    s_waitcnt lgkmcnt(4)
    v_mfma_f32_16x16x32_bf16 v[228:231], a[168:171], v[120:123], v[228:231]
    ds_read_b64_tr_b16 a[192:193], v8 offset:8192
    v_mfma_f32_16x16x32_bf16 v[228:231], a[172:175], v[128:131], v[228:231]
    ds_read_b64_tr_b16 a[194:195], v8 offset:10240
    v_mfma_f32_16x16x32_bf16 v[228:231], a[176:179], v[136:139], v[228:231]
    ds_read_b64_tr_b16 a[196:197], v8 offset:12288
    v_mfma_f32_16x16x32_bf16 v[228:231], a[180:183], v[144:147], v[228:231]
    ds_read_b64_tr_b16 a[198:199], v8 offset:14336
    v_mfma_f32_16x16x32_bf16 v[244:247], a[152:155], v[216:219], v[244:247]
    ds_read_b64_tr_b16 a[200:201], v8 offset:16384
    v_mfma_f32_16x16x32_bf16 v[244:247], a[156:159], v[224:227], v[244:247]
    ds_read_b64_tr_b16 a[202:203], v8 offset:18432
    v_mfma_f32_16x16x32_bf16 v[244:247], a[160:163], v[232:235], v[244:247]
    ds_read_b64_tr_b16 a[204:205], v8 offset:20480
    v_mfma_f32_16x16x32_bf16 v[244:247], a[164:167], v[240:243], v[244:247]
    ds_read_b64_tr_b16 a[206:207], v8 offset:22528
    v_mfma_f32_16x16x32_bf16 v[244:247], a[168:171], v[248:251], v[244:247]
    ds_read_b64_tr_b16 a[208:209], v8 offset:24576
L_pad6:
    s_cbranch_execz L_back1
    v_mfma_f32_16x16x32_bf16 v[244:247], a[172:175], v[16:19], v[244:247]
    ds_read_b64_tr_b16 a[210:211], v8 offset:26624
    v_mfma_f32_16x16x32_bf16 v[244:247], a[176:179], v[28:31], v[244:247]
    ds_read_b64_tr_b16 a[212:213], v8 offset:28672
    v_mfma_f32_16x16x32_bf16 v[244:247], a[180:183], v[36:39], v[244:247]
    ds_read_b64_tr_b16 a[214:215], v8 offset:30720
    v_mfma_f32_16x16x32_bf16 v[20:23], a[152:155], v[124:127], v[20:23]
    buffer_store_dwordx4 v[212:215], v10, s[32:35], s42 offen offset:0 sc1 nt
    v_mfma_f32_16x16x32_bf16 v[20:23], a[156:159], v[140:143], v[20:23]
    v_mul_f32 v148, v14, v148
    v_mul_f32 v149, v14, v149
    v_mfma_f32_16x16x32_bf16 v[20:23], a[160:163], v[220:223], v[20:23]
    v_mul_f32 v150, v14, v150
    v_mul_f32 v151, v14, v151
    v_mfma_f32_16x16x32_bf16 v[20:23], a[164:167], v[236:239], v[20:23]
    v_cvt_pk_bf16_f32 v102, v148, v149
    v_cvt_pk_bf16_f32 v103, v150, v151
    v_mfma_f32_16x16x32_bf16 v[20:23], a[168:171], v[252:255], v[20:23]
    v_permlane16_swap_b32 v100, v102
    v_permlane16_swap_b32 v101, v103
    v_mfma_f32_16x16x32_bf16 v[20:23], a[172:175], v[156:159], v[20:23]
    buffer_store_dwordx4 v[100:103], v11, s[32:35], s42 offen offset:0 sc1 nt
    v_mfma_f32_16x16x32_bf16 v[20:23], a[176:179], v[172:175], v[20:23]
    v_mul_f32 v228, v12, v228
    v_mul_f32 v229, v12, v229
    v_mfma_f32_16x16x32_bf16 v[20:23], a[180:183], v[188:191], v[20:23]
    v_mul_f32 v230, v12, v230
    s_waitcnt lgkmcnt(8)
    v_mfma_f32_16x16x32_bf16 v[164:167], a[184:187], v[88:91], v[164:167]
    s_waitcnt vmcnt(16)
    s_barrier
    v_add_u32 v8, 4294836224, v8
    v_mfma_f32_16x16x32_bf16 v[164:167], a[188:191], v[96:99], v[164:167]
    ds_read_b64_tr_b16 a[152:153], v5 offset:32768
    v_mul_f32 v231, v12, v231
    v_mfma_f32_16x16x32_bf16 v[164:167], a[192:195], v[104:107], v[164:167]
    ds_read_b64_tr_b16 a[154:155], v5 offset:34816
    v_cvt_pk_bf16_f32 v228, v228, v229
    v_mfma_f32_16x16x32_bf16 v[164:167], a[196:199], v[112:115], v[164:167]
    ds_read_b64_tr_b16 a[156:157], v5 offset:36864
    s_waitcnt lgkmcnt(3)
    v_mfma_f32_16x16x32_bf16 v[164:167], a[200:203], v[120:123], v[164:167]
    ds_read_b64_tr_b16 a[158:159], v5 offset:38912
    v_cvt_pk_bf16_f32 v229, v230, v231
    v_mfma_f32_16x16x32_bf16 v[164:167], a[204:207], v[128:131], v[164:167]
    ds_read_b64_tr_b16 a[160:161], v5 offset:40960
    v_mul_f32 v244, v13, v244
    v_mfma_f32_16x16x32_bf16 v[164:167], a[208:211], v[136:139], v[164:167]
    ds_read_b64_tr_b16 a[162:163], v5 offset:43008
    v_mul_f32 v245, v13, v245
    v_mfma_f32_16x16x32_bf16 v[164:167], a[212:215], v[144:147], v[164:167]
    ds_read_b64_tr_b16 a[164:165], v5 offset:45056
    v_mul_f32 v246, v13, v246
    v_mfma_f32_16x16x32_bf16 v[180:183], a[184:187], v[216:219], v[180:183]
    ds_read_b64_tr_b16 a[166:167], v5 offset:47104
    v_mul_f32 v247, v13, v247
    v_mfma_f32_16x16x32_bf16 v[180:183], a[188:191], v[224:227], v[180:183]
    ds_read_b64_tr_b16 a[168:169], v5 offset:49152
    v_cvt_pk_bf16_f32 v244, v244, v245
    v_mfma_f32_16x16x32_bf16 v[180:183], a[192:195], v[232:235], v[180:183]
    ds_read_b64_tr_b16 a[170:171], v5 offset:51200
    v_cvt_pk_bf16_f32 v245, v246, v247
    v_mfma_f32_16x16x32_bf16 v[180:183], a[196:199], v[240:243], v[180:183]
    ds_read_b64_tr_b16 a[172:173], v5 offset:53248
    v_mul_f32 v20, v14, v20
    v_mfma_f32_16x16x32_bf16 v[180:183], a[200:203], v[248:251], v[180:183]
    ds_read_b64_tr_b16 a[174:175], v5 offset:55296
    v_mul_f32 v21, v14, v21
    v_mfma_f32_16x16x32_bf16 v[180:183], a[204:207], v[16:19], v[180:183]
    ds_read_b64_tr_b16 a[176:177], v5 offset:57344
    v_mul_f32 v22, v14, v22
    v_mfma_f32_16x16x32_bf16 v[180:183], a[208:211], v[28:31], v[180:183]
    ds_read_b64_tr_b16 a[178:179], v5 offset:59392
    v_mul_f32 v23, v14, v23
    v_mfma_f32_16x16x32_bf16 v[180:183], a[212:215], v[36:39], v[180:183]
    ds_read_b64_tr_b16 a[180:181], v5 offset:61440
    v_cvt_pk_bf16_f32 v20, v20, v21
    v_mfma_f32_16x16x32_bf16 v[196:199], a[184:187], v[124:127], v[196:199]
    ds_read_b64_tr_b16 a[182:183], v5 offset:63488
    v_cvt_pk_bf16_f32 v21, v22, v23
    v_mfma_f32_16x16x32_bf16 v[196:199], a[188:191], v[140:143], v[196:199]
    v_mul_f32 v164, v12, v164
    v_mul_f32 v165, v12, v165
    v_mfma_f32_16x16x32_bf16 v[196:199], a[192:195], v[220:223], v[196:199]
    v_mul_f32 v166, v12, v166
    v_mul_f32 v167, v12, v167
    v_mfma_f32_16x16x32_bf16 v[196:199], a[196:199], v[236:239], v[196:199]
    v_cvt_pk_bf16_f32 v230, v164, v165
    v_cvt_pk_bf16_f32 v231, v166, v167
    v_mfma_f32_16x16x32_bf16 v[196:199], a[200:203], v[252:255], v[196:199]
    v_permlane16_swap_b32 v228, v230
    v_permlane16_swap_b32 v229, v231
    v_mfma_f32_16x16x32_bf16 v[196:199], a[204:207], v[156:159], v[196:199]
    v_add_u32 v5, 65536, v5
    v_mfma_f32_16x16x32_bf16 v[196:199], a[208:211], v[172:175], v[196:199]
    buffer_store_dwordx4 v[228:231], v9, s[32:35], s42 offen offset:64 sc1 nt
    v_mfma_f32_16x16x32_bf16 v[196:199], a[212:215], v[188:191], v[196:199]
    v_mul_f32 v180, v13, v180
    s_waitcnt lgkmcnt(8)
    v_mfma_f32_16x16x32_bf16 v[204:207], a[152:155], v[24:27], 0
    s_waitcnt vmcnt(4)
    s_barrier
    v_mfma_f32_16x16x32_bf16 v[204:207], a[156:159], v[32:35], v[204:207]
    ds_read_b64_tr_b16 a[184:185], v5 offset:0
    ds_read_b64_tr_b16 a[0:1], v7 offset:32768
    v_mfma_f32_16x16x32_bf16 v[204:207], a[160:163], v[40:43], v[204:207]
    ds_read_b64_tr_b16 a[186:187], v5 offset:2048
    ds_read_b64_tr_b16 a[2:3], v7 offset:34816
    v_mfma_f32_16x16x32_bf16 v[204:207], a[164:167], v[48:51], v[204:207]
    ds_read_b64_tr_b16 a[188:189], v5 offset:4096
    ds_read_b64_tr_b16 a[4:5], v7 offset:36864
    s_waitcnt lgkmcnt(6)
    v_mfma_f32_16x16x32_bf16 v[204:207], a[168:171], v[56:59], v[204:207]
    ds_read_b64_tr_b16 a[190:191], v5 offset:6144
    ds_read_b64_tr_b16 a[6:7], v7 offset:38912
    v_mfma_f32_16x16x32_bf16 v[204:207], a[172:175], v[64:67], v[204:207]
    ds_read_b64_tr_b16 a[192:193], v5 offset:8192
    ds_read_b64_tr_b16 a[8:9], v7 offset:40960
    v_mfma_f32_16x16x32_bf16 v[204:207], a[176:179], v[72:75], v[204:207]
    ds_read_b64_tr_b16 a[194:195], v5 offset:10240
    ds_read_b64_tr_b16 a[10:11], v7 offset:43008
    v_mfma_f32_16x16x32_bf16 v[204:207], a[180:183], v[80:83], v[204:207]
    ds_read_b64_tr_b16 a[196:197], v5 offset:12288
    ds_read_b64_tr_b16 a[12:13], v7 offset:45056
    v_mfma_f32_16x16x32_bf16 v[212:215], a[152:155], v[152:155], 0
    ds_read_b64_tr_b16 a[198:199], v5 offset:14336
    ds_read_b64_tr_b16 a[14:15], v7 offset:47104
    v_mfma_f32_16x16x32_bf16 v[212:215], a[156:159], v[160:163], v[212:215]
    ds_read_b64_tr_b16 a[200:201], v5 offset:16384
    ds_read_b64_tr_b16 a[16:17], v7 offset:49152
    v_mfma_f32_16x16x32_bf16 v[212:215], a[160:163], v[168:171], v[212:215]
    ds_read_b64_tr_b16 a[202:203], v5 offset:18432
    ds_read_b64_tr_b16 a[18:19], v7 offset:51200
    v_mfma_f32_16x16x32_bf16 v[212:215], a[164:167], v[176:179], v[212:215]
    ds_read_b64_tr_b16 a[204:205], v5 offset:20480
    ds_read_b64_tr_b16 a[20:21], v7 offset:53248
    v_mfma_f32_16x16x32_bf16 v[212:215], a[168:171], v[184:187], v[212:215]
    ds_read_b64_tr_b16 a[206:207], v5 offset:22528
    ds_read_b64_tr_b16 a[22:23], v7 offset:55296
    v_mfma_f32_16x16x32_bf16 v[212:215], a[172:175], v[192:195], v[212:215]
    ds_read_b64_tr_b16 a[208:209], v5 offset:24576
    ds_read_b64_tr_b16 a[24:25], v7 offset:57344
    v_mfma_f32_16x16x32_bf16 v[212:215], a[176:179], v[200:203], v[212:215]
    ds_read_b64_tr_b16 a[210:211], v5 offset:26624
    ds_read_b64_tr_b16 a[26:27], v7 offset:59392
    v_mfma_f32_16x16x32_bf16 v[212:215], a[180:183], v[208:211], v[212:215]
    ds_read_b64_tr_b16 a[212:213], v5 offset:28672
    ds_read_b64_tr_b16 a[28:29], v7 offset:61440
    v_mfma_f32_16x16x32_bf16 v[100:103], a[152:155], v[44:47], 0
    ds_read_b64_tr_b16 a[214:215], v5 offset:30720
    ds_read_b64_tr_b16 a[30:31], v7 offset:63488
    v_mfma_f32_16x16x32_bf16 v[100:103], a[156:159], v[52:55], v[100:103]
    v_mul_f32 v181, v13, v181
    v_mul_f32 v182, v13, v182
    v_mfma_f32_16x16x32_bf16 v[100:103], a[160:163], v[60:63], v[100:103]
    v_mul_f32 v183, v13, v183
    v_cvt_pk_bf16_f32 v246, v180, v181
    v_mfma_f32_16x16x32_bf16 v[100:103], a[164:167], v[68:71], v[100:103]
    v_cvt_pk_bf16_f32 v247, v182, v183
    v_mfma_f32_16x16x32_bf16 v[100:103], a[168:171], v[76:79], v[100:103]
    v_add_u32 v7, 65536, v7
    v_permlane16_swap_b32 v244, v246
    v_mfma_f32_16x16x32_bf16 v[100:103], a[172:175], v[84:87], v[100:103]
    v_permlane16_swap_b32 v245, v247
    v_mfma_f32_16x16x32_bf16 v[100:103], a[176:179], v[92:95], v[100:103]
    buffer_store_dwordx4 v[244:247], v10, s[32:35], s42 offen offset:64 sc1 nt
    v_mfma_f32_16x16x32_bf16 v[100:103], a[180:183], v[108:111], v[100:103]
    v_mul_f32 v196, v14, v196
    s_waitcnt lgkmcnt(15)
    v_mfma_f32_16x16x32_bf16 v[204:207], a[184:187], v[88:91], v[204:207]
    ds_read_b64_tr_b16 a[152:153], v6 offset:32768
    ds_read_b64_tr_b16 a[32:33], v7 offset:0
    v_mfma_f32_16x16x32_bf16 v[204:207], a[188:191], v[96:99], v[204:207]
    ds_read_b64_tr_b16 a[154:155], v6 offset:34816
    ds_read_b64_tr_b16 a[34:35], v7 offset:2048
    v_mfma_f32_16x16x32_bf16 v[204:207], a[192:195], v[104:107], v[204:207]
    ds_read_b64_tr_b16 a[156:157], v6 offset:36864
    ds_read_b64_tr_b16 a[36:37], v7 offset:4096
    v_mfma_f32_16x16x32_bf16 v[204:207], a[196:199], v[112:115], v[204:207]
    ds_read_b64_tr_b16 a[158:159], v6 offset:38912
    ds_read_b64_tr_b16 a[38:39], v7 offset:6144
    s_waitcnt lgkmcnt(9)
    v_mfma_f32_16x16x32_bf16 v[204:207], a[200:203], v[120:123], v[204:207]
    ds_read_b64_tr_b16 a[160:161], v6 offset:40960
    ds_read_b64_tr_b16 a[40:41], v7 offset:8192
    v_mfma_f32_16x16x32_bf16 v[204:207], a[204:207], v[128:131], v[204:207]
    ds_read_b64_tr_b16 a[162:163], v6 offset:43008
    ds_read_b64_tr_b16 a[42:43], v7 offset:10240
    v_mfma_f32_16x16x32_bf16 v[204:207], a[208:211], v[136:139], v[204:207]
    ds_read_b64_tr_b16 a[164:165], v6 offset:45056
    ds_read_b64_tr_b16 a[44:45], v7 offset:12288
    v_mfma_f32_16x16x32_bf16 v[204:207], a[212:215], v[144:147], v[204:207]
    ds_read_b64_tr_b16 a[166:167], v6 offset:47104
    ds_read_b64_tr_b16 a[46:47], v7 offset:14336
    v_mfma_f32_16x16x32_bf16 v[212:215], a[184:187], v[216:219], v[212:215]
    ds_read_b64_tr_b16 a[168:169], v6 offset:49152
    ds_read_b64_tr_b16 a[48:49], v7 offset:16384
    v_mfma_f32_16x16x32_bf16 v[212:215], a[188:191], v[224:227], v[212:215]
    ds_read_b64_tr_b16 a[170:171], v6 offset:51200
    ds_read_b64_tr_b16 a[50:51], v7 offset:18432
    v_mfma_f32_16x16x32_bf16 v[212:215], a[192:195], v[232:235], v[212:215]
    ds_read_b64_tr_b16 a[172:173], v6 offset:53248
    ds_read_b64_tr_b16 a[52:53], v7 offset:20480
    v_mfma_f32_16x16x32_bf16 v[212:215], a[196:199], v[240:243], v[212:215]
    ds_read_b64_tr_b16 a[174:175], v6 offset:55296
    ds_read_b64_tr_b16 a[54:55], v7 offset:22528
    v_mfma_f32_16x16x32_bf16 v[212:215], a[200:203], v[248:251], v[212:215]
    ds_read_b64_tr_b16 a[176:177], v6 offset:57344
    ds_read_b64_tr_b16 a[56:57], v7 offset:24576
    v_mfma_f32_16x16x32_bf16 v[212:215], a[204:207], v[16:19], v[212:215]
    ds_read_b64_tr_b16 a[178:179], v6 offset:59392
    ds_read_b64_tr_b16 a[58:59], v7 offset:26624
    v_mfma_f32_16x16x32_bf16 v[212:215], a[208:211], v[28:31], v[212:215]
    ds_read_b64_tr_b16 a[180:181], v6 offset:61440
    ds_read_b64_tr_b16 a[60:61], v7 offset:28672
    v_mfma_f32_16x16x32_bf16 v[212:215], a[212:215], v[36:39], v[212:215]
    ds_read_b64_tr_b16 a[182:183], v6 offset:63488
    ds_read_b64_tr_b16 a[62:63], v7 offset:30720
    v_mfma_f32_16x16x32_bf16 v[100:103], a[184:187], v[124:127], v[100:103]
    v_mul_f32 v197, v14, v197
    v_mul_f32 v198, v14, v198
    v_mfma_f32_16x16x32_bf16 v[100:103], a[188:191], v[140:143], v[100:103]
    v_mul_f32 v199, v14, v199
    v_cvt_pk_bf16_f32 v22, v196, v197
    v_mfma_f32_16x16x32_bf16 v[100:103], a[192:195], v[220:223], v[100:103]
    v_cvt_pk_bf16_f32 v23, v198, v199
    v_mfma_f32_16x16x32_bf16 v[100:103], a[196:199], v[236:239], v[100:103]
    v_permlane16_swap_b32 v20, v22
    v_permlane16_swap_b32 v21, v23
    v_mfma_f32_16x16x32_bf16 v[100:103], a[200:203], v[252:255], v[100:103]
    v_add_u32 v6, 65536, v6
    v_mfma_f32_16x16x32_bf16 v[100:103], a[204:207], v[156:159], v[100:103]
    buffer_store_dwordx4 v[20:23], v11, s[32:35], s42 offen offset:64 sc1 nt
    v_mfma_f32_16x16x32_bf16 v[100:103], a[208:211], v[172:175], v[100:103]
    v_mul_f32 v204, v12, v204
    v_mul_f32 v205, v12, v205
    v_mfma_f32_16x16x32_bf16 v[100:103], a[212:215], v[188:191], v[100:103]
    v_mul_f32 v206, v12, v206
    s_waitcnt lgkmcnt(15)
    v_mfma_f32_16x16x32_bf16 v[116:119], a[152:155], v[24:27], 0
    ds_read_b64_tr_b16 a[184:185], v6 offset:0
    ds_read_b64_tr_b16 a[64:65], v8 offset:32768
    v_mfma_f32_16x16x32_bf16 v[116:119], a[156:159], v[32:35], v[116:119]
    ds_read_b64_tr_b16 a[186:187], v6 offset:2048
    ds_read_b64_tr_b16 a[66:67], v8 offset:34816
    v_mfma_f32_16x16x32_bf16 v[116:119], a[160:163], v[40:43], v[116:119]
    ds_read_b64_tr_b16 a[188:189], v6 offset:4096
    ds_read_b64_tr_b16 a[68:69], v8 offset:36864
    v_mfma_f32_16x16x32_bf16 v[116:119], a[164:167], v[48:51], v[116:119]
    ds_read_b64_tr_b16 a[190:191], v6 offset:6144
    ds_read_b64_tr_b16 a[70:71], v8 offset:38912
    s_waitcnt lgkmcnt(9)
    v_mfma_f32_16x16x32_bf16 v[116:119], a[168:171], v[56:59], v[116:119]
    ds_read_b64_tr_b16 a[192:193], v6 offset:8192
    ds_read_b64_tr_b16 a[72:73], v8 offset:40960
    v_mfma_f32_16x16x32_bf16 v[116:119], a[172:175], v[64:67], v[116:119]
    ds_read_b64_tr_b16 a[194:195], v6 offset:10240
    ds_read_b64_tr_b16 a[74:75], v8 offset:43008
    v_mfma_f32_16x16x32_bf16 v[116:119], a[176:179], v[72:75], v[116:119]
    ds_read_b64_tr_b16 a[196:197], v6 offset:12288
    ds_read_b64_tr_b16 a[76:77], v8 offset:45056
    v_mfma_f32_16x16x32_bf16 v[116:119], a[180:183], v[80:83], v[116:119]
    ds_read_b64_tr_b16 a[198:199], v6 offset:14336
    ds_read_b64_tr_b16 a[78:79], v8 offset:47104
    v_mfma_f32_16x16x32_bf16 v[132:135], a[152:155], v[152:155], 0
    ds_read_b64_tr_b16 a[200:201], v6 offset:16384
    ds_read_b64_tr_b16 a[80:81], v8 offset:49152
    v_mfma_f32_16x16x32_bf16 v[132:135], a[156:159], v[160:163], v[132:135]
    ds_read_b64_tr_b16 a[202:203], v6 offset:18432
    ds_read_b64_tr_b16 a[82:83], v8 offset:51200
    v_mfma_f32_16x16x32_bf16 v[132:135], a[160:163], v[168:171], v[132:135]
    ds_read_b64_tr_b16 a[204:205], v6 offset:20480
    ds_read_b64_tr_b16 a[84:85], v8 offset:53248
    v_mfma_f32_16x16x32_bf16 v[132:135], a[164:167], v[176:179], v[132:135]
    ds_read_b64_tr_b16 a[206:207], v6 offset:22528
    ds_read_b64_tr_b16 a[86:87], v8 offset:55296
    v_mfma_f32_16x16x32_bf16 v[132:135], a[168:171], v[184:187], v[132:135]
    ds_read_b64_tr_b16 a[208:209], v6 offset:24576
    ds_read_b64_tr_b16 a[88:89], v8 offset:57344
    v_mfma_f32_16x16x32_bf16 v[132:135], a[172:175], v[192:195], v[132:135]
    ds_read_b64_tr_b16 a[210:211], v6 offset:26624
    ds_read_b64_tr_b16 a[90:91], v8 offset:59392
    v_mfma_f32_16x16x32_bf16 v[132:135], a[176:179], v[200:203], v[132:135]
    ds_read_b64_tr_b16 a[212:213], v6 offset:28672
    ds_read_b64_tr_b16 a[92:93], v8 offset:61440
    v_mfma_f32_16x16x32_bf16 v[132:135], a[180:183], v[208:211], v[132:135]
    ds_read_b64_tr_b16 a[214:215], v6 offset:30720
    ds_read_b64_tr_b16 a[94:95], v8 offset:63488
    v_mfma_f32_16x16x32_bf16 v[148:151], a[152:155], v[44:47], 0
    v_mul_f32 v207, v12, v207
    v_cvt_pk_bf16_f32 v204, v204, v205
    v_mfma_f32_16x16x32_bf16 v[148:151], a[156:159], v[52:55], v[148:151]
    v_cvt_pk_bf16_f32 v205, v206, v207
    v_mul_f32 v212, v13, v212
    v_mfma_f32_16x16x32_bf16 v[148:151], a[160:163], v[60:63], v[148:151]
    v_mul_f32 v213, v13, v213
    v_mul_f32 v214, v13, v214
    v_mfma_f32_16x16x32_bf16 v[148:151], a[164:167], v[68:71], v[148:151]
    v_mul_f32 v215, v13, v215
    v_cvt_pk_bf16_f32 v212, v212, v213
    v_mfma_f32_16x16x32_bf16 v[148:151], a[168:171], v[76:79], v[148:151]
    v_add_u32 v8, 65536, v8
    v_cvt_pk_bf16_f32 v213, v214, v215
    v_mfma_f32_16x16x32_bf16 v[148:151], a[172:175], v[84:87], v[148:151]
    v_mul_f32 v100, v14, v100
    v_mul_f32 v101, v14, v101
    v_mfma_f32_16x16x32_bf16 v[148:151], a[176:179], v[92:95], v[148:151]
    v_mul_f32 v102, v14, v102
    v_mul_f32 v103, v14, v103
    v_mfma_f32_16x16x32_bf16 v[148:151], a[180:183], v[108:111], v[148:151]
    v_cvt_pk_bf16_f32 v100, v100, v101
    s_waitcnt lgkmcnt(15)
    v_mfma_f32_16x16x32_bf16 v[116:119], a[184:187], v[88:91], v[116:119]
    ds_read_b64_tr_b16 a[96:97], v8 offset:0
    v_cvt_pk_bf16_f32 v101, v102, v103
    v_mfma_f32_16x16x32_bf16 v[116:119], a[188:191], v[96:99], v[116:119]
    ds_read_b64_tr_b16 a[98:99], v8 offset:2048
    v_mfma_f32_16x16x32_bf16 v[116:119], a[192:195], v[104:107], v[116:119]
    ds_read_b64_tr_b16 a[100:101], v8 offset:4096
    v_mfma_f32_16x16x32_bf16 v[116:119], a[196:199], v[112:115], v[116:119]
    ds_read_b64_tr_b16 a[102:103], v8 offset:6144
    s_waitcnt lgkmcnt(5)
    v_mfma_f32_16x16x32_bf16 v[116:119], a[200:203], v[120:123], v[116:119]
    ds_read_b64_tr_b16 a[104:105], v8 offset:8192
    v_mfma_f32_16x16x32_bf16 v[116:119], a[204:207], v[128:131], v[116:119]
    ds_read_b64_tr_b16 a[106:107], v8 offset:10240
    v_mfma_f32_16x16x32_bf16 v[116:119], a[208:211], v[136:139], v[116:119]
    ds_read_b64_tr_b16 a[108:109], v8 offset:12288
    v_mfma_f32_16x16x32_bf16 v[116:119], a[212:215], v[144:147], v[116:119]
    ds_read_b64_tr_b16 a[110:111], v8 offset:14336
    v_mfma_f32_16x16x32_bf16 v[132:135], a[184:187], v[216:219], v[132:135]
    ds_read_b64_tr_b16 a[112:113], v8 offset:16384
    v_mfma_f32_16x16x32_bf16 v[132:135], a[188:191], v[224:227], v[132:135]
    ds_read_b64_tr_b16 a[114:115], v8 offset:18432
    v_mfma_f32_16x16x32_bf16 v[132:135], a[192:195], v[232:235], v[132:135]
    ds_read_b64_tr_b16 a[116:117], v8 offset:20480
    v_mfma_f32_16x16x32_bf16 v[132:135], a[196:199], v[240:243], v[132:135]
    ds_read_b64_tr_b16 a[118:119], v8 offset:22528
    v_mfma_f32_16x16x32_bf16 v[132:135], a[200:203], v[248:251], v[132:135]
    ds_read_b64_tr_b16 a[120:121], v8 offset:24576
    v_mfma_f32_16x16x32_bf16 v[132:135], a[204:207], v[16:19], v[132:135]
    ds_read_b64_tr_b16 a[122:123], v8 offset:26624
    v_mfma_f32_16x16x32_bf16 v[132:135], a[208:211], v[28:31], v[132:135]
    ds_read_b64_tr_b16 a[124:125], v8 offset:28672
    v_mfma_f32_16x16x32_bf16 v[132:135], a[212:215], v[36:39], v[132:135]
    ds_read_b64_tr_b16 a[126:127], v8 offset:30720
    v_mul_f32 v116, v12, v116
    v_mfma_f32_16x16x32_bf16 v[148:151], a[184:187], v[124:127], v[148:151]
    v_mul_f32 v117, v12, v117
    v_mul_f32 v118, v12, v118
    v_mfma_f32_16x16x32_bf16 v[148:151], a[188:191], v[140:143], v[148:151]
    v_mul_f32 v119, v12, v119
    v_cvt_pk_bf16_f32 v206, v116, v117
    v_mfma_f32_16x16x32_bf16 v[148:151], a[192:195], v[220:223], v[148:151]
    v_cvt_pk_bf16_f32 v207, v118, v119
    v_mfma_f32_16x16x32_bf16 v[148:151], a[196:199], v[236:239], v[148:151]
    v_permlane16_swap_b32 v204, v206
    v_permlane16_swap_b32 v205, v207
    v_mfma_f32_16x16x32_bf16 v[148:151], a[200:203], v[252:255], v[148:151]
    buffer_store_dwordx4 v[204:207], v9, s[32:35], s43 offen offset:0 sc1 nt
    v_mfma_f32_16x16x32_bf16 v[148:151], a[204:207], v[156:159], v[148:151]
    v_mfma_f32_16x16x32_bf16 v[148:151], a[208:211], v[172:175], v[148:151]
    v_mfma_f32_16x16x32_bf16 v[148:151], a[212:215], v[188:191], v[148:151]
    v_mul_f32 v132, v13, v132
    v_mfma_f32_16x16x32_bf16 v[228:231], a[0:3], v[24:27], 0
    v_mul_f32 v133, v13, v133
    v_mul_f32 v134, v13, v134
    v_mfma_f32_16x16x32_bf16 v[228:231], a[4:7], v[32:35], v[228:231]
    v_mul_f32 v135, v13, v135
    v_cvt_pk_bf16_f32 v214, v132, v133
    v_mfma_f32_16x16x32_bf16 v[228:231], a[8:11], v[40:43], v[228:231]
    v_cvt_pk_bf16_f32 v215, v134, v135
    v_mfma_f32_16x16x32_bf16 v[228:231], a[12:15], v[48:51], v[228:231]
    v_permlane16_swap_b32 v212, v214
    v_mfma_f32_16x16x32_bf16 v[228:231], a[16:19], v[56:59], v[228:231]
    v_permlane16_swap_b32 v213, v215
    v_mfma_f32_16x16x32_bf16 v[228:231], a[20:23], v[64:67], v[228:231]
    buffer_store_dwordx4 v[212:215], v10, s[32:35], s43 offen offset:0 sc1 nt
    v_mfma_f32_16x16x32_bf16 v[228:231], a[24:27], v[72:75], v[228:231]
    v_mfma_f32_16x16x32_bf16 v[228:231], a[28:31], v[80:83], v[228:231]
    v_mul_f32 v148, v14, v148
    v_mfma_f32_16x16x32_bf16 v[228:231], a[32:35], v[88:91], v[228:231]
    v_mul_f32 v149, v14, v149
    v_mul_f32 v150, v14, v150
    v_mfma_f32_16x16x32_bf16 v[228:231], a[36:39], v[96:99], v[228:231]
    v_mul_f32 v151, v14, v151
    v_cvt_pk_bf16_f32 v102, v148, v149
    v_mfma_f32_16x16x32_bf16 v[228:231], a[40:43], v[104:107], v[228:231]
    v_cvt_pk_bf16_f32 v103, v150, v151
    v_mfma_f32_16x16x32_bf16 v[228:231], a[44:47], v[112:115], v[228:231]
    v_permlane16_swap_b32 v100, v102
    v_mfma_f32_16x16x32_bf16 v[228:231], a[48:51], v[120:123], v[228:231]
    v_permlane16_swap_b32 v101, v103
    v_mfma_f32_16x16x32_bf16 v[228:231], a[52:55], v[128:131], v[228:231]
    buffer_store_dwordx4 v[100:103], v11, s[32:35], s43 offen offset:0 sc1 nt
    v_mfma_f32_16x16x32_bf16 v[228:231], a[56:59], v[136:139], v[228:231]
    v_mfma_f32_16x16x32_bf16 v[228:231], a[60:63], v[144:147], v[228:231]
    v_mfma_f32_16x16x32_bf16 v[164:167], a[64:67], v[24:27], 0
    v_mfma_f32_16x16x32_bf16 v[164:167], a[68:71], v[32:35], v[164:167]
    v_mfma_f32_16x16x32_bf16 v[164:167], a[72:75], v[40:43], v[164:167]
    v_mfma_f32_16x16x32_bf16 v[164:167], a[76:79], v[48:51], v[164:167]
    s_waitcnt lgkmcnt(15)
    v_mfma_f32_16x16x32_bf16 v[164:167], a[80:83], v[56:59], v[164:167]
    v_mfma_f32_16x16x32_bf16 v[164:167], a[84:87], v[64:67], v[164:167]
    v_mfma_f32_16x16x32_bf16 v[164:167], a[88:91], v[72:75], v[164:167]
    v_mfma_f32_16x16x32_bf16 v[164:167], a[92:95], v[80:83], v[164:167]
    v_mul_f32 v228, v12, v228
    s_waitcnt lgkmcnt(8)
    v_mfma_f32_16x16x32_bf16 v[164:167], a[96:99], v[88:91], v[164:167]
    v_mul_f32 v229, v12, v229
    v_mul_f32 v230, v12, v230
    v_mfma_f32_16x16x32_bf16 v[164:167], a[100:103], v[96:99], v[164:167]
    v_mul_f32 v231, v12, v231
    v_cvt_pk_bf16_f32 v228, v228, v229
    v_mfma_f32_16x16x32_bf16 v[164:167], a[104:107], v[104:107], v[164:167]
    v_cvt_pk_bf16_f32 v229, v230, v231
    v_mfma_f32_16x16x32_bf16 v[164:167], a[108:111], v[112:115], v[164:167]
    s_waitcnt lgkmcnt(0)
    v_mfma_f32_16x16x32_bf16 v[164:167], a[112:115], v[120:123], v[164:167]
    v_mfma_f32_16x16x32_bf16 v[164:167], a[116:119], v[128:131], v[164:167]
    v_mfma_f32_16x16x32_bf16 v[164:167], a[120:123], v[136:139], v[164:167]
    v_mfma_f32_16x16x32_bf16 v[164:167], a[124:127], v[144:147], v[164:167]
    v_mfma_f32_16x16x32_bf16 v[244:247], a[0:3], v[152:155], 0
    v_mfma_f32_16x16x32_bf16 v[244:247], a[4:7], v[160:163], v[244:247]
    v_mfma_f32_16x16x32_bf16 v[244:247], a[8:11], v[168:171], v[244:247]
    v_mfma_f32_16x16x32_bf16 v[244:247], a[12:15], v[176:179], v[244:247]
    v_mfma_f32_16x16x32_bf16 v[244:247], a[16:19], v[184:187], v[244:247]
    v_mfma_f32_16x16x32_bf16 v[244:247], a[20:23], v[192:195], v[244:247]
    v_mfma_f32_16x16x32_bf16 v[244:247], a[24:27], v[200:203], v[244:247]
    v_mfma_f32_16x16x32_bf16 v[244:247], a[28:31], v[208:211], v[244:247]
    v_mul_f32 v164, v12, v164
    v_mul_f32 v165, v12, v165
    v_mfma_f32_16x16x32_bf16 v[244:247], a[32:35], v[216:219], v[244:247]
    v_mul_f32 v166, v12, v166
    v_mul_f32 v167, v12, v167
    v_mfma_f32_16x16x32_bf16 v[244:247], a[36:39], v[224:227], v[244:247]
    v_cvt_pk_bf16_f32 v230, v164, v165
    v_cvt_pk_bf16_f32 v231, v166, v167
    v_mfma_f32_16x16x32_bf16 v[244:247], a[40:43], v[232:235], v[244:247]
    v_permlane16_swap_b32 v228, v230
    v_permlane16_swap_b32 v229, v231
    v_mfma_f32_16x16x32_bf16 v[244:247], a[44:47], v[240:243], v[244:247]
    buffer_store_dwordx4 v[228:231], v9, s[32:35], s43 offen offset:64 sc1 nt
    v_mfma_f32_16x16x32_bf16 v[244:247], a[48:51], v[248:251], v[244:247]
    v_mfma_f32_16x16x32_bf16 v[244:247], a[52:55], v[16:19], v[244:247]
    v_mfma_f32_16x16x32_bf16 v[244:247], a[56:59], v[28:31], v[244:247]
    v_mfma_f32_16x16x32_bf16 v[244:247], a[60:63], v[36:39], v[244:247]
    v_mfma_f32_16x16x32_bf16 v[180:183], a[64:67], v[152:155], 0
    v_mfma_f32_16x16x32_bf16 v[180:183], a[68:71], v[160:163], v[180:183]
    v_mfma_f32_16x16x32_bf16 v[180:183], a[72:75], v[168:171], v[180:183]
    v_mfma_f32_16x16x32_bf16 v[180:183], a[76:79], v[176:179], v[180:183]
    v_mfma_f32_16x16x32_bf16 v[180:183], a[80:83], v[184:187], v[180:183]
    v_mfma_f32_16x16x32_bf16 v[180:183], a[84:87], v[192:195], v[180:183]
    v_mfma_f32_16x16x32_bf16 v[180:183], a[88:91], v[200:203], v[180:183]
    v_mfma_f32_16x16x32_bf16 v[180:183], a[92:95], v[208:211], v[180:183]
    v_mul_f32 v244, v13, v244
    v_mul_f32 v245, v13, v245
    v_mfma_f32_16x16x32_bf16 v[180:183], a[96:99], v[216:219], v[180:183]
    v_mul_f32 v246, v13, v246
    v_mul_f32 v247, v13, v247
    v_mfma_f32_16x16x32_bf16 v[180:183], a[100:103], v[224:227], v[180:183]
    v_cvt_pk_bf16_f32 v244, v244, v245
    v_cvt_pk_bf16_f32 v245, v246, v247
    v_mfma_f32_16x16x32_bf16 v[180:183], a[104:107], v[232:235], v[180:183]
    v_mfma_f32_16x16x32_bf16 v[180:183], a[108:111], v[240:243], v[180:183]
    v_mfma_f32_16x16x32_bf16 v[180:183], a[112:115], v[248:251], v[180:183]
    v_mfma_f32_16x16x32_bf16 v[180:183], a[116:119], v[16:19], v[180:183]
    v_mfma_f32_16x16x32_bf16 v[180:183], a[120:123], v[28:31], v[180:183]
    v_mfma_f32_16x16x32_bf16 v[180:183], a[124:127], v[36:39], v[180:183]
    v_mfma_f32_16x16x32_bf16 v[20:23], a[0:3], v[44:47], 0
    v_mfma_f32_16x16x32_bf16 v[20:23], a[4:7], v[52:55], v[20:23]
    v_mfma_f32_16x16x32_bf16 v[20:23], a[8:11], v[60:63], v[20:23]
    v_mfma_f32_16x16x32_bf16 v[20:23], a[12:15], v[68:71], v[20:23]
    v_mfma_f32_16x16x32_bf16 v[20:23], a[16:19], v[76:79], v[20:23]
    v_mfma_f32_16x16x32_bf16 v[20:23], a[20:23], v[84:87], v[20:23]
    v_mfma_f32_16x16x32_bf16 v[20:23], a[24:27], v[92:95], v[20:23]
    v_mfma_f32_16x16x32_bf16 v[20:23], a[28:31], v[108:111], v[20:23]
    v_mul_f32 v180, v13, v180
    v_mul_f32 v181, v13, v181
    v_mfma_f32_16x16x32_bf16 v[20:23], a[32:35], v[124:127], v[20:23]
    v_mul_f32 v182, v13, v182
    v_mul_f32 v183, v13, v183
    v_mfma_f32_16x16x32_bf16 v[20:23], a[36:39], v[140:143], v[20:23]
    v_cvt_pk_bf16_f32 v246, v180, v181
    v_cvt_pk_bf16_f32 v247, v182, v183
    v_mfma_f32_16x16x32_bf16 v[20:23], a[40:43], v[220:223], v[20:23]
    v_permlane16_swap_b32 v244, v246
    v_permlane16_swap_b32 v245, v247
    v_mfma_f32_16x16x32_bf16 v[20:23], a[44:47], v[236:239], v[20:23]
    buffer_store_dwordx4 v[244:247], v10, s[32:35], s43 offen offset:64 sc1 nt
    v_mfma_f32_16x16x32_bf16 v[20:23], a[48:51], v[252:255], v[20:23]
    v_mfma_f32_16x16x32_bf16 v[20:23], a[52:55], v[156:159], v[20:23]
    v_mfma_f32_16x16x32_bf16 v[20:23], a[56:59], v[172:175], v[20:23]
    v_mfma_f32_16x16x32_bf16 v[20:23], a[60:63], v[188:191], v[20:23]
    v_mfma_f32_16x16x32_bf16 v[196:199], a[64:67], v[44:47], 0
    v_mfma_f32_16x16x32_bf16 v[196:199], a[68:71], v[52:55], v[196:199]
    v_mfma_f32_16x16x32_bf16 v[196:199], a[72:75], v[60:63], v[196:199]
    v_mfma_f32_16x16x32_bf16 v[196:199], a[76:79], v[68:71], v[196:199]
    v_mfma_f32_16x16x32_bf16 v[196:199], a[80:83], v[76:79], v[196:199]
    v_mfma_f32_16x16x32_bf16 v[196:199], a[84:87], v[84:87], v[196:199]
    v_mfma_f32_16x16x32_bf16 v[196:199], a[88:91], v[92:95], v[196:199]
    v_mfma_f32_16x16x32_bf16 v[196:199], a[92:95], v[108:111], v[196:199]
    v_mul_f32 v20, v14, v20
    v_mul_f32 v21, v14, v21
    v_mfma_f32_16x16x32_bf16 v[196:199], a[96:99], v[124:127], v[196:199]
    v_mul_f32 v22, v14, v22
    v_mul_f32 v23, v14, v23
    v_mfma_f32_16x16x32_bf16 v[196:199], a[100:103], v[140:143], v[196:199]
    v_cvt_pk_bf16_f32 v20, v20, v21
    v_cvt_pk_bf16_f32 v21, v22, v23
    v_mfma_f32_16x16x32_bf16 v[196:199], a[104:107], v[220:223], v[196:199]
    v_mfma_f32_16x16x32_bf16 v[196:199], a[108:111], v[236:239], v[196:199]
    v_mfma_f32_16x16x32_bf16 v[196:199], a[112:115], v[252:255], v[196:199]
    v_mfma_f32_16x16x32_bf16 v[196:199], a[116:119], v[156:159], v[196:199]
    v_mfma_f32_16x16x32_bf16 v[196:199], a[120:123], v[172:175], v[196:199]
    v_mfma_f32_16x16x32_bf16 v[196:199], a[124:127], v[188:191], v[196:199]
    s_nop 7
    v_mul_f32 v196, v14, v196
    v_mul_f32 v197, v14, v197
    v_mul_f32 v198, v14, v198
    v_mul_f32 v199, v14, v199
    v_cvt_pk_bf16_f32 v22, v196, v197
    v_cvt_pk_bf16_f32 v23, v198, v199
    s_nop 0
    v_permlane16_swap_b32 v20, v22
    v_permlane16_swap_b32 v21, v23
    buffer_store_dwordx4 v[20:23], v11, s[32:35], s43 offen offset:64 sc1 nt
    s_waitcnt vmcnt(0)
L_end:
    s_endpgm
.p2align 12
L_fallback:
    s_waitcnt vmcnt(0) lgkmcnt(0)
    s_barrier
    v_mbcnt_lo_u32_b32 v0, -1, 0
    v_mbcnt_hi_u32_b32 v0, -1, v0
    s_lshl_b32 s19, s18, 6
    v_add_u32 v0, s19, v0
    s_nop 7
    s_load_dwordx4 s[4:7], s[0:1], 0
    s_load_dwordx4 s[8:11], s[0:1], 16
    v_lshrrev_b32 v1, 6, v0
    v_and_b32 v0, 63, v0
    v_readfirstlane_b32 s18, v1
    s_and_b32 s14, s2, 7
    s_lshr_b32 s15, s2, 3
    s_lshl_b32 s14, s14, 3
    s_lshr_b32 s16, s15, 2
    s_add_u32 s14, s14, s16
    s_and_b32 s15, s15, 3
    s_mul_i32 s16, s14, 736
    s_mul_i32 s17, s15, 184
    s_add_u32 s16, s16, s17
    s_lshl_b32 s16, s16, 9
    s_lshl_b32 s17, s14, 18
    v_lshrrev_b32 v104, 3, v0
    v_and_b32 v105, 7, v0
    v_lshrrev_b32 v106, 4, v0
    v_lshlrev_b32 v107, 1, v106
    v_xor_b32 v107, v105, v107
    v_lshlrev_b32 v107, 4, v107
    v_lshl_add_u32 v1, v104, 9, v107
    v_xor_b32 v2, 16, v1
    v_add_u32 v2, 3072, v2
    v_add_u32 v3, 6144, v1
    v_add_u32 v4, 6144, v2
    v_add_u32 v18, 16384, v1
    v_add_u32 v19, 16384, v2
    s_mul_i32 s19, s18, 24576
    s_lshl_b32 s36, s18, 12
    s_mul_i32 s37, s18, 6144
    s_add_u32 s37, s37, 114688
    s_lshl_b32 s38, s18, 14
    s_waitcnt lgkmcnt(0)
    s_add_u32 s20, s4, s16
    s_addc_u32 s21, s5, 0
    s_add_u32 s20, s20, s19
    s_addc_u32 s21, s21, 0
    s_sub_u32 s22, 94208, s19
    s_mov_b32 s23, 0x20000
    s_add_u32 s24, s6, s17
    s_addc_u32 s25, s7, 0
    s_mov_b32 s26, 262144
    s_mov_b32 s27, 0x20000
    s_add_u32 m0, s37, 0
    s_nop 0
    buffer_load_dwordx4 v1, s[20:23], 0 offen offset:0 nt lds
    buffer_load_dwordx4 v2, s[20:23], 0 offen offset:1024 nt lds
    buffer_load_dwordx4 v3, s[20:23], 0 offen offset:2048 nt lds
    buffer_load_dwordx4 v4, s[20:23], 0 offen offset:3072 nt lds
    s_add_u32 m0, s37, 4096
    s_nop 0
    buffer_load_dwordx4 v18, s[20:23], 0 offen offset:0 nt lds
    buffer_load_dwordx4 v19, s[20:23], 0 offen offset:1024 nt lds
    s_add_u32 m0, s36, 0
    s_add_u32 s48, s38, 0
    buffer_load_dwordx4 v1, s[24:27], s48 offen offset:0 nt lds
    buffer_load_dwordx4 v2, s[24:27], s48 offen offset:1024 nt lds
    buffer_load_dwordx4 v3, s[24:27], s48 offen offset:2048 nt lds
    buffer_load_dwordx4 v4, s[24:27], s48 offen offset:3072 nt lds
    s_mov_b32 s41, 128
    s_mov_b32 s42, 256
    s_mov_b32 s43, 384
    s_lshl_b32 s100, s18, 11
    s_lshl_b32 s101, s18, 13
    s_mov_b32 s92, 0
    s_mov_b32 s93, 128
    s_mov_b32 s94, 256
    s_mov_b32 s95, 384
    s_lshl_b32 s39, s15, 12
    s_add_u32 s39, s39, s38
    s_add_u32 s44, s39, 131328
    s_add_u32 s45, s39, 196864
    s_add_u32 s46, s39, 384
    s_add_u32 s47, s39, 65920
    s_add_u32 s56, s39, 131456
    s_add_u32 s57, s39, 196992
    s_add_u32 s28, s8, s17
    s_addc_u32 s29, s9, 0
    s_mov_b32 s30, 262144
    s_mov_b32 s31, 0x20000
    s_add_u32 s32, s10, s16
    s_addc_u32 s33, s11, 0
    s_mov_b32 s34, 94208
    s_mov_b32 s35, 0x20000
    s_mov_b32 s50, 1035512379
    s_mov_b32 s51, 1035512379
    v_and_b32 v108, 15, v0
    v_and_b32 v109, 6, v108
    v_lshrrev_b32 v113, 3, v108
    v_or_b32 v109, v109, v113
    v_lshlrev_b32 v113, 1, v106
    v_xor_b32 v109, v109, v113
    v_lshlrev_b32 v109, 4, v109
    v_lshl_add_u32 v20, v108, 7, v109
    v_xor_b32 v21, 16, v20
    v_add_u32 v22, 65536, v20
    v_add_u32 v16, s37, v20
    v_add_u32 v23, 65536, v21
    v_add_u32 v17, s37, v21
    v_lshrrev_b32 v109, 2, v0
    v_lshlrev_b32 v113, 7, v109
    v_and_b32 v114, 6, v109
    v_lshrrev_b32 v109, 3, v109
    v_or_b32 v114, v114, v109
    v_bfe_u32 v109, v0, 1, 1
    v_xor_b32 v114, v114, v109
    v_lshlrev_b32 v114, 4, v114
    v_and_b32 v109, 1, v0
    v_lshlrev_b32 v109, 3, v109
    v_add3_u32 v5, v113, v114, v109
    v_xor_b32 v6, 32, v5
    v_xor_b32 v7, 64, v5
    v_xor_b32 v8, 96, v5
    v_and_b32 v109, 1, v106
    v_lshlrev_b32 v109, 5, v109
    v_lshrrev_b32 v113, 1, v106
    v_lshlrev_b32 v113, 4, v113
    v_lshl_add_u32 v114, v108, 9, s19
    v_add3_u32 v9, v114, v109, v113
    v_add_u32 v10, 8192, v9
    v_add_u32 v11, 16384, v9
    v_mov_b32 v13, 1065369472
    v_accvgpr_write_b32 a232, v13
    v_accvgpr_write_b32 a233, v13
    v_accvgpr_write_b32 a234, v13
    v_accvgpr_write_b32 a235, v13
    s_add_u32 m0, s36, 16384
    s_add_u32 s48, s38, 65536
    s_waitcnt vmcnt(9)
    buffer_load_dwordx4 v1, s[24:27], s48 offen offset:0 nt lds
    s_waitcnt vmcnt(9)
    buffer_load_dwordx4 v2, s[24:27], s48 offen offset:1024 nt lds
    s_waitcnt vmcnt(9)
    buffer_load_dwordx4 v3, s[24:27], s48 offen offset:2048 nt lds
    s_waitcnt vmcnt(9)
    buffer_load_dwordx4 v4, s[24:27], s48 offen offset:3072 nt lds
    s_add_u32 m0, s36, 32768
    s_add_u32 s48, s38, 131072
    s_waitcnt vmcnt(9)
    buffer_load_dwordx4 v1, s[24:27], s48 offen offset:0 nt lds
    s_waitcnt vmcnt(9)
    buffer_load_dwordx4 v2, s[24:27], s48 offen offset:1024 nt lds
    s_waitcnt vmcnt(9)
    buffer_load_dwordx4 v3, s[24:27], s48 offen offset:2048 nt lds
    s_waitcnt vmcnt(9)
    buffer_load_dwordx4 v4, s[24:27], s48 offen offset:3072 nt lds
    s_add_u32 m0, s37, 24576
    s_waitcnt vmcnt(9)
    buffer_load_dwordx4 v1, s[20:23], s41 offen offset:0 nt lds
    s_waitcnt vmcnt(9)
    buffer_load_dwordx4 v2, s[20:23], s41 offen offset:1024 nt lds
    s_waitcnt vmcnt(14)
    ds_read_b128 a[184:187], v16 offset:0
    ds_read_b128 a[188:191], v17 offset:0
    ds_read_b128 a[192:195], v16 offset:2048
    ds_read_b128 a[196:199], v17 offset:2048
    ds_read_b128 a[200:203], v16 offset:4096
    ds_read_b128 a[204:207], v17 offset:4096
    s_waitcnt vmcnt(10)
    s_barrier
    ds_read_b128 a[152:155], v20 offset:0
    ds_read_b128 a[156:159], v21 offset:0
    ds_read_b128 a[160:163], v20 offset:2048
    ds_read_b128 a[164:167], v21 offset:2048
    s_waitcnt lgkmcnt(4)
    s_waitcnt lgkmcnt(2)
    v_mfma_f32_16x16x32_bf16 v[24:27], a[152:155], a[184:187], 0
    ds_read_b128 a[168:171], v20 offset:4096
    s_add_u32 m0, s36, 49152
    v_mfma_f32_16x16x32_bf16 v[24:27], a[156:159], a[188:191], v[24:27]
    ds_read_b128 a[172:175], v21 offset:4096
    s_add_u32 s48, s38, 196608
    v_mfma_f32_16x16x32_bf16 a[0:3], a[152:155], a[192:195], 0
    buffer_load_dwordx4 v1, s[24:27], s48 offen offset:0 nt lds
    v_mfma_f32_16x16x32_bf16 a[0:3], a[156:159], a[196:199], a[0:3]
    v_mfma_f32_16x16x32_bf16 a[24:27], a[152:155], a[200:203], 0
    v_mfma_f32_16x16x32_bf16 a[24:27], a[156:159], a[204:207], a[24:27]
    s_waitcnt lgkmcnt(2)
    v_mfma_f32_16x16x32_bf16 v[28:31], a[160:163], a[184:187], 0
    ds_read_b128 a[176:179], v20 offset:6144
    v_mfma_f32_16x16x32_bf16 v[28:31], a[164:167], a[188:191], v[28:31]
    ds_read_b128 a[180:183], v21 offset:6144
    v_mfma_f32_16x16x32_bf16 a[4:7], a[160:163], a[192:195], 0
    v_mfma_f32_16x16x32_bf16 a[4:7], a[164:167], a[196:199], a[4:7]
    buffer_load_dwordx4 v2, s[24:27], s48 offen offset:1024 nt lds
    v_mfma_f32_16x16x32_bf16 a[28:31], a[160:163], a[200:203], 0
    v_mfma_f32_16x16x32_bf16 a[28:31], a[164:167], a[204:207], a[28:31]
    s_waitcnt lgkmcnt(2)
    v_mfma_f32_16x16x32_bf16 v[32:35], a[168:171], a[184:187], 0
    ds_read_b128 a[152:155], v20 offset:8192
    v_mfma_f32_16x16x32_bf16 v[32:35], a[172:175], a[188:191], v[32:35]
    ds_read_b128 a[156:159], v21 offset:8192
    v_mfma_f32_16x16x32_bf16 a[8:11], a[168:171], a[192:195], 0
    v_mfma_f32_16x16x32_bf16 a[8:11], a[172:175], a[196:199], a[8:11]
    v_mfma_f32_16x16x32_bf16 a[32:35], a[168:171], a[200:203], 0
    buffer_load_dwordx4 v3, s[24:27], s48 offen offset:2048 nt lds
    v_mfma_f32_16x16x32_bf16 a[32:35], a[172:175], a[204:207], a[32:35]
    s_waitcnt lgkmcnt(2)
    v_mfma_f32_16x16x32_bf16 v[36:39], a[176:179], a[184:187], 0
    ds_read_b128 a[160:163], v20 offset:10240
    v_mfma_f32_16x16x32_bf16 v[36:39], a[180:183], a[188:191], v[36:39]
    ds_read_b128 a[164:167], v21 offset:10240
    v_mfma_f32_16x16x32_bf16 a[12:15], a[176:179], a[192:195], 0
    v_mfma_f32_16x16x32_bf16 a[12:15], a[180:183], a[196:199], a[12:15]
    v_mfma_f32_16x16x32_bf16 a[36:39], a[176:179], a[200:203], 0
    v_mfma_f32_16x16x32_bf16 a[36:39], a[180:183], a[204:207], a[36:39]
    buffer_load_dwordx4 v4, s[24:27], s48 offen offset:3072 nt lds
    s_waitcnt lgkmcnt(2)
    v_mfma_f32_16x16x32_bf16 v[40:43], a[152:155], a[184:187], 0
    ds_read_b128 a[168:171], v20 offset:12288
    v_mfma_f32_16x16x32_bf16 v[40:43], a[156:159], a[188:191], v[40:43]
    ds_read_b128 a[172:175], v21 offset:12288
    v_mfma_f32_16x16x32_bf16 a[16:19], a[152:155], a[192:195], 0
    v_mfma_f32_16x16x32_bf16 a[16:19], a[156:159], a[196:199], a[16:19]
    v_mfma_f32_16x16x32_bf16 a[40:43], a[152:155], a[200:203], 0
    v_mfma_f32_16x16x32_bf16 a[40:43], a[156:159], a[204:207], a[40:43]
    s_waitcnt lgkmcnt(2)
    v_mfma_f32_16x16x32_bf16 v[44:47], a[160:163], a[184:187], 0
    ds_read_b128 a[176:179], v20 offset:14336
    s_add_u32 m0, s37, 24576
    v_mfma_f32_16x16x32_bf16 v[44:47], a[164:167], a[188:191], v[44:47]
    ds_read_b128 a[180:183], v21 offset:14336
    buffer_load_dwordx4 v3, s[20:23], s41 offen offset:2048 nt lds
    v_mfma_f32_16x16x32_bf16 a[20:23], a[160:163], a[192:195], 0
    v_mfma_f32_16x16x32_bf16 a[20:23], a[164:167], a[196:199], a[20:23]
    v_mfma_f32_16x16x32_bf16 a[44:47], a[160:163], a[200:203], 0
    v_mfma_f32_16x16x32_bf16 a[44:47], a[164:167], a[204:207], a[44:47]
    s_waitcnt lgkmcnt(2)
    v_mfma_f32_16x16x32_bf16 v[48:51], a[168:171], a[184:187], 0
    s_waitcnt vmcnt(11)
    s_barrier
    v_mfma_f32_16x16x32_bf16 v[48:51], a[172:175], a[188:191], v[48:51]
    ds_read_b128 a[152:155], v20 offset:16384
    v_mfma_f32_16x16x32_bf16 v[152:155], a[168:171], a[192:195], 0
    ds_read_b128 a[156:159], v21 offset:16384
    buffer_load_dwordx4 v4, s[20:23], s41 offen offset:3072 nt lds
    v_mfma_f32_16x16x32_bf16 v[152:155], a[172:175], a[196:199], v[152:155]
    v_mfma_f32_16x16x32_bf16 a[48:51], a[168:171], a[200:203], 0
    v_mfma_f32_16x16x32_bf16 a[48:51], a[172:175], a[204:207], a[48:51]
    s_waitcnt lgkmcnt(2)
    v_mfma_f32_16x16x32_bf16 v[52:55], a[176:179], a[184:187], 0
    ds_read_b128 a[160:163], v20 offset:18432
    v_mfma_f32_16x16x32_bf16 v[52:55], a[180:183], a[188:191], v[52:55]
    ds_read_b128 a[164:167], v21 offset:18432
    v_mfma_f32_16x16x32_bf16 v[156:159], a[176:179], a[192:195], 0
    v_mfma_f32_16x16x32_bf16 v[156:159], a[180:183], a[196:199], v[156:159]
    s_add_u32 m0, s37, 28672
    v_mfma_f32_16x16x32_bf16 a[52:55], a[176:179], a[200:203], 0
    buffer_load_dwordx4 v18, s[20:23], s41 offen offset:0 nt lds
    v_mfma_f32_16x16x32_bf16 a[52:55], a[180:183], a[204:207], a[52:55]
    s_waitcnt lgkmcnt(2)
    v_mfma_f32_16x16x32_bf16 v[56:59], a[152:155], a[184:187], 0
    ds_read_b128 a[168:171], v20 offset:20480
    v_mfma_f32_16x16x32_bf16 v[56:59], a[156:159], a[188:191], v[56:59]
    ds_read_b128 a[172:175], v21 offset:20480
    v_mfma_f32_16x16x32_bf16 v[160:163], a[152:155], a[192:195], 0
    v_mfma_f32_16x16x32_bf16 v[160:163], a[156:159], a[196:199], v[160:163]
    v_mfma_f32_16x16x32_bf16 a[56:59], a[152:155], a[200:203], 0
    v_mfma_f32_16x16x32_bf16 a[56:59], a[156:159], a[204:207], a[56:59]
    buffer_load_dwordx4 v19, s[20:23], s41 offen offset:1024 nt lds
    s_waitcnt lgkmcnt(2)
    v_mfma_f32_16x16x32_bf16 v[60:63], a[160:163], a[184:187], 0
    ds_read_b128 a[176:179], v20 offset:22528
    v_mfma_f32_16x16x32_bf16 v[60:63], a[164:167], a[188:191], v[60:63]
    ds_read_b128 a[180:183], v21 offset:22528
    v_mfma_f32_16x16x32_bf16 v[164:167], a[160:163], a[192:195], 0
    v_mfma_f32_16x16x32_bf16 v[164:167], a[164:167], a[196:199], v[164:167]
    v_mfma_f32_16x16x32_bf16 a[60:63], a[160:163], a[200:203], 0
    v_mfma_f32_16x16x32_bf16 a[60:63], a[164:167], a[204:207], a[60:63]
    s_waitcnt lgkmcnt(2)
    v_mfma_f32_16x16x32_bf16 v[64:67], a[168:171], a[184:187], 0
    ds_read_b128 a[152:155], v20 offset:24576
    s_add_u32 m0, s36, 65536
    v_mfma_f32_16x16x32_bf16 v[64:67], a[172:175], a[188:191], v[64:67]
    ds_read_b128 a[156:159], v21 offset:24576
    s_add_u32 s48, s38, 128
    v_mfma_f32_16x16x32_bf16 v[168:171], a[168:171], a[192:195], 0
    buffer_load_dwordx4 v1, s[24:27], s48 offen offset:0 nt lds
    v_mfma_f32_16x16x32_bf16 v[168:171], a[172:175], a[196:199], v[168:171]
    v_mfma_f32_16x16x32_bf16 a[64:67], a[168:171], a[200:203], 0
    v_mfma_f32_16x16x32_bf16 a[64:67], a[172:175], a[204:207], a[64:67]
    s_waitcnt lgkmcnt(2)
    v_mfma_f32_16x16x32_bf16 v[68:71], a[176:179], a[184:187], 0
    ds_read_b128 a[160:163], v20 offset:26624
    v_mfma_f32_16x16x32_bf16 v[68:71], a[180:183], a[188:191], v[68:71]
    ds_read_b128 a[164:167], v21 offset:26624
    v_mfma_f32_16x16x32_bf16 v[172:175], a[176:179], a[192:195], 0
    v_mfma_f32_16x16x32_bf16 v[172:175], a[180:183], a[196:199], v[172:175]
    buffer_load_dwordx4 v2, s[24:27], s48 offen offset:1024 nt lds
    v_mfma_f32_16x16x32_bf16 a[68:71], a[176:179], a[200:203], 0
    v_mfma_f32_16x16x32_bf16 a[68:71], a[180:183], a[204:207], a[68:71]
    s_waitcnt lgkmcnt(2)
    v_mfma_f32_16x16x32_bf16 v[72:75], a[152:155], a[184:187], 0
    ds_read_b128 a[168:171], v20 offset:28672
    v_mfma_f32_16x16x32_bf16 v[72:75], a[156:159], a[188:191], v[72:75]
    ds_read_b128 a[172:175], v21 offset:28672
    v_mfma_f32_16x16x32_bf16 v[176:179], a[152:155], a[192:195], 0
    v_mfma_f32_16x16x32_bf16 v[176:179], a[156:159], a[196:199], v[176:179]
    v_mfma_f32_16x16x32_bf16 a[72:75], a[152:155], a[200:203], 0
    buffer_load_dwordx4 v3, s[24:27], s48 offen offset:2048 nt lds
    v_mfma_f32_16x16x32_bf16 a[72:75], a[156:159], a[204:207], a[72:75]
    s_waitcnt lgkmcnt(2)
    v_mfma_f32_16x16x32_bf16 v[76:79], a[160:163], a[184:187], 0
    ds_read_b128 a[176:179], v20 offset:30720
    v_mfma_f32_16x16x32_bf16 v[76:79], a[164:167], a[188:191], v[76:79]
    ds_read_b128 a[180:183], v21 offset:30720
    v_mfma_f32_16x16x32_bf16 v[180:183], a[160:163], a[192:195], 0
    v_mfma_f32_16x16x32_bf16 v[180:183], a[164:167], a[196:199], v[180:183]
    v_mfma_f32_16x16x32_bf16 a[76:79], a[160:163], a[200:203], 0
    v_mfma_f32_16x16x32_bf16 a[76:79], a[164:167], a[204:207], a[76:79]
    buffer_load_dwordx4 v4, s[24:27], s48 offen offset:3072 nt lds
    s_waitcnt lgkmcnt(2)
    v_mfma_f32_16x16x32_bf16 v[80:83], a[168:171], a[184:187], 0
    s_waitcnt vmcnt(14)
    s_barrier
    v_mfma_f32_16x16x32_bf16 v[80:83], a[172:175], a[188:191], v[80:83]
    ds_read_b128 a[152:155], v20 offset:32768
    v_mfma_f32_16x16x32_bf16 v[184:187], a[168:171], a[192:195], 0
    ds_read_b128 a[156:159], v21 offset:32768
    v_mfma_f32_16x16x32_bf16 v[184:187], a[172:175], a[196:199], v[184:187]
    v_mfma_f32_16x16x32_bf16 a[80:83], a[168:171], a[200:203], 0
    v_mfma_f32_16x16x32_bf16 a[80:83], a[172:175], a[204:207], a[80:83]
    s_waitcnt lgkmcnt(2)
    v_mfma_f32_16x16x32_bf16 v[84:87], a[176:179], a[184:187], 0
    ds_read_b128 a[160:163], v20 offset:34816
    s_add_u32 m0, s36, 81920
    v_mfma_f32_16x16x32_bf16 v[84:87], a[180:183], a[188:191], v[84:87]
    ds_read_b128 a[164:167], v21 offset:34816
    s_add_u32 s48, s38, 65664
    v_mfma_f32_16x16x32_bf16 v[188:191], a[176:179], a[192:195], 0
    buffer_load_dwordx4 v1, s[24:27], s48 offen offset:0 nt lds
    v_mfma_f32_16x16x32_bf16 v[188:191], a[180:183], a[196:199], v[188:191]
    v_mfma_f32_16x16x32_bf16 a[84:87], a[176:179], a[200:203], 0
    v_mfma_f32_16x16x32_bf16 a[84:87], a[180:183], a[204:207], a[84:87]
    s_waitcnt lgkmcnt(2)
    v_mfma_f32_16x16x32_bf16 v[88:91], a[152:155], a[184:187], 0
    ds_read_b128 a[168:171], v20 offset:36864
    v_mfma_f32_16x16x32_bf16 v[88:91], a[156:159], a[188:191], v[88:91]
    ds_read_b128 a[172:175], v21 offset:36864
    v_mfma_f32_16x16x32_bf16 v[192:195], a[152:155], a[192:195], 0
    v_mfma_f32_16x16x32_bf16 v[192:195], a[156:159], a[196:199], v[192:195]
    buffer_load_dwordx4 v2, s[24:27], s48 offen offset:1024 nt lds
    v_mfma_f32_16x16x32_bf16 a[88:91], a[152:155], a[200:203], 0
    v_mfma_f32_16x16x32_bf16 a[88:91], a[156:159], a[204:207], a[88:91]
    s_waitcnt lgkmcnt(2)
    v_mfma_f32_16x16x32_bf16 v[92:95], a[160:163], a[184:187], 0
    ds_read_b128 a[176:179], v20 offset:38912
    v_mfma_f32_16x16x32_bf16 v[92:95], a[164:167], a[188:191], v[92:95]
    ds_read_b128 a[180:183], v21 offset:38912
    v_mfma_f32_16x16x32_bf16 v[196:199], a[160:163], a[192:195], 0
    v_mfma_f32_16x16x32_bf16 v[196:199], a[164:167], a[196:199], v[196:199]
    v_mfma_f32_16x16x32_bf16 a[92:95], a[160:163], a[200:203], 0
    buffer_load_dwordx4 v3, s[24:27], s48 offen offset:2048 nt lds
    v_mfma_f32_16x16x32_bf16 a[92:95], a[164:167], a[204:207], a[92:95]
    s_waitcnt lgkmcnt(2)
    v_mfma_f32_16x16x32_bf16 v[96:99], a[168:171], a[184:187], 0
    ds_read_b128 a[152:155], v20 offset:40960
    v_mfma_f32_16x16x32_bf16 v[96:99], a[172:175], a[188:191], v[96:99]
    ds_read_b128 a[156:159], v21 offset:40960
    v_mfma_f32_16x16x32_bf16 v[200:203], a[168:171], a[192:195], 0
    v_mfma_f32_16x16x32_bf16 v[200:203], a[172:175], a[196:199], v[200:203]
    v_mfma_f32_16x16x32_bf16 a[96:99], a[168:171], a[200:203], 0
    v_mfma_f32_16x16x32_bf16 a[96:99], a[172:175], a[204:207], a[96:99]
    buffer_load_dwordx4 v4, s[24:27], s48 offen offset:3072 nt lds
    s_waitcnt lgkmcnt(2)
    v_mfma_f32_16x16x32_bf16 v[100:103], a[176:179], a[184:187], 0
    ds_read_b128 a[160:163], v20 offset:43008
    v_mfma_f32_16x16x32_bf16 v[100:103], a[180:183], a[188:191], v[100:103]
    ds_read_b128 a[164:167], v21 offset:43008
    v_mfma_f32_16x16x32_bf16 v[204:207], a[176:179], a[192:195], 0
    v_mfma_f32_16x16x32_bf16 v[204:207], a[180:183], a[196:199], v[204:207]
    v_mfma_f32_16x16x32_bf16 a[100:103], a[176:179], a[200:203], 0
    v_mfma_f32_16x16x32_bf16 a[100:103], a[180:183], a[204:207], a[100:103]
    s_waitcnt lgkmcnt(2)
    v_mfma_f32_16x16x32_bf16 v[104:107], a[152:155], a[184:187], 0
    ds_read_b128 a[168:171], v20 offset:45056
    s_add_u32 m0, s37, 0
    v_mfma_f32_16x16x32_bf16 v[104:107], a[156:159], a[188:191], v[104:107]
    ds_read_b128 a[172:175], v21 offset:45056
    buffer_load_dwordx4 v1, s[20:23], s42 offen offset:0 nt lds
    v_mfma_f32_16x16x32_bf16 v[208:211], a[152:155], a[192:195], 0
    v_mfma_f32_16x16x32_bf16 v[208:211], a[156:159], a[196:199], v[208:211]
    v_mfma_f32_16x16x32_bf16 a[104:107], a[152:155], a[200:203], 0
    v_mfma_f32_16x16x32_bf16 a[104:107], a[156:159], a[204:207], a[104:107]
    s_waitcnt lgkmcnt(2)
    v_mfma_f32_16x16x32_bf16 v[108:111], a[160:163], a[184:187], 0
    ds_read_b128 a[176:179], v20 offset:47104
    v_mfma_f32_16x16x32_bf16 v[108:111], a[164:167], a[188:191], v[108:111]
    ds_read_b128 a[180:183], v21 offset:47104
    v_mfma_f32_16x16x32_bf16 v[212:215], a[160:163], a[192:195], 0
    buffer_load_dwordx4 v2, s[20:23], s42 offen offset:1024 nt lds
    v_mfma_f32_16x16x32_bf16 v[212:215], a[164:167], a[196:199], v[212:215]
    v_mfma_f32_16x16x32_bf16 a[108:111], a[160:163], a[200:203], 0
    v_mfma_f32_16x16x32_bf16 a[108:111], a[164:167], a[204:207], a[108:111]
    s_waitcnt lgkmcnt(2)
    v_mfma_f32_16x16x32_bf16 v[112:115], a[168:171], a[184:187], 0
    s_waitcnt vmcnt(14)
    s_barrier
    v_mfma_f32_16x16x32_bf16 v[112:115], a[172:175], a[188:191], v[112:115]
    ds_read_b128 a[152:155], v20 offset:49152
    v_mfma_f32_16x16x32_bf16 v[216:219], a[168:171], a[192:195], 0
    ds_read_b128 a[156:159], v21 offset:49152
    v_mfma_f32_16x16x32_bf16 v[216:219], a[172:175], a[196:199], v[216:219]
    s_add_u32 m0, s36, 98304
    s_add_u32 s48, s38, 131200
    v_mfma_f32_16x16x32_bf16 a[112:115], a[168:171], a[200:203], 0
    buffer_load_dwordx4 v1, s[24:27], s48 offen offset:0 nt lds
    v_mfma_f32_16x16x32_bf16 a[112:115], a[172:175], a[204:207], a[112:115]
    s_waitcnt lgkmcnt(2)
    v_mfma_f32_16x16x32_bf16 v[116:119], a[176:179], a[184:187], 0
    ds_read_b128 a[160:163], v20 offset:51200
    v_mfma_f32_16x16x32_bf16 v[116:119], a[180:183], a[188:191], v[116:119]
    ds_read_b128 a[164:167], v21 offset:51200
    v_mfma_f32_16x16x32_bf16 v[220:223], a[176:179], a[192:195], 0
    v_mfma_f32_16x16x32_bf16 v[220:223], a[180:183], a[196:199], v[220:223]
    v_mfma_f32_16x16x32_bf16 a[116:119], a[176:179], a[200:203], 0
    v_mfma_f32_16x16x32_bf16 a[116:119], a[180:183], a[204:207], a[116:119]
    buffer_load_dwordx4 v2, s[24:27], s48 offen offset:1024 nt lds
    s_waitcnt lgkmcnt(2)
    v_mfma_f32_16x16x32_bf16 v[120:123], a[152:155], a[184:187], 0
    ds_read_b128 a[168:171], v20 offset:53248
    v_mfma_f32_16x16x32_bf16 v[120:123], a[156:159], a[188:191], v[120:123]
    ds_read_b128 a[172:175], v21 offset:53248
    v_mfma_f32_16x16x32_bf16 v[224:227], a[152:155], a[192:195], 0
    v_mfma_f32_16x16x32_bf16 v[224:227], a[156:159], a[196:199], v[224:227]
    s_waitcnt vmcnt(12)
    v_mfma_f32_16x16x32_bf16 a[120:123], a[152:155], a[200:203], 0
    v_mfma_f32_16x16x32_bf16 a[120:123], a[156:159], a[204:207], a[120:123]
    ds_read_b128 a[208:211], v16 offset:24576
    s_waitcnt lgkmcnt(3)
    v_mfma_f32_16x16x32_bf16 v[124:127], a[160:163], a[184:187], 0
    ds_read_b128 a[176:179], v20 offset:55296
    buffer_load_dwordx4 v3, s[24:27], s48 offen offset:2048 nt lds
    v_mfma_f32_16x16x32_bf16 v[124:127], a[164:167], a[188:191], v[124:127]
    ds_read_b128 a[180:183], v21 offset:55296
    ds_read_b128 a[212:215], v17 offset:24576
    v_mfma_f32_16x16x32_bf16 v[228:231], a[160:163], a[192:195], 0
    v_mfma_f32_16x16x32_bf16 v[228:231], a[164:167], a[196:199], v[228:231]
    ds_read_b128 a[216:219], v16 offset:26624
    v_mfma_f32_16x16x32_bf16 a[124:127], a[160:163], a[200:203], 0
    v_mfma_f32_16x16x32_bf16 a[124:127], a[164:167], a[204:207], a[124:127]
    ds_read_b128 a[220:223], v17 offset:26624
    s_waitcnt lgkmcnt(6)
    v_mfma_f32_16x16x32_bf16 v[128:131], a[168:171], a[184:187], 0
    ds_read_b128 a[152:155], v20 offset:57344
    v_mfma_f32_16x16x32_bf16 v[128:131], a[172:175], a[188:191], v[128:131]
    ds_read_b128 a[156:159], v21 offset:57344
    ds_read_b128 a[224:227], v16 offset:28672
    v_mfma_f32_16x16x32_bf16 v[232:235], a[168:171], a[192:195], 0
    buffer_load_dwordx4 v4, s[24:27], s48 offen offset:3072 nt lds
    v_mfma_f32_16x16x32_bf16 v[232:235], a[172:175], a[196:199], v[232:235]
    ds_read_b128 a[228:231], v17 offset:28672
    v_mfma_f32_16x16x32_bf16 a[128:131], a[168:171], a[200:203], 0
    v_mfma_f32_16x16x32_bf16 a[128:131], a[172:175], a[204:207], a[128:131]
    s_waitcnt lgkmcnt(7)
    v_mfma_f32_16x16x32_bf16 v[132:135], a[176:179], a[184:187], 0
    ds_read_b128 a[160:163], v20 offset:59392
    v_mfma_f32_16x16x32_bf16 v[132:135], a[180:183], a[188:191], v[132:135]
    ds_read_b128 a[164:167], v21 offset:59392
    v_mfma_f32_16x16x32_bf16 v[236:239], a[176:179], a[192:195], 0
    v_mfma_f32_16x16x32_bf16 v[236:239], a[180:183], a[196:199], v[236:239]
    s_add_u32 m0, s37, 0
    v_mfma_f32_16x16x32_bf16 a[132:135], a[176:179], a[200:203], 0
    buffer_load_dwordx4 v3, s[20:23], s42 offen offset:2048 nt lds
    v_mfma_f32_16x16x32_bf16 a[132:135], a[180:183], a[204:207], a[132:135]
    s_waitcnt lgkmcnt(4)
    v_mfma_f32_16x16x32_bf16 v[136:139], a[152:155], a[184:187], 0
    ds_read_b128 a[168:171], v20 offset:61440
    v_mfma_f32_16x16x32_bf16 v[136:139], a[156:159], a[188:191], v[136:139]
    ds_read_b128 a[172:175], v21 offset:61440
    v_mfma_f32_16x16x32_bf16 v[240:243], a[152:155], a[192:195], 0
    v_mfma_f32_16x16x32_bf16 v[240:243], a[156:159], a[196:199], v[240:243]
    v_mfma_f32_16x16x32_bf16 a[136:139], a[152:155], a[200:203], 0
    v_mfma_f32_16x16x32_bf16 a[136:139], a[156:159], a[204:207], a[136:139]
    buffer_load_dwordx4 v4, s[20:23], s42 offen offset:3072 nt lds
    s_waitcnt lgkmcnt(2)
    v_mfma_f32_16x16x32_bf16 v[140:143], a[160:163], a[184:187], 0
    ds_read_b128 a[176:179], v20 offset:63488
    v_mfma_f32_16x16x32_bf16 v[140:143], a[164:167], a[188:191], v[140:143]
    ds_read_b128 a[180:183], v21 offset:63488
    v_mfma_f32_16x16x32_bf16 v[244:247], a[160:163], a[192:195], 0
    v_mfma_f32_16x16x32_bf16 v[244:247], a[164:167], a[196:199], v[244:247]
    v_mfma_f32_16x16x32_bf16 a[140:143], a[160:163], a[200:203], 0
    v_mfma_f32_16x16x32_bf16 a[140:143], a[164:167], a[204:207], a[140:143]
    s_waitcnt lgkmcnt(2)
    v_mfma_f32_16x16x32_bf16 v[144:147], a[168:171], a[184:187], 0
    s_waitcnt vmcnt(12)
    s_barrier
    v_mfma_f32_16x16x32_bf16 v[144:147], a[172:175], a[188:191], v[144:147]
    ds_read_b128 a[152:155], v22 offset:0
    s_add_u32 m0, s36, 0
    v_mfma_f32_16x16x32_bf16 v[248:251], a[168:171], a[192:195], 0
    ds_read_b128 a[156:159], v23 offset:0
    s_add_u32 s48, s38, 196736
    v_mfma_f32_16x16x32_bf16 v[248:251], a[172:175], a[196:199], v[248:251]
    buffer_load_dwordx4 v1, s[24:27], s48 offen offset:0 nt lds
    v_mfma_f32_16x16x32_bf16 a[144:147], a[168:171], a[200:203], 0
    v_mfma_f32_16x16x32_bf16 a[144:147], a[172:175], a[204:207], a[144:147]
    s_waitcnt lgkmcnt(2)
    v_mfma_f32_16x16x32_bf16 v[148:151], a[176:179], a[184:187], 0
    ds_read_b128 a[160:163], v22 offset:2048
    v_mfma_f32_16x16x32_bf16 v[148:151], a[180:183], a[188:191], v[148:151]
    ds_read_b128 a[164:167], v23 offset:2048
    v_mfma_f32_16x16x32_bf16 v[252:255], a[176:179], a[192:195], 0
    v_mfma_f32_16x16x32_bf16 v[252:255], a[180:183], a[196:199], v[252:255]
    v_mfma_f32_16x16x32_bf16 a[148:151], a[176:179], a[200:203], 0
    buffer_load_dwordx4 v2, s[24:27], s48 offen offset:1024 nt lds
    v_mfma_f32_16x16x32_bf16 a[148:151], a[180:183], a[204:207], a[148:151]
    s_waitcnt lgkmcnt(2)
    v_mfma_f32_16x16x32_bf16 v[24:27], a[152:155], a[208:211], v[24:27]
    ds_read_b128 a[168:171], v22 offset:4096
    v_mfma_f32_16x16x32_bf16 v[24:27], a[156:159], a[212:215], v[24:27]
    ds_read_b128 a[172:175], v23 offset:4096
    v_mfma_f32_16x16x32_bf16 a[0:3], a[152:155], a[216:219], a[0:3]
    v_mfma_f32_16x16x32_bf16 a[0:3], a[156:159], a[220:223], a[0:3]
    v_mfma_f32_16x16x32_bf16 a[24:27], a[152:155], a[224:227], a[24:27]
    v_mfma_f32_16x16x32_bf16 a[24:27], a[156:159], a[228:231], a[24:27]
    buffer_load_dwordx4 v3, s[24:27], s48 offen offset:2048 nt lds
    s_waitcnt lgkmcnt(2)
    v_mfma_f32_16x16x32_bf16 v[28:31], a[160:163], a[208:211], v[28:31]
    ds_read_b128 a[176:179], v22 offset:6144
    v_mfma_f32_16x16x32_bf16 v[28:31], a[164:167], a[212:215], v[28:31]
    ds_read_b128 a[180:183], v23 offset:6144
    v_mfma_f32_16x16x32_bf16 a[4:7], a[160:163], a[216:219], a[4:7]
    v_mfma_f32_16x16x32_bf16 a[4:7], a[164:167], a[220:223], a[4:7]
    v_mfma_f32_16x16x32_bf16 a[28:31], a[160:163], a[224:227], a[28:31]
    v_mfma_f32_16x16x32_bf16 a[28:31], a[164:167], a[228:231], a[28:31]
    s_waitcnt lgkmcnt(2)
    v_mfma_f32_16x16x32_bf16 v[32:35], a[168:171], a[208:211], v[32:35]
    ds_read_b128 a[152:155], v22 offset:8192
    buffer_load_dwordx4 v4, s[24:27], s48 offen offset:3072 nt lds
    v_mfma_f32_16x16x32_bf16 v[32:35], a[172:175], a[212:215], v[32:35]
    ds_read_b128 a[156:159], v23 offset:8192
    v_mfma_f32_16x16x32_bf16 a[8:11], a[168:171], a[216:219], a[8:11]
    v_mfma_f32_16x16x32_bf16 a[8:11], a[172:175], a[220:223], a[8:11]
    v_mfma_f32_16x16x32_bf16 a[32:35], a[168:171], a[224:227], a[32:35]
    v_mfma_f32_16x16x32_bf16 a[32:35], a[172:175], a[228:231], a[32:35]
    s_waitcnt lgkmcnt(2)
    v_mfma_f32_16x16x32_bf16 v[36:39], a[176:179], a[208:211], v[36:39]
    ds_read_b128 a[160:163], v22 offset:10240
    v_mfma_f32_16x16x32_bf16 v[36:39], a[180:183], a[212:215], v[36:39]
    ds_read_b128 a[164:167], v23 offset:10240
    s_add_u32 m0, s37, 4096
    v_mfma_f32_16x16x32_bf16 a[12:15], a[176:179], a[216:219], a[12:15]
    buffer_load_dwordx4 v18, s[20:23], s42 offen offset:0 nt lds
    v_mfma_f32_16x16x32_bf16 a[12:15], a[180:183], a[220:223], a[12:15]
    v_mfma_f32_16x16x32_bf16 a[36:39], a[176:179], a[224:227], a[36:39]
    v_mfma_f32_16x16x32_bf16 a[36:39], a[180:183], a[228:231], a[36:39]
    s_waitcnt lgkmcnt(2)
    v_mfma_f32_16x16x32_bf16 v[40:43], a[152:155], a[208:211], v[40:43]
    ds_read_b128 a[168:171], v22 offset:12288
    v_mfma_f32_16x16x32_bf16 v[40:43], a[156:159], a[212:215], v[40:43]
    ds_read_b128 a[172:175], v23 offset:12288
    v_mfma_f32_16x16x32_bf16 a[16:19], a[152:155], a[216:219], a[16:19]
    v_mfma_f32_16x16x32_bf16 a[16:19], a[156:159], a[220:223], a[16:19]
    buffer_load_dwordx4 v19, s[20:23], s42 offen offset:1024 nt lds
    v_mfma_f32_16x16x32_bf16 a[40:43], a[152:155], a[224:227], a[40:43]
    v_mfma_f32_16x16x32_bf16 a[40:43], a[156:159], a[228:231], a[40:43]
    s_waitcnt lgkmcnt(2)
    v_mfma_f32_16x16x32_bf16 v[44:47], a[160:163], a[208:211], v[44:47]
    ds_read_b128 a[176:179], v22 offset:14336
    v_mfma_f32_16x16x32_bf16 v[44:47], a[164:167], a[212:215], v[44:47]
    ds_read_b128 a[180:183], v23 offset:14336
    v_mfma_f32_16x16x32_bf16 a[20:23], a[160:163], a[216:219], a[20:23]
    v_mfma_f32_16x16x32_bf16 a[20:23], a[164:167], a[220:223], a[20:23]
    v_mfma_f32_16x16x32_bf16 a[44:47], a[160:163], a[224:227], a[44:47]
    s_add_u32 m0, s36, 16384
    s_add_u32 s48, s38, 256
    v_mfma_f32_16x16x32_bf16 a[44:47], a[164:167], a[228:231], a[44:47]
    buffer_load_dwordx4 v1, s[24:27], s48 offen offset:0 nt lds
    s_waitcnt lgkmcnt(2)
    v_mfma_f32_16x16x32_bf16 v[48:51], a[168:171], a[208:211], v[48:51]
    s_waitcnt vmcnt(15)
    s_barrier
    v_mfma_f32_16x16x32_bf16 v[48:51], a[172:175], a[212:215], v[48:51]
    ds_read_b128 a[152:155], v22 offset:16384
    v_mfma_f32_16x16x32_bf16 v[152:155], a[168:171], a[216:219], v[152:155]
    ds_read_b128 a[156:159], v23 offset:16384
    v_mfma_f32_16x16x32_bf16 v[152:155], a[172:175], a[220:223], v[152:155]
    v_mfma_f32_16x16x32_bf16 a[48:51], a[168:171], a[224:227], a[48:51]
    v_mfma_f32_16x16x32_bf16 a[48:51], a[172:175], a[228:231], a[48:51]
    s_waitcnt lgkmcnt(2)
    v_mfma_f32_16x16x32_bf16 v[52:55], a[176:179], a[208:211], v[52:55]
    ds_read_b128 a[160:163], v22 offset:18432
    buffer_load_dwordx4 v2, s[24:27], s48 offen offset:1024 nt lds
    v_mfma_f32_16x16x32_bf16 v[52:55], a[180:183], a[212:215], v[52:55]
    ds_read_b128 a[164:167], v23 offset:18432
    v_mfma_f32_16x16x32_bf16 v[156:159], a[176:179], a[216:219], v[156:159]
    v_mfma_f32_16x16x32_bf16 v[156:159], a[180:183], a[220:223], v[156:159]
    v_mfma_f32_16x16x32_bf16 a[52:55], a[176:179], a[224:227], a[52:55]
    v_mfma_f32_16x16x32_bf16 a[52:55], a[180:183], a[228:231], a[52:55]
    s_waitcnt lgkmcnt(2)
    v_mfma_f32_16x16x32_bf16 v[56:59], a[152:155], a[208:211], v[56:59]
    ds_read_b128 a[168:171], v22 offset:20480
    v_mfma_f32_16x16x32_bf16 v[56:59], a[156:159], a[212:215], v[56:59]
    ds_read_b128 a[172:175], v23 offset:20480
    buffer_load_dwordx4 v3, s[24:27], s48 offen offset:2048 nt lds
    v_mfma_f32_16x16x32_bf16 v[160:163], a[152:155], a[216:219], v[160:163]
    v_mfma_f32_16x16x32_bf16 v[160:163], a[156:159], a[220:223], v[160:163]
    v_mfma_f32_16x16x32_bf16 a[56:59], a[152:155], a[224:227], a[56:59]
    v_mfma_f32_16x16x32_bf16 a[56:59], a[156:159], a[228:231], a[56:59]
    s_waitcnt lgkmcnt(2)
    v_mfma_f32_16x16x32_bf16 v[60:63], a[160:163], a[208:211], v[60:63]
    ds_read_b128 a[176:179], v22 offset:22528
    v_mfma_f32_16x16x32_bf16 v[60:63], a[164:167], a[212:215], v[60:63]
    ds_read_b128 a[180:183], v23 offset:22528
    v_mfma_f32_16x16x32_bf16 v[164:167], a[160:163], a[216:219], v[164:167]
    buffer_load_dwordx4 v4, s[24:27], s48 offen offset:3072 nt lds
    v_mfma_f32_16x16x32_bf16 v[164:167], a[164:167], a[220:223], v[164:167]
    v_mfma_f32_16x16x32_bf16 a[60:63], a[160:163], a[224:227], a[60:63]
    v_mfma_f32_16x16x32_bf16 a[60:63], a[164:167], a[228:231], a[60:63]
    s_waitcnt lgkmcnt(2)
    v_mfma_f32_16x16x32_bf16 v[64:67], a[168:171], a[208:211], v[64:67]
    ds_read_b128 a[152:155], v22 offset:24576
    v_mfma_f32_16x16x32_bf16 v[64:67], a[172:175], a[212:215], v[64:67]
    ds_read_b128 a[156:159], v23 offset:24576
    v_mfma_f32_16x16x32_bf16 v[168:171], a[168:171], a[216:219], v[168:171]
    v_mfma_f32_16x16x32_bf16 v[168:171], a[172:175], a[220:223], v[168:171]
    s_add_u32 m0, s36, 32768
    s_add_u32 s48, s38, 65792
    v_mfma_f32_16x16x32_bf16 a[64:67], a[168:171], a[224:227], a[64:67]
    buffer_load_dwordx4 v1, s[24:27], s48 offen offset:0 nt lds
    v_mfma_f32_16x16x32_bf16 a[64:67], a[172:175], a[228:231], a[64:67]
    s_waitcnt lgkmcnt(2)
    v_mfma_f32_16x16x32_bf16 v[68:71], a[176:179], a[208:211], v[68:71]
    ds_read_b128 a[160:163], v22 offset:26624
    v_mfma_f32_16x16x32_bf16 v[68:71], a[180:183], a[212:215], v[68:71]
    ds_read_b128 a[164:167], v23 offset:26624
    v_mfma_f32_16x16x32_bf16 v[172:175], a[176:179], a[216:219], v[172:175]
    v_mfma_f32_16x16x32_bf16 v[172:175], a[180:183], a[220:223], v[172:175]
    v_mfma_f32_16x16x32_bf16 a[68:71], a[176:179], a[224:227], a[68:71]
    v_mfma_f32_16x16x32_bf16 a[68:71], a[180:183], a[228:231], a[68:71]
    buffer_load_dwordx4 v2, s[24:27], s48 offen offset:1024 nt lds
    s_waitcnt lgkmcnt(2)
    v_mfma_f32_16x16x32_bf16 v[72:75], a[152:155], a[208:211], v[72:75]
    ds_read_b128 a[168:171], v22 offset:28672
    v_mfma_f32_16x16x32_bf16 v[72:75], a[156:159], a[212:215], v[72:75]
    ds_read_b128 a[172:175], v23 offset:28672
    v_mfma_f32_16x16x32_bf16 v[176:179], a[152:155], a[216:219], v[176:179]
    v_mfma_f32_16x16x32_bf16 v[176:179], a[156:159], a[220:223], v[176:179]
    v_mfma_f32_16x16x32_bf16 a[72:75], a[152:155], a[224:227], a[72:75]
    v_mfma_f32_16x16x32_bf16 a[72:75], a[156:159], a[228:231], a[72:75]
    s_waitcnt lgkmcnt(2)
    v_mfma_f32_16x16x32_bf16 v[76:79], a[160:163], a[208:211], v[76:79]
    ds_read_b128 a[176:179], v22 offset:30720
    buffer_load_dwordx4 v3, s[24:27], s48 offen offset:2048 nt lds
    v_mfma_f32_16x16x32_bf16 v[76:79], a[164:167], a[212:215], v[76:79]
    ds_read_b128 a[180:183], v23 offset:30720
    v_mfma_f32_16x16x32_bf16 v[180:183], a[160:163], a[216:219], v[180:183]
    v_mfma_f32_16x16x32_bf16 v[180:183], a[164:167], a[220:223], v[180:183]
    v_mfma_f32_16x16x32_bf16 a[76:79], a[160:163], a[224:227], a[76:79]
    v_mfma_f32_16x16x32_bf16 a[76:79], a[164:167], a[228:231], a[76:79]
    s_waitcnt lgkmcnt(2)
    v_mfma_f32_16x16x32_bf16 v[80:83], a[168:171], a[208:211], v[80:83]
    s_waitcnt vmcnt(15)
    s_barrier
    v_mfma_f32_16x16x32_bf16 v[80:83], a[172:175], a[212:215], v[80:83]
    ds_read_b128 a[152:155], v22 offset:32768
    buffer_load_dwordx4 v4, s[24:27], s48 offen offset:3072 nt lds
    v_mfma_f32_16x16x32_bf16 v[184:187], a[168:171], a[216:219], v[184:187]
    ds_read_b128 a[156:159], v23 offset:32768
    v_mfma_f32_16x16x32_bf16 v[184:187], a[172:175], a[220:223], v[184:187]
    v_mfma_f32_16x16x32_bf16 a[80:83], a[168:171], a[224:227], a[80:83]
    v_mfma_f32_16x16x32_bf16 a[80:83], a[172:175], a[228:231], a[80:83]
    s_waitcnt lgkmcnt(2)
    v_mfma_f32_16x16x32_bf16 v[84:87], a[176:179], a[208:211], v[84:87]
    ds_read_b128 a[160:163], v22 offset:34816
    v_mfma_f32_16x16x32_bf16 v[84:87], a[180:183], a[212:215], v[84:87]
    ds_read_b128 a[164:167], v23 offset:34816
    v_mfma_f32_16x16x32_bf16 v[188:191], a[176:179], a[216:219], v[188:191]
    s_add_u32 m0, s37, 24576
    v_mfma_f32_16x16x32_bf16 v[188:191], a[180:183], a[220:223], v[188:191]
    buffer_load_dwordx4 v1, s[20:23], s43 offen offset:0 nt lds
    v_mfma_f32_16x16x32_bf16 a[84:87], a[176:179], a[224:227], a[84:87]
    v_mfma_f32_16x16x32_bf16 a[84:87], a[180:183], a[228:231], a[84:87]
    s_waitcnt lgkmcnt(2)
    v_mfma_f32_16x16x32_bf16 v[88:91], a[152:155], a[208:211], v[88:91]
    ds_read_b128 a[168:171], v22 offset:36864
    v_mfma_f32_16x16x32_bf16 v[88:91], a[156:159], a[212:215], v[88:91]
    ds_read_b128 a[172:175], v23 offset:36864
    v_mfma_f32_16x16x32_bf16 v[192:195], a[152:155], a[216:219], v[192:195]
    v_mfma_f32_16x16x32_bf16 v[192:195], a[156:159], a[220:223], v[192:195]
    v_mfma_f32_16x16x32_bf16 a[88:91], a[152:155], a[224:227], a[88:91]
    buffer_load_dwordx4 v2, s[20:23], s43 offen offset:1024 nt lds
    v_mfma_f32_16x16x32_bf16 a[88:91], a[156:159], a[228:231], a[88:91]
    s_waitcnt lgkmcnt(2)
    v_mfma_f32_16x16x32_bf16 v[92:95], a[160:163], a[208:211], v[92:95]
    ds_read_b128 a[176:179], v22 offset:38912
    v_mfma_f32_16x16x32_bf16 v[92:95], a[164:167], a[212:215], v[92:95]
    ds_read_b128 a[180:183], v23 offset:38912
    v_mfma_f32_16x16x32_bf16 v[196:199], a[160:163], a[216:219], v[196:199]
    v_mfma_f32_16x16x32_bf16 v[196:199], a[164:167], a[220:223], v[196:199]
    v_mfma_f32_16x16x32_bf16 a[92:95], a[160:163], a[224:227], a[92:95]
    v_mfma_f32_16x16x32_bf16 a[92:95], a[164:167], a[228:231], a[92:95]
    s_add_u32 m0, s36, 49152
    s_waitcnt lgkmcnt(2)
    v_mfma_f32_16x16x32_bf16 v[96:99], a[168:171], a[208:211], v[96:99]
    ds_read_b128 a[152:155], v22 offset:40960
    s_add_u32 s48, s38, 131328
    v_mfma_f32_16x16x32_bf16 v[96:99], a[172:175], a[212:215], v[96:99]
    ds_read_b128 a[156:159], v23 offset:40960
    buffer_load_dwordx4 v1, s[24:27], s48 offen offset:0 nt lds
    v_mfma_f32_16x16x32_bf16 v[200:203], a[168:171], a[216:219], v[200:203]
    v_mfma_f32_16x16x32_bf16 v[200:203], a[172:175], a[220:223], v[200:203]
    v_mfma_f32_16x16x32_bf16 a[96:99], a[168:171], a[224:227], a[96:99]
    v_mfma_f32_16x16x32_bf16 a[96:99], a[172:175], a[228:231], a[96:99]
    s_waitcnt lgkmcnt(2)
    v_mfma_f32_16x16x32_bf16 v[100:103], a[176:179], a[208:211], v[100:103]
    ds_read_b128 a[160:163], v22 offset:43008
    v_mfma_f32_16x16x32_bf16 v[100:103], a[180:183], a[212:215], v[100:103]
    ds_read_b128 a[164:167], v23 offset:43008
    v_mfma_f32_16x16x32_bf16 v[204:207], a[176:179], a[216:219], v[204:207]
    buffer_load_dwordx4 v2, s[24:27], s48 offen offset:1024 nt lds
    v_mfma_f32_16x16x32_bf16 v[204:207], a[180:183], a[220:223], v[204:207]
    v_mfma_f32_16x16x32_bf16 a[100:103], a[176:179], a[224:227], a[100:103]
    v_mfma_f32_16x16x32_bf16 a[100:103], a[180:183], a[228:231], a[100:103]
    s_waitcnt lgkmcnt(2)
    v_mfma_f32_16x16x32_bf16 v[104:107], a[152:155], a[208:211], v[104:107]
    ds_read_b128 a[168:171], v22 offset:45056
    v_mfma_f32_16x16x32_bf16 v[104:107], a[156:159], a[212:215], v[104:107]
    ds_read_b128 a[172:175], v23 offset:45056
    v_mfma_f32_16x16x32_bf16 v[208:211], a[152:155], a[216:219], v[208:211]
    v_mfma_f32_16x16x32_bf16 v[208:211], a[156:159], a[220:223], v[208:211]
    buffer_load_dwordx4 v3, s[24:27], s48 offen offset:2048 nt lds
    v_mfma_f32_16x16x32_bf16 a[104:107], a[152:155], a[224:227], a[104:107]
    v_mfma_f32_16x16x32_bf16 a[104:107], a[156:159], a[228:231], a[104:107]
    s_waitcnt lgkmcnt(2)
    v_mfma_f32_16x16x32_bf16 v[108:111], a[160:163], a[208:211], v[108:111]
    ds_read_b128 a[176:179], v22 offset:47104
    v_mfma_f32_16x16x32_bf16 v[108:111], a[164:167], a[212:215], v[108:111]
    ds_read_b128 a[180:183], v23 offset:47104
    v_mfma_f32_16x16x32_bf16 v[212:215], a[160:163], a[216:219], v[212:215]
    v_mfma_f32_16x16x32_bf16 v[212:215], a[164:167], a[220:223], v[212:215]
    v_mfma_f32_16x16x32_bf16 a[108:111], a[160:163], a[224:227], a[108:111]
    buffer_load_dwordx4 v4, s[24:27], s48 offen offset:3072 nt lds
    v_mfma_f32_16x16x32_bf16 a[108:111], a[164:167], a[228:231], a[108:111]
    s_waitcnt lgkmcnt(2)
    v_mfma_f32_16x16x32_bf16 v[112:115], a[168:171], a[208:211], v[112:115]
    s_waitcnt vmcnt(16)
    s_barrier
    v_mfma_f32_16x16x32_bf16 v[112:115], a[172:175], a[212:215], v[112:115]
    ds_read_b128 a[152:155], v20 offset:0
    v_mfma_f32_16x16x32_bf16 v[216:219], a[168:171], a[216:219], v[216:219]
    ds_read_b128 a[156:159], v21 offset:0
    v_mfma_f32_16x16x32_bf16 v[216:219], a[172:175], a[220:223], v[216:219]
    v_mfma_f32_16x16x32_bf16 a[112:115], a[168:171], a[224:227], a[112:115]
    v_mfma_f32_16x16x32_bf16 a[112:115], a[172:175], a[228:231], a[112:115]
    s_add_u32 m0, s37, 24576
    s_waitcnt lgkmcnt(2)
    v_mfma_f32_16x16x32_bf16 v[116:119], a[176:179], a[208:211], v[116:119]
    ds_read_b128 a[160:163], v20 offset:2048
    buffer_load_dwordx4 v3, s[20:23], s43 offen offset:2048 nt lds
    v_mfma_f32_16x16x32_bf16 v[116:119], a[180:183], a[212:215], v[116:119]
    ds_read_b128 a[164:167], v21 offset:2048
    v_mfma_f32_16x16x32_bf16 v[220:223], a[176:179], a[216:219], v[220:223]
    v_mfma_f32_16x16x32_bf16 v[220:223], a[180:183], a[220:223], v[220:223]
    v_mfma_f32_16x16x32_bf16 a[116:119], a[176:179], a[224:227], a[116:119]
    v_mfma_f32_16x16x32_bf16 a[116:119], a[180:183], a[228:231], a[116:119]
    s_waitcnt lgkmcnt(2)
    v_mfma_f32_16x16x32_bf16 v[120:123], a[152:155], a[208:211], v[120:123]
    ds_read_b128 a[168:171], v20 offset:4096
    v_mfma_f32_16x16x32_bf16 v[120:123], a[156:159], a[212:215], v[120:123]
    ds_read_b128 a[172:175], v21 offset:4096
    buffer_load_dwordx4 v4, s[20:23], s43 offen offset:3072 nt lds
    v_mfma_f32_16x16x32_bf16 v[224:227], a[152:155], a[216:219], v[224:227]
    v_mfma_f32_16x16x32_bf16 v[224:227], a[156:159], a[220:223], v[224:227]
    s_waitcnt vmcnt(16)
    v_mfma_f32_16x16x32_bf16 a[120:123], a[152:155], a[224:227], a[120:123]
    v_mfma_f32_16x16x32_bf16 a[120:123], a[156:159], a[228:231], a[120:123]
    ds_read_b128 a[184:187], v16 offset:0
    s_waitcnt lgkmcnt(3)
    v_mfma_f32_16x16x32_bf16 v[124:127], a[160:163], a[208:211], v[124:127]
    ds_read_b128 a[176:179], v20 offset:6144
    v_mfma_f32_16x16x32_bf16 v[124:127], a[164:167], a[212:215], v[124:127]
    ds_read_b128 a[180:183], v21 offset:6144
    ds_read_b128 a[188:191], v17 offset:0
    v_mfma_f32_16x16x32_bf16 v[228:231], a[160:163], a[216:219], v[228:231]
    s_add_u32 m0, s36, 65536
    s_add_u32 s48, s38, 196864
    v_mfma_f32_16x16x32_bf16 v[228:231], a[164:167], a[220:223], v[228:231]
    ds_read_b128 a[192:195], v16 offset:2048
    buffer_load_dwordx4 v1, s[24:27], s48 offen offset:0 nt lds
    v_mfma_f32_16x16x32_bf16 a[124:127], a[160:163], a[224:227], a[124:127]
    v_mfma_f32_16x16x32_bf16 a[124:127], a[164:167], a[228:231], a[124:127]
    ds_read_b128 a[196:199], v17 offset:2048
    s_waitcnt lgkmcnt(6)
    v_mfma_f32_16x16x32_bf16 v[128:131], a[168:171], a[208:211], v[128:131]
    ds_read_b128 a[152:155], v20 offset:8192
    v_mfma_f32_16x16x32_bf16 v[128:131], a[172:175], a[212:215], v[128:131]
    ds_read_b128 a[156:159], v21 offset:8192
    ds_read_b128 a[200:203], v16 offset:4096
    v_mfma_f32_16x16x32_bf16 v[232:235], a[168:171], a[216:219], v[232:235]
    v_mfma_f32_16x16x32_bf16 v[232:235], a[172:175], a[220:223], v[232:235]
    ds_read_b128 a[204:207], v17 offset:4096
    v_mfma_f32_16x16x32_bf16 a[128:131], a[168:171], a[224:227], a[128:131]
    buffer_load_dwordx4 v2, s[24:27], s48 offen offset:1024 nt lds
    v_mfma_f32_16x16x32_bf16 a[128:131], a[172:175], a[228:231], a[128:131]
    s_waitcnt lgkmcnt(7)
    v_mfma_f32_16x16x32_bf16 v[132:135], a[176:179], a[208:211], v[132:135]
    ds_read_b128 a[160:163], v20 offset:10240
    v_mfma_f32_16x16x32_bf16 v[132:135], a[180:183], a[212:215], v[132:135]
    ds_read_b128 a[164:167], v21 offset:10240
    v_mfma_f32_16x16x32_bf16 v[236:239], a[176:179], a[216:219], v[236:239]
    v_mfma_f32_16x16x32_bf16 v[236:239], a[180:183], a[220:223], v[236:239]
    v_mfma_f32_16x16x32_bf16 a[132:135], a[176:179], a[224:227], a[132:135]
    v_mfma_f32_16x16x32_bf16 a[132:135], a[180:183], a[228:231], a[132:135]
    buffer_load_dwordx4 v3, s[24:27], s48 offen offset:2048 nt lds
    s_waitcnt lgkmcnt(4)
    v_mfma_f32_16x16x32_bf16 v[136:139], a[152:155], a[208:211], v[136:139]
    ds_read_b128 a[168:171], v20 offset:12288
    v_mfma_f32_16x16x32_bf16 v[136:139], a[156:159], a[212:215], v[136:139]
    ds_read_b128 a[172:175], v21 offset:12288
    v_mfma_f32_16x16x32_bf16 v[240:243], a[152:155], a[216:219], v[240:243]
    v_mfma_f32_16x16x32_bf16 v[240:243], a[156:159], a[220:223], v[240:243]
    v_mfma_f32_16x16x32_bf16 a[136:139], a[152:155], a[224:227], a[136:139]
    v_mfma_f32_16x16x32_bf16 a[136:139], a[156:159], a[228:231], a[136:139]
    s_waitcnt lgkmcnt(2)
    v_mfma_f32_16x16x32_bf16 v[140:143], a[160:163], a[208:211], v[140:143]
    ds_read_b128 a[176:179], v20 offset:14336
    buffer_load_dwordx4 v4, s[24:27], s48 offen offset:3072 nt lds
    v_mfma_f32_16x16x32_bf16 v[140:143], a[164:167], a[212:215], v[140:143]
    ds_read_b128 a[180:183], v21 offset:14336
    v_mfma_f32_16x16x32_bf16 v[244:247], a[160:163], a[216:219], v[244:247]
    v_mfma_f32_16x16x32_bf16 v[244:247], a[164:167], a[220:223], v[244:247]
    v_mfma_f32_16x16x32_bf16 a[140:143], a[160:163], a[224:227], a[140:143]
    v_mfma_f32_16x16x32_bf16 a[140:143], a[164:167], a[228:231], a[140:143]
    s_waitcnt lgkmcnt(2)
    v_mfma_f32_16x16x32_bf16 v[144:147], a[168:171], a[208:211], v[144:147]
    s_waitcnt vmcnt(16)
    s_barrier
    v_mfma_f32_16x16x32_bf16 v[144:147], a[172:175], a[212:215], v[144:147]
    ds_read_b128 a[152:155], v20 offset:16384
    s_add_u32 m0, s37, 28672
    v_mfma_f32_16x16x32_bf16 v[248:251], a[168:171], a[216:219], v[248:251]
    ds_read_b128 a[156:159], v21 offset:16384
    buffer_load_dwordx4 v18, s[20:23], s43 offen offset:0 nt lds
    v_mfma_f32_16x16x32_bf16 v[248:251], a[172:175], a[220:223], v[248:251]
    v_mfma_f32_16x16x32_bf16 a[144:147], a[168:171], a[224:227], a[144:147]
    v_mfma_f32_16x16x32_bf16 a[144:147], a[172:175], a[228:231], a[144:147]
    s_waitcnt lgkmcnt(2)
    v_mfma_f32_16x16x32_bf16 v[148:151], a[176:179], a[208:211], v[148:151]
    ds_read_b128 a[160:163], v20 offset:18432
    v_mfma_f32_16x16x32_bf16 v[148:151], a[180:183], a[212:215], v[148:151]
    ds_read_b128 a[164:167], v21 offset:18432
    v_mfma_f32_16x16x32_bf16 v[252:255], a[176:179], a[216:219], v[252:255]
    v_mfma_f32_16x16x32_bf16 v[252:255], a[180:183], a[220:223], v[252:255]
    buffer_load_dwordx4 v19, s[20:23], s43 offen offset:1024 nt lds
    v_mfma_f32_16x16x32_bf16 a[148:151], a[176:179], a[224:227], a[148:151]
    v_mfma_f32_16x16x32_bf16 a[148:151], a[180:183], a[228:231], a[148:151]
    s_waitcnt lgkmcnt(2)
    v_mfma_f32_16x16x32_bf16 v[24:27], a[152:155], a[184:187], v[24:27]
    ds_read_b128 a[168:171], v20 offset:20480
    v_mfma_f32_16x16x32_bf16 v[24:27], a[156:159], a[188:191], v[24:27]
    ds_read_b128 a[172:175], v21 offset:20480
    v_mfma_f32_16x16x32_bf16 a[0:3], a[152:155], a[192:195], a[0:3]
    v_mfma_f32_16x16x32_bf16 a[0:3], a[156:159], a[196:199], a[0:3]
    v_mfma_f32_16x16x32_bf16 a[24:27], a[152:155], a[200:203], a[24:27]
    s_add_u32 m0, s36, 81920
    s_add_u32 s48, s38, 384
    v_mfma_f32_16x16x32_bf16 a[24:27], a[156:159], a[204:207], a[24:27]
    buffer_load_dwordx4 v1, s[24:27], s48 offen offset:0 nt lds
    s_waitcnt lgkmcnt(2)
    v_mfma_f32_16x16x32_bf16 v[28:31], a[160:163], a[184:187], v[28:31]
    ds_read_b128 a[176:179], v20 offset:22528
    v_mfma_f32_16x16x32_bf16 v[28:31], a[164:167], a[188:191], v[28:31]
    ds_read_b128 a[180:183], v21 offset:22528
    v_mfma_f32_16x16x32_bf16 a[4:7], a[160:163], a[192:195], a[4:7]
    v_mfma_f32_16x16x32_bf16 a[4:7], a[164:167], a[196:199], a[4:7]
    v_mfma_f32_16x16x32_bf16 a[28:31], a[160:163], a[200:203], a[28:31]
    v_mfma_f32_16x16x32_bf16 a[28:31], a[164:167], a[204:207], a[28:31]
    s_waitcnt lgkmcnt(2)
    v_mfma_f32_16x16x32_bf16 v[32:35], a[168:171], a[184:187], v[32:35]
    ds_read_b128 a[152:155], v20 offset:24576
    buffer_load_dwordx4 v2, s[24:27], s48 offen offset:1024 nt lds
    v_mfma_f32_16x16x32_bf16 v[32:35], a[172:175], a[188:191], v[32:35]
    ds_read_b128 a[156:159], v21 offset:24576
    v_mfma_f32_16x16x32_bf16 a[8:11], a[168:171], a[192:195], a[8:11]
    v_mfma_f32_16x16x32_bf16 a[8:11], a[172:175], a[196:199], a[8:11]
    v_mfma_f32_16x16x32_bf16 a[32:35], a[168:171], a[200:203], a[32:35]
    v_mfma_f32_16x16x32_bf16 a[32:35], a[172:175], a[204:207], a[32:35]
    s_waitcnt lgkmcnt(2)
    v_mfma_f32_16x16x32_bf16 v[36:39], a[176:179], a[184:187], v[36:39]
    ds_read_b128 a[160:163], v20 offset:26624
    v_mfma_f32_16x16x32_bf16 v[36:39], a[180:183], a[188:191], v[36:39]
    ds_read_b128 a[164:167], v21 offset:26624
    buffer_load_dwordx4 v3, s[24:27], s48 offen offset:2048 nt lds
    v_mfma_f32_16x16x32_bf16 a[12:15], a[176:179], a[192:195], a[12:15]
    v_mfma_f32_16x16x32_bf16 a[12:15], a[180:183], a[196:199], a[12:15]
    v_mfma_f32_16x16x32_bf16 a[36:39], a[176:179], a[200:203], a[36:39]
    v_mfma_f32_16x16x32_bf16 a[36:39], a[180:183], a[204:207], a[36:39]
    s_waitcnt lgkmcnt(2)
    v_mfma_f32_16x16x32_bf16 v[40:43], a[152:155], a[184:187], v[40:43]
    ds_read_b128 a[168:171], v20 offset:28672
    v_mfma_f32_16x16x32_bf16 v[40:43], a[156:159], a[188:191], v[40:43]
    ds_read_b128 a[172:175], v21 offset:28672
    v_mfma_f32_16x16x32_bf16 a[16:19], a[152:155], a[192:195], a[16:19]
    buffer_load_dwordx4 v4, s[24:27], s48 offen offset:3072 nt lds
    v_mfma_f32_16x16x32_bf16 a[16:19], a[156:159], a[196:199], a[16:19]
    v_mfma_f32_16x16x32_bf16 a[40:43], a[152:155], a[200:203], a[40:43]
    v_mfma_f32_16x16x32_bf16 a[40:43], a[156:159], a[204:207], a[40:43]
    s_waitcnt lgkmcnt(2)
    v_mfma_f32_16x16x32_bf16 v[44:47], a[160:163], a[184:187], v[44:47]
    ds_read_b128 a[176:179], v20 offset:30720
    v_mfma_f32_16x16x32_bf16 v[44:47], a[164:167], a[188:191], v[44:47]
    ds_read_b128 a[180:183], v21 offset:30720
    v_mfma_f32_16x16x32_bf16 a[20:23], a[160:163], a[192:195], a[20:23]
    v_mfma_f32_16x16x32_bf16 a[20:23], a[164:167], a[196:199], a[20:23]
    s_add_u32 m0, s36, 98304
    s_add_u32 s48, s38, 65920
    v_mfma_f32_16x16x32_bf16 a[44:47], a[160:163], a[200:203], a[44:47]
    buffer_load_dwordx4 v1, s[24:27], s48 offen offset:0 nt lds
    v_mfma_f32_16x16x32_bf16 a[44:47], a[164:167], a[204:207], a[44:47]
    s_waitcnt lgkmcnt(2)
    v_mfma_f32_16x16x32_bf16 v[48:51], a[168:171], a[184:187], v[48:51]
    s_waitcnt vmcnt(19)
    s_barrier
    v_mfma_f32_16x16x32_bf16 v[48:51], a[172:175], a[188:191], v[48:51]
    ds_read_b128 a[152:155], v20 offset:32768
    v_mfma_f32_16x16x32_bf16 v[152:155], a[168:171], a[192:195], v[152:155]
    ds_read_b128 a[156:159], v21 offset:32768
    v_mfma_f32_16x16x32_bf16 v[152:155], a[172:175], a[196:199], v[152:155]
    v_mfma_f32_16x16x32_bf16 a[48:51], a[168:171], a[200:203], a[48:51]
    v_mfma_f32_16x16x32_bf16 a[48:51], a[172:175], a[204:207], a[48:51]
    buffer_load_dwordx4 v2, s[24:27], s48 offen offset:1024 nt lds
    s_waitcnt lgkmcnt(2)
    v_mfma_f32_16x16x32_bf16 v[52:55], a[176:179], a[184:187], v[52:55]
    ds_read_b128 a[160:163], v20 offset:34816
    v_mfma_f32_16x16x32_bf16 v[52:55], a[180:183], a[188:191], v[52:55]
    ds_read_b128 a[164:167], v21 offset:34816
    v_mfma_f32_16x16x32_bf16 v[156:159], a[176:179], a[192:195], v[156:159]
    v_mfma_f32_16x16x32_bf16 v[156:159], a[180:183], a[196:199], v[156:159]
    v_mfma_f32_16x16x32_bf16 a[52:55], a[176:179], a[200:203], a[52:55]
    v_mfma_f32_16x16x32_bf16 a[52:55], a[180:183], a[204:207], a[52:55]
    s_waitcnt lgkmcnt(2)
    v_mfma_f32_16x16x32_bf16 v[56:59], a[152:155], a[184:187], v[56:59]
    ds_read_b128 a[168:171], v20 offset:36864
    buffer_load_dwordx4 v3, s[24:27], s48 offen offset:2048 nt lds
    v_mfma_f32_16x16x32_bf16 v[56:59], a[156:159], a[188:191], v[56:59]
    ds_read_b128 a[172:175], v21 offset:36864
    v_mfma_f32_16x16x32_bf16 v[160:163], a[152:155], a[192:195], v[160:163]
    v_mfma_f32_16x16x32_bf16 v[160:163], a[156:159], a[196:199], v[160:163]
    v_mfma_f32_16x16x32_bf16 a[56:59], a[152:155], a[200:203], a[56:59]
    v_mfma_f32_16x16x32_bf16 a[56:59], a[156:159], a[204:207], a[56:59]
    s_waitcnt lgkmcnt(2)
    v_mfma_f32_16x16x32_bf16 v[60:63], a[160:163], a[184:187], v[60:63]
    ds_read_b128 a[176:179], v20 offset:38912
    v_mfma_f32_16x16x32_bf16 v[60:63], a[164:167], a[188:191], v[60:63]
    ds_read_b128 a[180:183], v21 offset:38912
    buffer_load_dwordx4 v4, s[24:27], s48 offen offset:3072 nt lds
    v_mfma_f32_16x16x32_bf16 v[164:167], a[160:163], a[192:195], v[164:167]
    v_mfma_f32_16x16x32_bf16 v[164:167], a[164:167], a[196:199], v[164:167]
    v_mfma_f32_16x16x32_bf16 a[60:63], a[160:163], a[200:203], a[60:63]
    v_mfma_f32_16x16x32_bf16 a[60:63], a[164:167], a[204:207], a[60:63]
    s_waitcnt lgkmcnt(2)
    v_mfma_f32_16x16x32_bf16 v[64:67], a[168:171], a[184:187], v[64:67]
    ds_read_b128 a[152:155], v20 offset:40960
    v_mfma_f32_16x16x32_bf16 v[64:67], a[172:175], a[188:191], v[64:67]
    ds_read_b128 a[156:159], v21 offset:40960
    v_mfma_f32_16x16x32_bf16 v[168:171], a[168:171], a[192:195], v[168:171]
    s_add_u32 m0, s36, 0
    s_add_u32 s48, s38, 131456
    v_mfma_f32_16x16x32_bf16 v[168:171], a[172:175], a[196:199], v[168:171]
    buffer_load_dwordx4 v1, s[24:27], s48 offen offset:0 nt lds
    v_mfma_f32_16x16x32_bf16 a[64:67], a[168:171], a[200:203], a[64:67]
    v_mfma_f32_16x16x32_bf16 a[64:67], a[172:175], a[204:207], a[64:67]
    s_waitcnt lgkmcnt(2)
    v_mfma_f32_16x16x32_bf16 v[68:71], a[176:179], a[184:187], v[68:71]
    ds_read_b128 a[160:163], v20 offset:43008
    v_mfma_f32_16x16x32_bf16 v[68:71], a[180:183], a[188:191], v[68:71]
    ds_read_b128 a[164:167], v21 offset:43008
    v_mfma_f32_16x16x32_bf16 v[172:175], a[176:179], a[192:195], v[172:175]
    v_mfma_f32_16x16x32_bf16 v[172:175], a[180:183], a[196:199], v[172:175]
    v_mfma_f32_16x16x32_bf16 a[68:71], a[176:179], a[200:203], a[68:71]
    buffer_load_dwordx4 v2, s[24:27], s48 offen offset:1024 nt lds
    v_mfma_f32_16x16x32_bf16 a[68:71], a[180:183], a[204:207], a[68:71]
    s_waitcnt lgkmcnt(2)
    v_mfma_f32_16x16x32_bf16 v[72:75], a[152:155], a[184:187], v[72:75]
    ds_read_b128 a[168:171], v20 offset:45056
    v_mfma_f32_16x16x32_bf16 v[72:75], a[156:159], a[188:191], v[72:75]
    ds_read_b128 a[172:175], v21 offset:45056
    v_mfma_f32_16x16x32_bf16 v[176:179], a[152:155], a[192:195], v[176:179]
    v_mfma_f32_16x16x32_bf16 v[176:179], a[156:159], a[196:199], v[176:179]
    v_mfma_f32_16x16x32_bf16 a[72:75], a[152:155], a[200:203], a[72:75]
    v_mfma_f32_16x16x32_bf16 a[72:75], a[156:159], a[204:207], a[72:75]
    buffer_load_dwordx4 v3, s[24:27], s48 offen offset:2048 nt lds
    s_waitcnt lgkmcnt(2)
    v_mfma_f32_16x16x32_bf16 v[76:79], a[160:163], a[184:187], v[76:79]
    ds_read_b128 a[176:179], v20 offset:47104
    v_mfma_f32_16x16x32_bf16 v[76:79], a[164:167], a[188:191], v[76:79]
    ds_read_b128 a[180:183], v21 offset:47104
    v_mfma_f32_16x16x32_bf16 v[180:183], a[160:163], a[192:195], v[180:183]
    v_mfma_f32_16x16x32_bf16 v[180:183], a[164:167], a[196:199], v[180:183]
    v_mfma_f32_16x16x32_bf16 a[76:79], a[160:163], a[200:203], a[76:79]
    v_mfma_f32_16x16x32_bf16 a[76:79], a[164:167], a[204:207], a[76:79]
    s_waitcnt lgkmcnt(2)
    v_mfma_f32_16x16x32_bf16 v[80:83], a[168:171], a[184:187], v[80:83]
    s_waitcnt vmcnt(19)
    s_barrier
    v_mfma_f32_16x16x32_bf16 v[80:83], a[172:175], a[188:191], v[80:83]
    ds_read_b128 a[152:155], v20 offset:49152
    buffer_load_dwordx4 v4, s[24:27], s48 offen offset:3072 nt lds
    v_mfma_f32_16x16x32_bf16 v[184:187], a[168:171], a[192:195], v[184:187]
    ds_read_b128 a[156:159], v21 offset:49152
    v_mfma_f32_16x16x32_bf16 v[184:187], a[172:175], a[196:199], v[184:187]
    v_mfma_f32_16x16x32_bf16 a[80:83], a[168:171], a[200:203], a[80:83]
    v_mfma_f32_16x16x32_bf16 a[80:83], a[172:175], a[204:207], a[80:83]
    s_waitcnt lgkmcnt(2)
    v_mfma_f32_16x16x32_bf16 v[84:87], a[176:179], a[184:187], v[84:87]
    ds_read_b128 a[160:163], v20 offset:51200
    v_mfma_f32_16x16x32_bf16 v[84:87], a[180:183], a[188:191], v[84:87]
    ds_read_b128 a[164:167], v21 offset:51200
    v_mfma_f32_16x16x32_bf16 v[188:191], a[176:179], a[192:195], v[188:191]
    s_add_u32 m0, s36, 16384
    s_add_u32 s48, s38, 196992
    v_mfma_f32_16x16x32_bf16 v[188:191], a[180:183], a[196:199], v[188:191]
    buffer_load_dwordx4 v1, s[24:27], s48 offen offset:0 nt lds
    v_mfma_f32_16x16x32_bf16 a[84:87], a[176:179], a[200:203], a[84:87]
    v_mfma_f32_16x16x32_bf16 a[84:87], a[180:183], a[204:207], a[84:87]
    s_waitcnt lgkmcnt(2)
    v_mfma_f32_16x16x32_bf16 v[88:91], a[152:155], a[184:187], v[88:91]
    ds_read_b128 a[168:171], v20 offset:53248
    v_mfma_f32_16x16x32_bf16 v[88:91], a[156:159], a[188:191], v[88:91]
    ds_read_b128 a[172:175], v21 offset:53248
    v_mfma_f32_16x16x32_bf16 v[192:195], a[152:155], a[192:195], v[192:195]
    v_mfma_f32_16x16x32_bf16 v[192:195], a[156:159], a[196:199], v[192:195]
    v_mfma_f32_16x16x32_bf16 a[88:91], a[152:155], a[200:203], a[88:91]
    buffer_load_dwordx4 v2, s[24:27], s48 offen offset:1024 nt lds
    v_mfma_f32_16x16x32_bf16 a[88:91], a[156:159], a[204:207], a[88:91]
    s_waitcnt lgkmcnt(2)
    v_mfma_f32_16x16x32_bf16 v[92:95], a[160:163], a[184:187], v[92:95]
    ds_read_b128 a[176:179], v20 offset:55296
    v_mfma_f32_16x16x32_bf16 v[92:95], a[164:167], a[188:191], v[92:95]
    ds_read_b128 a[180:183], v21 offset:55296
    v_mfma_f32_16x16x32_bf16 v[196:199], a[160:163], a[192:195], v[196:199]
    v_mfma_f32_16x16x32_bf16 v[196:199], a[164:167], a[196:199], v[196:199]
    v_mfma_f32_16x16x32_bf16 a[92:95], a[160:163], a[200:203], a[92:95]
    v_mfma_f32_16x16x32_bf16 a[92:95], a[164:167], a[204:207], a[92:95]
    buffer_load_dwordx4 v3, s[24:27], s48 offen offset:2048 nt lds
    s_waitcnt lgkmcnt(2)
    v_mfma_f32_16x16x32_bf16 v[96:99], a[168:171], a[184:187], v[96:99]
    ds_read_b128 a[152:155], v20 offset:57344
    v_mfma_f32_16x16x32_bf16 v[96:99], a[172:175], a[188:191], v[96:99]
    ds_read_b128 a[156:159], v21 offset:57344
    v_mfma_f32_16x16x32_bf16 v[200:203], a[168:171], a[192:195], v[200:203]
    v_mfma_f32_16x16x32_bf16 v[200:203], a[172:175], a[196:199], v[200:203]
    v_mfma_f32_16x16x32_bf16 a[96:99], a[168:171], a[200:203], a[96:99]
    v_mfma_f32_16x16x32_bf16 a[96:99], a[172:175], a[204:207], a[96:99]
    s_waitcnt lgkmcnt(2)
    v_mfma_f32_16x16x32_bf16 v[100:103], a[176:179], a[184:187], v[100:103]
    ds_read_b128 a[160:163], v20 offset:59392
    buffer_load_dwordx4 v4, s[24:27], s48 offen offset:3072 nt lds
    v_mfma_f32_16x16x32_bf16 v[100:103], a[180:183], a[188:191], v[100:103]
    ds_read_b128 a[164:167], v21 offset:59392
    v_mfma_f32_16x16x32_bf16 v[204:207], a[176:179], a[192:195], v[204:207]
    v_mfma_f32_16x16x32_bf16 v[204:207], a[180:183], a[196:199], v[204:207]
    v_mfma_f32_16x16x32_bf16 a[100:103], a[176:179], a[200:203], a[100:103]
    v_mfma_f32_16x16x32_bf16 a[100:103], a[180:183], a[204:207], a[100:103]
    s_waitcnt lgkmcnt(2)
    v_mfma_f32_16x16x32_bf16 v[104:107], a[152:155], a[184:187], v[104:107]
    ds_read_b128 a[168:171], v20 offset:61440
    v_mfma_f32_16x16x32_bf16 v[104:107], a[156:159], a[188:191], v[104:107]
    ds_read_b128 a[172:175], v21 offset:61440
    v_mfma_f32_16x16x32_bf16 v[208:211], a[152:155], a[192:195], v[208:211]
    v_mfma_f32_16x16x32_bf16 v[208:211], a[156:159], a[196:199], v[208:211]
    v_mfma_f32_16x16x32_bf16 a[104:107], a[152:155], a[200:203], a[104:107]
    v_mfma_f32_16x16x32_bf16 a[104:107], a[156:159], a[204:207], a[104:107]
    s_waitcnt lgkmcnt(2)
    v_mfma_f32_16x16x32_bf16 v[108:111], a[160:163], a[184:187], v[108:111]
    ds_read_b128 a[176:179], v20 offset:63488
    v_mfma_f32_16x16x32_bf16 v[108:111], a[164:167], a[188:191], v[108:111]
    ds_read_b128 a[180:183], v21 offset:63488
    v_mfma_f32_16x16x32_bf16 v[212:215], a[160:163], a[192:195], v[212:215]
    v_mfma_f32_16x16x32_bf16 v[212:215], a[164:167], a[196:199], v[212:215]
    v_mfma_f32_16x16x32_bf16 a[108:111], a[160:163], a[200:203], a[108:111]
    v_mfma_f32_16x16x32_bf16 a[108:111], a[164:167], a[204:207], a[108:111]
    s_waitcnt lgkmcnt(2)
    v_mfma_f32_16x16x32_bf16 v[112:115], a[168:171], a[184:187], v[112:115]
    s_waitcnt vmcnt(18)
    s_barrier
    v_mfma_f32_16x16x32_bf16 v[112:115], a[172:175], a[188:191], v[112:115]
    ds_read_b128 a[152:155], v22 offset:0
    s_add_u32 m0, s36, 32768
    v_mfma_f32_16x16x32_bf16 v[216:219], a[168:171], a[192:195], v[216:219]
    ds_read_b128 a[156:159], v23 offset:0
    s_add_u32 s48, s38, 0
    v_mfma_f32_16x16x32_bf16 v[216:219], a[172:175], a[196:199], v[216:219]
    buffer_load_dwordx4 v1, s[28:31], s48 offen offset:0 nt lds
    v_mfma_f32_16x16x32_bf16 a[112:115], a[168:171], a[200:203], a[112:115]
    v_mfma_f32_16x16x32_bf16 a[112:115], a[172:175], a[204:207], a[112:115]
    s_waitcnt lgkmcnt(2)
    v_mfma_f32_16x16x32_bf16 v[116:119], a[176:179], a[184:187], v[116:119]
    ds_read_b128 a[160:163], v22 offset:2048
    v_mfma_f32_16x16x32_bf16 v[116:119], a[180:183], a[188:191], v[116:119]
    ds_read_b128 a[164:167], v23 offset:2048
    v_mfma_f32_16x16x32_bf16 v[220:223], a[176:179], a[192:195], v[220:223]
    v_mfma_f32_16x16x32_bf16 v[220:223], a[180:183], a[196:199], v[220:223]
    v_mfma_f32_16x16x32_bf16 a[116:119], a[176:179], a[200:203], a[116:119]
    buffer_load_dwordx4 v2, s[28:31], s48 offen offset:1024 nt lds
    v_mfma_f32_16x16x32_bf16 a[116:119], a[180:183], a[204:207], a[116:119]
    s_waitcnt lgkmcnt(2)
    v_mfma_f32_16x16x32_bf16 v[120:123], a[152:155], a[184:187], v[120:123]
    ds_read_b128 a[168:171], v22 offset:4096
    v_mfma_f32_16x16x32_bf16 v[120:123], a[156:159], a[188:191], v[120:123]
    ds_read_b128 a[172:175], v23 offset:4096
    v_mfma_f32_16x16x32_bf16 v[224:227], a[152:155], a[192:195], v[224:227]
    v_mfma_f32_16x16x32_bf16 v[224:227], a[156:159], a[196:199], v[224:227]
    s_waitcnt vmcnt(18)
    v_mfma_f32_16x16x32_bf16 a[120:123], a[152:155], a[200:203], a[120:123]
    v_mfma_f32_16x16x32_bf16 a[120:123], a[156:159], a[204:207], a[120:123]
    ds_read_b128 a[208:211], v16 offset:24576
    s_waitcnt lgkmcnt(3)
    v_mfma_f32_16x16x32_bf16 v[124:127], a[160:163], a[184:187], v[124:127]
    ds_read_b128 a[176:179], v22 offset:6144
    buffer_load_dwordx4 v3, s[28:31], s48 offen offset:2048 nt lds
    v_mfma_f32_16x16x32_bf16 v[124:127], a[164:167], a[188:191], v[124:127]
    ds_read_b128 a[180:183], v23 offset:6144
    ds_read_b128 a[212:215], v17 offset:24576
    v_mfma_f32_16x16x32_bf16 v[228:231], a[160:163], a[192:195], v[228:231]
    v_mfma_f32_16x16x32_bf16 v[228:231], a[164:167], a[196:199], v[228:231]
    ds_read_b128 a[216:219], v16 offset:26624
    v_mfma_f32_16x16x32_bf16 a[124:127], a[160:163], a[200:203], a[124:127]
    v_mfma_f32_16x16x32_bf16 a[124:127], a[164:167], a[204:207], a[124:127]
    ds_read_b128 a[220:223], v17 offset:26624
    s_waitcnt lgkmcnt(6)
    v_mfma_f32_16x16x32_bf16 v[128:131], a[168:171], a[184:187], v[128:131]
    ds_read_b128 a[152:155], v22 offset:8192
    v_mfma_f32_16x16x32_bf16 v[128:131], a[172:175], a[188:191], v[128:131]
    ds_read_b128 a[156:159], v23 offset:8192
    ds_read_b128 a[224:227], v16 offset:28672
    v_mfma_f32_16x16x32_bf16 v[232:235], a[168:171], a[192:195], v[232:235]
    buffer_load_dwordx4 v4, s[28:31], s48 offen offset:3072 nt lds
    v_mfma_f32_16x16x32_bf16 v[232:235], a[172:175], a[196:199], v[232:235]
    ds_read_b128 a[228:231], v17 offset:28672
    v_mfma_f32_16x16x32_bf16 a[128:131], a[168:171], a[200:203], a[128:131]
    v_mfma_f32_16x16x32_bf16 a[128:131], a[172:175], a[204:207], a[128:131]
    s_waitcnt lgkmcnt(7)
    v_mfma_f32_16x16x32_bf16 v[132:135], a[176:179], a[184:187], v[132:135]
    ds_read_b128 a[160:163], v22 offset:10240
    v_mfma_f32_16x16x32_bf16 v[132:135], a[180:183], a[188:191], v[132:135]
    ds_read_b128 a[164:167], v23 offset:10240
    v_mfma_f32_16x16x32_bf16 v[236:239], a[176:179], a[192:195], v[236:239]
    v_mfma_f32_16x16x32_bf16 v[236:239], a[180:183], a[196:199], v[236:239]
    v_mfma_f32_16x16x32_bf16 a[132:135], a[176:179], a[200:203], a[132:135]
    v_mfma_f32_16x16x32_bf16 a[132:135], a[180:183], a[204:207], a[132:135]
    s_waitcnt lgkmcnt(4)
    v_mfma_f32_16x16x32_bf16 v[136:139], a[152:155], a[184:187], v[136:139]
    ds_read_b128 a[168:171], v22 offset:12288
    v_mfma_f32_16x16x32_bf16 v[136:139], a[156:159], a[188:191], v[136:139]
    ds_read_b128 a[172:175], v23 offset:12288
    v_mfma_f32_16x16x32_bf16 v[240:243], a[152:155], a[192:195], v[240:243]
    v_mfma_f32_16x16x32_bf16 v[240:243], a[156:159], a[196:199], v[240:243]
    v_mfma_f32_16x16x32_bf16 a[136:139], a[152:155], a[200:203], a[136:139]
    v_mfma_f32_16x16x32_bf16 a[136:139], a[156:159], a[204:207], a[136:139]
    s_waitcnt lgkmcnt(2)
    v_mfma_f32_16x16x32_bf16 v[140:143], a[160:163], a[184:187], v[140:143]
    ds_read_b128 a[176:179], v22 offset:14336
    v_mfma_f32_16x16x32_bf16 v[140:143], a[164:167], a[188:191], v[140:143]
    ds_read_b128 a[180:183], v23 offset:14336
    v_mfma_f32_16x16x32_bf16 v[244:247], a[160:163], a[192:195], v[244:247]
    v_mfma_f32_16x16x32_bf16 v[244:247], a[164:167], a[196:199], v[244:247]
    v_mfma_f32_16x16x32_bf16 a[140:143], a[160:163], a[200:203], a[140:143]
    v_mfma_f32_16x16x32_bf16 a[140:143], a[164:167], a[204:207], a[140:143]
    s_waitcnt lgkmcnt(2)
    v_mfma_f32_16x16x32_bf16 v[144:147], a[168:171], a[184:187], v[144:147]
    s_waitcnt vmcnt(16)
    s_barrier
    v_mfma_f32_16x16x32_bf16 v[144:147], a[172:175], a[188:191], v[144:147]
    ds_read_b128 a[152:155], v22 offset:16384
    s_add_u32 m0, s36, 49152
    v_mfma_f32_16x16x32_bf16 v[248:251], a[168:171], a[192:195], v[248:251]
    ds_read_b128 a[156:159], v23 offset:16384
    s_add_u32 s48, s38, 65536
    v_mfma_f32_16x16x32_bf16 v[248:251], a[172:175], a[196:199], v[248:251]
    buffer_load_dwordx4 v1, s[28:31], s48 offen offset:0 nt lds
    v_mfma_f32_16x16x32_bf16 a[144:147], a[168:171], a[200:203], a[144:147]
    v_mfma_f32_16x16x32_bf16 a[144:147], a[172:175], a[204:207], a[144:147]
    s_waitcnt lgkmcnt(2)
    v_mfma_f32_16x16x32_bf16 v[148:151], a[176:179], a[184:187], v[148:151]
    ds_read_b128 a[160:163], v22 offset:18432
    v_mfma_f32_16x16x32_bf16 v[148:151], a[180:183], a[188:191], v[148:151]
    ds_read_b128 a[164:167], v23 offset:18432
    v_mfma_f32_16x16x32_bf16 v[252:255], a[176:179], a[192:195], v[252:255]
    v_mfma_f32_16x16x32_bf16 v[252:255], a[180:183], a[196:199], v[252:255]
    v_mfma_f32_16x16x32_bf16 a[148:151], a[176:179], a[200:203], a[148:151]
    buffer_load_dwordx4 v2, s[28:31], s48 offen offset:1024 nt lds
    v_mfma_f32_16x16x32_bf16 a[148:151], a[180:183], a[204:207], a[148:151]
    s_waitcnt lgkmcnt(2)
    v_mfma_f32_16x16x32_bf16 v[24:27], a[152:155], a[208:211], v[24:27]
    ds_read_b128 a[168:171], v22 offset:20480
    v_mfma_f32_16x16x32_bf16 v[24:27], a[156:159], a[212:215], v[24:27]
    ds_read_b128 a[172:175], v23 offset:20480
    v_mfma_f32_16x16x32_bf16 a[0:3], a[152:155], a[216:219], a[0:3]
    v_mfma_f32_16x16x32_bf16 a[0:3], a[156:159], a[220:223], a[0:3]
    v_mfma_f32_16x16x32_bf16 a[24:27], a[152:155], a[224:227], a[24:27]
    v_mfma_f32_16x16x32_bf16 a[24:27], a[156:159], a[228:231], a[24:27]
    buffer_load_dwordx4 v3, s[28:31], s48 offen offset:2048 nt lds
    s_waitcnt lgkmcnt(2)
    v_mfma_f32_16x16x32_bf16 v[28:31], a[160:163], a[208:211], v[28:31]
    ds_read_b128 a[176:179], v22 offset:22528
    v_max3_f32 v12, v24, v25, v24
    v_mfma_f32_16x16x32_bf16 v[28:31], a[164:167], a[212:215], v[28:31]
    ds_read_b128 a[180:183], v23 offset:22528
    v_max3_f32 v12, v26, v27, v12
    v_mfma_f32_16x16x32_bf16 a[4:7], a[160:163], a[216:219], a[4:7]
    v_mfma_f32_16x16x32_bf16 a[4:7], a[164:167], a[220:223], a[4:7]
    v_mfma_f32_16x16x32_bf16 a[28:31], a[160:163], a[224:227], a[28:31]
    v_accvgpr_read_b32 v13, a24
    v_accvgpr_read_b32 v15, a25
    v_mfma_f32_16x16x32_bf16 a[28:31], a[164:167], a[228:231], a[28:31]
    v_max3_f32 v0, v13, v15, v13
    s_waitcnt lgkmcnt(2)
    v_mfma_f32_16x16x32_bf16 v[32:35], a[168:171], a[208:211], v[32:35]
    ds_read_b128 a[152:155], v22 offset:24576
    buffer_load_dwordx4 v4, s[28:31], s48 offen offset:3072 nt lds
    v_mfma_f32_16x16x32_bf16 v[32:35], a[172:175], a[212:215], v[32:35]
    ds_read_b128 a[156:159], v23 offset:24576
    v_accvgpr_read_b32 v13, a26
    v_mfma_f32_16x16x32_bf16 a[8:11], a[168:171], a[216:219], a[8:11]
    v_accvgpr_read_b32 v15, a27
    v_max3_f32 v0, v13, v15, v0
    v_mfma_f32_16x16x32_bf16 a[8:11], a[172:175], a[220:223], a[8:11]
    v_max3_f32 v12, v28, v29, v12
    v_max3_f32 v12, v30, v31, v12
    v_mfma_f32_16x16x32_bf16 a[32:35], a[168:171], a[224:227], a[32:35]
    v_accvgpr_read_b32 v13, a28
    v_accvgpr_read_b32 v15, a29
    v_mfma_f32_16x16x32_bf16 a[32:35], a[172:175], a[228:231], a[32:35]
    v_max3_f32 v0, v13, v15, v0
    s_waitcnt lgkmcnt(2)
    v_mfma_f32_16x16x32_bf16 v[36:39], a[176:179], a[208:211], v[36:39]
    ds_read_b128 a[160:163], v22 offset:26624
    v_accvgpr_read_b32 v13, a30
    v_mfma_f32_16x16x32_bf16 v[36:39], a[180:183], a[212:215], v[36:39]
    ds_read_b128 a[164:167], v23 offset:26624
    v_accvgpr_read_b32 v15, a31
    v_mfma_f32_16x16x32_bf16 a[12:15], a[176:179], a[216:219], a[12:15]
    v_max3_f32 v0, v13, v15, v0
    v_max3_f32 v12, v32, v33, v12
    v_mfma_f32_16x16x32_bf16 a[12:15], a[180:183], a[220:223], a[12:15]
    v_max3_f32 v12, v34, v35, v12
    v_mfma_f32_16x16x32_bf16 a[36:39], a[176:179], a[224:227], a[36:39]
    v_accvgpr_read_b32 v13, a32
    v_accvgpr_read_b32 v15, a33
    v_mfma_f32_16x16x32_bf16 a[36:39], a[180:183], a[228:231], a[36:39]
    v_max3_f32 v0, v13, v15, v0
    s_waitcnt lgkmcnt(2)
    v_mfma_f32_16x16x32_bf16 v[40:43], a[152:155], a[208:211], v[40:43]
    ds_read_b128 a[168:171], v22 offset:28672
    v_accvgpr_read_b32 v13, a34
    v_mfma_f32_16x16x32_bf16 v[40:43], a[156:159], a[212:215], v[40:43]
    ds_read_b128 a[172:175], v23 offset:28672
    v_accvgpr_read_b32 v15, a35
    v_mfma_f32_16x16x32_bf16 a[16:19], a[152:155], a[216:219], a[16:19]
    v_max3_f32 v0, v13, v15, v0
    v_max3_f32 v12, v36, v37, v12
    v_mfma_f32_16x16x32_bf16 a[16:19], a[156:159], a[220:223], a[16:19]
    v_max3_f32 v12, v38, v39, v12
    v_mfma_f32_16x16x32_bf16 a[40:43], a[152:155], a[224:227], a[40:43]
    v_accvgpr_read_b32 v13, a36
    v_accvgpr_read_b32 v15, a37
    v_mfma_f32_16x16x32_bf16 a[40:43], a[156:159], a[228:231], a[40:43]
    v_max3_f32 v0, v13, v15, v0
    s_waitcnt lgkmcnt(2)
    v_mfma_f32_16x16x32_bf16 v[44:47], a[160:163], a[208:211], v[44:47]
    ds_read_b128 a[176:179], v22 offset:30720
    v_accvgpr_read_b32 v13, a38
    v_mfma_f32_16x16x32_bf16 v[44:47], a[164:167], a[212:215], v[44:47]
    ds_read_b128 a[180:183], v23 offset:30720
    v_accvgpr_read_b32 v15, a39
    v_mfma_f32_16x16x32_bf16 a[20:23], a[160:163], a[216:219], a[20:23]
    v_max3_f32 v0, v13, v15, v0
    v_max3_f32 v12, v40, v41, v12
    v_mfma_f32_16x16x32_bf16 a[20:23], a[164:167], a[220:223], a[20:23]
    v_max3_f32 v12, v42, v43, v12
    v_mfma_f32_16x16x32_bf16 a[44:47], a[160:163], a[224:227], a[44:47]
    v_accvgpr_read_b32 v13, a40
    v_accvgpr_read_b32 v15, a41
    v_mfma_f32_16x16x32_bf16 a[44:47], a[164:167], a[228:231], a[44:47]
    v_max3_f32 v0, v13, v15, v0
    s_waitcnt lgkmcnt(2)
    v_mfma_f32_16x16x32_bf16 v[48:51], a[168:171], a[208:211], v[48:51]
    s_waitcnt vmcnt(16)
    s_barrier
    v_mfma_f32_16x16x32_bf16 v[48:51], a[172:175], a[212:215], v[48:51]
    ds_read_b128 a[152:155], v22 offset:32768
    s_add_u32 m0, s36, 65536
    v_mfma_f32_16x16x32_bf16 v[152:155], a[168:171], a[216:219], v[152:155]
    ds_read_b128 a[156:159], v23 offset:32768
    s_add_u32 s48, s38, 131072
    v_mfma_f32_16x16x32_bf16 v[152:155], a[172:175], a[220:223], v[152:155]
    buffer_load_dwordx4 v1, s[28:31], s48 offen offset:0 nt lds
    v_accvgpr_read_b32 v13, a42
    v_mfma_f32_16x16x32_bf16 a[48:51], a[168:171], a[224:227], a[48:51]
    v_accvgpr_read_b32 v15, a43
    v_max3_f32 v0, v13, v15, v0
    v_mfma_f32_16x16x32_bf16 a[48:51], a[172:175], a[228:231], a[48:51]
    v_max3_f32 v12, v44, v45, v12
    s_waitcnt lgkmcnt(2)
    v_mfma_f32_16x16x32_bf16 v[52:55], a[176:179], a[208:211], v[52:55]
    ds_read_b128 a[160:163], v22 offset:34816
    v_max3_f32 v12, v46, v47, v12
    v_mfma_f32_16x16x32_bf16 v[52:55], a[180:183], a[212:215], v[52:55]
    ds_read_b128 a[164:167], v23 offset:34816
    v_accvgpr_read_b32 v13, a44
    v_mfma_f32_16x16x32_bf16 v[156:159], a[176:179], a[216:219], v[156:159]
    v_accvgpr_read_b32 v15, a45
    v_max3_f32 v0, v13, v15, v0
    v_mfma_f32_16x16x32_bf16 v[156:159], a[180:183], a[220:223], v[156:159]
    v_accvgpr_read_b32 v13, a46
    v_accvgpr_read_b32 v15, a47
    v_mfma_f32_16x16x32_bf16 a[52:55], a[176:179], a[224:227], a[52:55]
    buffer_load_dwordx4 v2, s[28:31], s48 offen offset:1024 nt lds
    v_max3_f32 v0, v13, v15, v0
    v_mfma_f32_16x16x32_bf16 a[52:55], a[180:183], a[228:231], a[52:55]
    v_max3_f32 v12, v48, v49, v12
    s_waitcnt lgkmcnt(2)
    v_mfma_f32_16x16x32_bf16 v[56:59], a[152:155], a[208:211], v[56:59]
    ds_read_b128 a[168:171], v22 offset:36864
    v_max3_f32 v12, v50, v51, v12
    v_mfma_f32_16x16x32_bf16 v[56:59], a[156:159], a[212:215], v[56:59]
    ds_read_b128 a[172:175], v23 offset:36864
    v_max3_f32 v14, v152, v153, v152
    v_mfma_f32_16x16x32_bf16 v[160:163], a[152:155], a[216:219], v[160:163]
    v_max3_f32 v14, v154, v155, v14
    v_accvgpr_read_b32 v13, a48
    v_mfma_f32_16x16x32_bf16 v[160:163], a[156:159], a[220:223], v[160:163]
    v_accvgpr_read_b32 v15, a49
    v_max3_f32 v0, v13, v15, v0
    v_mfma_f32_16x16x32_bf16 a[56:59], a[152:155], a[224:227], a[56:59]
    v_accvgpr_read_b32 v13, a50
    v_accvgpr_read_b32 v15, a51
    v_mfma_f32_16x16x32_bf16 a[56:59], a[156:159], a[228:231], a[56:59]
    buffer_load_dwordx4 v3, s[28:31], s48 offen offset:2048 nt lds
    s_waitcnt lgkmcnt(2)
    v_mfma_f32_16x16x32_bf16 v[60:63], a[160:163], a[208:211], v[60:63]
    ds_read_b128 a[176:179], v22 offset:38912
    v_max3_f32 v0, v13, v15, v0
    v_mfma_f32_16x16x32_bf16 v[60:63], a[164:167], a[212:215], v[60:63]
    ds_read_b128 a[180:183], v23 offset:38912
    v_max3_f32 v12, v52, v53, v12
    v_mfma_f32_16x16x32_bf16 v[164:167], a[160:163], a[216:219], v[164:167]
    v_max3_f32 v12, v54, v55, v12
    v_max3_f32 v14, v156, v157, v14
    v_mfma_f32_16x16x32_bf16 v[164:167], a[164:167], a[220:223], v[164:167]
    v_max3_f32 v14, v158, v159, v14
    v_accvgpr_read_b32 v13, a52
    v_mfma_f32_16x16x32_bf16 a[60:63], a[160:163], a[224:227], a[60:63]
    v_accvgpr_read_b32 v15, a53
    v_max3_f32 v0, v13, v15, v0
    v_mfma_f32_16x16x32_bf16 a[60:63], a[164:167], a[228:231], a[60:63]
    v_accvgpr_read_b32 v13, a54
    s_waitcnt lgkmcnt(2)
    v_mfma_f32_16x16x32_bf16 v[64:67], a[168:171], a[208:211], v[64:67]
    ds_read_b128 a[152:155], v22 offset:40960
    buffer_load_dwordx4 v4, s[28:31], s48 offen offset:3072 nt lds
    v_mfma_f32_16x16x32_bf16 v[64:67], a[172:175], a[212:215], v[64:67]
    ds_read_b128 a[156:159], v23 offset:40960
    v_accvgpr_read_b32 v15, a55
    v_mfma_f32_16x16x32_bf16 v[168:171], a[168:171], a[216:219], v[168:171]
    v_max3_f32 v0, v13, v15, v0
    v_max3_f32 v12, v56, v57, v12
    v_mfma_f32_16x16x32_bf16 v[168:171], a[172:175], a[220:223], v[168:171]
    v_max3_f32 v12, v58, v59, v12
    v_max3_f32 v14, v160, v161, v14
    v_mfma_f32_16x16x32_bf16 a[64:67], a[168:171], a[224:227], a[64:67]
    v_max3_f32 v14, v162, v163, v14
    v_accvgpr_read_b32 v13, a56
    v_mfma_f32_16x16x32_bf16 a[64:67], a[172:175], a[228:231], a[64:67]
    v_accvgpr_read_b32 v15, a57
    s_waitcnt lgkmcnt(2)
    v_mfma_f32_16x16x32_bf16 v[68:71], a[176:179], a[208:211], v[68:71]
    ds_read_b128 a[160:163], v22 offset:43008
    v_max3_f32 v0, v13, v15, v0
    v_mfma_f32_16x16x32_bf16 v[68:71], a[180:183], a[212:215], v[68:71]
    ds_read_b128 a[164:167], v23 offset:43008
    v_accvgpr_read_b32 v13, a58
    v_mfma_f32_16x16x32_bf16 v[172:175], a[176:179], a[216:219], v[172:175]
    v_accvgpr_read_b32 v15, a59
    v_max3_f32 v0, v13, v15, v0
    v_mfma_f32_16x16x32_bf16 v[172:175], a[180:183], a[220:223], v[172:175]
    v_max3_f32 v12, v60, v61, v12
    v_max3_f32 v12, v62, v63, v12
    v_mfma_f32_16x16x32_bf16 a[68:71], a[176:179], a[224:227], a[68:71]
    v_max3_f32 v14, v164, v165, v14
    v_max3_f32 v14, v166, v167, v14
    v_mfma_f32_16x16x32_bf16 a[68:71], a[180:183], a[228:231], a[68:71]
    v_accvgpr_read_b32 v13, a60
    s_waitcnt lgkmcnt(2)
    v_mfma_f32_16x16x32_bf16 v[72:75], a[152:155], a[208:211], v[72:75]
    ds_read_b128 a[168:171], v22 offset:45056
    v_accvgpr_read_b32 v15, a61
    v_mfma_f32_16x16x32_bf16 v[72:75], a[156:159], a[212:215], v[72:75]
    ds_read_b128 a[172:175], v23 offset:45056
    v_max3_f32 v0, v13, v15, v0
    v_mfma_f32_16x16x32_bf16 v[176:179], a[152:155], a[216:219], v[176:179]
    v_accvgpr_read_b32 v13, a62
    v_accvgpr_read_b32 v15, a63
    v_mfma_f32_16x16x32_bf16 v[176:179], a[156:159], a[220:223], v[176:179]
    v_max3_f32 v0, v13, v15, v0
    v_max3_f32 v12, v64, v65, v12
    v_mfma_f32_16x16x32_bf16 a[72:75], a[152:155], a[224:227], a[72:75]
    v_max3_f32 v12, v66, v67, v12
    v_max3_f32 v14, v168, v169, v14
    v_mfma_f32_16x16x32_bf16 a[72:75], a[156:159], a[228:231], a[72:75]
    v_max3_f32 v14, v170, v171, v14
    s_waitcnt lgkmcnt(2)
    v_mfma_f32_16x16x32_bf16 v[76:79], a[160:163], a[208:211], v[76:79]
    ds_read_b128 a[176:179], v22 offset:47104
    v_accvgpr_read_b32 v13, a64
    v_mfma_f32_16x16x32_bf16 v[76:79], a[164:167], a[212:215], v[76:79]
    ds_read_b128 a[180:183], v23 offset:47104
    v_accvgpr_read_b32 v15, a65
    v_mfma_f32_16x16x32_bf16 v[180:183], a[160:163], a[216:219], v[180:183]
    v_max3_f32 v0, v13, v15, v0
    v_accvgpr_read_b32 v13, a66
    v_mfma_f32_16x16x32_bf16 v[180:183], a[164:167], a[220:223], v[180:183]
    v_accvgpr_read_b32 v15, a67
    v_max3_f32 v0, v13, v15, v0
    v_mfma_f32_16x16x32_bf16 a[76:79], a[160:163], a[224:227], a[76:79]
    v_max3_f32 v12, v68, v69, v12
    v_max3_f32 v12, v70, v71, v12
    v_mfma_f32_16x16x32_bf16 a[76:79], a[164:167], a[228:231], a[76:79]
    v_max3_f32 v14, v172, v173, v14
    s_waitcnt lgkmcnt(2)
    v_mfma_f32_16x16x32_bf16 v[80:83], a[168:171], a[208:211], v[80:83]
    s_waitcnt vmcnt(16)
    s_barrier
    v_mfma_f32_16x16x32_bf16 v[80:83], a[172:175], a[212:215], v[80:83]
    ds_read_b128 a[152:155], v20 offset:0
    s_add_u32 m0, s36, 81920
    v_mfma_f32_16x16x32_bf16 v[184:187], a[168:171], a[216:219], v[184:187]
    ds_read_b128 a[156:159], v21 offset:0
    s_add_u32 s48, s38, 196608
    v_mfma_f32_16x16x32_bf16 v[184:187], a[172:175], a[220:223], v[184:187]
    buffer_load_dwordx4 v1, s[28:31], s48 offen offset:0 nt lds
    v_max3_f32 v14, v174, v175, v14
    v_mfma_f32_16x16x32_bf16 a[80:83], a[168:171], a[224:227], a[80:83]
    v_accvgpr_read_b32 v13, a68
    v_accvgpr_read_b32 v15, a69
    v_mfma_f32_16x16x32_bf16 a[80:83], a[172:175], a[228:231], a[80:83]
    v_max3_f32 v0, v13, v15, v0
    s_waitcnt lgkmcnt(2)
    v_mfma_f32_16x16x32_bf16 v[84:87], a[176:179], a[208:211], v[84:87]
    ds_read_b128 a[160:163], v20 offset:2048
    v_accvgpr_read_b32 v13, a70
    v_mfma_f32_16x16x32_bf16 v[84:87], a[180:183], a[212:215], v[84:87]
    ds_read_b128 a[164:167], v21 offset:2048
    v_accvgpr_read_b32 v15, a71
    v_mfma_f32_16x16x32_bf16 v[188:191], a[176:179], a[216:219], v[188:191]
    v_max3_f32 v0, v13, v15, v0
    v_max3_f32 v12, v72, v73, v12
    v_mfma_f32_16x16x32_bf16 v[188:191], a[180:183], a[220:223], v[188:191]
    v_max3_f32 v12, v74, v75, v12
    v_max3_f32 v14, v176, v177, v14
    v_mfma_f32_16x16x32_bf16 a[84:87], a[176:179], a[224:227], a[84:87]
    buffer_load_dwordx4 v2, s[28:31], s48 offen offset:1024 nt lds
    v_max3_f32 v14, v178, v179, v14
    v_mfma_f32_16x16x32_bf16 a[84:87], a[180:183], a[228:231], a[84:87]
    v_accvgpr_read_b32 v13, a72
    s_waitcnt lgkmcnt(2)
    v_mfma_f32_16x16x32_bf16 v[88:91], a[152:155], a[208:211], v[88:91]
    ds_read_b128 a[168:171], v20 offset:4096
    v_accvgpr_read_b32 v15, a73
    v_mfma_f32_16x16x32_bf16 v[88:91], a[156:159], a[212:215], v[88:91]
    ds_read_b128 a[172:175], v21 offset:4096
    v_max3_f32 v0, v13, v15, v0
    v_mfma_f32_16x16x32_bf16 v[192:195], a[152:155], a[216:219], v[192:195]
    v_accvgpr_read_b32 v13, a74
    v_accvgpr_read_b32 v15, a75
    v_mfma_f32_16x16x32_bf16 v[192:195], a[156:159], a[220:223], v[192:195]
    v_max3_f32 v0, v13, v15, v0
    v_max3_f32 v12, v76, v77, v12
    v_mfma_f32_16x16x32_bf16 a[88:91], a[152:155], a[224:227], a[88:91]
    v_max3_f32 v12, v78, v79, v12
    v_max3_f32 v14, v180, v181, v14
    v_mfma_f32_16x16x32_bf16 a[88:91], a[156:159], a[228:231], a[88:91]
    buffer_load_dwordx4 v3, s[28:31], s48 offen offset:2048 nt lds
    s_waitcnt lgkmcnt(2)
    v_mfma_f32_16x16x32_bf16 v[92:95], a[160:163], a[208:211], v[92:95]
    ds_read_b128 a[176:179], v20 offset:6144
    v_max3_f32 v14, v182, v183, v14
    v_mfma_f32_16x16x32_bf16 v[92:95], a[164:167], a[212:215], v[92:95]
    ds_read_b128 a[180:183], v21 offset:6144
    v_accvgpr_read_b32 v13, a76
    v_mfma_f32_16x16x32_bf16 v[196:199], a[160:163], a[216:219], v[196:199]
    v_accvgpr_read_b32 v15, a77
    v_max3_f32 v0, v13, v15, v0
    v_mfma_f32_16x16x32_bf16 v[196:199], a[164:167], a[220:223], v[196:199]
    v_accvgpr_read_b32 v13, a78
    v_accvgpr_read_b32 v15, a79
    v_mfma_f32_16x16x32_bf16 a[92:95], a[160:163], a[224:227], a[92:95]
    v_max3_f32 v0, v13, v15, v0
    v_max3_f32 v12, v80, v81, v12
    v_mfma_f32_16x16x32_bf16 a[92:95], a[164:167], a[228:231], a[92:95]
    v_max3_f32 v12, v82, v83, v12
    s_waitcnt lgkmcnt(2)
    v_mfma_f32_16x16x32_bf16 v[96:99], a[168:171], a[208:211], v[96:99]
    ds_read_b128 a[152:155], v20 offset:8192
    buffer_load_dwordx4 v4, s[28:31], s48 offen offset:3072 nt lds
    v_mfma_f32_16x16x32_bf16 v[96:99], a[172:175], a[212:215], v[96:99]
    ds_read_b128 a[156:159], v21 offset:8192
    v_max3_f32 v14, v184, v185, v14
    v_mfma_f32_16x16x32_bf16 v[200:203], a[168:171], a[216:219], v[200:203]
    v_max3_f32 v14, v186, v187, v14
    v_accvgpr_read_b32 v13, a80
    v_mfma_f32_16x16x32_bf16 v[200:203], a[172:175], a[220:223], v[200:203]
    v_accvgpr_read_b32 v15, a81
    v_max3_f32 v0, v13, v15, v0
    v_mfma_f32_16x16x32_bf16 a[96:99], a[168:171], a[224:227], a[96:99]
    v_accvgpr_read_b32 v13, a82
    v_accvgpr_read_b32 v15, a83
    v_mfma_f32_16x16x32_bf16 a[96:99], a[172:175], a[228:231], a[96:99]
    v_max3_f32 v0, v13, v15, v0
    s_waitcnt lgkmcnt(2)
    v_mfma_f32_16x16x32_bf16 v[100:103], a[176:179], a[208:211], v[100:103]
    ds_read_b128 a[160:163], v20 offset:10240
    v_max3_f32 v12, v84, v85, v12
    v_mfma_f32_16x16x32_bf16 v[100:103], a[180:183], a[212:215], v[100:103]
    ds_read_b128 a[164:167], v21 offset:10240
    s_add_u32 m0, s36, 131072
    v_mfma_f32_16x16x32_bf16 v[204:207], a[176:179], a[216:219], v[204:207]
    s_add_u32 s48, s38, 128
    buffer_load_dwordx4 v1, s[28:31], s48 offen offset:0 nt lds
    v_mfma_f32_16x16x32_bf16 v[204:207], a[180:183], a[220:223], v[204:207]
    v_max3_f32 v12, v86, v87, v12
    v_max3_f32 v14, v188, v189, v14
    v_mfma_f32_16x16x32_bf16 a[100:103], a[176:179], a[224:227], a[100:103]
    v_max3_f32 v14, v190, v191, v14
    v_accvgpr_read_b32 v13, a84
    v_mfma_f32_16x16x32_bf16 a[100:103], a[180:183], a[228:231], a[100:103]
    v_accvgpr_read_b32 v15, a85
    s_waitcnt lgkmcnt(2)
    v_mfma_f32_16x16x32_bf16 v[104:107], a[152:155], a[208:211], v[104:107]
    ds_read_b128 a[168:171], v20 offset:12288
    v_max3_f32 v0, v13, v15, v0
    v_mfma_f32_16x16x32_bf16 v[104:107], a[156:159], a[212:215], v[104:107]
    ds_read_b128 a[172:175], v21 offset:12288
    v_accvgpr_read_b32 v13, a86
    v_mfma_f32_16x16x32_bf16 v[208:211], a[152:155], a[216:219], v[208:211]
    v_accvgpr_read_b32 v15, a87
    v_max3_f32 v0, v13, v15, v0
    v_mfma_f32_16x16x32_bf16 v[208:211], a[156:159], a[220:223], v[208:211]
    buffer_load_dwordx4 v2, s[28:31], s48 offen offset:1024 nt lds
    v_max3_f32 v12, v88, v89, v12
    v_mfma_f32_16x16x32_bf16 a[104:107], a[152:155], a[224:227], a[104:107]
    v_max3_f32 v12, v90, v91, v12
    v_max3_f32 v14, v192, v193, v14
    v_mfma_f32_16x16x32_bf16 a[104:107], a[156:159], a[228:231], a[104:107]
    v_max3_f32 v14, v194, v195, v14
    s_waitcnt lgkmcnt(2)
    v_mfma_f32_16x16x32_bf16 v[108:111], a[160:163], a[208:211], v[108:111]
    ds_read_b128 a[176:179], v20 offset:14336
    v_accvgpr_read_b32 v13, a88
    v_mfma_f32_16x16x32_bf16 v[108:111], a[164:167], a[212:215], v[108:111]
    ds_read_b128 a[180:183], v21 offset:14336
    v_accvgpr_read_b32 v15, a89
    v_mfma_f32_16x16x32_bf16 v[212:215], a[160:163], a[216:219], v[212:215]
    v_max3_f32 v0, v13, v15, v0
    v_accvgpr_read_b32 v13, a90
    v_mfma_f32_16x16x32_bf16 v[212:215], a[164:167], a[220:223], v[212:215]
    v_accvgpr_read_b32 v15, a91
    v_max3_f32 v0, v13, v15, v0
    v_mfma_f32_16x16x32_bf16 a[108:111], a[160:163], a[224:227], a[108:111]
    buffer_load_dwordx4 v3, s[28:31], s48 offen offset:2048 nt lds
    v_max3_f32 v12, v92, v93, v12
    v_mfma_f32_16x16x32_bf16 a[108:111], a[164:167], a[228:231], a[108:111]
    v_max3_f32 v12, v94, v95, v12
    s_waitcnt lgkmcnt(2)
    v_mfma_f32_16x16x32_bf16 v[112:115], a[168:171], a[208:211], v[112:115]
    s_waitcnt vmcnt(19)
    s_barrier
    v_mfma_f32_16x16x32_bf16 v[112:115], a[172:175], a[212:215], v[112:115]
    ds_read_b128 a[152:155], v20 offset:16384
    v_max3_f32 v14, v196, v197, v14
    v_mfma_f32_16x16x32_bf16 v[216:219], a[168:171], a[216:219], v[216:219]
    ds_read_b128 a[156:159], v21 offset:16384
    v_max3_f32 v14, v198, v199, v14
    v_mfma_f32_16x16x32_bf16 v[216:219], a[172:175], a[220:223], v[216:219]
    v_accvgpr_read_b32 v13, a92
    v_accvgpr_read_b32 v15, a93
    v_mfma_f32_16x16x32_bf16 a[112:115], a[168:171], a[224:227], a[112:115]
    v_max3_f32 v0, v13, v15, v0
    v_accvgpr_read_b32 v13, a94
    v_mfma_f32_16x16x32_bf16 a[112:115], a[172:175], a[228:231], a[112:115]
    buffer_load_dwordx4 v4, s[28:31], s48 offen offset:3072 nt lds
    s_waitcnt lgkmcnt(2)
    v_mfma_f32_16x16x32_bf16 v[116:119], a[176:179], a[208:211], v[116:119]
    ds_read_b128 a[160:163], v20 offset:18432
    v_accvgpr_read_b32 v15, a95
    v_mfma_f32_16x16x32_bf16 v[116:119], a[180:183], a[212:215], v[116:119]
    ds_read_b128 a[164:167], v21 offset:18432
    v_max3_f32 v0, v13, v15, v0
    v_mfma_f32_16x16x32_bf16 v[220:223], a[176:179], a[216:219], v[220:223]
    v_max3_f32 v12, v96, v97, v12
    v_max3_f32 v12, v98, v99, v12
    v_mfma_f32_16x16x32_bf16 v[220:223], a[180:183], a[220:223], v[220:223]
    v_max3_f32 v14, v200, v201, v14
    v_max3_f32 v14, v202, v203, v14
    v_mfma_f32_16x16x32_bf16 a[116:119], a[176:179], a[224:227], a[116:119]
    v_accvgpr_read_b32 v13, a96
    v_accvgpr_read_b32 v15, a97
    v_mfma_f32_16x16x32_bf16 a[116:119], a[180:183], a[228:231], a[116:119]
    v_max3_f32 v0, v13, v15, v0
    s_waitcnt lgkmcnt(2)
    v_mfma_f32_16x16x32_bf16 v[120:123], a[152:155], a[208:211], v[120:123]
    ds_read_b128 a[168:171], v20 offset:20480
    s_add_u32 m0, s36, 147456
    v_mfma_f32_16x16x32_bf16 v[120:123], a[156:159], a[212:215], v[120:123]
    ds_read_b128 a[172:175], v21 offset:20480
    s_add_u32 s48, s38, 65664
    v_mfma_f32_16x16x32_bf16 v[224:227], a[152:155], a[216:219], v[224:227]
    buffer_load_dwordx4 v1, s[28:31], s48 offen offset:0 nt lds
    v_accvgpr_read_b32 v13, a98
    v_mfma_f32_16x16x32_bf16 v[224:227], a[156:159], a[220:223], v[224:227]
    v_accvgpr_read_b32 v15, a99
    v_max3_f32 v0, v13, v15, v0
    v_mfma_f32_16x16x32_bf16 a[120:123], a[152:155], a[224:227], a[120:123]
    v_max3_f32 v12, v100, v101, v12
    v_max3_f32 v12, v102, v103, v12
    v_mfma_f32_16x16x32_bf16 a[120:123], a[156:159], a[228:231], a[120:123]
    v_max3_f32 v14, v204, v205, v14
    s_waitcnt lgkmcnt(2)
    v_mfma_f32_16x16x32_bf16 v[124:127], a[160:163], a[208:211], v[124:127]
    ds_read_b128 a[176:179], v20 offset:22528
    v_max3_f32 v14, v206, v207, v14
    v_mfma_f32_16x16x32_bf16 v[124:127], a[164:167], a[212:215], v[124:127]
    ds_read_b128 a[180:183], v21 offset:22528
    v_accvgpr_read_b32 v13, a100
    v_mfma_f32_16x16x32_bf16 v[228:231], a[160:163], a[216:219], v[228:231]
    v_accvgpr_read_b32 v15, a101
    v_max3_f32 v0, v13, v15, v0
    v_mfma_f32_16x16x32_bf16 v[228:231], a[164:167], a[220:223], v[228:231]
    buffer_load_dwordx4 v2, s[28:31], s48 offen offset:1024 nt lds
    v_accvgpr_read_b32 v13, a102
    v_mfma_f32_16x16x32_bf16 a[124:127], a[160:163], a[224:227], a[124:127]
    v_accvgpr_read_b32 v15, a103
    v_max3_f32 v0, v13, v15, v0
    v_mfma_f32_16x16x32_bf16 a[124:127], a[164:167], a[228:231], a[124:127]
    v_max3_f32 v12, v104, v105, v12
    s_waitcnt lgkmcnt(2)
    v_mfma_f32_16x16x32_bf16 v[128:131], a[168:171], a[208:211], v[128:131]
    ds_read_b128 a[152:155], v20 offset:24576
    v_max3_f32 v12, v106, v107, v12
    v_mfma_f32_16x16x32_bf16 v[128:131], a[172:175], a[212:215], v[128:131]
    ds_read_b128 a[156:159], v21 offset:24576
    v_max3_f32 v14, v208, v209, v14
    v_mfma_f32_16x16x32_bf16 v[232:235], a[168:171], a[216:219], v[232:235]
    v_max3_f32 v14, v210, v211, v14
    v_max3_f32 v12, v108, v109, v12
    v_mfma_f32_16x16x32_bf16 v[232:235], a[172:175], a[220:223], v[232:235]
    v_max3_f32 v12, v110, v111, v12
    v_max3_f32 v14, v212, v213, v14
    v_mfma_f32_16x16x32_bf16 a[128:131], a[168:171], a[224:227], a[128:131]
    buffer_load_dwordx4 v3, s[28:31], s48 offen offset:2048 nt lds
    v_max3_f32 v14, v214, v215, v14
    v_mfma_f32_16x16x32_bf16 a[128:131], a[172:175], a[228:231], a[128:131]
    v_max3_f32 v12, v112, v113, v12
    s_waitcnt lgkmcnt(2)
    v_mfma_f32_16x16x32_bf16 v[132:135], a[176:179], a[208:211], v[132:135]
    ds_read_b128 a[160:163], v20 offset:26624
    v_max3_f32 v12, v114, v115, v12
    v_mfma_f32_16x16x32_bf16 v[132:135], a[180:183], a[212:215], v[132:135]
    ds_read_b128 a[164:167], v21 offset:26624
    v_max3_f32 v14, v216, v217, v14
    v_mfma_f32_16x16x32_bf16 v[236:239], a[176:179], a[216:219], v[236:239]
    v_max3_f32 v14, v218, v219, v14
    v_max3_f32 v12, v116, v117, v12
    v_mfma_f32_16x16x32_bf16 v[236:239], a[180:183], a[220:223], v[236:239]
    v_max3_f32 v12, v118, v119, v12
    v_max3_f32 v14, v220, v221, v14
    v_mfma_f32_16x16x32_bf16 a[132:135], a[176:179], a[224:227], a[132:135]
    v_max3_f32 v14, v222, v223, v14
    v_max3_f32 v12, v120, v121, v12
    v_mfma_f32_16x16x32_bf16 a[132:135], a[180:183], a[228:231], a[132:135]
    buffer_load_dwordx4 v4, s[28:31], s48 offen offset:3072 nt lds
    s_waitcnt lgkmcnt(2)
    v_mfma_f32_16x16x32_bf16 v[136:139], a[152:155], a[208:211], v[136:139]
    ds_read_b128 a[168:171], v20 offset:28672
    v_max3_f32 v12, v122, v123, v12
    v_mfma_f32_16x16x32_bf16 v[136:139], a[156:159], a[212:215], v[136:139]
    ds_read_b128 a[172:175], v21 offset:28672
    v_max3_f32 v14, v224, v225, v14
    v_mfma_f32_16x16x32_bf16 v[240:243], a[152:155], a[216:219], v[240:243]
    v_max3_f32 v14, v226, v227, v14
    v_max3_f32 v12, v124, v125, v12
    v_mfma_f32_16x16x32_bf16 v[240:243], a[156:159], a[220:223], v[240:243]
    v_max3_f32 v12, v126, v127, v12
    v_max3_f32 v14, v228, v229, v14
    v_mfma_f32_16x16x32_bf16 a[136:139], a[152:155], a[224:227], a[136:139]
    v_max3_f32 v14, v230, v231, v14
    v_max3_f32 v12, v128, v129, v12
    v_mfma_f32_16x16x32_bf16 a[136:139], a[156:159], a[228:231], a[136:139]
    v_max3_f32 v12, v130, v131, v12
    s_waitcnt lgkmcnt(2)
    v_mfma_f32_16x16x32_bf16 v[140:143], a[160:163], a[208:211], v[140:143]
    ds_read_b128 a[176:179], v20 offset:30720
    v_max3_f32 v14, v232, v233, v14
    v_mfma_f32_16x16x32_bf16 v[140:143], a[164:167], a[212:215], v[140:143]
    ds_read_b128 a[180:183], v21 offset:30720
    v_max3_f32 v14, v234, v235, v14
    v_mfma_f32_16x16x32_bf16 v[244:247], a[160:163], a[216:219], v[244:247]
    v_max3_f32 v12, v132, v133, v12
    v_max3_f32 v12, v134, v135, v12
    v_mfma_f32_16x16x32_bf16 v[244:247], a[164:167], a[220:223], v[244:247]
    v_max3_f32 v14, v236, v237, v14
    v_max3_f32 v14, v238, v239, v14
    v_mfma_f32_16x16x32_bf16 a[140:143], a[160:163], a[224:227], a[140:143]
    v_max3_f32 v12, v136, v137, v12
    v_max3_f32 v12, v138, v139, v12
    v_mfma_f32_16x16x32_bf16 a[140:143], a[164:167], a[228:231], a[140:143]
    v_max3_f32 v14, v240, v241, v14
    s_waitcnt lgkmcnt(2)
    v_mfma_f32_16x16x32_bf16 v[144:147], a[168:171], a[208:211], v[144:147]
    v_max3_f32 v14, v242, v243, v14
    v_max3_f32 v12, v140, v141, v12
    v_mfma_f32_16x16x32_bf16 v[144:147], a[172:175], a[212:215], v[144:147]
    v_max3_f32 v12, v142, v143, v12
    v_mfma_f32_16x16x32_bf16 v[248:251], a[168:171], a[216:219], v[248:251]
    v_max3_f32 v14, v244, v245, v14
    v_max3_f32 v14, v246, v247, v14
    v_mfma_f32_16x16x32_bf16 v[248:251], a[172:175], a[220:223], v[248:251]
    v_mfma_f32_16x16x32_bf16 a[144:147], a[168:171], a[224:227], a[144:147]
    v_mfma_f32_16x16x32_bf16 a[144:147], a[172:175], a[228:231], a[144:147]
    s_waitcnt lgkmcnt(0)
    v_mfma_f32_16x16x32_bf16 v[148:151], a[176:179], a[208:211], v[148:151]
    v_max3_f32 v12, v144, v145, v12
    v_max3_f32 v12, v146, v147, v12
    v_mfma_f32_16x16x32_bf16 v[148:151], a[180:183], a[212:215], v[148:151]
    v_mfma_f32_16x16x32_bf16 v[252:255], a[176:179], a[216:219], v[252:255]
    v_max3_f32 v14, v248, v249, v14
    v_max3_f32 v14, v250, v251, v14
    v_mfma_f32_16x16x32_bf16 v[252:255], a[180:183], a[220:223], v[252:255]
    v_mfma_f32_16x16x32_bf16 a[148:151], a[176:179], a[224:227], a[148:151]
    v_mfma_f32_16x16x32_bf16 a[148:151], a[180:183], a[228:231], a[148:151]
    s_barrier
    s_add_u32 m0, s36, 98304
    s_add_u32 s48, s38, 131200
    buffer_load_dwordx4 v1, s[28:31], s48 offen offset:0 nt lds
    v_max3_f32 v12, v148, v149, v12
    v_max3_f32 v12, v150, v151, v12
    v_mov_b32 v13, v12
    v_max3_f32 v14, v252, v253, v14
    v_max3_f32 v14, v254, v255, v14
    v_permlane32_swap_b32 v12, v13
    v_max_f32 v12, v12, v13
    v_mov_b32 v13, v12
    s_nop 1
    v_permlane16_swap_b32 v12, v13
    v_max_f32 v12, v12, v13
    v_mul_f32 v12, 3182996027, v12
    v_pk_fma_f32 v[24:25], v[24:25], s[50:51], v[12:13] op_sel_hi:[1,1,0]
    v_pk_fma_f32 v[26:27], v[26:27], s[50:51], v[12:13] op_sel_hi:[1,1,0]
    v_pk_fma_f32 v[28:29], v[28:29], s[50:51], v[12:13] op_sel_hi:[1,1,0]
    v_pk_fma_f32 v[30:31], v[30:31], s[50:51], v[12:13] op_sel_hi:[1,1,0]
    v_exp_f32 v24, v24
    buffer_load_dwordx4 v2, s[28:31], s48 offen offset:1024 nt lds
    buffer_load_dwordx4 v3, s[28:31], s48 offen offset:2048 nt lds
    v_exp_f32 v25, v25
    v_accvgpr_read_b32 v16, a0
    v_accvgpr_read_b32 v17, a1
    v_exp_f32 v26, v26
    v_accvgpr_read_b32 v18, a2
    v_accvgpr_read_b32 v19, a3
    v_exp_f32 v27, v27
    v_max3_f32 v14, v16, v17, v14
    v_max3_f32 v14, v18, v19, v14
    v_exp_f32 v28, v28
    v_accvgpr_read_b32 v20, a4
    v_accvgpr_read_b32 v21, a5
    v_exp_f32 v29, v29
    v_accvgpr_read_b32 v22, a6
    v_accvgpr_read_b32 v23, a7
    v_exp_f32 v30, v30
    v_max3_f32 v14, v20, v21, v14
    v_max3_f32 v14, v22, v23, v14
    v_exp_f32 v31, v31
    v_pk_fma_f32 v[32:33], v[32:33], s[50:51], v[12:13] op_sel_hi:[1,1,0]
    v_pk_fma_f32 v[34:35], v[34:35], s[50:51], v[12:13] op_sel_hi:[1,1,0]
    v_pk_fma_f32 v[36:37], v[36:37], s[50:51], v[12:13] op_sel_hi:[1,1,0]
    v_pk_fma_f32 v[38:39], v[38:39], s[50:51], v[12:13] op_sel_hi:[1,1,0]
    v_exp_f32 v32, v32
    buffer_load_dwordx4 v4, s[28:31], s48 offen offset:3072 nt lds
    v_exp_f32 v33, v33
    s_add_u32 m0, s36, 114688
    v_exp_f32 v34, v34
    v_cvt_pk_bf16_f32 v24, v24, v25
    v_exp_f32 v35, v35
    v_cvt_pk_bf16_f32 v25, v26, v27
    v_exp_f32 v36, v36
    v_cvt_pk_bf16_f32 v26, v28, v29
    v_exp_f32 v37, v37
    v_cvt_pk_bf16_f32 v27, v30, v31
    v_exp_f32 v38, v38
    v_exp_f32 v39, v39
    v_pk_fma_f32 v[40:41], v[40:41], s[50:51], v[12:13] op_sel_hi:[1,1,0]
    v_pk_fma_f32 v[42:43], v[42:43], s[50:51], v[12:13] op_sel_hi:[1,1,0]
    v_pk_fma_f32 v[44:45], v[44:45], s[50:51], v[12:13] op_sel_hi:[1,1,0]
    v_pk_fma_f32 v[46:47], v[46:47], s[50:51], v[12:13] op_sel_hi:[1,1,0]
    v_exp_f32 v40, v40
    s_add_u32 s48, s38, 196736
    buffer_load_dwordx4 v1, s[28:31], s48 offen offset:0 nt lds
    v_cvt_pk_bf16_f32 v32, v32, v33
    v_exp_f32 v41, v41
    v_mfma_f32_16x16x32_bf16 a[236:239], a[232:235], v[24:27], 0
    v_cvt_pk_bf16_f32 v33, v34, v35
    v_cvt_pk_bf16_f32 v34, v36, v37
    v_cvt_pk_bf16_f32 v35, v38, v39
    v_exp_f32 v42, v42
    v_accvgpr_read_b32 v28, a8
    v_accvgpr_read_b32 v29, a9
    v_accvgpr_read_b32 v30, a10
    v_exp_f32 v43, v43
    v_accvgpr_read_b32 v31, a11
    v_max3_f32 v14, v28, v29, v14
    v_max3_f32 v14, v30, v31, v14
    v_exp_f32 v44, v44
    v_accvgpr_read_b32 v36, a12
    v_accvgpr_read_b32 v37, a13
    v_accvgpr_read_b32 v38, a14
    v_exp_f32 v45, v45
    v_accvgpr_read_b32 v39, a15
    v_max3_f32 v14, v36, v37, v14
    v_max3_f32 v14, v38, v39, v14
    v_exp_f32 v46, v46
    v_exp_f32 v47, v47
    v_pk_fma_f32 v[48:49], v[48:49], s[50:51], v[12:13] op_sel_hi:[1,1,0]
    v_pk_fma_f32 v[50:51], v[50:51], s[50:51], v[12:13] op_sel_hi:[1,1,0]
    v_pk_fma_f32 v[52:53], v[52:53], s[50:51], v[12:13] op_sel_hi:[1,1,0]
    v_pk_fma_f32 v[54:55], v[54:55], s[50:51], v[12:13] op_sel_hi:[1,1,0]
    v_exp_f32 v48, v48
    buffer_load_dwordx4 v2, s[28:31], s48 offen offset:1024 nt lds
    v_exp_f32 v49, v49
    v_mfma_f32_16x16x32_bf16 a[236:239], a[232:235], v[32:35], a[236:239]
    buffer_load_dwordx4 v3, s[28:31], s48 offen offset:2048 nt lds
    v_exp_f32 v50, v50
    v_cvt_pk_bf16_f32 v40, v40, v41
    v_exp_f32 v51, v51
    v_cvt_pk_bf16_f32 v41, v42, v43
    v_exp_f32 v52, v52
    v_cvt_pk_bf16_f32 v42, v44, v45
    v_exp_f32 v53, v53
    v_cvt_pk_bf16_f32 v43, v46, v47
    v_exp_f32 v54, v54
    v_exp_f32 v55, v55
    v_pk_fma_f32 v[56:57], v[56:57], s[50:51], v[12:13] op_sel_hi:[1,1,0]
    v_pk_fma_f32 v[58:59], v[58:59], s[50:51], v[12:13] op_sel_hi:[1,1,0]
    v_pk_fma_f32 v[60:61], v[60:61], s[50:51], v[12:13] op_sel_hi:[1,1,0]
    v_pk_fma_f32 v[62:63], v[62:63], s[50:51], v[12:13] op_sel_hi:[1,1,0]
    v_exp_f32 v56, v56
    buffer_load_dwordx4 v4, s[28:31], s48 offen offset:3072 nt lds
    s_add_u32 m0, s36, 0
    v_cvt_pk_bf16_f32 v48, v48, v49
    v_exp_f32 v57, v57
    v_mfma_f32_16x16x32_bf16 a[236:239], a[232:235], v[40:43], a[236:239]
    v_cvt_pk_bf16_f32 v49, v50, v51
    v_cvt_pk_bf16_f32 v50, v52, v53
    v_cvt_pk_bf16_f32 v51, v54, v55
    v_exp_f32 v58, v58
    v_accvgpr_read_b32 v44, a16
    v_accvgpr_read_b32 v45, a17
    v_accvgpr_read_b32 v46, a18
    v_exp_f32 v59, v59
    v_accvgpr_read_b32 v47, a19
    v_max3_f32 v14, v44, v45, v14
    v_max3_f32 v14, v46, v47, v14
    v_exp_f32 v60, v60
    v_accvgpr_read_b32 v52, a20
    v_accvgpr_read_b32 v53, a21
    v_accvgpr_read_b32 v54, a22
    v_exp_f32 v61, v61
    v_accvgpr_read_b32 v55, a23
    v_max3_f32 v14, v52, v53, v14
    v_max3_f32 v14, v54, v55, v14
    v_exp_f32 v62, v62
    v_exp_f32 v63, v63
    v_pk_fma_f32 v[64:65], v[64:65], s[50:51], v[12:13] op_sel_hi:[1,1,0]
    v_pk_fma_f32 v[66:67], v[66:67], s[50:51], v[12:13] op_sel_hi:[1,1,0]
    v_pk_fma_f32 v[68:69], v[68:69], s[50:51], v[12:13] op_sel_hi:[1,1,0]
    v_pk_fma_f32 v[70:71], v[70:71], s[50:51], v[12:13] op_sel_hi:[1,1,0]
    v_exp_f32 v64, v64
    s_add_u32 s48, s38, 256
    v_exp_f32 v65, v65
    v_mfma_f32_16x16x32_bf16 a[236:239], a[232:235], v[48:51], a[236:239]
    buffer_load_dwordx4 v1, s[28:31], s48 offen offset:0 nt lds
    v_exp_f32 v66, v66
    v_cvt_pk_bf16_f32 v56, v56, v57
    v_exp_f32 v67, v67
    v_cvt_pk_bf16_f32 v57, v58, v59
    v_exp_f32 v68, v68
    v_cvt_pk_bf16_f32 v58, v60, v61
    v_exp_f32 v69, v69
    v_cvt_pk_bf16_f32 v59, v62, v63
    v_exp_f32 v70, v70
    v_exp_f32 v71, v71
    v_pk_fma_f32 v[72:73], v[72:73], s[50:51], v[12:13] op_sel_hi:[1,1,0]
    v_pk_fma_f32 v[74:75], v[74:75], s[50:51], v[12:13] op_sel_hi:[1,1,0]
    v_pk_fma_f32 v[76:77], v[76:77], s[50:51], v[12:13] op_sel_hi:[1,1,0]
    v_pk_fma_f32 v[78:79], v[78:79], s[50:51], v[12:13] op_sel_hi:[1,1,0]
    v_exp_f32 v72, v72
    buffer_load_dwordx4 v2, s[28:31], s48 offen offset:1024 nt lds
    buffer_load_dwordx4 v3, s[28:31], s48 offen offset:2048 nt lds
    v_cvt_pk_bf16_f32 v64, v64, v65
    v_exp_f32 v73, v73
    v_mfma_f32_16x16x32_bf16 a[236:239], a[232:235], v[56:59], a[236:239]
    v_cvt_pk_bf16_f32 v65, v66, v67
    v_cvt_pk_bf16_f32 v66, v68, v69
    v_cvt_pk_bf16_f32 v67, v70, v71
    v_exp_f32 v74, v74
    v_accvgpr_read_b32 v60, a104
    v_accvgpr_read_b32 v61, a105
    v_accvgpr_read_b32 v62, a106
    v_exp_f32 v75, v75
    v_accvgpr_read_b32 v63, a107
    v_max3_f32 v0, v60, v61, v0
    v_max3_f32 v0, v62, v63, v0
    v_exp_f32 v76, v76
    v_accvgpr_read_b32 v68, a108
    v_accvgpr_read_b32 v69, a109
    v_accvgpr_read_b32 v70, a110
    v_exp_f32 v77, v77
    v_accvgpr_read_b32 v71, a111
    v_max3_f32 v0, v68, v69, v0
    v_max3_f32 v0, v70, v71, v0
    v_exp_f32 v78, v78
    v_exp_f32 v79, v79
    v_pk_fma_f32 v[80:81], v[80:81], s[50:51], v[12:13] op_sel_hi:[1,1,0]
    v_pk_fma_f32 v[82:83], v[82:83], s[50:51], v[12:13] op_sel_hi:[1,1,0]
    v_pk_fma_f32 v[84:85], v[84:85], s[50:51], v[12:13] op_sel_hi:[1,1,0]
    v_pk_fma_f32 v[86:87], v[86:87], s[50:51], v[12:13] op_sel_hi:[1,1,0]
    v_exp_f32 v80, v80
    buffer_load_dwordx4 v4, s[28:31], s48 offen offset:3072 nt lds
    v_exp_f32 v81, v81
    v_mfma_f32_16x16x32_bf16 a[236:239], a[232:235], v[64:67], a[236:239]
    s_add_u32 m0, s36, 16384
    v_exp_f32 v82, v82
    v_cvt_pk_bf16_f32 v72, v72, v73
    v_exp_f32 v83, v83
    v_cvt_pk_bf16_f32 v73, v74, v75
    v_exp_f32 v84, v84
    v_cvt_pk_bf16_f32 v74, v76, v77
    v_exp_f32 v85, v85
    v_cvt_pk_bf16_f32 v75, v78, v79
    v_exp_f32 v86, v86
    v_exp_f32 v87, v87
    v_pk_fma_f32 v[88:89], v[88:89], s[50:51], v[12:13] op_sel_hi:[1,1,0]
    v_pk_fma_f32 v[90:91], v[90:91], s[50:51], v[12:13] op_sel_hi:[1,1,0]
    v_pk_fma_f32 v[92:93], v[92:93], s[50:51], v[12:13] op_sel_hi:[1,1,0]
    v_pk_fma_f32 v[94:95], v[94:95], s[50:51], v[12:13] op_sel_hi:[1,1,0]
    v_exp_f32 v88, v88
    s_add_u32 s48, s38, 65792
    buffer_load_dwordx4 v1, s[28:31], s48 offen offset:0 nt lds
    v_cvt_pk_bf16_f32 v80, v80, v81
    v_exp_f32 v89, v89
    v_mfma_f32_16x16x32_bf16 a[236:239], a[232:235], v[72:75], a[236:239]
    v_cvt_pk_bf16_f32 v81, v82, v83
    v_cvt_pk_bf16_f32 v82, v84, v85
    v_cvt_pk_bf16_f32 v83, v86, v87
    v_exp_f32 v90, v90
    v_accvgpr_read_b32 v76, a112
    v_accvgpr_read_b32 v77, a113
    v_accvgpr_read_b32 v78, a114
    v_exp_f32 v91, v91
    v_accvgpr_read_b32 v79, a115
    v_max3_f32 v0, v76, v77, v0
    v_max3_f32 v0, v78, v79, v0
    v_exp_f32 v92, v92
    v_accvgpr_read_b32 v84, a116
    v_accvgpr_read_b32 v85, a117
    v_accvgpr_read_b32 v86, a118
    v_exp_f32 v93, v93
    v_accvgpr_read_b32 v87, a119
    v_max3_f32 v0, v84, v85, v0
    v_max3_f32 v0, v86, v87, v0
    v_exp_f32 v94, v94
    v_exp_f32 v95, v95
    v_pk_fma_f32 v[96:97], v[96:97], s[50:51], v[12:13] op_sel_hi:[1,1,0]
    v_pk_fma_f32 v[98:99], v[98:99], s[50:51], v[12:13] op_sel_hi:[1,1,0]
    v_pk_fma_f32 v[100:101], v[100:101], s[50:51], v[12:13] op_sel_hi:[1,1,0]
    v_pk_fma_f32 v[102:103], v[102:103], s[50:51], v[12:13] op_sel_hi:[1,1,0]
    v_exp_f32 v96, v96
    buffer_load_dwordx4 v2, s[28:31], s48 offen offset:1024 nt lds
    v_exp_f32 v97, v97
    v_mfma_f32_16x16x32_bf16 a[236:239], a[232:235], v[80:83], a[236:239]
    buffer_load_dwordx4 v3, s[28:31], s48 offen offset:2048 nt lds
    v_exp_f32 v98, v98
    v_cvt_pk_bf16_f32 v88, v88, v89
    v_exp_f32 v99, v99
    v_cvt_pk_bf16_f32 v89, v90, v91
    v_exp_f32 v100, v100
    v_cvt_pk_bf16_f32 v90, v92, v93
    v_exp_f32 v101, v101
    v_cvt_pk_bf16_f32 v91, v94, v95
    v_exp_f32 v102, v102
    v_exp_f32 v103, v103
    v_pk_fma_f32 v[104:105], v[104:105], s[50:51], v[12:13] op_sel_hi:[1,1,0]
    v_pk_fma_f32 v[106:107], v[106:107], s[50:51], v[12:13] op_sel_hi:[1,1,0]
    v_pk_fma_f32 v[108:109], v[108:109], s[50:51], v[12:13] op_sel_hi:[1,1,0]
    v_pk_fma_f32 v[110:111], v[110:111], s[50:51], v[12:13] op_sel_hi:[1,1,0]
    v_exp_f32 v104, v104
    buffer_load_dwordx4 v4, s[28:31], s48 offen offset:3072 nt lds
    v_cvt_pk_bf16_f32 v96, v96, v97
    v_cvt_pk_bf16_f32 v97, v98, v99
    v_exp_f32 v105, v105
    v_mfma_f32_16x16x32_bf16 a[236:239], a[232:235], v[88:91], a[236:239]
    v_cvt_pk_bf16_f32 v98, v100, v101
    v_cvt_pk_bf16_f32 v99, v102, v103
    v_accvgpr_read_b32 v92, a120
    v_exp_f32 v106, v106
    v_accvgpr_read_b32 v93, a121
    v_accvgpr_read_b32 v94, a122
    v_accvgpr_read_b32 v95, a123
    v_exp_f32 v107, v107
    v_max3_f32 v0, v92, v93, v0
    v_max3_f32 v0, v94, v95, v0
    v_accvgpr_read_b32 v100, a124
    v_exp_f32 v108, v108
    v_accvgpr_read_b32 v101, a125
    v_accvgpr_read_b32 v102, a126
    v_accvgpr_read_b32 v103, a127
    v_exp_f32 v109, v109
    v_max3_f32 v0, v100, v101, v0
    v_max3_f32 v0, v102, v103, v0
    v_exp_f32 v110, v110
    v_exp_f32 v111, v111
    v_pk_fma_f32 v[112:113], v[112:113], s[50:51], v[12:13] op_sel_hi:[1,1,0]
    v_pk_fma_f32 v[114:115], v[114:115], s[50:51], v[12:13] op_sel_hi:[1,1,0]
    v_pk_fma_f32 v[116:117], v[116:117], s[50:51], v[12:13] op_sel_hi:[1,1,0]
    v_pk_fma_f32 v[118:119], v[118:119], s[50:51], v[12:13] op_sel_hi:[1,1,0]
    v_exp_f32 v112, v112
    v_cvt_pk_bf16_f32 v104, v104, v105
    v_exp_f32 v113, v113
    v_mfma_f32_16x16x32_bf16 a[236:239], a[232:235], v[96:99], a[236:239]
    v_cvt_pk_bf16_f32 v105, v106, v107
    v_exp_f32 v114, v114
    v_cvt_pk_bf16_f32 v106, v108, v109
    v_exp_f32 v115, v115
    v_cvt_pk_bf16_f32 v107, v110, v111
    v_exp_f32 v116, v116
    v_exp_f32 v117, v117
    v_exp_f32 v118, v118
    v_exp_f32 v119, v119
    v_pk_fma_f32 v[120:121], v[120:121], s[50:51], v[12:13] op_sel_hi:[1,1,0]
    v_pk_fma_f32 v[122:123], v[122:123], s[50:51], v[12:13] op_sel_hi:[1,1,0]
    v_pk_fma_f32 v[124:125], v[124:125], s[50:51], v[12:13] op_sel_hi:[1,1,0]
    v_pk_fma_f32 v[126:127], v[126:127], s[50:51], v[12:13] op_sel_hi:[1,1,0]
    v_exp_f32 v120, v120
    v_cvt_pk_bf16_f32 v112, v112, v113
    v_cvt_pk_bf16_f32 v113, v114, v115
    v_exp_f32 v121, v121
    v_mfma_f32_16x16x32_bf16 a[236:239], a[232:235], v[104:107], a[236:239]
    v_cvt_pk_bf16_f32 v114, v116, v117
    v_cvt_pk_bf16_f32 v115, v118, v119
    v_exp_f32 v122, v122
    v_accvgpr_read_b32 v108, a128
    v_accvgpr_read_b32 v109, a129
    v_exp_f32 v123, v123
    v_accvgpr_read_b32 v110, a130
    v_accvgpr_read_b32 v111, a131
    v_exp_f32 v124, v124
    v_max3_f32 v0, v108, v109, v0
    v_max3_f32 v0, v110, v111, v0
    v_exp_f32 v125, v125
    v_accvgpr_read_b32 v116, a132
    v_accvgpr_read_b32 v117, a133
    v_exp_f32 v126, v126
    v_accvgpr_read_b32 v118, a134
    v_accvgpr_read_b32 v119, a135
    v_exp_f32 v127, v127
    v_max3_f32 v0, v116, v117, v0
    v_max3_f32 v0, v118, v119, v0
    v_pk_fma_f32 v[128:129], v[128:129], s[50:51], v[12:13] op_sel_hi:[1,1,0]
    v_pk_fma_f32 v[130:131], v[130:131], s[50:51], v[12:13] op_sel_hi:[1,1,0]
    v_pk_fma_f32 v[132:133], v[132:133], s[50:51], v[12:13] op_sel_hi:[1,1,0]
    v_pk_fma_f32 v[134:135], v[134:135], s[50:51], v[12:13] op_sel_hi:[1,1,0]
    v_exp_f32 v128, v128
    v_cvt_pk_bf16_f32 v120, v120, v121
    v_exp_f32 v129, v129
    v_mfma_f32_16x16x32_bf16 a[236:239], a[232:235], v[112:115], a[236:239]
    v_cvt_pk_bf16_f32 v121, v122, v123
    v_exp_f32 v130, v130
    v_cvt_pk_bf16_f32 v122, v124, v125
    v_exp_f32 v131, v131
    v_cvt_pk_bf16_f32 v123, v126, v127
    v_exp_f32 v132, v132
    v_exp_f32 v133, v133
    v_exp_f32 v134, v134
    v_exp_f32 v135, v135
    v_pk_fma_f32 v[136:137], v[136:137], s[50:51], v[12:13] op_sel_hi:[1,1,0]
    v_pk_fma_f32 v[138:139], v[138:139], s[50:51], v[12:13] op_sel_hi:[1,1,0]
    v_pk_fma_f32 v[140:141], v[140:141], s[50:51], v[12:13] op_sel_hi:[1,1,0]
    v_pk_fma_f32 v[142:143], v[142:143], s[50:51], v[12:13] op_sel_hi:[1,1,0]
    v_exp_f32 v136, v136
    v_cvt_pk_bf16_f32 v128, v128, v129
    v_cvt_pk_bf16_f32 v129, v130, v131
    v_exp_f32 v137, v137
    v_mfma_f32_16x16x32_bf16 a[236:239], a[232:235], v[120:123], a[236:239]
    v_cvt_pk_bf16_f32 v130, v132, v133
    v_cvt_pk_bf16_f32 v131, v134, v135
    v_exp_f32 v138, v138
    v_accvgpr_read_b32 v124, a136
    v_accvgpr_read_b32 v125, a137
    v_exp_f32 v139, v139
    v_accvgpr_read_b32 v126, a138
    v_accvgpr_read_b32 v127, a139
    v_exp_f32 v140, v140
    v_max3_f32 v0, v124, v125, v0
    v_max3_f32 v0, v126, v127, v0
    v_exp_f32 v141, v141
    v_accvgpr_read_b32 v132, a140
    v_accvgpr_read_b32 v133, a141
    v_exp_f32 v142, v142
    v_accvgpr_read_b32 v134, a142
    v_accvgpr_read_b32 v135, a143
    v_exp_f32 v143, v143
    v_max3_f32 v0, v132, v133, v0
    v_max3_f32 v0, v134, v135, v0
    v_pk_fma_f32 v[144:145], v[144:145], s[50:51], v[12:13] op_sel_hi:[1,1,0]
    v_pk_fma_f32 v[146:147], v[146:147], s[50:51], v[12:13] op_sel_hi:[1,1,0]
    v_pk_fma_f32 v[148:149], v[148:149], s[50:51], v[12:13] op_sel_hi:[1,1,0]
    v_pk_fma_f32 v[150:151], v[150:151], s[50:51], v[12:13] op_sel_hi:[1,1,0]
    v_exp_f32 v144, v144
    v_cvt_pk_bf16_f32 v136, v136, v137
    v_exp_f32 v145, v145
    v_mfma_f32_16x16x32_bf16 a[236:239], a[232:235], v[128:131], a[236:239]
    v_cvt_pk_bf16_f32 v137, v138, v139
    v_exp_f32 v146, v146
    v_cvt_pk_bf16_f32 v138, v140, v141
    v_exp_f32 v147, v147
    v_cvt_pk_bf16_f32 v139, v142, v143
    v_exp_f32 v148, v148
    v_exp_f32 v149, v149
    v_exp_f32 v150, v150
    v_exp_f32 v151, v151
    v_cvt_pk_bf16_f32 v144, v144, v145
    v_cvt_pk_bf16_f32 v145, v146, v147
    v_cvt_pk_bf16_f32 v146, v148, v149
    v_cvt_pk_bf16_f32 v147, v150, v151
    v_accvgpr_read_b32 v140, a144
    v_accvgpr_read_b32 v141, a145
    v_accvgpr_read_b32 v142, a146
    v_accvgpr_read_b32 v143, a147
    v_max3_f32 v0, v140, v141, v0
    v_max3_f32 v0, v142, v143, v0
    v_accvgpr_read_b32 v148, a148
    v_accvgpr_read_b32 v149, a149
    v_accvgpr_read_b32 v150, a150
    v_accvgpr_read_b32 v151, a151
    v_max3_f32 v0, v148, v149, v0
    v_max3_f32 v0, v150, v151, v0
    v_mov_b32 v13, v14
    s_nop 1
    v_permlane32_swap_b32 v14, v13
    v_max_f32 v14, v14, v13
    v_mov_b32 v13, v14
    s_nop 1
    v_permlane16_swap_b32 v14, v13
    v_max_f32 v14, v14, v13
    v_mul_f32 v14, 3182996027, v14
    v_pk_fma_f32 v[152:153], v[152:153], s[50:51], v[14:15] op_sel_hi:[1,1,0]
    v_pk_fma_f32 v[154:155], v[154:155], s[50:51], v[14:15] op_sel_hi:[1,1,0]
    v_pk_fma_f32 v[156:157], v[156:157], s[50:51], v[14:15] op_sel_hi:[1,1,0]
    v_pk_fma_f32 v[158:159], v[158:159], s[50:51], v[14:15] op_sel_hi:[1,1,0]
    v_exp_f32 v152, v152
    v_exp_f32 v153, v153
    v_mfma_f32_16x16x32_bf16 a[236:239], a[232:235], v[136:139], a[236:239]
    v_exp_f32 v154, v154
    v_exp_f32 v155, v155
    v_exp_f32 v156, v156
    v_exp_f32 v157, v157
    v_exp_f32 v158, v158
    v_exp_f32 v159, v159
    v_pk_fma_f32 v[160:161], v[160:161], s[50:51], v[14:15] op_sel_hi:[1,1,0]
    v_pk_fma_f32 v[162:163], v[162:163], s[50:51], v[14:15] op_sel_hi:[1,1,0]
    v_pk_fma_f32 v[164:165], v[164:165], s[50:51], v[14:15] op_sel_hi:[1,1,0]
    v_pk_fma_f32 v[166:167], v[166:167], s[50:51], v[14:15] op_sel_hi:[1,1,0]
    v_exp_f32 v160, v160
    v_cvt_pk_bf16_f32 v152, v152, v153
    v_exp_f32 v161, v161
    v_mfma_f32_16x16x32_bf16 a[236:239], a[232:235], v[144:147], a[236:239]
    v_cvt_pk_bf16_f32 v153, v154, v155
    v_exp_f32 v162, v162
    v_cvt_pk_bf16_f32 v154, v156, v157
    v_exp_f32 v163, v163
    v_cvt_pk_bf16_f32 v155, v158, v159
    v_exp_f32 v164, v164
    v_exp_f32 v165, v165
    v_exp_f32 v166, v166
    v_exp_f32 v167, v167
    v_pk_fma_f32 v[168:169], v[168:169], s[50:51], v[14:15] op_sel_hi:[1,1,0]
    v_pk_fma_f32 v[170:171], v[170:171], s[50:51], v[14:15] op_sel_hi:[1,1,0]
    v_pk_fma_f32 v[172:173], v[172:173], s[50:51], v[14:15] op_sel_hi:[1,1,0]
    v_pk_fma_f32 v[174:175], v[174:175], s[50:51], v[14:15] op_sel_hi:[1,1,0]
    v_exp_f32 v168, v168
    buffer_load_dwordx4 a[252:255], v1, s[28:31], s44 offen offset:0
    v_cvt_pk_bf16_f32 v160, v160, v161
    v_exp_f32 v169, v169
    v_mfma_f32_16x16x32_bf16 a[240:243], a[232:235], v[152:155], 0
    v_cvt_pk_bf16_f32 v161, v162, v163
    v_cvt_pk_bf16_f32 v162, v164, v165
    v_exp_f32 v170, v170
    v_cvt_pk_bf16_f32 v163, v166, v167
    v_accvgpr_read_b32 v156, a24
    v_exp_f32 v171, v171
    v_accvgpr_read_b32 v157, a25
    v_accvgpr_read_b32 v158, a26
    v_exp_f32 v172, v172
    v_accvgpr_read_b32 v159, a27
    v_accvgpr_read_b32 v164, a28
    v_exp_f32 v173, v173
    v_accvgpr_read_b32 v165, a29
    v_accvgpr_read_b32 v166, a30
    v_exp_f32 v174, v174
    v_accvgpr_read_b32 v167, a31
    v_exp_f32 v175, v175
    v_pk_fma_f32 v[176:177], v[176:177], s[50:51], v[14:15] op_sel_hi:[1,1,0]
    v_pk_fma_f32 v[178:179], v[178:179], s[50:51], v[14:15] op_sel_hi:[1,1,0]
    v_pk_fma_f32 v[180:181], v[180:181], s[50:51], v[14:15] op_sel_hi:[1,1,0]
    v_pk_fma_f32 v[182:183], v[182:183], s[50:51], v[14:15] op_sel_hi:[1,1,0]
    v_exp_f32 v176, v176
    buffer_load_dwordx4 a[252:255], v1, s[28:31], s45 offen offset:0
    v_exp_f32 v177, v177
    v_mfma_f32_16x16x32_bf16 a[240:243], a[232:235], v[160:163], a[240:243]
    v_cvt_pk_bf16_f32 v168, v168, v169
    v_exp_f32 v178, v178
    v_cvt_pk_bf16_f32 v169, v170, v171
    v_exp_f32 v179, v179
    v_cvt_pk_bf16_f32 v170, v172, v173
    v_exp_f32 v180, v180
    v_cvt_pk_bf16_f32 v171, v174, v175
    v_exp_f32 v181, v181
    v_exp_f32 v182, v182
    v_exp_f32 v183, v183
    v_pk_fma_f32 v[184:185], v[184:185], s[50:51], v[14:15] op_sel_hi:[1,1,0]
    v_pk_fma_f32 v[186:187], v[186:187], s[50:51], v[14:15] op_sel_hi:[1,1,0]
    v_pk_fma_f32 v[188:189], v[188:189], s[50:51], v[14:15] op_sel_hi:[1,1,0]
    v_pk_fma_f32 v[190:191], v[190:191], s[50:51], v[14:15] op_sel_hi:[1,1,0]
    v_exp_f32 v184, v184
    buffer_load_dwordx4 a[252:255], v1, s[28:31], s46 offen offset:0
    v_cvt_pk_bf16_f32 v176, v176, v177
    v_exp_f32 v185, v185
    v_mfma_f32_16x16x32_bf16 a[240:243], a[232:235], v[168:171], a[240:243]
    v_cvt_pk_bf16_f32 v177, v178, v179
    v_cvt_pk_bf16_f32 v178, v180, v181
    v_exp_f32 v186, v186
    v_cvt_pk_bf16_f32 v179, v182, v183
    v_accvgpr_read_b32 v172, a32
    v_exp_f32 v187, v187
    v_accvgpr_read_b32 v173, a33
    v_accvgpr_read_b32 v174, a34
    v_exp_f32 v188, v188
    v_accvgpr_read_b32 v175, a35
    v_accvgpr_read_b32 v180, a36
    v_exp_f32 v189, v189
    v_accvgpr_read_b32 v181, a37
    v_accvgpr_read_b32 v182, a38
    v_exp_f32 v190, v190
    v_accvgpr_read_b32 v183, a39
    v_exp_f32 v191, v191
    v_pk_fma_f32 v[192:193], v[192:193], s[50:51], v[14:15] op_sel_hi:[1,1,0]
    v_pk_fma_f32 v[194:195], v[194:195], s[50:51], v[14:15] op_sel_hi:[1,1,0]
    v_pk_fma_f32 v[196:197], v[196:197], s[50:51], v[14:15] op_sel_hi:[1,1,0]
    v_pk_fma_f32 v[198:199], v[198:199], s[50:51], v[14:15] op_sel_hi:[1,1,0]
    v_exp_f32 v192, v192
    buffer_load_dwordx4 a[252:255], v1, s[28:31], s47 offen offset:0
    v_exp_f32 v193, v193
    v_mfma_f32_16x16x32_bf16 a[240:243], a[232:235], v[176:179], a[240:243]
    v_cvt_pk_bf16_f32 v184, v184, v185
    v_exp_f32 v194, v194
    v_cvt_pk_bf16_f32 v185, v186, v187
    v_exp_f32 v195, v195
    v_cvt_pk_bf16_f32 v186, v188, v189
    v_exp_f32 v196, v196
    v_cvt_pk_bf16_f32 v187, v190, v191
    v_exp_f32 v197, v197
    v_exp_f32 v198, v198
    v_exp_f32 v199, v199
    v_pk_fma_f32 v[200:201], v[200:201], s[50:51], v[14:15] op_sel_hi:[1,1,0]
    v_pk_fma_f32 v[202:203], v[202:203], s[50:51], v[14:15] op_sel_hi:[1,1,0]
    v_pk_fma_f32 v[204:205], v[204:205], s[50:51], v[14:15] op_sel_hi:[1,1,0]
    v_pk_fma_f32 v[206:207], v[206:207], s[50:51], v[14:15] op_sel_hi:[1,1,0]
    v_exp_f32 v200, v200
    buffer_load_dwordx4 a[252:255], v1, s[28:31], s56 offen offset:0
    v_cvt_pk_bf16_f32 v192, v192, v193
    v_exp_f32 v201, v201
    v_mfma_f32_16x16x32_bf16 a[240:243], a[232:235], v[184:187], a[240:243]
    v_cvt_pk_bf16_f32 v193, v194, v195
    v_cvt_pk_bf16_f32 v194, v196, v197
    v_exp_f32 v202, v202
    v_cvt_pk_bf16_f32 v195, v198, v199
    v_accvgpr_read_b32 v188, a40
    v_exp_f32 v203, v203
    v_accvgpr_read_b32 v189, a41
    v_accvgpr_read_b32 v190, a42
    v_exp_f32 v204, v204
    v_accvgpr_read_b32 v191, a43
    v_accvgpr_read_b32 v196, a44
    v_exp_f32 v205, v205
    v_accvgpr_read_b32 v197, a45
    v_accvgpr_read_b32 v198, a46
    v_exp_f32 v206, v206
    v_accvgpr_read_b32 v199, a47
    v_exp_f32 v207, v207
    v_pk_fma_f32 v[208:209], v[208:209], s[50:51], v[14:15] op_sel_hi:[1,1,0]
    v_pk_fma_f32 v[210:211], v[210:211], s[50:51], v[14:15] op_sel_hi:[1,1,0]
    v_pk_fma_f32 v[212:213], v[212:213], s[50:51], v[14:15] op_sel_hi:[1,1,0]
    v_pk_fma_f32 v[214:215], v[214:215], s[50:51], v[14:15] op_sel_hi:[1,1,0]
    v_exp_f32 v208, v208
    buffer_load_dwordx4 a[252:255], v1, s[28:31], s57 offen offset:0
    v_exp_f32 v209, v209
    v_mfma_f32_16x16x32_bf16 a[240:243], a[232:235], v[192:195], a[240:243]
    v_cvt_pk_bf16_f32 v200, v200, v201
    v_exp_f32 v210, v210
    v_cvt_pk_bf16_f32 v201, v202, v203
    v_exp_f32 v211, v211
    v_cvt_pk_bf16_f32 v202, v204, v205
    v_exp_f32 v212, v212
    v_cvt_pk_bf16_f32 v203, v206, v207
    v_exp_f32 v213, v213
    v_exp_f32 v214, v214
    v_exp_f32 v215, v215
    v_pk_fma_f32 v[216:217], v[216:217], s[50:51], v[14:15] op_sel_hi:[1,1,0]
    v_pk_fma_f32 v[218:219], v[218:219], s[50:51], v[14:15] op_sel_hi:[1,1,0]
    v_pk_fma_f32 v[220:221], v[220:221], s[50:51], v[14:15] op_sel_hi:[1,1,0]
    v_pk_fma_f32 v[222:223], v[222:223], s[50:51], v[14:15] op_sel_hi:[1,1,0]
    v_exp_f32 v216, v216
    v_cvt_pk_bf16_f32 v208, v208, v209
    v_cvt_pk_bf16_f32 v209, v210, v211
    v_exp_f32 v217, v217
    v_mfma_f32_16x16x32_bf16 a[240:243], a[232:235], v[200:203], a[240:243]
    v_cvt_pk_bf16_f32 v210, v212, v213
    v_cvt_pk_bf16_f32 v211, v214, v215
    v_exp_f32 v218, v218
    v_accvgpr_read_b32 v204, a48
    v_accvgpr_read_b32 v205, a49
    v_exp_f32 v219, v219
    v_accvgpr_read_b32 v206, a50
    v_accvgpr_read_b32 v207, a51
    v_exp_f32 v220, v220
    v_accvgpr_read_b32 v212, a52
    v_accvgpr_read_b32 v213, a53
    v_exp_f32 v221, v221
    v_accvgpr_read_b32 v214, a54
    v_accvgpr_read_b32 v215, a55
    v_exp_f32 v222, v222
    v_exp_f32 v223, v223
    v_pk_fma_f32 v[224:225], v[224:225], s[50:51], v[14:15] op_sel_hi:[1,1,0]
    v_pk_fma_f32 v[226:227], v[226:227], s[50:51], v[14:15] op_sel_hi:[1,1,0]
    v_pk_fma_f32 v[228:229], v[228:229], s[50:51], v[14:15] op_sel_hi:[1,1,0]
    v_pk_fma_f32 v[230:231], v[230:231], s[50:51], v[14:15] op_sel_hi:[1,1,0]
    v_exp_f32 v224, v224
    v_cvt_pk_bf16_f32 v216, v216, v217
    v_exp_f32 v225, v225
    v_mfma_f32_16x16x32_bf16 a[240:243], a[232:235], v[208:211], a[240:243]
    v_cvt_pk_bf16_f32 v217, v218, v219
    v_exp_f32 v226, v226
    v_cvt_pk_bf16_f32 v218, v220, v221
    v_exp_f32 v227, v227
    v_cvt_pk_bf16_f32 v219, v222, v223
    v_exp_f32 v228, v228
    v_exp_f32 v229, v229
    v_exp_f32 v230, v230
    v_exp_f32 v231, v231
    v_pk_fma_f32 v[232:233], v[232:233], s[50:51], v[14:15] op_sel_hi:[1,1,0]
    v_pk_fma_f32 v[234:235], v[234:235], s[50:51], v[14:15] op_sel_hi:[1,1,0]
    v_pk_fma_f32 v[236:237], v[236:237], s[50:51], v[14:15] op_sel_hi:[1,1,0]
    v_pk_fma_f32 v[238:239], v[238:239], s[50:51], v[14:15] op_sel_hi:[1,1,0]
    v_exp_f32 v232, v232
    v_cvt_pk_bf16_f32 v224, v224, v225
    v_cvt_pk_bf16_f32 v225, v226, v227
    v_exp_f32 v233, v233
    v_mfma_f32_16x16x32_bf16 a[240:243], a[232:235], v[216:219], a[240:243]
    v_cvt_pk_bf16_f32 v226, v228, v229
    v_cvt_pk_bf16_f32 v227, v230, v231
    v_exp_f32 v234, v234
    v_accvgpr_read_b32 v220, a56
    v_accvgpr_read_b32 v221, a57
    v_exp_f32 v235, v235
    v_accvgpr_read_b32 v222, a58
    v_accvgpr_read_b32 v223, a59
    v_exp_f32 v236, v236
    v_accvgpr_read_b32 v228, a60
    v_accvgpr_read_b32 v229, a61
    v_exp_f32 v237, v237
    v_accvgpr_read_b32 v230, a62
    v_accvgpr_read_b32 v231, a63
    v_exp_f32 v238, v238
    v_exp_f32 v239, v239
    v_pk_fma_f32 v[240:241], v[240:241], s[50:51], v[14:15] op_sel_hi:[1,1,0]
    v_pk_fma_f32 v[242:243], v[242:243], s[50:51], v[14:15] op_sel_hi:[1,1,0]
    v_pk_fma_f32 v[244:245], v[244:245], s[50:51], v[14:15] op_sel_hi:[1,1,0]
    v_pk_fma_f32 v[246:247], v[246:247], s[50:51], v[14:15] op_sel_hi:[1,1,0]
    v_exp_f32 v240, v240
    v_cvt_pk_bf16_f32 v232, v232, v233
    v_exp_f32 v241, v241
    v_mfma_f32_16x16x32_bf16 a[240:243], a[232:235], v[224:227], a[240:243]
    v_cvt_pk_bf16_f32 v233, v234, v235
    v_exp_f32 v242, v242
    v_cvt_pk_bf16_f32 v234, v236, v237
    v_exp_f32 v243, v243
    v_cvt_pk_bf16_f32 v235, v238, v239
    v_exp_f32 v244, v244
    v_exp_f32 v245, v245
    v_exp_f32 v246, v246
    v_exp_f32 v247, v247
    v_pk_fma_f32 v[248:249], v[248:249], s[50:51], v[14:15] op_sel_hi:[1,1,0]
    v_pk_fma_f32 v[250:251], v[250:251], s[50:51], v[14:15] op_sel_hi:[1,1,0]
    v_pk_fma_f32 v[252:253], v[252:253], s[50:51], v[14:15] op_sel_hi:[1,1,0]
    v_pk_fma_f32 v[254:255], v[254:255], s[50:51], v[14:15] op_sel_hi:[1,1,0]
    v_exp_f32 v248, v248
    v_cvt_pk_bf16_f32 v240, v240, v241
    v_cvt_pk_bf16_f32 v241, v242, v243
    v_exp_f32 v249, v249
    v_mfma_f32_16x16x32_bf16 a[240:243], a[232:235], v[232:235], a[240:243]
    v_cvt_pk_bf16_f32 v242, v244, v245
    v_cvt_pk_bf16_f32 v243, v246, v247
    v_exp_f32 v250, v250
    v_accvgpr_read_b32 v236, a64
    v_accvgpr_read_b32 v237, a65
    v_exp_f32 v251, v251
    v_accvgpr_read_b32 v238, a66
    v_accvgpr_read_b32 v239, a67
    v_exp_f32 v252, v252
    v_accvgpr_read_b32 v244, a68
    v_accvgpr_read_b32 v245, a69
    v_exp_f32 v253, v253
    v_accvgpr_read_b32 v246, a70
    v_accvgpr_read_b32 v247, a71
    v_exp_f32 v254, v254
    v_exp_f32 v255, v255
    v_pk_fma_f32 v[16:17], v[16:17], s[50:51], v[14:15] op_sel_hi:[1,1,0]
    v_pk_fma_f32 v[18:19], v[18:19], s[50:51], v[14:15] op_sel_hi:[1,1,0]
    v_pk_fma_f32 v[20:21], v[20:21], s[50:51], v[14:15] op_sel_hi:[1,1,0]
    v_pk_fma_f32 v[22:23], v[22:23], s[50:51], v[14:15] op_sel_hi:[1,1,0]
    v_exp_f32 v16, v16
    v_cvt_pk_bf16_f32 v248, v248, v249
    v_exp_f32 v17, v17
    v_mfma_f32_16x16x32_bf16 a[240:243], a[232:235], v[240:243], a[240:243]
    v_cvt_pk_bf16_f32 v249, v250, v251
    v_exp_f32 v18, v18
    v_cvt_pk_bf16_f32 v250, v252, v253
    v_exp_f32 v19, v19
    v_cvt_pk_bf16_f32 v251, v254, v255
    v_exp_f32 v20, v20
    v_exp_f32 v21, v21
    v_exp_f32 v22, v22
    v_exp_f32 v23, v23
    v_pk_fma_f32 v[28:29], v[28:29], s[50:51], v[14:15] op_sel_hi:[1,1,0]
    v_pk_fma_f32 v[30:31], v[30:31], s[50:51], v[14:15] op_sel_hi:[1,1,0]
    v_pk_fma_f32 v[36:37], v[36:37], s[50:51], v[14:15] op_sel_hi:[1,1,0]
    v_pk_fma_f32 v[38:39], v[38:39], s[50:51], v[14:15] op_sel_hi:[1,1,0]
    v_exp_f32 v28, v28
    v_cvt_pk_bf16_f32 v16, v16, v17
    v_cvt_pk_bf16_f32 v17, v18, v19
    v_exp_f32 v29, v29
    v_mfma_f32_16x16x32_bf16 a[240:243], a[232:235], v[248:251], a[240:243]
    v_cvt_pk_bf16_f32 v18, v20, v21
    v_cvt_pk_bf16_f32 v19, v22, v23
    v_exp_f32 v30, v30
    v_accvgpr_read_b32 v252, a72
    v_accvgpr_read_b32 v253, a73
    v_exp_f32 v31, v31
    v_accvgpr_read_b32 v254, a74
    v_accvgpr_read_b32 v255, a75
    v_exp_f32 v36, v36
    v_accvgpr_read_b32 v20, a76
    v_accvgpr_read_b32 v21, a77
    v_exp_f32 v37, v37
    v_accvgpr_read_b32 v22, a78
    v_accvgpr_read_b32 v23, a79
    v_exp_f32 v38, v38
    v_exp_f32 v39, v39
    v_pk_fma_f32 v[44:45], v[44:45], s[50:51], v[14:15] op_sel_hi:[1,1,0]
    v_pk_fma_f32 v[46:47], v[46:47], s[50:51], v[14:15] op_sel_hi:[1,1,0]
    v_pk_fma_f32 v[52:53], v[52:53], s[50:51], v[14:15] op_sel_hi:[1,1,0]
    v_pk_fma_f32 v[54:55], v[54:55], s[50:51], v[14:15] op_sel_hi:[1,1,0]
    v_exp_f32 v44, v44
    v_cvt_pk_bf16_f32 v28, v28, v29
    v_exp_f32 v45, v45
    v_mfma_f32_16x16x32_bf16 a[240:243], a[232:235], v[16:19], a[240:243]
    v_cvt_pk_bf16_f32 v29, v30, v31
    v_exp_f32 v46, v46
    v_cvt_pk_bf16_f32 v30, v36, v37
    v_exp_f32 v47, v47
    v_cvt_pk_bf16_f32 v31, v38, v39
    v_exp_f32 v52, v52
    v_exp_f32 v53, v53
    v_exp_f32 v54, v54
    v_exp_f32 v55, v55
    v_cvt_pk_bf16_f32 v44, v44, v45
    v_cvt_pk_bf16_f32 v45, v46, v47
    v_cvt_pk_bf16_f32 v46, v52, v53
    v_cvt_pk_bf16_f32 v47, v54, v55
    v_accvgpr_read_b32 v36, a80
    v_accvgpr_read_b32 v37, a81
    v_accvgpr_read_b32 v38, a82
    v_accvgpr_read_b32 v39, a83
    v_accvgpr_read_b32 v52, a84
    v_accvgpr_read_b32 v53, a85
    v_accvgpr_read_b32 v54, a86
    v_accvgpr_read_b32 v55, a87
    v_mov_b32 v13, v0
    s_nop 1
    v_permlane32_swap_b32 v0, v13
    v_max_f32 v0, v0, v13
    v_mov_b32 v13, v0
    s_nop 1
    v_permlane16_swap_b32 v0, v13
    v_max_f32 v0, v0, v13
    v_mul_f32 v0, 3182996027, v0
    v_pk_fma_f32 v[156:157], v[156:157], s[50:51], v[0:1] op_sel_hi:[1,1,0]
    v_pk_fma_f32 v[158:159], v[158:159], s[50:51], v[0:1] op_sel_hi:[1,1,0]
    v_pk_fma_f32 v[164:165], v[164:165], s[50:51], v[0:1] op_sel_hi:[1,1,0]
    v_pk_fma_f32 v[166:167], v[166:167], s[50:51], v[0:1] op_sel_hi:[1,1,0]
    v_exp_f32 v156, v156
    v_exp_f32 v157, v157
    v_mfma_f32_16x16x32_bf16 a[240:243], a[232:235], v[28:31], a[240:243]
    v_exp_f32 v158, v158
    v_exp_f32 v159, v159
    v_exp_f32 v164, v164
    v_exp_f32 v165, v165
    v_exp_f32 v166, v166
    v_exp_f32 v167, v167
    v_pk_fma_f32 v[172:173], v[172:173], s[50:51], v[0:1] op_sel_hi:[1,1,0]
    v_pk_fma_f32 v[174:175], v[174:175], s[50:51], v[0:1] op_sel_hi:[1,1,0]
    v_pk_fma_f32 v[180:181], v[180:181], s[50:51], v[0:1] op_sel_hi:[1,1,0]
    v_pk_fma_f32 v[182:183], v[182:183], s[50:51], v[0:1] op_sel_hi:[1,1,0]
    v_exp_f32 v172, v172
    v_cvt_pk_bf16_f32 v156, v156, v157
    v_exp_f32 v173, v173
    v_mfma_f32_16x16x32_bf16 a[240:243], a[232:235], v[44:47], a[240:243]
    v_cvt_pk_bf16_f32 v157, v158, v159
    v_exp_f32 v174, v174
    v_cvt_pk_bf16_f32 v158, v164, v165
    v_exp_f32 v175, v175
    v_cvt_pk_bf16_f32 v159, v166, v167
    v_exp_f32 v180, v180
    v_exp_f32 v181, v181
    v_exp_f32 v182, v182
    v_exp_f32 v183, v183
    v_pk_fma_f32 v[188:189], v[188:189], s[50:51], v[0:1] op_sel_hi:[1,1,0]
    v_pk_fma_f32 v[190:191], v[190:191], s[50:51], v[0:1] op_sel_hi:[1,1,0]
    v_pk_fma_f32 v[196:197], v[196:197], s[50:51], v[0:1] op_sel_hi:[1,1,0]
    v_pk_fma_f32 v[198:199], v[198:199], s[50:51], v[0:1] op_sel_hi:[1,1,0]
    v_exp_f32 v188, v188
    v_cvt_pk_bf16_f32 v172, v172, v173
    v_cvt_pk_bf16_f32 v173, v174, v175
    v_exp_f32 v189, v189
    v_mfma_f32_16x16x32_bf16 a[244:247], a[232:235], v[156:159], 0
    v_cvt_pk_bf16_f32 v174, v180, v181
    v_cvt_pk_bf16_f32 v175, v182, v183
    v_exp_f32 v190, v190
    v_accvgpr_read_b32 v164, a88
    v_accvgpr_read_b32 v165, a89
    v_exp_f32 v191, v191
    v_accvgpr_read_b32 v166, a90
    v_accvgpr_read_b32 v167, a91
    v_exp_f32 v196, v196
    v_accvgpr_read_b32 v180, a92
    v_accvgpr_read_b32 v181, a93
    v_exp_f32 v197, v197
    v_accvgpr_read_b32 v182, a94
    v_accvgpr_read_b32 v183, a95
    v_exp_f32 v198, v198
    v_exp_f32 v199, v199
    v_pk_fma_f32 v[204:205], v[204:205], s[50:51], v[0:1] op_sel_hi:[1,1,0]
    v_pk_fma_f32 v[206:207], v[206:207], s[50:51], v[0:1] op_sel_hi:[1,1,0]
    v_pk_fma_f32 v[212:213], v[212:213], s[50:51], v[0:1] op_sel_hi:[1,1,0]
    v_pk_fma_f32 v[214:215], v[214:215], s[50:51], v[0:1] op_sel_hi:[1,1,0]
    v_exp_f32 v204, v204
    v_cvt_pk_bf16_f32 v188, v188, v189
    v_exp_f32 v205, v205
    v_mfma_f32_16x16x32_bf16 a[244:247], a[232:235], v[172:175], a[244:247]
    v_cvt_pk_bf16_f32 v189, v190, v191
    v_exp_f32 v206, v206
    v_cvt_pk_bf16_f32 v190, v196, v197
    v_exp_f32 v207, v207
    v_cvt_pk_bf16_f32 v191, v198, v199
    v_exp_f32 v212, v212
    v_exp_f32 v213, v213
    v_exp_f32 v214, v214
    v_exp_f32 v215, v215
    v_pk_fma_f32 v[220:221], v[220:221], s[50:51], v[0:1] op_sel_hi:[1,1,0]
    v_pk_fma_f32 v[222:223], v[222:223], s[50:51], v[0:1] op_sel_hi:[1,1,0]
    v_pk_fma_f32 v[228:229], v[228:229], s[50:51], v[0:1] op_sel_hi:[1,1,0]
    v_pk_fma_f32 v[230:231], v[230:231], s[50:51], v[0:1] op_sel_hi:[1,1,0]
    v_exp_f32 v220, v220
    v_cvt_pk_bf16_f32 v204, v204, v205
    v_cvt_pk_bf16_f32 v205, v206, v207
    v_exp_f32 v221, v221
    v_mfma_f32_16x16x32_bf16 a[244:247], a[232:235], v[188:191], a[244:247]
    v_cvt_pk_bf16_f32 v206, v212, v213
    v_cvt_pk_bf16_f32 v207, v214, v215
    v_exp_f32 v222, v222
    v_accvgpr_read_b32 v196, a96
    v_accvgpr_read_b32 v197, a97
    v_exp_f32 v223, v223
    v_accvgpr_read_b32 v198, a98
    v_accvgpr_read_b32 v199, a99
    v_exp_f32 v228, v228
    v_accvgpr_read_b32 v212, a100
    v_accvgpr_read_b32 v213, a101
    v_exp_f32 v229, v229
    v_accvgpr_read_b32 v214, a102
    v_accvgpr_read_b32 v215, a103
    v_exp_f32 v230, v230
    v_exp_f32 v231, v231
    v_pk_fma_f32 v[236:237], v[236:237], s[50:51], v[0:1] op_sel_hi:[1,1,0]
    v_pk_fma_f32 v[238:239], v[238:239], s[50:51], v[0:1] op_sel_hi:[1,1,0]
    v_pk_fma_f32 v[244:245], v[244:245], s[50:51], v[0:1] op_sel_hi:[1,1,0]
    v_pk_fma_f32 v[246:247], v[246:247], s[50:51], v[0:1] op_sel_hi:[1,1,0]
    v_exp_f32 v236, v236
    v_cvt_pk_bf16_f32 v220, v220, v221
    v_exp_f32 v237, v237
    v_mfma_f32_16x16x32_bf16 a[244:247], a[232:235], v[204:207], a[244:247]
    v_cvt_pk_bf16_f32 v221, v222, v223
    v_exp_f32 v238, v238
    v_cvt_pk_bf16_f32 v222, v228, v229
    v_exp_f32 v239, v239
    v_cvt_pk_bf16_f32 v223, v230, v231
    v_exp_f32 v244, v244
    v_exp_f32 v245, v245
    v_exp_f32 v246, v246
    v_exp_f32 v247, v247
    v_pk_fma_f32 v[252:253], v[252:253], s[50:51], v[0:1] op_sel_hi:[1,1,0]
    v_pk_fma_f32 v[254:255], v[254:255], s[50:51], v[0:1] op_sel_hi:[1,1,0]
    v_pk_fma_f32 v[20:21], v[20:21], s[50:51], v[0:1] op_sel_hi:[1,1,0]
    v_pk_fma_f32 v[22:23], v[22:23], s[50:51], v[0:1] op_sel_hi:[1,1,0]
    v_exp_f32 v252, v252
    s_waitcnt vmcnt(38)
    v_exp_f32 v253, v253
    v_mfma_f32_16x16x32_bf16 a[244:247], a[232:235], v[220:223], a[244:247]
    s_barrier
    v_exp_f32 v254, v254
    v_cvt_pk_bf16_f32 v236, v236, v237
    v_exp_f32 v255, v255
    v_cvt_pk_bf16_f32 v237, v238, v239
    v_exp_f32 v20, v20
    v_cvt_pk_bf16_f32 v238, v244, v245
    v_exp_f32 v21, v21
    v_cvt_pk_bf16_f32 v239, v246, v247
    v_exp_f32 v22, v22
    v_exp_f32 v23, v23
    v_pk_fma_f32 v[36:37], v[36:37], s[50:51], v[0:1] op_sel_hi:[1,1,0]
    v_pk_fma_f32 v[38:39], v[38:39], s[50:51], v[0:1] op_sel_hi:[1,1,0]
    v_pk_fma_f32 v[52:53], v[52:53], s[50:51], v[0:1] op_sel_hi:[1,1,0]
    v_pk_fma_f32 v[54:55], v[54:55], s[50:51], v[0:1] op_sel_hi:[1,1,0]
    v_exp_f32 v36, v36
    v_cvt_pk_bf16_f32 v252, v252, v253
    v_exp_f32 v37, v37
    v_mfma_f32_16x16x32_bf16 a[244:247], a[232:235], v[236:239], a[244:247]
    v_cvt_pk_bf16_f32 v253, v254, v255
    v_exp_f32 v38, v38
    v_cvt_pk_bf16_f32 v254, v20, v21
    v_exp_f32 v39, v39
    v_cvt_pk_bf16_f32 v255, v22, v23
    v_exp_f32 v52, v52
    v_exp_f32 v53, v53
    v_exp_f32 v54, v54
    v_exp_f32 v55, v55
    v_pk_fma_f32 v[164:165], v[164:165], s[50:51], v[0:1] op_sel_hi:[1,1,0]
    v_pk_fma_f32 v[166:167], v[166:167], s[50:51], v[0:1] op_sel_hi:[1,1,0]
    v_pk_fma_f32 v[180:181], v[180:181], s[50:51], v[0:1] op_sel_hi:[1,1,0]
    v_pk_fma_f32 v[182:183], v[182:183], s[50:51], v[0:1] op_sel_hi:[1,1,0]
    v_exp_f32 v164, v164
    v_cvt_pk_bf16_f32 v36, v36, v37
    v_exp_f32 v165, v165
    v_mfma_f32_16x16x32_bf16 a[244:247], a[232:235], v[252:255], a[244:247]
    v_cvt_pk_bf16_f32 v37, v38, v39
    v_exp_f32 v166, v166
    v_cvt_pk_bf16_f32 v38, v52, v53
    v_exp_f32 v167, v167
    v_cvt_pk_bf16_f32 v39, v54, v55
    v_exp_f32 v180, v180
    ds_read_b64_tr_b16 a[152:153], v5 offset:32768
    v_exp_f32 v181, v181
    ds_read_b64_tr_b16 a[154:155], v5 offset:34816
    v_exp_f32 v182, v182
    ds_read_b64_tr_b16 a[156:157], v5 offset:36864
    v_exp_f32 v183, v183
    ds_read_b64_tr_b16 a[158:159], v5 offset:38912
    v_pk_fma_f32 v[196:197], v[196:197], s[50:51], v[0:1] op_sel_hi:[1,1,0]
    v_pk_fma_f32 v[198:199], v[198:199], s[50:51], v[0:1] op_sel_hi:[1,1,0]
    v_pk_fma_f32 v[212:213], v[212:213], s[50:51], v[0:1] op_sel_hi:[1,1,0]
    v_pk_fma_f32 v[214:215], v[214:215], s[50:51], v[0:1] op_sel_hi:[1,1,0]
    v_exp_f32 v196, v196
    v_cvt_pk_bf16_f32 v164, v164, v165
    v_exp_f32 v197, v197
    v_mfma_f32_16x16x32_bf16 a[244:247], a[232:235], v[36:39], a[244:247]
    v_cvt_pk_bf16_f32 v165, v166, v167
    v_exp_f32 v198, v198
    v_cvt_pk_bf16_f32 v166, v180, v181
    v_exp_f32 v199, v199
    v_cvt_pk_bf16_f32 v167, v182, v183
    v_exp_f32 v212, v212
    ds_read_b64_tr_b16 a[160:161], v5 offset:40960
    v_exp_f32 v213, v213
    ds_read_b64_tr_b16 a[162:163], v5 offset:43008
    v_exp_f32 v214, v214
    ds_read_b64_tr_b16 a[164:165], v5 offset:45056
    v_exp_f32 v215, v215
    ds_read_b64_tr_b16 a[166:167], v5 offset:47104
    v_pk_fma_f32 v[60:61], v[60:61], s[50:51], v[0:1] op_sel_hi:[1,1,0]
    v_pk_fma_f32 v[62:63], v[62:63], s[50:51], v[0:1] op_sel_hi:[1,1,0]
    v_pk_fma_f32 v[68:69], v[68:69], s[50:51], v[0:1] op_sel_hi:[1,1,0]
    v_pk_fma_f32 v[70:71], v[70:71], s[50:51], v[0:1] op_sel_hi:[1,1,0]
    v_exp_f32 v60, v60
    v_cvt_pk_bf16_f32 v196, v196, v197
    v_exp_f32 v61, v61
    v_mfma_f32_16x16x32_bf16 a[244:247], a[232:235], v[164:167], a[244:247]
    v_cvt_pk_bf16_f32 v197, v198, v199
    v_exp_f32 v62, v62
    v_cvt_pk_bf16_f32 v198, v212, v213
    v_exp_f32 v63, v63
    v_cvt_pk_bf16_f32 v199, v214, v215
    v_exp_f32 v68, v68
    ds_read_b64_tr_b16 a[168:169], v5 offset:49152
    v_exp_f32 v69, v69
    ds_read_b64_tr_b16 a[170:171], v5 offset:51200
    v_exp_f32 v70, v70
    ds_read_b64_tr_b16 a[172:173], v5 offset:53248
    v_exp_f32 v71, v71
    ds_read_b64_tr_b16 a[174:175], v5 offset:55296
    v_pk_fma_f32 v[76:77], v[76:77], s[50:51], v[0:1] op_sel_hi:[1,1,0]
    v_pk_fma_f32 v[78:79], v[78:79], s[50:51], v[0:1] op_sel_hi:[1,1,0]
    v_pk_fma_f32 v[84:85], v[84:85], s[50:51], v[0:1] op_sel_hi:[1,1,0]
    v_pk_fma_f32 v[86:87], v[86:87], s[50:51], v[0:1] op_sel_hi:[1,1,0]
    v_exp_f32 v76, v76
    v_cvt_pk_bf16_f32 v60, v60, v61
    v_exp_f32 v77, v77
    v_mfma_f32_16x16x32_bf16 a[244:247], a[232:235], v[196:199], a[244:247]
    v_cvt_pk_bf16_f32 v61, v62, v63
    v_exp_f32 v78, v78
    v_cvt_pk_bf16_f32 v62, v68, v69
    v_exp_f32 v79, v79
    v_cvt_pk_bf16_f32 v63, v70, v71
    v_exp_f32 v84, v84
    ds_read_b64_tr_b16 a[176:177], v5 offset:57344
    v_exp_f32 v85, v85
    ds_read_b64_tr_b16 a[178:179], v5 offset:59392
    v_exp_f32 v86, v86
    ds_read_b64_tr_b16 a[180:181], v5 offset:61440
    v_exp_f32 v87, v87
    ds_read_b64_tr_b16 a[182:183], v5 offset:63488
    v_cvt_pk_bf16_f32 v76, v76, v77
    v_cvt_pk_bf16_f32 v77, v78, v79
    v_cvt_pk_bf16_f32 v78, v84, v85
    v_cvt_pk_bf16_f32 v79, v86, v87
    s_waitcnt lgkmcnt(8)
    v_mfma_f32_16x16x32_bf16 v[228:231], a[152:155], v[24:27], 0
    ds_read_b64_tr_b16 a[184:185], v6 offset:32768
    v_fma_f32 v92, v92, s50, v0
    v_add_u32 v5, 65536, v5
    v_mfma_f32_16x16x32_bf16 v[228:231], a[156:159], v[32:35], v[228:231]
    ds_read_b64_tr_b16 a[186:187], v6 offset:34816
    v_fma_f32 v93, v93, s50, v0
    v_mfma_f32_16x16x32_bf16 v[228:231], a[160:163], v[40:43], v[228:231]
    ds_read_b64_tr_b16 a[188:189], v6 offset:36864
    v_exp_f32 v92, v92
    v_mfma_f32_16x16x32_bf16 v[228:231], a[164:167], v[48:51], v[228:231]
    ds_read_b64_tr_b16 a[190:191], v6 offset:38912
    v_mfma_f32_16x16x32_bf16 a[244:247], a[232:235], v[60:63], a[244:247]
    s_waitcnt lgkmcnt(4)
    v_mfma_f32_16x16x32_bf16 v[228:231], a[168:171], v[56:59], v[228:231]
    ds_read_b64_tr_b16 a[192:193], v6 offset:40960
    v_fma_f32 v94, v94, s50, v0
    v_mfma_f32_16x16x32_bf16 v[228:231], a[172:175], v[64:67], v[228:231]
    ds_read_b64_tr_b16 a[194:195], v6 offset:43008
    v_exp_f32 v93, v93
    v_mfma_f32_16x16x32_bf16 v[228:231], a[176:179], v[72:75], v[228:231]
    ds_read_b64_tr_b16 a[196:197], v6 offset:45056
    v_fma_f32 v95, v95, s50, v0
    v_mfma_f32_16x16x32_bf16 a[244:247], a[232:235], v[76:79], a[244:247]
    v_mfma_f32_16x16x32_bf16 v[228:231], a[180:183], v[80:83], v[228:231]
    ds_read_b64_tr_b16 a[198:199], v6 offset:47104
    v_exp_f32 v94, v94
    v_mfma_f32_16x16x32_bf16 v[244:247], a[152:155], v[16:19], 0
    ds_read_b64_tr_b16 a[200:201], v6 offset:49152
    v_fma_f32 v100, v100, s50, v0
    v_mfma_f32_16x16x32_bf16 v[244:247], a[156:159], v[28:31], v[244:247]
    ds_read_b64_tr_b16 a[202:203], v6 offset:51200
    v_exp_f32 v95, v95
    v_mfma_f32_16x16x32_bf16 v[244:247], a[160:163], v[44:47], v[244:247]
    ds_read_b64_tr_b16 a[204:205], v6 offset:53248
    v_fma_f32 v101, v101, s50, v0
    v_mfma_f32_16x16x32_bf16 v[244:247], a[164:167], v[152:155], v[244:247]
    ds_read_b64_tr_b16 a[206:207], v6 offset:55296
    v_exp_f32 v100, v100
    v_mfma_f32_16x16x32_bf16 v[244:247], a[168:171], v[160:163], v[244:247]
    ds_read_b64_tr_b16 a[208:209], v6 offset:57344
    v_fma_f32 v102, v102, s50, v0
    v_mfma_f32_16x16x32_bf16 v[244:247], a[172:175], v[168:171], v[244:247]
    ds_read_b64_tr_b16 a[210:211], v6 offset:59392
    v_exp_f32 v101, v101
    v_mfma_f32_16x16x32_bf16 v[244:247], a[176:179], v[176:179], v[244:247]
    ds_read_b64_tr_b16 a[212:213], v6 offset:61440
    v_fma_f32 v103, v103, s50, v0
    v_mfma_f32_16x16x32_bf16 v[244:247], a[180:183], v[184:187], v[244:247]
    ds_read_b64_tr_b16 a[214:215], v6 offset:63488
    v_exp_f32 v102, v102
    v_mfma_f32_16x16x32_bf16 v[20:23], a[152:155], v[156:159], 0
    v_exp_f32 v103, v103
    v_mfma_f32_16x16x32_bf16 v[20:23], a[156:159], v[172:175], v[20:23]
    v_cvt_pk_bf16_f32 v92, v92, v93
    v_cvt_pk_bf16_f32 v93, v94, v95
    v_mfma_f32_16x16x32_bf16 v[20:23], a[160:163], v[188:191], v[20:23]
    v_cvt_pk_bf16_f32 v94, v100, v101
    v_cvt_pk_bf16_f32 v95, v102, v103
    v_mfma_f32_16x16x32_bf16 v[20:23], a[164:167], v[204:207], v[20:23]
    v_fma_f32 v108, v108, s50, v0
    v_fma_f32 v109, v109, s50, v0
    v_mfma_f32_16x16x32_bf16 v[20:23], a[168:171], v[220:223], v[20:23]
    v_exp_f32 v108, v108
    v_mfma_f32_16x16x32_bf16 v[20:23], a[172:175], v[236:239], v[20:23]
    v_fma_f32 v110, v110, s50, v0
    v_exp_f32 v109, v109
    v_mfma_f32_16x16x32_bf16 v[20:23], a[176:179], v[252:255], v[20:23]
    v_fma_f32 v111, v111, s50, v0
    v_exp_f32 v110, v110
    v_mfma_f32_16x16x32_bf16 v[20:23], a[180:183], v[36:39], v[20:23]
    v_fma_f32 v116, v116, s50, v0
    s_waitcnt lgkmcnt(8)
    v_mfma_f32_16x16x32_bf16 v[52:55], a[184:187], v[24:27], 0
    ds_read_b64_tr_b16 a[152:153], v7 offset:32768
    v_exp_f32 v111, v111
    v_mfma_f32_16x16x32_bf16 v[52:55], a[188:191], v[32:35], v[52:55]
    ds_read_b64_tr_b16 a[154:155], v7 offset:34816
    v_fma_f32 v117, v117, s50, v0
    v_add_u32 v6, 65536, v6
    v_mfma_f32_16x16x32_bf16 v[52:55], a[192:195], v[40:43], v[52:55]
    ds_read_b64_tr_b16 a[156:157], v7 offset:36864
    v_exp_f32 v116, v116
    v_mfma_f32_16x16x32_bf16 v[52:55], a[196:199], v[48:51], v[52:55]
    ds_read_b64_tr_b16 a[158:159], v7 offset:38912
    s_waitcnt lgkmcnt(4)
    v_mfma_f32_16x16x32_bf16 v[52:55], a[200:203], v[56:59], v[52:55]
    ds_read_b64_tr_b16 a[160:161], v7 offset:40960
    v_fma_f32 v118, v118, s50, v0
    v_mfma_f32_16x16x32_bf16 v[52:55], a[204:207], v[64:67], v[52:55]
    ds_read_b64_tr_b16 a[162:163], v7 offset:43008
    v_exp_f32 v117, v117
    v_mfma_f32_16x16x32_bf16 v[52:55], a[208:211], v[72:75], v[52:55]
    ds_read_b64_tr_b16 a[164:165], v7 offset:45056
    v_fma_f32 v119, v119, s50, v0
    v_mfma_f32_16x16x32_bf16 v[52:55], a[212:215], v[80:83], v[52:55]
    ds_read_b64_tr_b16 a[166:167], v7 offset:47104
    v_exp_f32 v118, v118
    v_mfma_f32_16x16x32_bf16 v[180:183], a[184:187], v[16:19], 0
    ds_read_b64_tr_b16 a[168:169], v7 offset:49152
    v_exp_f32 v119, v119
    v_mfma_f32_16x16x32_bf16 v[180:183], a[188:191], v[28:31], v[180:183]
    ds_read_b64_tr_b16 a[170:171], v7 offset:51200
    v_cvt_pk_bf16_f32 v108, v108, v109
    v_mfma_f32_16x16x32_bf16 v[180:183], a[192:195], v[44:47], v[180:183]
    ds_read_b64_tr_b16 a[172:173], v7 offset:53248
    v_cvt_pk_bf16_f32 v109, v110, v111
    v_mfma_f32_16x16x32_bf16 v[180:183], a[196:199], v[152:155], v[180:183]
    ds_read_b64_tr_b16 a[174:175], v7 offset:55296
    v_cvt_pk_bf16_f32 v110, v116, v117
    v_mfma_f32_16x16x32_bf16 v[180:183], a[200:203], v[160:163], v[180:183]
    ds_read_b64_tr_b16 a[176:177], v7 offset:57344
    v_cvt_pk_bf16_f32 v111, v118, v119
    v_mfma_f32_16x16x32_bf16 v[180:183], a[204:207], v[168:171], v[180:183]
    ds_read_b64_tr_b16 a[178:179], v7 offset:59392
    v_fma_f32 v124, v124, s50, v0
    v_mfma_f32_16x16x32_bf16 v[180:183], a[208:211], v[176:179], v[180:183]
    ds_read_b64_tr_b16 a[180:181], v7 offset:61440
    v_fma_f32 v125, v125, s50, v0
    v_mfma_f32_16x16x32_bf16 v[180:183], a[212:215], v[184:187], v[180:183]
    ds_read_b64_tr_b16 a[182:183], v7 offset:63488
    v_exp_f32 v124, v124
    v_mfma_f32_16x16x32_bf16 v[212:215], a[184:187], v[156:159], 0
    v_fma_f32 v126, v126, s50, v0
    v_exp_f32 v125, v125
    v_mfma_f32_16x16x32_bf16 v[212:215], a[188:191], v[172:175], v[212:215]
    v_fma_f32 v127, v127, s50, v0
    v_exp_f32 v126, v126
    v_mfma_f32_16x16x32_bf16 v[212:215], a[192:195], v[188:191], v[212:215]
    v_fma_f32 v132, v132, s50, v0
    v_exp_f32 v127, v127
    v_mfma_f32_16x16x32_bf16 v[212:215], a[196:199], v[204:207], v[212:215]
    v_fma_f32 v133, v133, s50, v0
    v_exp_f32 v132, v132
    v_mfma_f32_16x16x32_bf16 v[212:215], a[200:203], v[220:223], v[212:215]
    v_fma_f32 v134, v134, s50, v0
    v_exp_f32 v133, v133
    v_mfma_f32_16x16x32_bf16 v[212:215], a[204:207], v[236:239], v[212:215]
    v_fma_f32 v135, v135, s50, v0
    v_exp_f32 v134, v134
    v_mfma_f32_16x16x32_bf16 v[212:215], a[208:211], v[252:255], v[212:215]
    v_exp_f32 v135, v135
    v_mfma_f32_16x16x32_bf16 v[212:215], a[212:215], v[36:39], v[212:215]
    v_cvt_pk_bf16_f32 v124, v124, v125
    s_waitcnt lgkmcnt(8)
    v_mfma_f32_16x16x32_bf16 v[68:71], a[152:155], v[24:27], 0
    ds_read_b64_tr_b16 a[184:185], v8 offset:32768
    v_cvt_pk_bf16_f32 v125, v126, v127
    v_add_u32 v7, 65536, v7
    v_mfma_f32_16x16x32_bf16 v[68:71], a[156:159], v[32:35], v[68:71]
    ds_read_b64_tr_b16 a[186:187], v8 offset:34816
    v_cvt_pk_bf16_f32 v126, v132, v133
    v_mfma_f32_16x16x32_bf16 v[68:71], a[160:163], v[40:43], v[68:71]
    ds_read_b64_tr_b16 a[188:189], v8 offset:36864
    v_cvt_pk_bf16_f32 v127, v134, v135
    v_mfma_f32_16x16x32_bf16 v[68:71], a[164:167], v[48:51], v[68:71]
    ds_read_b64_tr_b16 a[190:191], v8 offset:38912
    s_waitcnt lgkmcnt(4)
    v_mfma_f32_16x16x32_bf16 v[68:71], a[168:171], v[56:59], v[68:71]
    ds_read_b64_tr_b16 a[192:193], v8 offset:40960
    v_fma_f32 v140, v140, s50, v0
    v_mfma_f32_16x16x32_bf16 v[68:71], a[172:175], v[64:67], v[68:71]
    ds_read_b64_tr_b16 a[194:195], v8 offset:43008
    v_fma_f32 v141, v141, s50, v0
    v_mfma_f32_16x16x32_bf16 v[68:71], a[176:179], v[72:75], v[68:71]
    ds_read_b64_tr_b16 a[196:197], v8 offset:45056
    v_exp_f32 v140, v140
    v_mfma_f32_16x16x32_bf16 v[68:71], a[180:183], v[80:83], v[68:71]
    ds_read_b64_tr_b16 a[198:199], v8 offset:47104
    v_fma_f32 v142, v142, s50, v0
    v_mfma_f32_16x16x32_bf16 v[84:87], a[152:155], v[16:19], 0
    ds_read_b64_tr_b16 a[200:201], v8 offset:49152
    v_exp_f32 v141, v141
    v_mfma_f32_16x16x32_bf16 v[84:87], a[156:159], v[28:31], v[84:87]
    ds_read_b64_tr_b16 a[202:203], v8 offset:51200
    v_fma_f32 v143, v143, s50, v0
    v_mfma_f32_16x16x32_bf16 v[84:87], a[160:163], v[44:47], v[84:87]
    ds_read_b64_tr_b16 a[204:205], v8 offset:53248
    v_exp_f32 v142, v142
    v_mfma_f32_16x16x32_bf16 v[84:87], a[164:167], v[152:155], v[84:87]
    ds_read_b64_tr_b16 a[206:207], v8 offset:55296
    v_fma_f32 v148, v148, s50, v0
    v_mfma_f32_16x16x32_bf16 v[84:87], a[168:171], v[160:163], v[84:87]
    ds_read_b64_tr_b16 a[208:209], v8 offset:57344
    v_exp_f32 v143, v143
    v_mfma_f32_16x16x32_bf16 v[84:87], a[172:175], v[168:171], v[84:87]
    ds_read_b64_tr_b16 a[210:211], v8 offset:59392
    v_fma_f32 v149, v149, s50, v0
    v_mfma_f32_16x16x32_bf16 v[84:87], a[176:179], v[176:179], v[84:87]
    ds_read_b64_tr_b16 a[212:213], v8 offset:61440
    v_exp_f32 v148, v148
    v_mfma_f32_16x16x32_bf16 v[84:87], a[180:183], v[184:187], v[84:87]
    ds_read_b64_tr_b16 a[214:215], v8 offset:63488
    v_fma_f32 v150, v150, s50, v0
    v_mfma_f32_16x16x32_bf16 v[100:103], a[152:155], v[156:159], 0
    v_exp_f32 v149, v149
    v_mfma_f32_16x16x32_bf16 v[100:103], a[156:159], v[172:175], v[100:103]
    v_fma_f32 v151, v151, s50, v0
    v_exp_f32 v150, v150
    v_mfma_f32_16x16x32_bf16 v[100:103], a[160:163], v[188:191], v[100:103]
    v_exp_f32 v151, v151
    v_mfma_f32_16x16x32_bf16 v[100:103], a[164:167], v[204:207], v[100:103]
    v_cvt_pk_bf16_f32 v140, v140, v141
    v_cvt_pk_bf16_f32 v141, v142, v143
    v_mfma_f32_16x16x32_bf16 v[100:103], a[168:171], v[220:223], v[100:103]
    v_cvt_pk_bf16_f32 v142, v148, v149
    v_cvt_pk_bf16_f32 v143, v150, v151
    v_mfma_f32_16x16x32_bf16 v[100:103], a[172:175], v[236:239], v[100:103]
    v_mfma_f32_16x16x32_bf16 v[100:103], a[176:179], v[252:255], v[100:103]
    v_mfma_f32_16x16x32_bf16 a[244:247], a[232:235], v[92:95], a[244:247]
    v_mfma_f32_16x16x32_bf16 v[100:103], a[180:183], v[36:39], v[100:103]
    s_waitcnt lgkmcnt(8)
    v_mfma_f32_16x16x32_bf16 v[116:119], a[184:187], v[24:27], 0
    s_waitcnt vmcnt(30)
    s_barrier
    v_add_u32 v8, 65536, v8
    v_mfma_f32_16x16x32_bf16 v[116:119], a[188:191], v[32:35], v[116:119]
    ds_read_b64_tr_b16 a[152:153], v5 offset:0
    v_mfma_f32_16x16x32_bf16 a[244:247], a[232:235], v[108:111], a[244:247]
    v_mfma_f32_16x16x32_bf16 v[116:119], a[192:195], v[40:43], v[116:119]
    ds_read_b64_tr_b16 a[154:155], v5 offset:2048
    v_mfma_f32_16x16x32_bf16 v[116:119], a[196:199], v[48:51], v[116:119]
    ds_read_b64_tr_b16 a[156:157], v5 offset:4096
    s_waitcnt lgkmcnt(3)
    v_mfma_f32_16x16x32_bf16 v[116:119], a[200:203], v[56:59], v[116:119]
    ds_read_b64_tr_b16 a[158:159], v5 offset:6144
    v_mfma_f32_16x16x32_bf16 a[244:247], a[232:235], v[124:127], a[244:247]
    v_mfma_f32_16x16x32_bf16 v[116:119], a[204:207], v[64:67], v[116:119]
    ds_read_b64_tr_b16 a[160:161], v5 offset:8192
    v_mfma_f32_16x16x32_bf16 v[116:119], a[208:211], v[72:75], v[116:119]
    ds_read_b64_tr_b16 a[162:163], v5 offset:10240
    v_mfma_f32_16x16x32_bf16 v[116:119], a[212:215], v[80:83], v[116:119]
    ds_read_b64_tr_b16 a[164:165], v5 offset:12288
    v_mfma_f32_16x16x32_bf16 a[244:247], a[232:235], v[140:143], a[244:247]
    v_mfma_f32_16x16x32_bf16 v[132:135], a[184:187], v[16:19], 0
    ds_read_b64_tr_b16 a[166:167], v5 offset:14336
    v_mfma_f32_16x16x32_bf16 v[132:135], a[188:191], v[28:31], v[132:135]
    ds_read_b64_tr_b16 a[168:169], v5 offset:16384
    v_mfma_f32_16x16x32_bf16 v[132:135], a[192:195], v[44:47], v[132:135]
    ds_read_b64_tr_b16 a[170:171], v5 offset:18432
    v_mfma_f32_16x16x32_bf16 v[132:135], a[196:199], v[152:155], v[132:135]
    ds_read_b64_tr_b16 a[172:173], v5 offset:20480
    v_mfma_f32_16x16x32_bf16 v[132:135], a[200:203], v[160:163], v[132:135]
    ds_read_b64_tr_b16 a[174:175], v5 offset:22528
    v_mfma_f32_16x16x32_bf16 v[132:135], a[204:207], v[168:171], v[132:135]
    ds_read_b64_tr_b16 a[176:177], v5 offset:24576
    v_accvgpr_read_b32 v12, a236
    v_accvgpr_read_b32 v13, a240
    v_mfma_f32_16x16x32_bf16 v[132:135], a[208:211], v[176:179], v[132:135]
    ds_read_b64_tr_b16 a[178:179], v5 offset:26624
    v_accvgpr_read_b32 v14, a244
    v_mfma_f32_16x16x32_bf16 v[132:135], a[212:215], v[184:187], v[132:135]
    ds_read_b64_tr_b16 a[180:181], v5 offset:28672
    v_rcp_f32 v12, v12
    v_mfma_f32_16x16x32_bf16 v[148:151], a[184:187], v[156:159], 0
    ds_read_b64_tr_b16 a[182:183], v5 offset:30720
    v_rcp_f32 v13, v13
    v_mfma_f32_16x16x32_bf16 v[148:151], a[188:191], v[172:175], v[148:151]
    v_rcp_f32 v14, v14
    v_mfma_f32_16x16x32_bf16 v[148:151], a[192:195], v[188:191], v[148:151]
    v_mfma_f32_16x16x32_bf16 v[148:151], a[196:199], v[204:207], v[148:151]
    v_mfma_f32_16x16x32_bf16 v[148:151], a[200:203], v[220:223], v[148:151]
    v_mfma_f32_16x16x32_bf16 v[148:151], a[204:207], v[236:239], v[148:151]
    v_mfma_f32_16x16x32_bf16 v[148:151], a[208:211], v[252:255], v[148:151]
    v_mfma_f32_16x16x32_bf16 v[148:151], a[212:215], v[36:39], v[148:151]
    s_waitcnt lgkmcnt(8)
    v_mfma_f32_16x16x32_bf16 v[228:231], a[152:155], v[88:91], v[228:231]
    ds_read_b64_tr_b16 a[184:185], v6 offset:0
    v_add_u32 v5, 65536, v5
    v_mfma_f32_16x16x32_bf16 v[228:231], a[156:159], v[96:99], v[228:231]
    ds_read_b64_tr_b16 a[186:187], v6 offset:2048
    v_mfma_f32_16x16x32_bf16 v[228:231], a[160:163], v[104:107], v[228:231]
    ds_read_b64_tr_b16 a[188:189], v6 offset:4096
    v_mfma_f32_16x16x32_bf16 v[228:231], a[164:167], v[112:115], v[228:231]
    ds_read_b64_tr_b16 a[190:191], v6 offset:6144
    s_waitcnt lgkmcnt(4)
    v_mfma_f32_16x16x32_bf16 v[228:231], a[168:171], v[120:123], v[228:231]
    ds_read_b64_tr_b16 a[192:193], v6 offset:8192
    v_mfma_f32_16x16x32_bf16 v[228:231], a[172:175], v[128:131], v[228:231]
    ds_read_b64_tr_b16 a[194:195], v6 offset:10240
    v_mfma_f32_16x16x32_bf16 v[228:231], a[176:179], v[136:139], v[228:231]
    ds_read_b64_tr_b16 a[196:197], v6 offset:12288
    v_mfma_f32_16x16x32_bf16 v[228:231], a[180:183], v[144:147], v[228:231]
    ds_read_b64_tr_b16 a[198:199], v6 offset:14336
    v_mfma_f32_16x16x32_bf16 v[244:247], a[152:155], v[192:195], v[244:247]
    ds_read_b64_tr_b16 a[200:201], v6 offset:16384
    v_mfma_f32_16x16x32_bf16 v[244:247], a[156:159], v[200:203], v[244:247]
    ds_read_b64_tr_b16 a[202:203], v6 offset:18432
    v_mfma_f32_16x16x32_bf16 v[244:247], a[160:163], v[208:211], v[244:247]
    ds_read_b64_tr_b16 a[204:205], v6 offset:20480
    v_mfma_f32_16x16x32_bf16 v[244:247], a[164:167], v[216:219], v[244:247]
    ds_read_b64_tr_b16 a[206:207], v6 offset:22528
    v_mfma_f32_16x16x32_bf16 v[244:247], a[168:171], v[224:227], v[244:247]
    ds_read_b64_tr_b16 a[208:209], v6 offset:24576
    v_mul_f32 v228, v12, v228
    v_mfma_f32_16x16x32_bf16 v[244:247], a[172:175], v[232:235], v[244:247]
    ds_read_b64_tr_b16 a[210:211], v6 offset:26624
    v_mul_f32 v229, v12, v229
    v_mfma_f32_16x16x32_bf16 v[244:247], a[176:179], v[240:243], v[244:247]
    ds_read_b64_tr_b16 a[212:213], v6 offset:28672
    v_mul_f32 v230, v12, v230
    v_mfma_f32_16x16x32_bf16 v[244:247], a[180:183], v[248:251], v[244:247]
    ds_read_b64_tr_b16 a[214:215], v6 offset:30720
    v_mul_f32 v231, v12, v231
    v_mfma_f32_16x16x32_bf16 v[20:23], a[152:155], v[164:167], v[20:23]
    v_cvt_pk_bf16_f32 v228, v228, v229
    v_cvt_pk_bf16_f32 v229, v230, v231
    v_mfma_f32_16x16x32_bf16 v[20:23], a[156:159], v[196:199], v[20:23]
    v_mfma_f32_16x16x32_bf16 v[20:23], a[160:163], v[60:63], v[20:23]
    v_mfma_f32_16x16x32_bf16 v[20:23], a[164:167], v[76:79], v[20:23]
    v_mfma_f32_16x16x32_bf16 v[20:23], a[168:171], v[92:95], v[20:23]
    v_mul_f32 v244, v13, v244
    v_mul_f32 v245, v13, v245
    v_mfma_f32_16x16x32_bf16 v[20:23], a[172:175], v[108:111], v[20:23]
    v_mul_f32 v246, v13, v246
    v_mul_f32 v247, v13, v247
    v_mfma_f32_16x16x32_bf16 v[20:23], a[176:179], v[124:127], v[20:23]
    v_cvt_pk_bf16_f32 v244, v244, v245
    v_cvt_pk_bf16_f32 v245, v246, v247
    v_mfma_f32_16x16x32_bf16 v[20:23], a[180:183], v[140:143], v[20:23]
    s_waitcnt lgkmcnt(8)
    v_mfma_f32_16x16x32_bf16 v[52:55], a[184:187], v[88:91], v[52:55]
    ds_read_b64_tr_b16 a[152:153], v7 offset:0
    v_add_u32 v6, 65536, v6
    v_mfma_f32_16x16x32_bf16 v[52:55], a[188:191], v[96:99], v[52:55]
    ds_read_b64_tr_b16 a[154:155], v7 offset:2048
    v_mfma_f32_16x16x32_bf16 v[52:55], a[192:195], v[104:107], v[52:55]
    ds_read_b64_tr_b16 a[156:157], v7 offset:4096
    v_mfma_f32_16x16x32_bf16 v[52:55], a[196:199], v[112:115], v[52:55]
    ds_read_b64_tr_b16 a[158:159], v7 offset:6144
    s_waitcnt lgkmcnt(4)
    v_mfma_f32_16x16x32_bf16 v[52:55], a[200:203], v[120:123], v[52:55]
    ds_read_b64_tr_b16 a[160:161], v7 offset:8192
    v_mul_f32 v20, v14, v20
    v_mfma_f32_16x16x32_bf16 v[52:55], a[204:207], v[128:131], v[52:55]
    ds_read_b64_tr_b16 a[162:163], v7 offset:10240
    v_mul_f32 v21, v14, v21
    v_mfma_f32_16x16x32_bf16 v[52:55], a[208:211], v[136:139], v[52:55]
    ds_read_b64_tr_b16 a[164:165], v7 offset:12288
    v_mul_f32 v22, v14, v22
    v_mfma_f32_16x16x32_bf16 v[52:55], a[212:215], v[144:147], v[52:55]
    ds_read_b64_tr_b16 a[166:167], v7 offset:14336
    v_mul_f32 v23, v14, v23
    v_mfma_f32_16x16x32_bf16 v[180:183], a[184:187], v[192:195], v[180:183]
    ds_read_b64_tr_b16 a[168:169], v7 offset:16384
    v_cvt_pk_bf16_f32 v20, v20, v21
    v_mfma_f32_16x16x32_bf16 v[180:183], a[188:191], v[200:203], v[180:183]
    ds_read_b64_tr_b16 a[170:171], v7 offset:18432
    v_cvt_pk_bf16_f32 v21, v22, v23
    v_mfma_f32_16x16x32_bf16 v[180:183], a[192:195], v[208:211], v[180:183]
    ds_read_b64_tr_b16 a[172:173], v7 offset:20480
    v_mfma_f32_16x16x32_bf16 v[180:183], a[196:199], v[216:219], v[180:183]
    ds_read_b64_tr_b16 a[174:175], v7 offset:22528
    v_mfma_f32_16x16x32_bf16 v[180:183], a[200:203], v[224:227], v[180:183]
    ds_read_b64_tr_b16 a[176:177], v7 offset:24576
    v_mul_f32 v52, v12, v52
    v_mfma_f32_16x16x32_bf16 v[180:183], a[204:207], v[232:235], v[180:183]
    ds_read_b64_tr_b16 a[178:179], v7 offset:26624
    v_mul_f32 v53, v12, v53
    v_mfma_f32_16x16x32_bf16 v[180:183], a[208:211], v[240:243], v[180:183]
    ds_read_b64_tr_b16 a[180:181], v7 offset:28672
    v_mul_f32 v54, v12, v54
    v_mfma_f32_16x16x32_bf16 v[180:183], a[212:215], v[248:251], v[180:183]
    ds_read_b64_tr_b16 a[182:183], v7 offset:30720
    v_mul_f32 v55, v12, v55
    v_mfma_f32_16x16x32_bf16 v[212:215], a[184:187], v[164:167], v[212:215]
    v_cvt_pk_bf16_f32 v230, v52, v53
    v_cvt_pk_bf16_f32 v231, v54, v55
    v_mfma_f32_16x16x32_bf16 v[212:215], a[188:191], v[196:199], v[212:215]
    v_permlane16_swap_b32 v228, v230
    v_permlane16_swap_b32 v229, v231
    v_mfma_f32_16x16x32_bf16 v[212:215], a[192:195], v[60:63], v[212:215]
    buffer_store_dwordx4 v[228:231], v9, s[32:35], s92 offen offset:0 sc1 nt
    v_mfma_f32_16x16x32_bf16 v[212:215], a[196:199], v[76:79], v[212:215]
    v_mfma_f32_16x16x32_bf16 v[212:215], a[200:203], v[92:95], v[212:215]
    v_mul_f32 v180, v13, v180
    v_mul_f32 v181, v13, v181
    v_mfma_f32_16x16x32_bf16 v[212:215], a[204:207], v[108:111], v[212:215]
    v_mul_f32 v182, v13, v182
    v_mul_f32 v183, v13, v183
    v_mfma_f32_16x16x32_bf16 v[212:215], a[208:211], v[124:127], v[212:215]
    v_cvt_pk_bf16_f32 v246, v180, v181
    v_cvt_pk_bf16_f32 v247, v182, v183
    v_mfma_f32_16x16x32_bf16 v[212:215], a[212:215], v[140:143], v[212:215]
    v_permlane16_swap_b32 v244, v246
    s_waitcnt lgkmcnt(8)
    v_mfma_f32_16x16x32_bf16 v[68:71], a[152:155], v[88:91], v[68:71]
    ds_read_b64_tr_b16 a[184:185], v8 offset:0
    v_add_u32 v7, 65536, v7
    v_mfma_f32_16x16x32_bf16 v[68:71], a[156:159], v[96:99], v[68:71]
    ds_read_b64_tr_b16 a[186:187], v8 offset:2048
    v_permlane16_swap_b32 v245, v247
    v_mfma_f32_16x16x32_bf16 v[68:71], a[160:163], v[104:107], v[68:71]
    ds_read_b64_tr_b16 a[188:189], v8 offset:4096
    v_mfma_f32_16x16x32_bf16 v[68:71], a[164:167], v[112:115], v[68:71]
    ds_read_b64_tr_b16 a[190:191], v8 offset:6144
    s_waitcnt lgkmcnt(4)
    v_mfma_f32_16x16x32_bf16 v[68:71], a[168:171], v[120:123], v[68:71]
    ds_read_b64_tr_b16 a[192:193], v8 offset:8192
    v_mfma_f32_16x16x32_bf16 v[68:71], a[172:175], v[128:131], v[68:71]
    ds_read_b64_tr_b16 a[194:195], v8 offset:10240
    v_mfma_f32_16x16x32_bf16 v[68:71], a[176:179], v[136:139], v[68:71]
    ds_read_b64_tr_b16 a[196:197], v8 offset:12288
    v_mfma_f32_16x16x32_bf16 v[68:71], a[180:183], v[144:147], v[68:71]
    ds_read_b64_tr_b16 a[198:199], v8 offset:14336
    v_mfma_f32_16x16x32_bf16 v[84:87], a[152:155], v[192:195], v[84:87]
    ds_read_b64_tr_b16 a[200:201], v8 offset:16384
    v_mfma_f32_16x16x32_bf16 v[84:87], a[156:159], v[200:203], v[84:87]
    ds_read_b64_tr_b16 a[202:203], v8 offset:18432
    v_mfma_f32_16x16x32_bf16 v[84:87], a[160:163], v[208:211], v[84:87]
    ds_read_b64_tr_b16 a[204:205], v8 offset:20480
    v_mfma_f32_16x16x32_bf16 v[84:87], a[164:167], v[216:219], v[84:87]
    ds_read_b64_tr_b16 a[206:207], v8 offset:22528
    v_mfma_f32_16x16x32_bf16 v[84:87], a[168:171], v[224:227], v[84:87]
    ds_read_b64_tr_b16 a[208:209], v8 offset:24576
    v_mfma_f32_16x16x32_bf16 v[84:87], a[172:175], v[232:235], v[84:87]
    ds_read_b64_tr_b16 a[210:211], v8 offset:26624
    v_mfma_f32_16x16x32_bf16 v[84:87], a[176:179], v[240:243], v[84:87]
    ds_read_b64_tr_b16 a[212:213], v8 offset:28672
    v_mfma_f32_16x16x32_bf16 v[84:87], a[180:183], v[248:251], v[84:87]
    ds_read_b64_tr_b16 a[214:215], v8 offset:30720
    v_mfma_f32_16x16x32_bf16 v[100:103], a[152:155], v[164:167], v[100:103]
    buffer_store_dwordx4 v[244:247], v10, s[32:35], s92 offen offset:0 sc1 nt
    v_mfma_f32_16x16x32_bf16 v[100:103], a[156:159], v[196:199], v[100:103]
    v_mul_f32 v212, v14, v212
    v_mul_f32 v213, v14, v213
    v_mfma_f32_16x16x32_bf16 v[100:103], a[160:163], v[60:63], v[100:103]
    v_mul_f32 v214, v14, v214
    v_mul_f32 v215, v14, v215
    v_mfma_f32_16x16x32_bf16 v[100:103], a[164:167], v[76:79], v[100:103]
    v_cvt_pk_bf16_f32 v22, v212, v213
    v_cvt_pk_bf16_f32 v23, v214, v215
    v_mfma_f32_16x16x32_bf16 v[100:103], a[168:171], v[92:95], v[100:103]
    v_permlane16_swap_b32 v20, v22
    v_permlane16_swap_b32 v21, v23
    v_mfma_f32_16x16x32_bf16 v[100:103], a[172:175], v[108:111], v[100:103]
    buffer_store_dwordx4 v[20:23], v11, s[32:35], s92 offen offset:0 sc1 nt
    v_mfma_f32_16x16x32_bf16 v[100:103], a[176:179], v[124:127], v[100:103]
    v_mul_f32 v68, v12, v68
    v_mul_f32 v69, v12, v69
    v_mfma_f32_16x16x32_bf16 v[100:103], a[180:183], v[140:143], v[100:103]
    v_mul_f32 v70, v12, v70
    s_waitcnt lgkmcnt(8)
    v_mfma_f32_16x16x32_bf16 v[116:119], a[184:187], v[88:91], v[116:119]
    s_waitcnt vmcnt(25)
    s_barrier
    v_add_u32 v8, 65536, v8
    v_mfma_f32_16x16x32_bf16 v[116:119], a[188:191], v[96:99], v[116:119]
    ds_read_b64_tr_b16 a[152:153], v5 offset:0
    s_add_u32 m0, s36, 32768
    v_mfma_f32_16x16x32_bf16 v[116:119], a[192:195], v[104:107], v[116:119]
    ds_read_b64_tr_b16 a[154:155], v5 offset:2048
    s_add_u32 s48, s38, 131328
    v_mfma_f32_16x16x32_bf16 v[116:119], a[196:199], v[112:115], v[116:119]
    ds_read_b64_tr_b16 a[156:157], v5 offset:4096
    s_waitcnt lgkmcnt(3)
    v_mfma_f32_16x16x32_bf16 v[116:119], a[200:203], v[120:123], v[116:119]
    ds_read_b64_tr_b16 a[158:159], v5 offset:6144
    buffer_load_dwordx4 v1, s[28:31], s48 offen offset:0 lds
    v_mfma_f32_16x16x32_bf16 v[116:119], a[204:207], v[128:131], v[116:119]
    ds_read_b64_tr_b16 a[160:161], v5 offset:8192
    v_mul_f32 v71, v12, v71
    v_mfma_f32_16x16x32_bf16 v[116:119], a[208:211], v[136:139], v[116:119]
    ds_read_b64_tr_b16 a[162:163], v5 offset:10240
    v_cvt_pk_bf16_f32 v68, v68, v69
    v_mfma_f32_16x16x32_bf16 v[116:119], a[212:215], v[144:147], v[116:119]
    ds_read_b64_tr_b16 a[164:165], v5 offset:12288
    v_cvt_pk_bf16_f32 v69, v70, v71
    v_mfma_f32_16x16x32_bf16 v[132:135], a[184:187], v[192:195], v[132:135]
    ds_read_b64_tr_b16 a[166:167], v5 offset:14336
    v_mul_f32 v84, v13, v84
    v_mfma_f32_16x16x32_bf16 v[132:135], a[188:191], v[200:203], v[132:135]
    ds_read_b64_tr_b16 a[168:169], v5 offset:16384
    v_mul_f32 v85, v13, v85
    v_mfma_f32_16x16x32_bf16 v[132:135], a[192:195], v[208:211], v[132:135]
    ds_read_b64_tr_b16 a[170:171], v5 offset:18432
    v_mul_f32 v86, v13, v86
    v_mfma_f32_16x16x32_bf16 v[132:135], a[196:199], v[216:219], v[132:135]
    ds_read_b64_tr_b16 a[172:173], v5 offset:20480
    v_mul_f32 v87, v13, v87
    v_mfma_f32_16x16x32_bf16 v[132:135], a[200:203], v[224:227], v[132:135]
    ds_read_b64_tr_b16 a[174:175], v5 offset:22528
    v_cvt_pk_bf16_f32 v84, v84, v85
    v_mfma_f32_16x16x32_bf16 v[132:135], a[204:207], v[232:235], v[132:135]
    ds_read_b64_tr_b16 a[176:177], v5 offset:24576
    v_cvt_pk_bf16_f32 v85, v86, v87
    v_mfma_f32_16x16x32_bf16 v[132:135], a[208:211], v[240:243], v[132:135]
    ds_read_b64_tr_b16 a[178:179], v5 offset:26624
    buffer_load_dwordx4 v2, s[28:31], s48 offen offset:1024 lds
    v_mfma_f32_16x16x32_bf16 v[132:135], a[212:215], v[248:251], v[132:135]
    ds_read_b64_tr_b16 a[180:181], v5 offset:28672
    v_mul_f32 v100, v14, v100
    v_mfma_f32_16x16x32_bf16 v[148:151], a[184:187], v[164:167], v[148:151]
    ds_read_b64_tr_b16 a[182:183], v5 offset:30720
    v_mul_f32 v101, v14, v101
    v_mfma_f32_16x16x32_bf16 v[148:151], a[188:191], v[196:199], v[148:151]
    v_mul_f32 v102, v14, v102
    v_mul_f32 v103, v14, v103
    v_mfma_f32_16x16x32_bf16 v[148:151], a[192:195], v[60:63], v[148:151]
    v_cvt_pk_bf16_f32 v100, v100, v101
    v_cvt_pk_bf16_f32 v101, v102, v103
    v_mfma_f32_16x16x32_bf16 v[148:151], a[196:199], v[76:79], v[148:151]
    v_mul_f32 v116, v12, v116
    v_mul_f32 v117, v12, v117
    v_mfma_f32_16x16x32_bf16 v[148:151], a[200:203], v[92:95], v[148:151]
    v_mul_f32 v118, v12, v118
    v_mul_f32 v119, v12, v119
    v_mfma_f32_16x16x32_bf16 v[148:151], a[204:207], v[108:111], v[148:151]
    v_cvt_pk_bf16_f32 v70, v116, v117
    v_cvt_pk_bf16_f32 v71, v118, v119
    v_mfma_f32_16x16x32_bf16 v[148:151], a[208:211], v[124:127], v[148:151]
    v_permlane16_swap_b32 v68, v70
    v_permlane16_swap_b32 v69, v71
    v_mfma_f32_16x16x32_bf16 v[148:151], a[212:215], v[140:143], v[148:151]
    s_waitcnt lgkmcnt(8)
    v_mfma_f32_16x16x32_bf16 v[228:231], a[152:155], v[24:27], 0
    ds_read_b64_tr_b16 a[184:185], v6 offset:0
    v_add_u32 v5, 4294901760, v5
    v_mfma_f32_16x16x32_bf16 v[228:231], a[156:159], v[32:35], v[228:231]
    ds_read_b64_tr_b16 a[186:187], v6 offset:2048
    buffer_load_dwordx4 v3, s[28:31], s48 offen offset:2048 lds
    v_mfma_f32_16x16x32_bf16 v[228:231], a[160:163], v[40:43], v[228:231]
    ds_read_b64_tr_b16 a[188:189], v6 offset:4096
    v_mfma_f32_16x16x32_bf16 v[228:231], a[164:167], v[48:51], v[228:231]
    ds_read_b64_tr_b16 a[190:191], v6 offset:6144
    s_waitcnt lgkmcnt(4)
    v_mfma_f32_16x16x32_bf16 v[228:231], a[168:171], v[56:59], v[228:231]
    ds_read_b64_tr_b16 a[192:193], v6 offset:8192
    v_mfma_f32_16x16x32_bf16 v[228:231], a[172:175], v[64:67], v[228:231]
    ds_read_b64_tr_b16 a[194:195], v6 offset:10240
    v_mfma_f32_16x16x32_bf16 v[228:231], a[176:179], v[72:75], v[228:231]
    ds_read_b64_tr_b16 a[196:197], v6 offset:12288
    v_mfma_f32_16x16x32_bf16 v[228:231], a[180:183], v[80:83], v[228:231]
    ds_read_b64_tr_b16 a[198:199], v6 offset:14336
    v_mfma_f32_16x16x32_bf16 v[244:247], a[152:155], v[16:19], 0
    ds_read_b64_tr_b16 a[200:201], v6 offset:16384
    v_mfma_f32_16x16x32_bf16 v[244:247], a[156:159], v[28:31], v[244:247]
    ds_read_b64_tr_b16 a[202:203], v6 offset:18432
    v_mfma_f32_16x16x32_bf16 v[244:247], a[160:163], v[44:47], v[244:247]
    ds_read_b64_tr_b16 a[204:205], v6 offset:20480
    v_mfma_f32_16x16x32_bf16 v[244:247], a[164:167], v[152:155], v[244:247]
    ds_read_b64_tr_b16 a[206:207], v6 offset:22528
    buffer_load_dwordx4 v4, s[28:31], s48 offen offset:3072 lds
    v_mfma_f32_16x16x32_bf16 v[244:247], a[168:171], v[160:163], v[244:247]
    ds_read_b64_tr_b16 a[208:209], v6 offset:24576
    v_mfma_f32_16x16x32_bf16 v[244:247], a[172:175], v[168:171], v[244:247]
    ds_read_b64_tr_b16 a[210:211], v6 offset:26624
    v_mfma_f32_16x16x32_bf16 v[244:247], a[176:179], v[176:179], v[244:247]
    ds_read_b64_tr_b16 a[212:213], v6 offset:28672
    v_mfma_f32_16x16x32_bf16 v[244:247], a[180:183], v[184:187], v[244:247]
    ds_read_b64_tr_b16 a[214:215], v6 offset:30720
    v_mfma_f32_16x16x32_bf16 v[20:23], a[152:155], v[156:159], 0
    buffer_store_dwordx4 v[68:71], v9, s[32:35], s92 offen offset:64 sc1 nt
    v_mfma_f32_16x16x32_bf16 v[20:23], a[156:159], v[172:175], v[20:23]
    v_mul_f32 v132, v13, v132
    v_mul_f32 v133, v13, v133
    v_mfma_f32_16x16x32_bf16 v[20:23], a[160:163], v[188:191], v[20:23]
    v_mul_f32 v134, v13, v134
    v_mul_f32 v135, v13, v135
    v_mfma_f32_16x16x32_bf16 v[20:23], a[164:167], v[204:207], v[20:23]
    v_cvt_pk_bf16_f32 v86, v132, v133
    v_cvt_pk_bf16_f32 v87, v134, v135
    v_mfma_f32_16x16x32_bf16 v[20:23], a[168:171], v[220:223], v[20:23]
    v_permlane16_swap_b32 v84, v86
    v_permlane16_swap_b32 v85, v87
    v_mfma_f32_16x16x32_bf16 v[20:23], a[172:175], v[236:239], v[20:23]
    s_add_u32 m0, s36, 49152
    s_add_u32 s48, s38, 196864
    v_mfma_f32_16x16x32_bf16 v[20:23], a[176:179], v[252:255], v[20:23]
    buffer_load_dwordx4 v1, s[28:31], s48 offen offset:0 lds
    v_mfma_f32_16x16x32_bf16 v[20:23], a[180:183], v[36:39], v[20:23]
    s_waitcnt lgkmcnt(8)
    v_mfma_f32_16x16x32_bf16 v[52:55], a[184:187], v[24:27], 0
    ds_read_b64_tr_b16 a[152:153], v7 offset:0
    v_add_u32 v6, 4294901760, v6
    v_mfma_f32_16x16x32_bf16 v[52:55], a[188:191], v[32:35], v[52:55]
    ds_read_b64_tr_b16 a[154:155], v7 offset:2048
    v_mfma_f32_16x16x32_bf16 v[52:55], a[192:195], v[40:43], v[52:55]
    ds_read_b64_tr_b16 a[156:157], v7 offset:4096
    v_mfma_f32_16x16x32_bf16 v[52:55], a[196:199], v[48:51], v[52:55]
    ds_read_b64_tr_b16 a[158:159], v7 offset:6144
    s_waitcnt lgkmcnt(4)
    v_mfma_f32_16x16x32_bf16 v[52:55], a[200:203], v[56:59], v[52:55]
    ds_read_b64_tr_b16 a[160:161], v7 offset:8192
    v_mfma_f32_16x16x32_bf16 v[52:55], a[204:207], v[64:67], v[52:55]
    ds_read_b64_tr_b16 a[162:163], v7 offset:10240
    v_mfma_f32_16x16x32_bf16 v[52:55], a[208:211], v[72:75], v[52:55]
    ds_read_b64_tr_b16 a[164:165], v7 offset:12288
    v_mfma_f32_16x16x32_bf16 v[52:55], a[212:215], v[80:83], v[52:55]
    ds_read_b64_tr_b16 a[166:167], v7 offset:14336
    v_mfma_f32_16x16x32_bf16 v[180:183], a[184:187], v[16:19], 0
    ds_read_b64_tr_b16 a[168:169], v7 offset:16384
    buffer_load_dwordx4 v2, s[28:31], s48 offen offset:1024 lds
    v_mfma_f32_16x16x32_bf16 v[180:183], a[188:191], v[28:31], v[180:183]
    ds_read_b64_tr_b16 a[170:171], v7 offset:18432
    v_mfma_f32_16x16x32_bf16 v[180:183], a[192:195], v[44:47], v[180:183]
    ds_read_b64_tr_b16 a[172:173], v7 offset:20480
    v_mfma_f32_16x16x32_bf16 v[180:183], a[196:199], v[152:155], v[180:183]
    ds_read_b64_tr_b16 a[174:175], v7 offset:22528
    v_mfma_f32_16x16x32_bf16 v[180:183], a[200:203], v[160:163], v[180:183]
    ds_read_b64_tr_b16 a[176:177], v7 offset:24576
    v_mfma_f32_16x16x32_bf16 v[180:183], a[204:207], v[168:171], v[180:183]
    ds_read_b64_tr_b16 a[178:179], v7 offset:26624
    v_mfma_f32_16x16x32_bf16 v[180:183], a[208:211], v[176:179], v[180:183]
    ds_read_b64_tr_b16 a[180:181], v7 offset:28672
    v_mfma_f32_16x16x32_bf16 v[180:183], a[212:215], v[184:187], v[180:183]
    ds_read_b64_tr_b16 a[182:183], v7 offset:30720
    v_mfma_f32_16x16x32_bf16 v[212:215], a[184:187], v[156:159], 0
    buffer_store_dwordx4 v[84:87], v10, s[32:35], s92 offen offset:64 sc1 nt
    v_mfma_f32_16x16x32_bf16 v[212:215], a[188:191], v[172:175], v[212:215]
    v_mul_f32 v148, v14, v148
    v_mul_f32 v149, v14, v149
    v_mfma_f32_16x16x32_bf16 v[212:215], a[192:195], v[188:191], v[212:215]
    buffer_load_dwordx4 v3, s[28:31], s48 offen offset:2048 lds
    v_mul_f32 v150, v14, v150
    v_mfma_f32_16x16x32_bf16 v[212:215], a[196:199], v[204:207], v[212:215]
    v_mul_f32 v151, v14, v151
    v_cvt_pk_bf16_f32 v102, v148, v149
    v_mfma_f32_16x16x32_bf16 v[212:215], a[200:203], v[220:223], v[212:215]
    v_cvt_pk_bf16_f32 v103, v150, v151
    v_mfma_f32_16x16x32_bf16 v[212:215], a[204:207], v[236:239], v[212:215]
    v_permlane16_swap_b32 v100, v102
    v_permlane16_swap_b32 v101, v103
    v_mfma_f32_16x16x32_bf16 v[212:215], a[208:211], v[252:255], v[212:215]
    buffer_store_dwordx4 v[100:103], v11, s[32:35], s92 offen offset:64 sc1 nt
    v_mfma_f32_16x16x32_bf16 v[212:215], a[212:215], v[36:39], v[212:215]
    s_waitcnt lgkmcnt(8)
    v_mfma_f32_16x16x32_bf16 v[68:71], a[152:155], v[24:27], 0
    ds_read_b64_tr_b16 a[184:185], v8 offset:0
    v_add_u32 v7, 4294901760, v7
    v_mfma_f32_16x16x32_bf16 v[68:71], a[156:159], v[32:35], v[68:71]
    ds_read_b64_tr_b16 a[186:187], v8 offset:2048
    v_mfma_f32_16x16x32_bf16 v[68:71], a[160:163], v[40:43], v[68:71]
    ds_read_b64_tr_b16 a[188:189], v8 offset:4096
    v_mfma_f32_16x16x32_bf16 v[68:71], a[164:167], v[48:51], v[68:71]
    ds_read_b64_tr_b16 a[190:191], v8 offset:6144
    s_waitcnt lgkmcnt(4)
    v_mfma_f32_16x16x32_bf16 v[68:71], a[168:171], v[56:59], v[68:71]
    ds_read_b64_tr_b16 a[192:193], v8 offset:8192
    buffer_load_dwordx4 v4, s[28:31], s48 offen offset:3072 lds
    v_mfma_f32_16x16x32_bf16 v[68:71], a[172:175], v[64:67], v[68:71]
    ds_read_b64_tr_b16 a[194:195], v8 offset:10240
    v_mfma_f32_16x16x32_bf16 v[68:71], a[176:179], v[72:75], v[68:71]
    ds_read_b64_tr_b16 a[196:197], v8 offset:12288
    v_mfma_f32_16x16x32_bf16 v[68:71], a[180:183], v[80:83], v[68:71]
    ds_read_b64_tr_b16 a[198:199], v8 offset:14336
    v_mfma_f32_16x16x32_bf16 v[84:87], a[152:155], v[16:19], 0
    ds_read_b64_tr_b16 a[200:201], v8 offset:16384
    v_mfma_f32_16x16x32_bf16 v[84:87], a[156:159], v[28:31], v[84:87]
    ds_read_b64_tr_b16 a[202:203], v8 offset:18432
    v_mfma_f32_16x16x32_bf16 v[84:87], a[160:163], v[44:47], v[84:87]
    ds_read_b64_tr_b16 a[204:205], v8 offset:20480
    v_mfma_f32_16x16x32_bf16 v[84:87], a[164:167], v[152:155], v[84:87]
    ds_read_b64_tr_b16 a[206:207], v8 offset:22528
    v_mfma_f32_16x16x32_bf16 v[84:87], a[168:171], v[160:163], v[84:87]
    ds_read_b64_tr_b16 a[208:209], v8 offset:24576
    v_mfma_f32_16x16x32_bf16 v[84:87], a[172:175], v[168:171], v[84:87]
    ds_read_b64_tr_b16 a[210:211], v8 offset:26624
    v_mfma_f32_16x16x32_bf16 v[84:87], a[176:179], v[176:179], v[84:87]
    ds_read_b64_tr_b16 a[212:213], v8 offset:28672
    v_mfma_f32_16x16x32_bf16 v[84:87], a[180:183], v[184:187], v[84:87]
    ds_read_b64_tr_b16 a[214:215], v8 offset:30720
    v_mfma_f32_16x16x32_bf16 v[100:103], a[152:155], v[156:159], 0
    v_mfma_f32_16x16x32_bf16 v[100:103], a[156:159], v[172:175], v[100:103]
    v_mfma_f32_16x16x32_bf16 v[100:103], a[160:163], v[188:191], v[100:103]
    v_mfma_f32_16x16x32_bf16 v[100:103], a[164:167], v[204:207], v[100:103]
    v_mfma_f32_16x16x32_bf16 v[100:103], a[168:171], v[220:223], v[100:103]
    v_mfma_f32_16x16x32_bf16 v[100:103], a[172:175], v[236:239], v[100:103]
    v_mfma_f32_16x16x32_bf16 v[100:103], a[176:179], v[252:255], v[100:103]
    v_mfma_f32_16x16x32_bf16 v[100:103], a[180:183], v[36:39], v[100:103]
    s_waitcnt lgkmcnt(8)
    v_mfma_f32_16x16x32_bf16 v[116:119], a[184:187], v[24:27], 0
    s_waitcnt vmcnt(28)
    s_barrier
    v_add_u32 v8, 4294901760, v8
    v_mfma_f32_16x16x32_bf16 v[116:119], a[188:191], v[32:35], v[116:119]
    ds_read_b64_tr_b16 a[152:153], v5 offset:32768
    s_add_u32 m0, s36, 65536
    v_mfma_f32_16x16x32_bf16 v[116:119], a[192:195], v[40:43], v[116:119]
    ds_read_b64_tr_b16 a[154:155], v5 offset:34816
    s_add_u32 s48, s38, 384
    v_mfma_f32_16x16x32_bf16 v[116:119], a[196:199], v[48:51], v[116:119]
    ds_read_b64_tr_b16 a[156:157], v5 offset:36864
    s_waitcnt lgkmcnt(3)
    v_mfma_f32_16x16x32_bf16 v[116:119], a[200:203], v[56:59], v[116:119]
    ds_read_b64_tr_b16 a[158:159], v5 offset:38912
    buffer_load_dwordx4 v1, s[28:31], s48 offen offset:0 lds
    v_mfma_f32_16x16x32_bf16 v[116:119], a[204:207], v[64:67], v[116:119]
    ds_read_b64_tr_b16 a[160:161], v5 offset:40960
    v_mfma_f32_16x16x32_bf16 v[116:119], a[208:211], v[72:75], v[116:119]
    ds_read_b64_tr_b16 a[162:163], v5 offset:43008
    v_mfma_f32_16x16x32_bf16 v[116:119], a[212:215], v[80:83], v[116:119]
    ds_read_b64_tr_b16 a[164:165], v5 offset:45056
    v_mfma_f32_16x16x32_bf16 v[132:135], a[184:187], v[16:19], 0
    ds_read_b64_tr_b16 a[166:167], v5 offset:47104
    v_mfma_f32_16x16x32_bf16 v[132:135], a[188:191], v[28:31], v[132:135]
    ds_read_b64_tr_b16 a[168:169], v5 offset:49152
    v_mfma_f32_16x16x32_bf16 v[132:135], a[192:195], v[44:47], v[132:135]
    ds_read_b64_tr_b16 a[170:171], v5 offset:51200
    v_mfma_f32_16x16x32_bf16 v[132:135], a[196:199], v[152:155], v[132:135]
    ds_read_b64_tr_b16 a[172:173], v5 offset:53248
    v_mfma_f32_16x16x32_bf16 v[132:135], a[200:203], v[160:163], v[132:135]
    ds_read_b64_tr_b16 a[174:175], v5 offset:55296
    v_mfma_f32_16x16x32_bf16 v[132:135], a[204:207], v[168:171], v[132:135]
    ds_read_b64_tr_b16 a[176:177], v5 offset:57344
    v_mfma_f32_16x16x32_bf16 v[132:135], a[208:211], v[176:179], v[132:135]
    ds_read_b64_tr_b16 a[178:179], v5 offset:59392
    buffer_load_dwordx4 v2, s[28:31], s48 offen offset:1024 lds
    v_mfma_f32_16x16x32_bf16 v[132:135], a[212:215], v[184:187], v[132:135]
    ds_read_b64_tr_b16 a[180:181], v5 offset:61440
    v_mfma_f32_16x16x32_bf16 v[148:151], a[184:187], v[156:159], 0
    ds_read_b64_tr_b16 a[182:183], v5 offset:63488
    v_mfma_f32_16x16x32_bf16 v[148:151], a[188:191], v[172:175], v[148:151]
    v_mfma_f32_16x16x32_bf16 v[148:151], a[192:195], v[188:191], v[148:151]
    v_mfma_f32_16x16x32_bf16 v[148:151], a[196:199], v[204:207], v[148:151]
    v_mfma_f32_16x16x32_bf16 v[148:151], a[200:203], v[220:223], v[148:151]
    v_mfma_f32_16x16x32_bf16 v[148:151], a[204:207], v[236:239], v[148:151]
    v_mfma_f32_16x16x32_bf16 v[148:151], a[208:211], v[252:255], v[148:151]
    v_mfma_f32_16x16x32_bf16 v[148:151], a[212:215], v[36:39], v[148:151]
    s_waitcnt lgkmcnt(8)
    v_mfma_f32_16x16x32_bf16 v[228:231], a[152:155], v[88:91], v[228:231]
    ds_read_b64_tr_b16 a[184:185], v6 offset:32768
    v_add_u32 v5, 4294901760, v5
    v_mfma_f32_16x16x32_bf16 v[228:231], a[156:159], v[96:99], v[228:231]
    ds_read_b64_tr_b16 a[186:187], v6 offset:34816
    buffer_load_dwordx4 v3, s[28:31], s48 offen offset:2048 lds
    v_mfma_f32_16x16x32_bf16 v[228:231], a[160:163], v[104:107], v[228:231]
    ds_read_b64_tr_b16 a[188:189], v6 offset:36864
    v_mfma_f32_16x16x32_bf16 v[228:231], a[164:167], v[112:115], v[228:231]
    ds_read_b64_tr_b16 a[190:191], v6 offset:38912
    s_waitcnt lgkmcnt(4)
    v_mfma_f32_16x16x32_bf16 v[228:231], a[168:171], v[120:123], v[228:231]
    ds_read_b64_tr_b16 a[192:193], v6 offset:40960
    v_mfma_f32_16x16x32_bf16 v[228:231], a[172:175], v[128:131], v[228:231]
    ds_read_b64_tr_b16 a[194:195], v6 offset:43008
    v_mfma_f32_16x16x32_bf16 v[228:231], a[176:179], v[136:139], v[228:231]
    ds_read_b64_tr_b16 a[196:197], v6 offset:45056
    v_mfma_f32_16x16x32_bf16 v[228:231], a[180:183], v[144:147], v[228:231]
    ds_read_b64_tr_b16 a[198:199], v6 offset:47104
    v_mfma_f32_16x16x32_bf16 v[244:247], a[152:155], v[192:195], v[244:247]
    ds_read_b64_tr_b16 a[200:201], v6 offset:49152
    v_mfma_f32_16x16x32_bf16 v[244:247], a[156:159], v[200:203], v[244:247]
    ds_read_b64_tr_b16 a[202:203], v6 offset:51200
    v_mfma_f32_16x16x32_bf16 v[244:247], a[160:163], v[208:211], v[244:247]
    ds_read_b64_tr_b16 a[204:205], v6 offset:53248
    v_mfma_f32_16x16x32_bf16 v[244:247], a[164:167], v[216:219], v[244:247]
    ds_read_b64_tr_b16 a[206:207], v6 offset:55296
    buffer_load_dwordx4 v4, s[28:31], s48 offen offset:3072 lds
    v_mfma_f32_16x16x32_bf16 v[244:247], a[168:171], v[224:227], v[244:247]
    ds_read_b64_tr_b16 a[208:209], v6 offset:57344
    v_mul_f32 v228, v12, v228
    v_mfma_f32_16x16x32_bf16 v[244:247], a[172:175], v[232:235], v[244:247]
    ds_read_b64_tr_b16 a[210:211], v6 offset:59392
    v_mul_f32 v229, v12, v229
    v_mfma_f32_16x16x32_bf16 v[244:247], a[176:179], v[240:243], v[244:247]
    ds_read_b64_tr_b16 a[212:213], v6 offset:61440
    v_mul_f32 v230, v12, v230
    v_mfma_f32_16x16x32_bf16 v[244:247], a[180:183], v[248:251], v[244:247]
    ds_read_b64_tr_b16 a[214:215], v6 offset:63488
    v_mul_f32 v231, v12, v231
    v_mfma_f32_16x16x32_bf16 v[20:23], a[152:155], v[164:167], v[20:23]
    v_cvt_pk_bf16_f32 v228, v228, v229
    v_cvt_pk_bf16_f32 v229, v230, v231
    v_mfma_f32_16x16x32_bf16 v[20:23], a[156:159], v[196:199], v[20:23]
    v_mfma_f32_16x16x32_bf16 v[20:23], a[160:163], v[60:63], v[20:23]
    v_mfma_f32_16x16x32_bf16 v[20:23], a[164:167], v[76:79], v[20:23]
    v_mfma_f32_16x16x32_bf16 v[20:23], a[168:171], v[92:95], v[20:23]
    v_mul_f32 v244, v13, v244
    v_mul_f32 v245, v13, v245
    v_mfma_f32_16x16x32_bf16 v[20:23], a[172:175], v[108:111], v[20:23]
    s_add_u32 m0, s36, 81920
    s_add_u32 s48, s38, 65920
    v_mfma_f32_16x16x32_bf16 v[20:23], a[176:179], v[124:127], v[20:23]
    buffer_load_dwordx4 v1, s[28:31], s48 offen offset:0 lds
    v_mul_f32 v246, v13, v246
    v_mfma_f32_16x16x32_bf16 v[20:23], a[180:183], v[140:143], v[20:23]
    v_mul_f32 v247, v13, v247
    s_waitcnt lgkmcnt(8)
    v_mfma_f32_16x16x32_bf16 v[52:55], a[184:187], v[88:91], v[52:55]
    ds_read_b64_tr_b16 a[152:153], v7 offset:32768
    v_add_u32 v6, 4294901760, v6
    v_mfma_f32_16x16x32_bf16 v[52:55], a[188:191], v[96:99], v[52:55]
    ds_read_b64_tr_b16 a[154:155], v7 offset:34816
    v_cvt_pk_bf16_f32 v244, v244, v245
    v_mfma_f32_16x16x32_bf16 v[52:55], a[192:195], v[104:107], v[52:55]
    ds_read_b64_tr_b16 a[156:157], v7 offset:36864
    v_cvt_pk_bf16_f32 v245, v246, v247
    v_mfma_f32_16x16x32_bf16 v[52:55], a[196:199], v[112:115], v[52:55]
    ds_read_b64_tr_b16 a[158:159], v7 offset:38912
    s_waitcnt lgkmcnt(4)
    v_mfma_f32_16x16x32_bf16 v[52:55], a[200:203], v[120:123], v[52:55]
    ds_read_b64_tr_b16 a[160:161], v7 offset:40960
    v_mul_f32 v20, v14, v20
    v_mfma_f32_16x16x32_bf16 v[52:55], a[204:207], v[128:131], v[52:55]
    ds_read_b64_tr_b16 a[162:163], v7 offset:43008
    v_mul_f32 v21, v14, v21
    v_mfma_f32_16x16x32_bf16 v[52:55], a[208:211], v[136:139], v[52:55]
    ds_read_b64_tr_b16 a[164:165], v7 offset:45056
    v_mul_f32 v22, v14, v22
    v_mfma_f32_16x16x32_bf16 v[52:55], a[212:215], v[144:147], v[52:55]
    ds_read_b64_tr_b16 a[166:167], v7 offset:47104
    v_mul_f32 v23, v14, v23
    v_mfma_f32_16x16x32_bf16 v[180:183], a[184:187], v[192:195], v[180:183]
    ds_read_b64_tr_b16 a[168:169], v7 offset:49152
    buffer_load_dwordx4 v2, s[28:31], s48 offen offset:1024 lds
    v_mfma_f32_16x16x32_bf16 v[180:183], a[188:191], v[200:203], v[180:183]
    ds_read_b64_tr_b16 a[170:171], v7 offset:51200
    v_cvt_pk_bf16_f32 v20, v20, v21
    v_mfma_f32_16x16x32_bf16 v[180:183], a[192:195], v[208:211], v[180:183]
    ds_read_b64_tr_b16 a[172:173], v7 offset:53248
    v_cvt_pk_bf16_f32 v21, v22, v23
    v_mfma_f32_16x16x32_bf16 v[180:183], a[196:199], v[216:219], v[180:183]
    ds_read_b64_tr_b16 a[174:175], v7 offset:55296
    v_mfma_f32_16x16x32_bf16 v[180:183], a[200:203], v[224:227], v[180:183]
    ds_read_b64_tr_b16 a[176:177], v7 offset:57344
    v_mul_f32 v52, v12, v52
    v_mfma_f32_16x16x32_bf16 v[180:183], a[204:207], v[232:235], v[180:183]
    ds_read_b64_tr_b16 a[178:179], v7 offset:59392
    v_mul_f32 v53, v12, v53
    v_mfma_f32_16x16x32_bf16 v[180:183], a[208:211], v[240:243], v[180:183]
    ds_read_b64_tr_b16 a[180:181], v7 offset:61440
    v_mul_f32 v54, v12, v54
    v_mfma_f32_16x16x32_bf16 v[180:183], a[212:215], v[248:251], v[180:183]
    ds_read_b64_tr_b16 a[182:183], v7 offset:63488
    v_mul_f32 v55, v12, v55
    v_mfma_f32_16x16x32_bf16 v[212:215], a[184:187], v[164:167], v[212:215]
    v_cvt_pk_bf16_f32 v230, v52, v53
    v_cvt_pk_bf16_f32 v231, v54, v55
    v_mfma_f32_16x16x32_bf16 v[212:215], a[188:191], v[196:199], v[212:215]
    v_permlane16_swap_b32 v228, v230
    v_permlane16_swap_b32 v229, v231
    v_mfma_f32_16x16x32_bf16 v[212:215], a[192:195], v[60:63], v[212:215]
    buffer_load_dwordx4 v3, s[28:31], s48 offen offset:2048 lds
    v_mfma_f32_16x16x32_bf16 v[212:215], a[196:199], v[76:79], v[212:215]
    buffer_store_dwordx4 v[228:231], v9, s[32:35], s93 offen offset:0 sc1 nt
    v_mfma_f32_16x16x32_bf16 v[212:215], a[200:203], v[92:95], v[212:215]
    v_mul_f32 v180, v13, v180
    v_mul_f32 v181, v13, v181
    v_mfma_f32_16x16x32_bf16 v[212:215], a[204:207], v[108:111], v[212:215]
    v_mul_f32 v182, v13, v182
    v_mul_f32 v183, v13, v183
    v_mfma_f32_16x16x32_bf16 v[212:215], a[208:211], v[124:127], v[212:215]
    v_cvt_pk_bf16_f32 v246, v180, v181
    v_cvt_pk_bf16_f32 v247, v182, v183
    v_mfma_f32_16x16x32_bf16 v[212:215], a[212:215], v[140:143], v[212:215]
    v_permlane16_swap_b32 v244, v246
    s_waitcnt lgkmcnt(8)
    v_mfma_f32_16x16x32_bf16 v[68:71], a[152:155], v[88:91], v[68:71]
    ds_read_b64_tr_b16 a[184:185], v8 offset:32768
    v_add_u32 v7, 4294901760, v7
    v_mfma_f32_16x16x32_bf16 v[68:71], a[156:159], v[96:99], v[68:71]
    ds_read_b64_tr_b16 a[186:187], v8 offset:34816
    v_permlane16_swap_b32 v245, v247
    v_mfma_f32_16x16x32_bf16 v[68:71], a[160:163], v[104:107], v[68:71]
    ds_read_b64_tr_b16 a[188:189], v8 offset:36864
    v_mfma_f32_16x16x32_bf16 v[68:71], a[164:167], v[112:115], v[68:71]
    ds_read_b64_tr_b16 a[190:191], v8 offset:38912
    s_waitcnt lgkmcnt(4)
    v_mfma_f32_16x16x32_bf16 v[68:71], a[168:171], v[120:123], v[68:71]
    ds_read_b64_tr_b16 a[192:193], v8 offset:40960
    buffer_load_dwordx4 v4, s[28:31], s48 offen offset:3072 lds
    v_mfma_f32_16x16x32_bf16 v[68:71], a[172:175], v[128:131], v[68:71]
    ds_read_b64_tr_b16 a[194:195], v8 offset:43008
    v_mfma_f32_16x16x32_bf16 v[68:71], a[176:179], v[136:139], v[68:71]
    ds_read_b64_tr_b16 a[196:197], v8 offset:45056
    v_mfma_f32_16x16x32_bf16 v[68:71], a[180:183], v[144:147], v[68:71]
    ds_read_b64_tr_b16 a[198:199], v8 offset:47104
    v_mfma_f32_16x16x32_bf16 v[84:87], a[152:155], v[192:195], v[84:87]
    ds_read_b64_tr_b16 a[200:201], v8 offset:49152
    v_mfma_f32_16x16x32_bf16 v[84:87], a[156:159], v[200:203], v[84:87]
    ds_read_b64_tr_b16 a[202:203], v8 offset:51200
    v_mfma_f32_16x16x32_bf16 v[84:87], a[160:163], v[208:211], v[84:87]
    ds_read_b64_tr_b16 a[204:205], v8 offset:53248
    v_mfma_f32_16x16x32_bf16 v[84:87], a[164:167], v[216:219], v[84:87]
    ds_read_b64_tr_b16 a[206:207], v8 offset:55296
    v_mfma_f32_16x16x32_bf16 v[84:87], a[168:171], v[224:227], v[84:87]
    ds_read_b64_tr_b16 a[208:209], v8 offset:57344
    v_mfma_f32_16x16x32_bf16 v[84:87], a[172:175], v[232:235], v[84:87]
    ds_read_b64_tr_b16 a[210:211], v8 offset:59392
    v_mfma_f32_16x16x32_bf16 v[84:87], a[176:179], v[240:243], v[84:87]
    ds_read_b64_tr_b16 a[212:213], v8 offset:61440
    v_mfma_f32_16x16x32_bf16 v[84:87], a[180:183], v[248:251], v[84:87]
    ds_read_b64_tr_b16 a[214:215], v8 offset:63488
    v_mfma_f32_16x16x32_bf16 v[100:103], a[152:155], v[164:167], v[100:103]
    buffer_store_dwordx4 v[244:247], v10, s[32:35], s93 offen offset:0 sc1 nt
    v_mfma_f32_16x16x32_bf16 v[100:103], a[156:159], v[196:199], v[100:103]
    v_mul_f32 v212, v14, v212
    v_mul_f32 v213, v14, v213
    v_mfma_f32_16x16x32_bf16 v[100:103], a[160:163], v[60:63], v[100:103]
    v_mul_f32 v214, v14, v214
    v_mul_f32 v215, v14, v215
    v_mfma_f32_16x16x32_bf16 v[100:103], a[164:167], v[76:79], v[100:103]
    v_cvt_pk_bf16_f32 v22, v212, v213
    v_cvt_pk_bf16_f32 v23, v214, v215
    v_mfma_f32_16x16x32_bf16 v[100:103], a[168:171], v[92:95], v[100:103]
    v_permlane16_swap_b32 v20, v22
    v_permlane16_swap_b32 v21, v23
    v_mfma_f32_16x16x32_bf16 v[100:103], a[172:175], v[108:111], v[100:103]
    buffer_store_dwordx4 v[20:23], v11, s[32:35], s93 offen offset:0 sc1 nt
    v_mfma_f32_16x16x32_bf16 v[100:103], a[176:179], v[124:127], v[100:103]
    v_mul_f32 v68, v12, v68
    v_mul_f32 v69, v12, v69
    v_mfma_f32_16x16x32_bf16 v[100:103], a[180:183], v[140:143], v[100:103]
    v_mul_f32 v70, v12, v70
    s_waitcnt lgkmcnt(8)
    v_mfma_f32_16x16x32_bf16 v[116:119], a[184:187], v[88:91], v[116:119]
    s_waitcnt vmcnt(31)
    s_barrier
    v_add_u32 v8, 4294901760, v8
    v_mfma_f32_16x16x32_bf16 v[116:119], a[188:191], v[96:99], v[116:119]
    ds_read_b64_tr_b16 a[152:153], v5 offset:0
    s_add_u32 m0, s36, 131072
    v_mfma_f32_16x16x32_bf16 v[116:119], a[192:195], v[104:107], v[116:119]
    ds_read_b64_tr_b16 a[154:155], v5 offset:2048
    s_add_u32 s48, s38, 131456
    v_mfma_f32_16x16x32_bf16 v[116:119], a[196:199], v[112:115], v[116:119]
    ds_read_b64_tr_b16 a[156:157], v5 offset:4096
    s_waitcnt lgkmcnt(3)
    v_mfma_f32_16x16x32_bf16 v[116:119], a[200:203], v[120:123], v[116:119]
    ds_read_b64_tr_b16 a[158:159], v5 offset:6144
    buffer_load_dwordx4 v1, s[28:31], s48 offen offset:0 lds
    v_mfma_f32_16x16x32_bf16 v[116:119], a[204:207], v[128:131], v[116:119]
    ds_read_b64_tr_b16 a[160:161], v5 offset:8192
    v_mul_f32 v71, v12, v71
    v_mfma_f32_16x16x32_bf16 v[116:119], a[208:211], v[136:139], v[116:119]
    ds_read_b64_tr_b16 a[162:163], v5 offset:10240
    v_cvt_pk_bf16_f32 v68, v68, v69
    v_mfma_f32_16x16x32_bf16 v[116:119], a[212:215], v[144:147], v[116:119]
    ds_read_b64_tr_b16 a[164:165], v5 offset:12288
    v_cvt_pk_bf16_f32 v69, v70, v71
    v_mfma_f32_16x16x32_bf16 v[132:135], a[184:187], v[192:195], v[132:135]
    ds_read_b64_tr_b16 a[166:167], v5 offset:14336
    v_mul_f32 v84, v13, v84
    v_mfma_f32_16x16x32_bf16 v[132:135], a[188:191], v[200:203], v[132:135]
    ds_read_b64_tr_b16 a[168:169], v5 offset:16384
    v_mul_f32 v85, v13, v85
    v_mfma_f32_16x16x32_bf16 v[132:135], a[192:195], v[208:211], v[132:135]
    ds_read_b64_tr_b16 a[170:171], v5 offset:18432
    v_mul_f32 v86, v13, v86
    v_mfma_f32_16x16x32_bf16 v[132:135], a[196:199], v[216:219], v[132:135]
    ds_read_b64_tr_b16 a[172:173], v5 offset:20480
    v_mul_f32 v87, v13, v87
    v_mfma_f32_16x16x32_bf16 v[132:135], a[200:203], v[224:227], v[132:135]
    ds_read_b64_tr_b16 a[174:175], v5 offset:22528
    v_cvt_pk_bf16_f32 v84, v84, v85
    v_mfma_f32_16x16x32_bf16 v[132:135], a[204:207], v[232:235], v[132:135]
    ds_read_b64_tr_b16 a[176:177], v5 offset:24576
    v_cvt_pk_bf16_f32 v85, v86, v87
    v_mfma_f32_16x16x32_bf16 v[132:135], a[208:211], v[240:243], v[132:135]
    ds_read_b64_tr_b16 a[178:179], v5 offset:26624
    buffer_load_dwordx4 v2, s[28:31], s48 offen offset:1024 lds
    v_mfma_f32_16x16x32_bf16 v[132:135], a[212:215], v[248:251], v[132:135]
    ds_read_b64_tr_b16 a[180:181], v5 offset:28672
    v_mul_f32 v100, v14, v100
    v_mfma_f32_16x16x32_bf16 v[148:151], a[184:187], v[164:167], v[148:151]
    ds_read_b64_tr_b16 a[182:183], v5 offset:30720
    v_mul_f32 v101, v14, v101
    v_mfma_f32_16x16x32_bf16 v[148:151], a[188:191], v[196:199], v[148:151]
    v_mul_f32 v102, v14, v102
    v_mul_f32 v103, v14, v103
    v_mfma_f32_16x16x32_bf16 v[148:151], a[192:195], v[60:63], v[148:151]
    v_cvt_pk_bf16_f32 v100, v100, v101
    v_cvt_pk_bf16_f32 v101, v102, v103
    v_mfma_f32_16x16x32_bf16 v[148:151], a[196:199], v[76:79], v[148:151]
    v_mul_f32 v116, v12, v116
    v_mul_f32 v117, v12, v117
    v_mfma_f32_16x16x32_bf16 v[148:151], a[200:203], v[92:95], v[148:151]
    v_mul_f32 v118, v12, v118
    v_mul_f32 v119, v12, v119
    v_mfma_f32_16x16x32_bf16 v[148:151], a[204:207], v[108:111], v[148:151]
    v_cvt_pk_bf16_f32 v70, v116, v117
    v_cvt_pk_bf16_f32 v71, v118, v119
    v_mfma_f32_16x16x32_bf16 v[148:151], a[208:211], v[124:127], v[148:151]
    v_permlane16_swap_b32 v68, v70
    v_permlane16_swap_b32 v69, v71
    v_mfma_f32_16x16x32_bf16 v[148:151], a[212:215], v[140:143], v[148:151]
    s_waitcnt lgkmcnt(8)
    v_mfma_f32_16x16x32_bf16 v[228:231], a[152:155], v[24:27], 0
    ds_read_b64_tr_b16 a[184:185], v6 offset:0
    buffer_load_dwordx4 v3, s[28:31], s48 offen offset:2048 lds
    v_mfma_f32_16x16x32_bf16 v[228:231], a[156:159], v[32:35], v[228:231]
    ds_read_b64_tr_b16 a[186:187], v6 offset:2048
    v_mfma_f32_16x16x32_bf16 v[228:231], a[160:163], v[40:43], v[228:231]
    ds_read_b64_tr_b16 a[188:189], v6 offset:4096
    v_mfma_f32_16x16x32_bf16 v[228:231], a[164:167], v[48:51], v[228:231]
    ds_read_b64_tr_b16 a[190:191], v6 offset:6144
    s_waitcnt lgkmcnt(4)
    v_mfma_f32_16x16x32_bf16 v[228:231], a[168:171], v[56:59], v[228:231]
    ds_read_b64_tr_b16 a[192:193], v6 offset:8192
    v_mfma_f32_16x16x32_bf16 v[228:231], a[172:175], v[64:67], v[228:231]
    ds_read_b64_tr_b16 a[194:195], v6 offset:10240
    v_mfma_f32_16x16x32_bf16 v[228:231], a[176:179], v[72:75], v[228:231]
    ds_read_b64_tr_b16 a[196:197], v6 offset:12288
    v_mfma_f32_16x16x32_bf16 v[228:231], a[180:183], v[80:83], v[228:231]
    ds_read_b64_tr_b16 a[198:199], v6 offset:14336
    v_mfma_f32_16x16x32_bf16 v[244:247], a[152:155], v[16:19], 0
    ds_read_b64_tr_b16 a[200:201], v6 offset:16384
    v_mfma_f32_16x16x32_bf16 v[244:247], a[156:159], v[28:31], v[244:247]
    ds_read_b64_tr_b16 a[202:203], v6 offset:18432
    v_mfma_f32_16x16x32_bf16 v[244:247], a[160:163], v[44:47], v[244:247]
    ds_read_b64_tr_b16 a[204:205], v6 offset:20480
    buffer_load_dwordx4 v4, s[28:31], s48 offen offset:3072 lds
    v_mfma_f32_16x16x32_bf16 v[244:247], a[164:167], v[152:155], v[244:247]
    ds_read_b64_tr_b16 a[206:207], v6 offset:22528
    v_mfma_f32_16x16x32_bf16 v[244:247], a[168:171], v[160:163], v[244:247]
    ds_read_b64_tr_b16 a[208:209], v6 offset:24576
    v_mfma_f32_16x16x32_bf16 v[244:247], a[172:175], v[168:171], v[244:247]
    ds_read_b64_tr_b16 a[210:211], v6 offset:26624
    v_mfma_f32_16x16x32_bf16 v[244:247], a[176:179], v[176:179], v[244:247]
    ds_read_b64_tr_b16 a[212:213], v6 offset:28672
    v_mfma_f32_16x16x32_bf16 v[244:247], a[180:183], v[184:187], v[244:247]
    ds_read_b64_tr_b16 a[214:215], v6 offset:30720
    v_mfma_f32_16x16x32_bf16 v[20:23], a[152:155], v[156:159], 0
    buffer_store_dwordx4 v[68:71], v9, s[32:35], s93 offen offset:64 sc1 nt
    v_mfma_f32_16x16x32_bf16 v[20:23], a[156:159], v[172:175], v[20:23]
    v_mul_f32 v132, v13, v132
    v_mul_f32 v133, v13, v133
    v_mfma_f32_16x16x32_bf16 v[20:23], a[160:163], v[188:191], v[20:23]
    v_mul_f32 v134, v13, v134
    v_mul_f32 v135, v13, v135
    v_mfma_f32_16x16x32_bf16 v[20:23], a[164:167], v[204:207], v[20:23]
    v_cvt_pk_bf16_f32 v86, v132, v133
    v_cvt_pk_bf16_f32 v87, v134, v135
    v_mfma_f32_16x16x32_bf16 v[20:23], a[168:171], v[220:223], v[20:23]
    s_add_u32 m0, s36, 147456
    s_add_u32 s48, s38, 196992
    v_mfma_f32_16x16x32_bf16 v[20:23], a[172:175], v[236:239], v[20:23]
    buffer_load_dwordx4 v1, s[28:31], s48 offen offset:0 lds
    v_permlane16_swap_b32 v84, v86
    v_mfma_f32_16x16x32_bf16 v[20:23], a[176:179], v[252:255], v[20:23]
    v_permlane16_swap_b32 v85, v87
    v_mfma_f32_16x16x32_bf16 v[20:23], a[180:183], v[36:39], v[20:23]
    s_waitcnt lgkmcnt(8)
    v_mfma_f32_16x16x32_bf16 v[52:55], a[184:187], v[24:27], 0
    ds_read_b64_tr_b16 a[152:153], v7 offset:0
    v_mfma_f32_16x16x32_bf16 v[52:55], a[188:191], v[32:35], v[52:55]
    ds_read_b64_tr_b16 a[154:155], v7 offset:2048
    v_mfma_f32_16x16x32_bf16 v[52:55], a[192:195], v[40:43], v[52:55]
    ds_read_b64_tr_b16 a[156:157], v7 offset:4096
    v_mfma_f32_16x16x32_bf16 v[52:55], a[196:199], v[48:51], v[52:55]
    ds_read_b64_tr_b16 a[158:159], v7 offset:6144
    s_waitcnt lgkmcnt(4)
    v_mfma_f32_16x16x32_bf16 v[52:55], a[200:203], v[56:59], v[52:55]
    ds_read_b64_tr_b16 a[160:161], v7 offset:8192
    v_mfma_f32_16x16x32_bf16 v[52:55], a[204:207], v[64:67], v[52:55]
    ds_read_b64_tr_b16 a[162:163], v7 offset:10240
    v_mfma_f32_16x16x32_bf16 v[52:55], a[208:211], v[72:75], v[52:55]
    ds_read_b64_tr_b16 a[164:165], v7 offset:12288
    v_mfma_f32_16x16x32_bf16 v[52:55], a[212:215], v[80:83], v[52:55]
    ds_read_b64_tr_b16 a[166:167], v7 offset:14336
    buffer_load_dwordx4 v2, s[28:31], s48 offen offset:1024 lds
    v_mfma_f32_16x16x32_bf16 v[180:183], a[184:187], v[16:19], 0
    ds_read_b64_tr_b16 a[168:169], v7 offset:16384
    v_mfma_f32_16x16x32_bf16 v[180:183], a[188:191], v[28:31], v[180:183]
    ds_read_b64_tr_b16 a[170:171], v7 offset:18432
    v_mfma_f32_16x16x32_bf16 v[180:183], a[192:195], v[44:47], v[180:183]
    ds_read_b64_tr_b16 a[172:173], v7 offset:20480
    v_mfma_f32_16x16x32_bf16 v[180:183], a[196:199], v[152:155], v[180:183]
    ds_read_b64_tr_b16 a[174:175], v7 offset:22528
    v_mfma_f32_16x16x32_bf16 v[180:183], a[200:203], v[160:163], v[180:183]
    ds_read_b64_tr_b16 a[176:177], v7 offset:24576
    v_mfma_f32_16x16x32_bf16 v[180:183], a[204:207], v[168:171], v[180:183]
    ds_read_b64_tr_b16 a[178:179], v7 offset:26624
    v_mfma_f32_16x16x32_bf16 v[180:183], a[208:211], v[176:179], v[180:183]
    ds_read_b64_tr_b16 a[180:181], v7 offset:28672
    v_mfma_f32_16x16x32_bf16 v[180:183], a[212:215], v[184:187], v[180:183]
    ds_read_b64_tr_b16 a[182:183], v7 offset:30720
    v_mfma_f32_16x16x32_bf16 v[212:215], a[184:187], v[156:159], 0
    buffer_store_dwordx4 v[84:87], v10, s[32:35], s93 offen offset:64 sc1 nt
    v_mfma_f32_16x16x32_bf16 v[212:215], a[188:191], v[172:175], v[212:215]
    buffer_load_dwordx4 v3, s[28:31], s48 offen offset:2048 lds
    v_mul_f32 v148, v14, v148
    v_mfma_f32_16x16x32_bf16 v[212:215], a[192:195], v[188:191], v[212:215]
    v_mul_f32 v149, v14, v149
    v_mul_f32 v150, v14, v150
    v_mfma_f32_16x16x32_bf16 v[212:215], a[196:199], v[204:207], v[212:215]
    v_mul_f32 v151, v14, v151
    v_cvt_pk_bf16_f32 v102, v148, v149
    v_mfma_f32_16x16x32_bf16 v[212:215], a[200:203], v[220:223], v[212:215]
    v_cvt_pk_bf16_f32 v103, v150, v151
    v_mfma_f32_16x16x32_bf16 v[212:215], a[204:207], v[236:239], v[212:215]
    v_permlane16_swap_b32 v100, v102
    v_permlane16_swap_b32 v101, v103
    v_mfma_f32_16x16x32_bf16 v[212:215], a[208:211], v[252:255], v[212:215]
    buffer_store_dwordx4 v[100:103], v11, s[32:35], s93 offen offset:64 sc1 nt
    v_mfma_f32_16x16x32_bf16 v[212:215], a[212:215], v[36:39], v[212:215]
    s_waitcnt lgkmcnt(8)
    v_mfma_f32_16x16x32_bf16 v[68:71], a[152:155], v[24:27], 0
    ds_read_b64_tr_b16 a[184:185], v8 offset:0
    v_mfma_f32_16x16x32_bf16 v[68:71], a[156:159], v[32:35], v[68:71]
    ds_read_b64_tr_b16 a[186:187], v8 offset:2048
    v_mfma_f32_16x16x32_bf16 v[68:71], a[160:163], v[40:43], v[68:71]
    ds_read_b64_tr_b16 a[188:189], v8 offset:4096
    v_mfma_f32_16x16x32_bf16 v[68:71], a[164:167], v[48:51], v[68:71]
    ds_read_b64_tr_b16 a[190:191], v8 offset:6144
    s_waitcnt lgkmcnt(4)
    v_mfma_f32_16x16x32_bf16 v[68:71], a[168:171], v[56:59], v[68:71]
    ds_read_b64_tr_b16 a[192:193], v8 offset:8192
    buffer_load_dwordx4 v4, s[28:31], s48 offen offset:3072 lds
    v_mfma_f32_16x16x32_bf16 v[68:71], a[172:175], v[64:67], v[68:71]
    ds_read_b64_tr_b16 a[194:195], v8 offset:10240
    v_mfma_f32_16x16x32_bf16 v[68:71], a[176:179], v[72:75], v[68:71]
    ds_read_b64_tr_b16 a[196:197], v8 offset:12288
    v_mfma_f32_16x16x32_bf16 v[68:71], a[180:183], v[80:83], v[68:71]
    ds_read_b64_tr_b16 a[198:199], v8 offset:14336
    v_mfma_f32_16x16x32_bf16 v[84:87], a[152:155], v[16:19], 0
    ds_read_b64_tr_b16 a[200:201], v8 offset:16384
    v_mfma_f32_16x16x32_bf16 v[84:87], a[156:159], v[28:31], v[84:87]
    ds_read_b64_tr_b16 a[202:203], v8 offset:18432
    v_mfma_f32_16x16x32_bf16 v[84:87], a[160:163], v[44:47], v[84:87]
    ds_read_b64_tr_b16 a[204:205], v8 offset:20480
    v_mfma_f32_16x16x32_bf16 v[84:87], a[164:167], v[152:155], v[84:87]
    ds_read_b64_tr_b16 a[206:207], v8 offset:22528
    v_mfma_f32_16x16x32_bf16 v[84:87], a[168:171], v[160:163], v[84:87]
    ds_read_b64_tr_b16 a[208:209], v8 offset:24576
    v_mfma_f32_16x16x32_bf16 v[84:87], a[172:175], v[168:171], v[84:87]
    ds_read_b64_tr_b16 a[210:211], v8 offset:26624
    v_mfma_f32_16x16x32_bf16 v[84:87], a[176:179], v[176:179], v[84:87]
    ds_read_b64_tr_b16 a[212:213], v8 offset:28672
    v_mfma_f32_16x16x32_bf16 v[84:87], a[180:183], v[184:187], v[84:87]
    ds_read_b64_tr_b16 a[214:215], v8 offset:30720
    v_mfma_f32_16x16x32_bf16 v[100:103], a[152:155], v[156:159], 0
    v_mfma_f32_16x16x32_bf16 v[100:103], a[156:159], v[172:175], v[100:103]
    v_mfma_f32_16x16x32_bf16 v[100:103], a[160:163], v[188:191], v[100:103]
    v_mfma_f32_16x16x32_bf16 v[100:103], a[164:167], v[204:207], v[100:103]
    v_mfma_f32_16x16x32_bf16 v[100:103], a[168:171], v[220:223], v[100:103]
    v_mfma_f32_16x16x32_bf16 v[100:103], a[172:175], v[236:239], v[100:103]
    v_mfma_f32_16x16x32_bf16 v[100:103], a[176:179], v[252:255], v[100:103]
    v_mfma_f32_16x16x32_bf16 v[100:103], a[180:183], v[36:39], v[100:103]
    s_waitcnt lgkmcnt(8)
    v_mfma_f32_16x16x32_bf16 v[116:119], a[184:187], v[24:27], 0
    s_waitcnt vmcnt(22)
    s_barrier
    v_mfma_f32_16x16x32_bf16 v[116:119], a[188:191], v[32:35], v[116:119]
    ds_read_b64_tr_b16 a[152:153], v5 offset:32768
    v_mfma_f32_16x16x32_bf16 v[116:119], a[192:195], v[40:43], v[116:119]
    ds_read_b64_tr_b16 a[154:155], v5 offset:34816
    v_mfma_f32_16x16x32_bf16 v[116:119], a[196:199], v[48:51], v[116:119]
    ds_read_b64_tr_b16 a[156:157], v5 offset:36864
    s_waitcnt lgkmcnt(3)
    v_mfma_f32_16x16x32_bf16 v[116:119], a[200:203], v[56:59], v[116:119]
    ds_read_b64_tr_b16 a[158:159], v5 offset:38912
    v_mfma_f32_16x16x32_bf16 v[116:119], a[204:207], v[64:67], v[116:119]
    ds_read_b64_tr_b16 a[160:161], v5 offset:40960
    v_mfma_f32_16x16x32_bf16 v[116:119], a[208:211], v[72:75], v[116:119]
    ds_read_b64_tr_b16 a[162:163], v5 offset:43008
    v_mfma_f32_16x16x32_bf16 v[116:119], a[212:215], v[80:83], v[116:119]
    ds_read_b64_tr_b16 a[164:165], v5 offset:45056
    v_mfma_f32_16x16x32_bf16 v[132:135], a[184:187], v[16:19], 0
    ds_read_b64_tr_b16 a[166:167], v5 offset:47104
    v_mfma_f32_16x16x32_bf16 v[132:135], a[188:191], v[28:31], v[132:135]
    ds_read_b64_tr_b16 a[168:169], v5 offset:49152
    v_mfma_f32_16x16x32_bf16 v[132:135], a[192:195], v[44:47], v[132:135]
    ds_read_b64_tr_b16 a[170:171], v5 offset:51200
    v_mfma_f32_16x16x32_bf16 v[132:135], a[196:199], v[152:155], v[132:135]
    ds_read_b64_tr_b16 a[172:173], v5 offset:53248
    v_mfma_f32_16x16x32_bf16 v[132:135], a[200:203], v[160:163], v[132:135]
    ds_read_b64_tr_b16 a[174:175], v5 offset:55296
    v_mfma_f32_16x16x32_bf16 v[132:135], a[204:207], v[168:171], v[132:135]
    ds_read_b64_tr_b16 a[176:177], v5 offset:57344
    v_mfma_f32_16x16x32_bf16 v[132:135], a[208:211], v[176:179], v[132:135]
    ds_read_b64_tr_b16 a[178:179], v5 offset:59392
    v_mfma_f32_16x16x32_bf16 v[132:135], a[212:215], v[184:187], v[132:135]
    ds_read_b64_tr_b16 a[180:181], v5 offset:61440
    v_mfma_f32_16x16x32_bf16 v[148:151], a[184:187], v[156:159], 0
    ds_read_b64_tr_b16 a[182:183], v5 offset:63488
    v_mfma_f32_16x16x32_bf16 v[148:151], a[188:191], v[172:175], v[148:151]
    v_mfma_f32_16x16x32_bf16 v[148:151], a[192:195], v[188:191], v[148:151]
    v_mfma_f32_16x16x32_bf16 v[148:151], a[196:199], v[204:207], v[148:151]
    v_mfma_f32_16x16x32_bf16 v[148:151], a[200:203], v[220:223], v[148:151]
    v_mfma_f32_16x16x32_bf16 v[148:151], a[204:207], v[236:239], v[148:151]
    v_mfma_f32_16x16x32_bf16 v[148:151], a[208:211], v[252:255], v[148:151]
    v_mfma_f32_16x16x32_bf16 v[148:151], a[212:215], v[36:39], v[148:151]
    s_waitcnt lgkmcnt(8)
    v_mfma_f32_16x16x32_bf16 v[228:231], a[152:155], v[88:91], v[228:231]
    ds_read_b64_tr_b16 a[184:185], v6 offset:32768
    v_add_u32 v5, 65536, v5
    v_mfma_f32_16x16x32_bf16 v[228:231], a[156:159], v[96:99], v[228:231]
    ds_read_b64_tr_b16 a[186:187], v6 offset:34816
    v_mfma_f32_16x16x32_bf16 v[228:231], a[160:163], v[104:107], v[228:231]
    ds_read_b64_tr_b16 a[188:189], v6 offset:36864
    v_mfma_f32_16x16x32_bf16 v[228:231], a[164:167], v[112:115], v[228:231]
    ds_read_b64_tr_b16 a[190:191], v6 offset:38912
    s_waitcnt lgkmcnt(4)
    v_mfma_f32_16x16x32_bf16 v[228:231], a[168:171], v[120:123], v[228:231]
    ds_read_b64_tr_b16 a[192:193], v6 offset:40960
    v_mfma_f32_16x16x32_bf16 v[228:231], a[172:175], v[128:131], v[228:231]
    ds_read_b64_tr_b16 a[194:195], v6 offset:43008
    v_mfma_f32_16x16x32_bf16 v[228:231], a[176:179], v[136:139], v[228:231]
    ds_read_b64_tr_b16 a[196:197], v6 offset:45056
    v_mfma_f32_16x16x32_bf16 v[228:231], a[180:183], v[144:147], v[228:231]
    ds_read_b64_tr_b16 a[198:199], v6 offset:47104
    v_mfma_f32_16x16x32_bf16 v[244:247], a[152:155], v[192:195], v[244:247]
    ds_read_b64_tr_b16 a[200:201], v6 offset:49152
    v_mfma_f32_16x16x32_bf16 v[244:247], a[156:159], v[200:203], v[244:247]
    ds_read_b64_tr_b16 a[202:203], v6 offset:51200
    v_mfma_f32_16x16x32_bf16 v[244:247], a[160:163], v[208:211], v[244:247]
    ds_read_b64_tr_b16 a[204:205], v6 offset:53248
    v_mfma_f32_16x16x32_bf16 v[244:247], a[164:167], v[216:219], v[244:247]
    ds_read_b64_tr_b16 a[206:207], v6 offset:55296
    v_mfma_f32_16x16x32_bf16 v[244:247], a[168:171], v[224:227], v[244:247]
    ds_read_b64_tr_b16 a[208:209], v6 offset:57344
    v_mul_f32 v228, v12, v228
    v_mfma_f32_16x16x32_bf16 v[244:247], a[172:175], v[232:235], v[244:247]
    ds_read_b64_tr_b16 a[210:211], v6 offset:59392
    v_mul_f32 v229, v12, v229
    v_mfma_f32_16x16x32_bf16 v[244:247], a[176:179], v[240:243], v[244:247]
    ds_read_b64_tr_b16 a[212:213], v6 offset:61440
    v_mul_f32 v230, v12, v230
    v_mfma_f32_16x16x32_bf16 v[244:247], a[180:183], v[248:251], v[244:247]
    ds_read_b64_tr_b16 a[214:215], v6 offset:63488
    v_mul_f32 v231, v12, v231
    v_mfma_f32_16x16x32_bf16 v[20:23], a[152:155], v[164:167], v[20:23]
    v_cvt_pk_bf16_f32 v228, v228, v229
    v_cvt_pk_bf16_f32 v229, v230, v231
    v_mfma_f32_16x16x32_bf16 v[20:23], a[156:159], v[196:199], v[20:23]
    v_mfma_f32_16x16x32_bf16 v[20:23], a[160:163], v[60:63], v[20:23]
    v_mfma_f32_16x16x32_bf16 v[20:23], a[164:167], v[76:79], v[20:23]
    v_mfma_f32_16x16x32_bf16 v[20:23], a[168:171], v[92:95], v[20:23]
    v_mul_f32 v244, v13, v244
    v_mul_f32 v245, v13, v245
    v_mfma_f32_16x16x32_bf16 v[20:23], a[172:175], v[108:111], v[20:23]
    v_mul_f32 v246, v13, v246
    v_mul_f32 v247, v13, v247
    v_mfma_f32_16x16x32_bf16 v[20:23], a[176:179], v[124:127], v[20:23]
    v_cvt_pk_bf16_f32 v244, v244, v245
    v_cvt_pk_bf16_f32 v245, v246, v247
    v_mfma_f32_16x16x32_bf16 v[20:23], a[180:183], v[140:143], v[20:23]
    s_waitcnt lgkmcnt(8)
    v_mfma_f32_16x16x32_bf16 v[52:55], a[184:187], v[88:91], v[52:55]
    ds_read_b64_tr_b16 a[152:153], v7 offset:32768
    v_add_u32 v6, 65536, v6
    v_mfma_f32_16x16x32_bf16 v[52:55], a[188:191], v[96:99], v[52:55]
    ds_read_b64_tr_b16 a[154:155], v7 offset:34816
    v_mfma_f32_16x16x32_bf16 v[52:55], a[192:195], v[104:107], v[52:55]
    ds_read_b64_tr_b16 a[156:157], v7 offset:36864
    v_mfma_f32_16x16x32_bf16 v[52:55], a[196:199], v[112:115], v[52:55]
    ds_read_b64_tr_b16 a[158:159], v7 offset:38912
    s_waitcnt lgkmcnt(4)
    v_mfma_f32_16x16x32_bf16 v[52:55], a[200:203], v[120:123], v[52:55]
    ds_read_b64_tr_b16 a[160:161], v7 offset:40960
    v_mul_f32 v20, v14, v20
    v_mfma_f32_16x16x32_bf16 v[52:55], a[204:207], v[128:131], v[52:55]
    ds_read_b64_tr_b16 a[162:163], v7 offset:43008
    v_mul_f32 v21, v14, v21
    v_mfma_f32_16x16x32_bf16 v[52:55], a[208:211], v[136:139], v[52:55]
    ds_read_b64_tr_b16 a[164:165], v7 offset:45056
    v_mul_f32 v22, v14, v22
    v_mfma_f32_16x16x32_bf16 v[52:55], a[212:215], v[144:147], v[52:55]
    ds_read_b64_tr_b16 a[166:167], v7 offset:47104
    v_mul_f32 v23, v14, v23
    v_mfma_f32_16x16x32_bf16 v[180:183], a[184:187], v[192:195], v[180:183]
    ds_read_b64_tr_b16 a[168:169], v7 offset:49152
    v_cvt_pk_bf16_f32 v20, v20, v21
    v_mfma_f32_16x16x32_bf16 v[180:183], a[188:191], v[200:203], v[180:183]
    ds_read_b64_tr_b16 a[170:171], v7 offset:51200
    v_cvt_pk_bf16_f32 v21, v22, v23
    v_mfma_f32_16x16x32_bf16 v[180:183], a[192:195], v[208:211], v[180:183]
    ds_read_b64_tr_b16 a[172:173], v7 offset:53248
    v_mfma_f32_16x16x32_bf16 v[180:183], a[196:199], v[216:219], v[180:183]
    ds_read_b64_tr_b16 a[174:175], v7 offset:55296
    v_mfma_f32_16x16x32_bf16 v[180:183], a[200:203], v[224:227], v[180:183]
    ds_read_b64_tr_b16 a[176:177], v7 offset:57344
    v_mul_f32 v52, v12, v52
    v_mfma_f32_16x16x32_bf16 v[180:183], a[204:207], v[232:235], v[180:183]
    ds_read_b64_tr_b16 a[178:179], v7 offset:59392
    v_mul_f32 v53, v12, v53
    v_mfma_f32_16x16x32_bf16 v[180:183], a[208:211], v[240:243], v[180:183]
    ds_read_b64_tr_b16 a[180:181], v7 offset:61440
    v_mul_f32 v54, v12, v54
    v_mfma_f32_16x16x32_bf16 v[180:183], a[212:215], v[248:251], v[180:183]
    ds_read_b64_tr_b16 a[182:183], v7 offset:63488
    v_mul_f32 v55, v12, v55
    v_mfma_f32_16x16x32_bf16 v[212:215], a[184:187], v[164:167], v[212:215]
    v_cvt_pk_bf16_f32 v230, v52, v53
    v_cvt_pk_bf16_f32 v231, v54, v55
    v_mfma_f32_16x16x32_bf16 v[212:215], a[188:191], v[196:199], v[212:215]
    v_permlane16_swap_b32 v228, v230
    v_permlane16_swap_b32 v229, v231
    v_mfma_f32_16x16x32_bf16 v[212:215], a[192:195], v[60:63], v[212:215]
    buffer_store_dwordx4 v[228:231], v9, s[32:35], s94 offen offset:0 sc1 nt
    v_mfma_f32_16x16x32_bf16 v[212:215], a[196:199], v[76:79], v[212:215]
    v_mfma_f32_16x16x32_bf16 v[212:215], a[200:203], v[92:95], v[212:215]
    v_mul_f32 v180, v13, v180
    v_mul_f32 v181, v13, v181
    v_mfma_f32_16x16x32_bf16 v[212:215], a[204:207], v[108:111], v[212:215]
    v_mul_f32 v182, v13, v182
    v_mul_f32 v183, v13, v183
    v_mfma_f32_16x16x32_bf16 v[212:215], a[208:211], v[124:127], v[212:215]
    v_cvt_pk_bf16_f32 v246, v180, v181
    v_cvt_pk_bf16_f32 v247, v182, v183
    v_mfma_f32_16x16x32_bf16 v[212:215], a[212:215], v[140:143], v[212:215]
    v_permlane16_swap_b32 v244, v246
    s_waitcnt lgkmcnt(8)
    v_mfma_f32_16x16x32_bf16 v[68:71], a[152:155], v[88:91], v[68:71]
    ds_read_b64_tr_b16 a[184:185], v8 offset:32768
    v_add_u32 v7, 65536, v7
    v_mfma_f32_16x16x32_bf16 v[68:71], a[156:159], v[96:99], v[68:71]
    ds_read_b64_tr_b16 a[186:187], v8 offset:34816
    v_permlane16_swap_b32 v245, v247
    v_mfma_f32_16x16x32_bf16 v[68:71], a[160:163], v[104:107], v[68:71]
    ds_read_b64_tr_b16 a[188:189], v8 offset:36864
    v_mfma_f32_16x16x32_bf16 v[68:71], a[164:167], v[112:115], v[68:71]
    ds_read_b64_tr_b16 a[190:191], v8 offset:38912
    s_waitcnt lgkmcnt(4)
    v_mfma_f32_16x16x32_bf16 v[68:71], a[168:171], v[120:123], v[68:71]
    ds_read_b64_tr_b16 a[192:193], v8 offset:40960
    v_mfma_f32_16x16x32_bf16 v[68:71], a[172:175], v[128:131], v[68:71]
    ds_read_b64_tr_b16 a[194:195], v8 offset:43008
    v_mfma_f32_16x16x32_bf16 v[68:71], a[176:179], v[136:139], v[68:71]
    ds_read_b64_tr_b16 a[196:197], v8 offset:45056
    v_mfma_f32_16x16x32_bf16 v[68:71], a[180:183], v[144:147], v[68:71]
    ds_read_b64_tr_b16 a[198:199], v8 offset:47104
    v_mfma_f32_16x16x32_bf16 v[84:87], a[152:155], v[192:195], v[84:87]
    ds_read_b64_tr_b16 a[200:201], v8 offset:49152
    v_mfma_f32_16x16x32_bf16 v[84:87], a[156:159], v[200:203], v[84:87]
    ds_read_b64_tr_b16 a[202:203], v8 offset:51200
    v_mfma_f32_16x16x32_bf16 v[84:87], a[160:163], v[208:211], v[84:87]
    ds_read_b64_tr_b16 a[204:205], v8 offset:53248
    v_mfma_f32_16x16x32_bf16 v[84:87], a[164:167], v[216:219], v[84:87]
    ds_read_b64_tr_b16 a[206:207], v8 offset:55296
    v_mfma_f32_16x16x32_bf16 v[84:87], a[168:171], v[224:227], v[84:87]
    ds_read_b64_tr_b16 a[208:209], v8 offset:57344
    v_mfma_f32_16x16x32_bf16 v[84:87], a[172:175], v[232:235], v[84:87]
    ds_read_b64_tr_b16 a[210:211], v8 offset:59392
    v_mfma_f32_16x16x32_bf16 v[84:87], a[176:179], v[240:243], v[84:87]
    ds_read_b64_tr_b16 a[212:213], v8 offset:61440
    v_mfma_f32_16x16x32_bf16 v[84:87], a[180:183], v[248:251], v[84:87]
    ds_read_b64_tr_b16 a[214:215], v8 offset:63488
    v_mfma_f32_16x16x32_bf16 v[100:103], a[152:155], v[164:167], v[100:103]
    buffer_store_dwordx4 v[244:247], v10, s[32:35], s94 offen offset:0 sc1 nt
    v_mfma_f32_16x16x32_bf16 v[100:103], a[156:159], v[196:199], v[100:103]
    v_mul_f32 v212, v14, v212
    v_mul_f32 v213, v14, v213
    v_mfma_f32_16x16x32_bf16 v[100:103], a[160:163], v[60:63], v[100:103]
    v_mul_f32 v214, v14, v214
    v_mul_f32 v215, v14, v215
    v_mfma_f32_16x16x32_bf16 v[100:103], a[164:167], v[76:79], v[100:103]
    v_cvt_pk_bf16_f32 v22, v212, v213
    v_cvt_pk_bf16_f32 v23, v214, v215
    v_mfma_f32_16x16x32_bf16 v[100:103], a[168:171], v[92:95], v[100:103]
    v_permlane16_swap_b32 v20, v22
    v_permlane16_swap_b32 v21, v23
    v_mfma_f32_16x16x32_bf16 v[100:103], a[172:175], v[108:111], v[100:103]
    buffer_store_dwordx4 v[20:23], v11, s[32:35], s94 offen offset:0 sc1 nt
    v_mfma_f32_16x16x32_bf16 v[100:103], a[176:179], v[124:127], v[100:103]
    v_mul_f32 v68, v12, v68
    v_mul_f32 v69, v12, v69
    v_mfma_f32_16x16x32_bf16 v[100:103], a[180:183], v[140:143], v[100:103]
    v_mul_f32 v70, v12, v70
    s_waitcnt lgkmcnt(8)
    v_mfma_f32_16x16x32_bf16 v[116:119], a[184:187], v[88:91], v[116:119]
    s_waitcnt vmcnt(16)
    s_barrier
    v_add_u32 v8, 65536, v8
    v_mfma_f32_16x16x32_bf16 v[116:119], a[188:191], v[96:99], v[116:119]
    ds_read_b64_tr_b16 a[152:153], v5 offset:0
    v_mul_f32 v71, v12, v71
    v_mfma_f32_16x16x32_bf16 v[116:119], a[192:195], v[104:107], v[116:119]
    ds_read_b64_tr_b16 a[154:155], v5 offset:2048
    v_cvt_pk_bf16_f32 v68, v68, v69
    v_mfma_f32_16x16x32_bf16 v[116:119], a[196:199], v[112:115], v[116:119]
    ds_read_b64_tr_b16 a[156:157], v5 offset:4096
    s_waitcnt lgkmcnt(3)
    v_mfma_f32_16x16x32_bf16 v[116:119], a[200:203], v[120:123], v[116:119]
    ds_read_b64_tr_b16 a[158:159], v5 offset:6144
    v_cvt_pk_bf16_f32 v69, v70, v71
    v_mfma_f32_16x16x32_bf16 v[116:119], a[204:207], v[128:131], v[116:119]
    ds_read_b64_tr_b16 a[160:161], v5 offset:8192
    v_mul_f32 v84, v13, v84
    v_mfma_f32_16x16x32_bf16 v[116:119], a[208:211], v[136:139], v[116:119]
    ds_read_b64_tr_b16 a[162:163], v5 offset:10240
    v_mul_f32 v85, v13, v85
    v_mfma_f32_16x16x32_bf16 v[116:119], a[212:215], v[144:147], v[116:119]
    ds_read_b64_tr_b16 a[164:165], v5 offset:12288
    v_mul_f32 v86, v13, v86
    v_mfma_f32_16x16x32_bf16 v[132:135], a[184:187], v[192:195], v[132:135]
    ds_read_b64_tr_b16 a[166:167], v5 offset:14336
    v_mul_f32 v87, v13, v87
    v_mfma_f32_16x16x32_bf16 v[132:135], a[188:191], v[200:203], v[132:135]
    ds_read_b64_tr_b16 a[168:169], v5 offset:16384
    v_cvt_pk_bf16_f32 v84, v84, v85
    v_mfma_f32_16x16x32_bf16 v[132:135], a[192:195], v[208:211], v[132:135]
    ds_read_b64_tr_b16 a[170:171], v5 offset:18432
    v_cvt_pk_bf16_f32 v85, v86, v87
    v_mfma_f32_16x16x32_bf16 v[132:135], a[196:199], v[216:219], v[132:135]
    ds_read_b64_tr_b16 a[172:173], v5 offset:20480
    v_mul_f32 v100, v14, v100
    v_mfma_f32_16x16x32_bf16 v[132:135], a[200:203], v[224:227], v[132:135]
    ds_read_b64_tr_b16 a[174:175], v5 offset:22528
    v_mul_f32 v101, v14, v101
    v_mfma_f32_16x16x32_bf16 v[132:135], a[204:207], v[232:235], v[132:135]
    ds_read_b64_tr_b16 a[176:177], v5 offset:24576
    v_mul_f32 v102, v14, v102
    v_mfma_f32_16x16x32_bf16 v[132:135], a[208:211], v[240:243], v[132:135]
    ds_read_b64_tr_b16 a[178:179], v5 offset:26624
    v_mul_f32 v103, v14, v103
    v_mfma_f32_16x16x32_bf16 v[132:135], a[212:215], v[248:251], v[132:135]
    ds_read_b64_tr_b16 a[180:181], v5 offset:28672
    v_cvt_pk_bf16_f32 v100, v100, v101
    v_mfma_f32_16x16x32_bf16 v[148:151], a[184:187], v[164:167], v[148:151]
    ds_read_b64_tr_b16 a[182:183], v5 offset:30720
    v_cvt_pk_bf16_f32 v101, v102, v103
    v_mfma_f32_16x16x32_bf16 v[148:151], a[188:191], v[196:199], v[148:151]
    v_mul_f32 v116, v12, v116
    v_mul_f32 v117, v12, v117
    v_mfma_f32_16x16x32_bf16 v[148:151], a[192:195], v[60:63], v[148:151]
    v_mul_f32 v118, v12, v118
    v_mul_f32 v119, v12, v119
    v_mfma_f32_16x16x32_bf16 v[148:151], a[196:199], v[76:79], v[148:151]
    v_cvt_pk_bf16_f32 v70, v116, v117
    v_cvt_pk_bf16_f32 v71, v118, v119
    v_mfma_f32_16x16x32_bf16 v[148:151], a[200:203], v[92:95], v[148:151]
    v_permlane16_swap_b32 v68, v70
    v_permlane16_swap_b32 v69, v71
    v_mfma_f32_16x16x32_bf16 v[148:151], a[204:207], v[108:111], v[148:151]
    buffer_store_dwordx4 v[68:71], v9, s[32:35], s94 offen offset:64 sc1 nt
    v_mfma_f32_16x16x32_bf16 v[148:151], a[208:211], v[124:127], v[148:151]
    v_mul_f32 v132, v13, v132
    v_mul_f32 v133, v13, v133
    v_mfma_f32_16x16x32_bf16 v[148:151], a[212:215], v[140:143], v[148:151]
    v_mul_f32 v134, v13, v134
    s_waitcnt lgkmcnt(8)
    v_mfma_f32_16x16x32_bf16 v[228:231], a[152:155], v[24:27], 0
    ds_read_b64_tr_b16 a[184:185], v6 offset:0
    v_add_u32 v5, 65536, v5
    v_mfma_f32_16x16x32_bf16 v[228:231], a[156:159], v[32:35], v[228:231]
    ds_read_b64_tr_b16 a[186:187], v6 offset:2048
    v_mul_f32 v135, v13, v135
    v_mfma_f32_16x16x32_bf16 v[228:231], a[160:163], v[40:43], v[228:231]
    ds_read_b64_tr_b16 a[188:189], v6 offset:4096
    v_cvt_pk_bf16_f32 v86, v132, v133
    v_mfma_f32_16x16x32_bf16 v[228:231], a[164:167], v[48:51], v[228:231]
    ds_read_b64_tr_b16 a[190:191], v6 offset:6144
    s_waitcnt lgkmcnt(4)
    v_mfma_f32_16x16x32_bf16 v[228:231], a[168:171], v[56:59], v[228:231]
    ds_read_b64_tr_b16 a[192:193], v6 offset:8192
    v_cvt_pk_bf16_f32 v87, v134, v135
    v_mfma_f32_16x16x32_bf16 v[228:231], a[172:175], v[64:67], v[228:231]
    ds_read_b64_tr_b16 a[194:195], v6 offset:10240
    v_permlane16_swap_b32 v84, v86
    v_mfma_f32_16x16x32_bf16 v[228:231], a[176:179], v[72:75], v[228:231]
    ds_read_b64_tr_b16 a[196:197], v6 offset:12288
    v_permlane16_swap_b32 v85, v87
    v_mfma_f32_16x16x32_bf16 v[228:231], a[180:183], v[80:83], v[228:231]
    ds_read_b64_tr_b16 a[198:199], v6 offset:14336
    v_mfma_f32_16x16x32_bf16 v[244:247], a[152:155], v[16:19], 0
    ds_read_b64_tr_b16 a[200:201], v6 offset:16384
    v_mfma_f32_16x16x32_bf16 v[244:247], a[156:159], v[28:31], v[244:247]
    ds_read_b64_tr_b16 a[202:203], v6 offset:18432
    v_mfma_f32_16x16x32_bf16 v[244:247], a[160:163], v[44:47], v[244:247]
    ds_read_b64_tr_b16 a[204:205], v6 offset:20480
    v_mfma_f32_16x16x32_bf16 v[244:247], a[164:167], v[152:155], v[244:247]
    ds_read_b64_tr_b16 a[206:207], v6 offset:22528
    v_mfma_f32_16x16x32_bf16 v[244:247], a[168:171], v[160:163], v[244:247]
    ds_read_b64_tr_b16 a[208:209], v6 offset:24576
    v_mfma_f32_16x16x32_bf16 v[244:247], a[172:175], v[168:171], v[244:247]
    ds_read_b64_tr_b16 a[210:211], v6 offset:26624
    v_mfma_f32_16x16x32_bf16 v[244:247], a[176:179], v[176:179], v[244:247]
    ds_read_b64_tr_b16 a[212:213], v6 offset:28672
    v_mfma_f32_16x16x32_bf16 v[244:247], a[180:183], v[184:187], v[244:247]
    ds_read_b64_tr_b16 a[214:215], v6 offset:30720
    v_mfma_f32_16x16x32_bf16 v[20:23], a[152:155], v[156:159], 0
    buffer_store_dwordx4 v[84:87], v10, s[32:35], s94 offen offset:64 sc1 nt
    v_mfma_f32_16x16x32_bf16 v[20:23], a[156:159], v[172:175], v[20:23]
    v_mul_f32 v148, v14, v148
    v_mul_f32 v149, v14, v149
    v_mfma_f32_16x16x32_bf16 v[20:23], a[160:163], v[188:191], v[20:23]
    v_mul_f32 v150, v14, v150
    v_mul_f32 v151, v14, v151
    v_mfma_f32_16x16x32_bf16 v[20:23], a[164:167], v[204:207], v[20:23]
    v_cvt_pk_bf16_f32 v102, v148, v149
    v_cvt_pk_bf16_f32 v103, v150, v151
    v_mfma_f32_16x16x32_bf16 v[20:23], a[168:171], v[220:223], v[20:23]
    v_permlane16_swap_b32 v100, v102
    v_permlane16_swap_b32 v101, v103
    v_mfma_f32_16x16x32_bf16 v[20:23], a[172:175], v[236:239], v[20:23]
    buffer_store_dwordx4 v[100:103], v11, s[32:35], s94 offen offset:64 sc1 nt
    v_mfma_f32_16x16x32_bf16 v[20:23], a[176:179], v[252:255], v[20:23]
    v_mfma_f32_16x16x32_bf16 v[20:23], a[180:183], v[36:39], v[20:23]
    s_waitcnt lgkmcnt(8)
    v_mfma_f32_16x16x32_bf16 v[52:55], a[184:187], v[24:27], 0
    ds_read_b64_tr_b16 a[152:153], v7 offset:0
    v_add_u32 v6, 65536, v6
    v_mfma_f32_16x16x32_bf16 v[52:55], a[188:191], v[32:35], v[52:55]
    ds_read_b64_tr_b16 a[154:155], v7 offset:2048
    v_mfma_f32_16x16x32_bf16 v[52:55], a[192:195], v[40:43], v[52:55]
    ds_read_b64_tr_b16 a[156:157], v7 offset:4096
    v_mfma_f32_16x16x32_bf16 v[52:55], a[196:199], v[48:51], v[52:55]
    ds_read_b64_tr_b16 a[158:159], v7 offset:6144
    s_waitcnt lgkmcnt(4)
    v_mfma_f32_16x16x32_bf16 v[52:55], a[200:203], v[56:59], v[52:55]
    ds_read_b64_tr_b16 a[160:161], v7 offset:8192
    v_mfma_f32_16x16x32_bf16 v[52:55], a[204:207], v[64:67], v[52:55]
    ds_read_b64_tr_b16 a[162:163], v7 offset:10240
    v_mfma_f32_16x16x32_bf16 v[52:55], a[208:211], v[72:75], v[52:55]
    ds_read_b64_tr_b16 a[164:165], v7 offset:12288
    v_mfma_f32_16x16x32_bf16 v[52:55], a[212:215], v[80:83], v[52:55]
    ds_read_b64_tr_b16 a[166:167], v7 offset:14336
    v_mfma_f32_16x16x32_bf16 v[180:183], a[184:187], v[16:19], 0
    ds_read_b64_tr_b16 a[168:169], v7 offset:16384
    v_mfma_f32_16x16x32_bf16 v[180:183], a[188:191], v[28:31], v[180:183]
    ds_read_b64_tr_b16 a[170:171], v7 offset:18432
    v_mfma_f32_16x16x32_bf16 v[180:183], a[192:195], v[44:47], v[180:183]
    ds_read_b64_tr_b16 a[172:173], v7 offset:20480
    v_mfma_f32_16x16x32_bf16 v[180:183], a[196:199], v[152:155], v[180:183]
    ds_read_b64_tr_b16 a[174:175], v7 offset:22528
    v_mfma_f32_16x16x32_bf16 v[180:183], a[200:203], v[160:163], v[180:183]
    ds_read_b64_tr_b16 a[176:177], v7 offset:24576
    v_mfma_f32_16x16x32_bf16 v[180:183], a[204:207], v[168:171], v[180:183]
    ds_read_b64_tr_b16 a[178:179], v7 offset:26624
    v_mfma_f32_16x16x32_bf16 v[180:183], a[208:211], v[176:179], v[180:183]
    ds_read_b64_tr_b16 a[180:181], v7 offset:28672
    v_mfma_f32_16x16x32_bf16 v[180:183], a[212:215], v[184:187], v[180:183]
    ds_read_b64_tr_b16 a[182:183], v7 offset:30720
    v_mfma_f32_16x16x32_bf16 v[212:215], a[184:187], v[156:159], 0
    v_mfma_f32_16x16x32_bf16 v[212:215], a[188:191], v[172:175], v[212:215]
    v_mfma_f32_16x16x32_bf16 v[212:215], a[192:195], v[188:191], v[212:215]
    v_mfma_f32_16x16x32_bf16 v[212:215], a[196:199], v[204:207], v[212:215]
    v_mfma_f32_16x16x32_bf16 v[212:215], a[200:203], v[220:223], v[212:215]
    v_mfma_f32_16x16x32_bf16 v[212:215], a[204:207], v[236:239], v[212:215]
    v_mfma_f32_16x16x32_bf16 v[212:215], a[208:211], v[252:255], v[212:215]
    v_mfma_f32_16x16x32_bf16 v[212:215], a[212:215], v[36:39], v[212:215]
    s_waitcnt lgkmcnt(8)
    v_mfma_f32_16x16x32_bf16 v[68:71], a[152:155], v[24:27], 0
    ds_read_b64_tr_b16 a[184:185], v8 offset:0
    v_add_u32 v7, 65536, v7
    v_mfma_f32_16x16x32_bf16 v[68:71], a[156:159], v[32:35], v[68:71]
    ds_read_b64_tr_b16 a[186:187], v8 offset:2048
    v_mfma_f32_16x16x32_bf16 v[68:71], a[160:163], v[40:43], v[68:71]
    ds_read_b64_tr_b16 a[188:189], v8 offset:4096
    v_mfma_f32_16x16x32_bf16 v[68:71], a[164:167], v[48:51], v[68:71]
    ds_read_b64_tr_b16 a[190:191], v8 offset:6144
    s_waitcnt lgkmcnt(4)
    v_mfma_f32_16x16x32_bf16 v[68:71], a[168:171], v[56:59], v[68:71]
    ds_read_b64_tr_b16 a[192:193], v8 offset:8192
    v_mfma_f32_16x16x32_bf16 v[68:71], a[172:175], v[64:67], v[68:71]
    ds_read_b64_tr_b16 a[194:195], v8 offset:10240
    v_mfma_f32_16x16x32_bf16 v[68:71], a[176:179], v[72:75], v[68:71]
    ds_read_b64_tr_b16 a[196:197], v8 offset:12288
    v_mfma_f32_16x16x32_bf16 v[68:71], a[180:183], v[80:83], v[68:71]
    ds_read_b64_tr_b16 a[198:199], v8 offset:14336
    v_mfma_f32_16x16x32_bf16 v[84:87], a[152:155], v[16:19], 0
    ds_read_b64_tr_b16 a[200:201], v8 offset:16384
    v_mfma_f32_16x16x32_bf16 v[84:87], a[156:159], v[28:31], v[84:87]
    ds_read_b64_tr_b16 a[202:203], v8 offset:18432
    v_mfma_f32_16x16x32_bf16 v[84:87], a[160:163], v[44:47], v[84:87]
    ds_read_b64_tr_b16 a[204:205], v8 offset:20480
    v_mfma_f32_16x16x32_bf16 v[84:87], a[164:167], v[152:155], v[84:87]
    ds_read_b64_tr_b16 a[206:207], v8 offset:22528
    v_mfma_f32_16x16x32_bf16 v[84:87], a[168:171], v[160:163], v[84:87]
    ds_read_b64_tr_b16 a[208:209], v8 offset:24576
    v_mfma_f32_16x16x32_bf16 v[84:87], a[172:175], v[168:171], v[84:87]
    ds_read_b64_tr_b16 a[210:211], v8 offset:26624
    v_mfma_f32_16x16x32_bf16 v[84:87], a[176:179], v[176:179], v[84:87]
    ds_read_b64_tr_b16 a[212:213], v8 offset:28672
    v_mfma_f32_16x16x32_bf16 v[84:87], a[180:183], v[184:187], v[84:87]
    ds_read_b64_tr_b16 a[214:215], v8 offset:30720
    v_mfma_f32_16x16x32_bf16 v[100:103], a[152:155], v[156:159], 0
    v_mfma_f32_16x16x32_bf16 v[100:103], a[156:159], v[172:175], v[100:103]
    v_mfma_f32_16x16x32_bf16 v[100:103], a[160:163], v[188:191], v[100:103]
    v_mfma_f32_16x16x32_bf16 v[100:103], a[164:167], v[204:207], v[100:103]
    v_mfma_f32_16x16x32_bf16 v[100:103], a[168:171], v[220:223], v[100:103]
    v_mfma_f32_16x16x32_bf16 v[100:103], a[172:175], v[236:239], v[100:103]
    v_mfma_f32_16x16x32_bf16 v[100:103], a[176:179], v[252:255], v[100:103]
    v_mfma_f32_16x16x32_bf16 v[100:103], a[180:183], v[36:39], v[100:103]
    s_waitcnt lgkmcnt(8)
    v_mfma_f32_16x16x32_bf16 v[116:119], a[184:187], v[24:27], 0
    s_waitcnt vmcnt(6)
    s_barrier
    v_add_u32 v8, 65536, v8
    v_mfma_f32_16x16x32_bf16 v[116:119], a[188:191], v[32:35], v[116:119]
    ds_read_b64_tr_b16 a[152:153], v5 offset:0
    v_mfma_f32_16x16x32_bf16 v[116:119], a[192:195], v[40:43], v[116:119]
    ds_read_b64_tr_b16 a[154:155], v5 offset:2048
    v_mfma_f32_16x16x32_bf16 v[116:119], a[196:199], v[48:51], v[116:119]
    ds_read_b64_tr_b16 a[156:157], v5 offset:4096
    s_waitcnt lgkmcnt(3)
    v_mfma_f32_16x16x32_bf16 v[116:119], a[200:203], v[56:59], v[116:119]
    ds_read_b64_tr_b16 a[158:159], v5 offset:6144
    v_mfma_f32_16x16x32_bf16 v[116:119], a[204:207], v[64:67], v[116:119]
    ds_read_b64_tr_b16 a[160:161], v5 offset:8192
    v_mfma_f32_16x16x32_bf16 v[116:119], a[208:211], v[72:75], v[116:119]
    ds_read_b64_tr_b16 a[162:163], v5 offset:10240
    v_mfma_f32_16x16x32_bf16 v[116:119], a[212:215], v[80:83], v[116:119]
    ds_read_b64_tr_b16 a[164:165], v5 offset:12288
    v_mfma_f32_16x16x32_bf16 v[132:135], a[184:187], v[16:19], 0
    ds_read_b64_tr_b16 a[166:167], v5 offset:14336
    v_mfma_f32_16x16x32_bf16 v[132:135], a[188:191], v[28:31], v[132:135]
    ds_read_b64_tr_b16 a[168:169], v5 offset:16384
    v_mfma_f32_16x16x32_bf16 v[132:135], a[192:195], v[44:47], v[132:135]
    ds_read_b64_tr_b16 a[170:171], v5 offset:18432
    v_mfma_f32_16x16x32_bf16 v[132:135], a[196:199], v[152:155], v[132:135]
    ds_read_b64_tr_b16 a[172:173], v5 offset:20480
    v_mfma_f32_16x16x32_bf16 v[132:135], a[200:203], v[160:163], v[132:135]
    ds_read_b64_tr_b16 a[174:175], v5 offset:22528
    v_mfma_f32_16x16x32_bf16 v[132:135], a[204:207], v[168:171], v[132:135]
    ds_read_b64_tr_b16 a[176:177], v5 offset:24576
    v_mfma_f32_16x16x32_bf16 v[132:135], a[208:211], v[176:179], v[132:135]
    ds_read_b64_tr_b16 a[178:179], v5 offset:26624
    v_mfma_f32_16x16x32_bf16 v[132:135], a[212:215], v[184:187], v[132:135]
    ds_read_b64_tr_b16 a[180:181], v5 offset:28672
    v_mfma_f32_16x16x32_bf16 v[148:151], a[184:187], v[156:159], 0
    ds_read_b64_tr_b16 a[182:183], v5 offset:30720
    v_mfma_f32_16x16x32_bf16 v[148:151], a[188:191], v[172:175], v[148:151]
    v_mfma_f32_16x16x32_bf16 v[148:151], a[192:195], v[188:191], v[148:151]
    v_mfma_f32_16x16x32_bf16 v[148:151], a[196:199], v[204:207], v[148:151]
    v_mfma_f32_16x16x32_bf16 v[148:151], a[200:203], v[220:223], v[148:151]
    v_mfma_f32_16x16x32_bf16 v[148:151], a[204:207], v[236:239], v[148:151]
    v_mfma_f32_16x16x32_bf16 v[148:151], a[208:211], v[252:255], v[148:151]
    v_mfma_f32_16x16x32_bf16 v[148:151], a[212:215], v[36:39], v[148:151]
    s_waitcnt lgkmcnt(8)
    v_mfma_f32_16x16x32_bf16 v[228:231], a[152:155], v[88:91], v[228:231]
    ds_read_b64_tr_b16 a[184:185], v6 offset:0
    v_mfma_f32_16x16x32_bf16 v[228:231], a[156:159], v[96:99], v[228:231]
    ds_read_b64_tr_b16 a[186:187], v6 offset:2048
    v_mfma_f32_16x16x32_bf16 v[228:231], a[160:163], v[104:107], v[228:231]
    ds_read_b64_tr_b16 a[188:189], v6 offset:4096
    v_mfma_f32_16x16x32_bf16 v[228:231], a[164:167], v[112:115], v[228:231]
    ds_read_b64_tr_b16 a[190:191], v6 offset:6144
    s_waitcnt lgkmcnt(4)
    v_mfma_f32_16x16x32_bf16 v[228:231], a[168:171], v[120:123], v[228:231]
    ds_read_b64_tr_b16 a[192:193], v6 offset:8192
    v_mfma_f32_16x16x32_bf16 v[228:231], a[172:175], v[128:131], v[228:231]
    ds_read_b64_tr_b16 a[194:195], v6 offset:10240
    v_mfma_f32_16x16x32_bf16 v[228:231], a[176:179], v[136:139], v[228:231]
    ds_read_b64_tr_b16 a[196:197], v6 offset:12288
    v_mfma_f32_16x16x32_bf16 v[228:231], a[180:183], v[144:147], v[228:231]
    ds_read_b64_tr_b16 a[198:199], v6 offset:14336
    v_mfma_f32_16x16x32_bf16 v[244:247], a[152:155], v[192:195], v[244:247]
    ds_read_b64_tr_b16 a[200:201], v6 offset:16384
    v_mfma_f32_16x16x32_bf16 v[244:247], a[156:159], v[200:203], v[244:247]
    ds_read_b64_tr_b16 a[202:203], v6 offset:18432
    v_mfma_f32_16x16x32_bf16 v[244:247], a[160:163], v[208:211], v[244:247]
    ds_read_b64_tr_b16 a[204:205], v6 offset:20480
    v_mfma_f32_16x16x32_bf16 v[244:247], a[164:167], v[216:219], v[244:247]
    ds_read_b64_tr_b16 a[206:207], v6 offset:22528
    v_mfma_f32_16x16x32_bf16 v[244:247], a[168:171], v[224:227], v[244:247]
    ds_read_b64_tr_b16 a[208:209], v6 offset:24576
    v_mul_f32 v228, v12, v228
    v_mfma_f32_16x16x32_bf16 v[244:247], a[172:175], v[232:235], v[244:247]
    ds_read_b64_tr_b16 a[210:211], v6 offset:26624
    v_mul_f32 v229, v12, v229
    v_mfma_f32_16x16x32_bf16 v[244:247], a[176:179], v[240:243], v[244:247]
    ds_read_b64_tr_b16 a[212:213], v6 offset:28672
    v_mul_f32 v230, v12, v230
    v_mfma_f32_16x16x32_bf16 v[244:247], a[180:183], v[248:251], v[244:247]
    ds_read_b64_tr_b16 a[214:215], v6 offset:30720
    v_mul_f32 v231, v12, v231
    v_mfma_f32_16x16x32_bf16 v[20:23], a[152:155], v[164:167], v[20:23]
    v_cvt_pk_bf16_f32 v228, v228, v229
    v_cvt_pk_bf16_f32 v229, v230, v231
    v_mfma_f32_16x16x32_bf16 v[20:23], a[156:159], v[196:199], v[20:23]
    v_mfma_f32_16x16x32_bf16 v[20:23], a[160:163], v[60:63], v[20:23]
    v_mfma_f32_16x16x32_bf16 v[20:23], a[164:167], v[76:79], v[20:23]
    v_mfma_f32_16x16x32_bf16 v[20:23], a[168:171], v[92:95], v[20:23]
    v_mul_f32 v244, v13, v244
    v_mul_f32 v245, v13, v245
    v_mfma_f32_16x16x32_bf16 v[20:23], a[172:175], v[108:111], v[20:23]
    v_mul_f32 v246, v13, v246
    v_mul_f32 v247, v13, v247
    v_mfma_f32_16x16x32_bf16 v[20:23], a[176:179], v[124:127], v[20:23]
    v_cvt_pk_bf16_f32 v244, v244, v245
    v_cvt_pk_bf16_f32 v245, v246, v247
    v_mfma_f32_16x16x32_bf16 v[20:23], a[180:183], v[140:143], v[20:23]
    s_waitcnt lgkmcnt(8)
    v_mfma_f32_16x16x32_bf16 v[52:55], a[184:187], v[88:91], v[52:55]
    ds_read_b64_tr_b16 a[152:153], v7 offset:0
    v_mfma_f32_16x16x32_bf16 v[52:55], a[188:191], v[96:99], v[52:55]
    ds_read_b64_tr_b16 a[154:155], v7 offset:2048
    v_mfma_f32_16x16x32_bf16 v[52:55], a[192:195], v[104:107], v[52:55]
    ds_read_b64_tr_b16 a[156:157], v7 offset:4096
    v_mfma_f32_16x16x32_bf16 v[52:55], a[196:199], v[112:115], v[52:55]
    ds_read_b64_tr_b16 a[158:159], v7 offset:6144
    s_waitcnt lgkmcnt(4)
    v_mfma_f32_16x16x32_bf16 v[52:55], a[200:203], v[120:123], v[52:55]
    ds_read_b64_tr_b16 a[160:161], v7 offset:8192
    v_mul_f32 v20, v14, v20
    v_mfma_f32_16x16x32_bf16 v[52:55], a[204:207], v[128:131], v[52:55]
    ds_read_b64_tr_b16 a[162:163], v7 offset:10240
    v_mul_f32 v21, v14, v21
    v_mfma_f32_16x16x32_bf16 v[52:55], a[208:211], v[136:139], v[52:55]
    ds_read_b64_tr_b16 a[164:165], v7 offset:12288
    v_mul_f32 v22, v14, v22
    v_mfma_f32_16x16x32_bf16 v[52:55], a[212:215], v[144:147], v[52:55]
    ds_read_b64_tr_b16 a[166:167], v7 offset:14336
    v_mul_f32 v23, v14, v23
    v_mfma_f32_16x16x32_bf16 v[180:183], a[184:187], v[192:195], v[180:183]
    ds_read_b64_tr_b16 a[168:169], v7 offset:16384
    v_cvt_pk_bf16_f32 v20, v20, v21
    v_mfma_f32_16x16x32_bf16 v[180:183], a[188:191], v[200:203], v[180:183]
    ds_read_b64_tr_b16 a[170:171], v7 offset:18432
    v_cvt_pk_bf16_f32 v21, v22, v23
    v_mfma_f32_16x16x32_bf16 v[180:183], a[192:195], v[208:211], v[180:183]
    ds_read_b64_tr_b16 a[172:173], v7 offset:20480
    v_mfma_f32_16x16x32_bf16 v[180:183], a[196:199], v[216:219], v[180:183]
    ds_read_b64_tr_b16 a[174:175], v7 offset:22528
    v_mfma_f32_16x16x32_bf16 v[180:183], a[200:203], v[224:227], v[180:183]
    ds_read_b64_tr_b16 a[176:177], v7 offset:24576
    v_mul_f32 v52, v12, v52
    v_mfma_f32_16x16x32_bf16 v[180:183], a[204:207], v[232:235], v[180:183]
    ds_read_b64_tr_b16 a[178:179], v7 offset:26624
    v_mul_f32 v53, v12, v53
    v_mfma_f32_16x16x32_bf16 v[180:183], a[208:211], v[240:243], v[180:183]
    ds_read_b64_tr_b16 a[180:181], v7 offset:28672
    v_mul_f32 v54, v12, v54
    v_mfma_f32_16x16x32_bf16 v[180:183], a[212:215], v[248:251], v[180:183]
    ds_read_b64_tr_b16 a[182:183], v7 offset:30720
    v_mul_f32 v55, v12, v55
    v_mfma_f32_16x16x32_bf16 v[212:215], a[184:187], v[164:167], v[212:215]
    v_cvt_pk_bf16_f32 v230, v52, v53
    v_cvt_pk_bf16_f32 v231, v54, v55
    v_mfma_f32_16x16x32_bf16 v[212:215], a[188:191], v[196:199], v[212:215]
    v_permlane16_swap_b32 v228, v230
    v_permlane16_swap_b32 v229, v231
    v_mfma_f32_16x16x32_bf16 v[212:215], a[192:195], v[60:63], v[212:215]
    buffer_store_dwordx4 v[228:231], v9, s[32:35], s95 offen offset:0 sc1 nt
    v_mfma_f32_16x16x32_bf16 v[212:215], a[196:199], v[76:79], v[212:215]
    v_mfma_f32_16x16x32_bf16 v[212:215], a[200:203], v[92:95], v[212:215]
    v_mul_f32 v180, v13, v180
    v_mul_f32 v181, v13, v181
    v_mfma_f32_16x16x32_bf16 v[212:215], a[204:207], v[108:111], v[212:215]
    v_mul_f32 v182, v13, v182
    v_mul_f32 v183, v13, v183
    v_mfma_f32_16x16x32_bf16 v[212:215], a[208:211], v[124:127], v[212:215]
    v_cvt_pk_bf16_f32 v246, v180, v181
    v_cvt_pk_bf16_f32 v247, v182, v183
    v_mfma_f32_16x16x32_bf16 v[212:215], a[212:215], v[140:143], v[212:215]
    v_permlane16_swap_b32 v244, v246
    s_waitcnt lgkmcnt(8)
    v_mfma_f32_16x16x32_bf16 v[68:71], a[152:155], v[88:91], v[68:71]
    ds_read_b64_tr_b16 a[184:185], v8 offset:0
    v_permlane16_swap_b32 v245, v247
    v_mfma_f32_16x16x32_bf16 v[68:71], a[156:159], v[96:99], v[68:71]
    ds_read_b64_tr_b16 a[186:187], v8 offset:2048
    v_mfma_f32_16x16x32_bf16 v[68:71], a[160:163], v[104:107], v[68:71]
    ds_read_b64_tr_b16 a[188:189], v8 offset:4096
    v_mfma_f32_16x16x32_bf16 v[68:71], a[164:167], v[112:115], v[68:71]
    ds_read_b64_tr_b16 a[190:191], v8 offset:6144
    s_waitcnt lgkmcnt(4)
    v_mfma_f32_16x16x32_bf16 v[68:71], a[168:171], v[120:123], v[68:71]
    ds_read_b64_tr_b16 a[192:193], v8 offset:8192
    v_mfma_f32_16x16x32_bf16 v[68:71], a[172:175], v[128:131], v[68:71]
    ds_read_b64_tr_b16 a[194:195], v8 offset:10240
    v_mfma_f32_16x16x32_bf16 v[68:71], a[176:179], v[136:139], v[68:71]
    ds_read_b64_tr_b16 a[196:197], v8 offset:12288
    v_mfma_f32_16x16x32_bf16 v[68:71], a[180:183], v[144:147], v[68:71]
    ds_read_b64_tr_b16 a[198:199], v8 offset:14336
    v_mfma_f32_16x16x32_bf16 v[84:87], a[152:155], v[192:195], v[84:87]
    ds_read_b64_tr_b16 a[200:201], v8 offset:16384
    v_mfma_f32_16x16x32_bf16 v[84:87], a[156:159], v[200:203], v[84:87]
    ds_read_b64_tr_b16 a[202:203], v8 offset:18432
    v_mfma_f32_16x16x32_bf16 v[84:87], a[160:163], v[208:211], v[84:87]
    ds_read_b64_tr_b16 a[204:205], v8 offset:20480
    v_mfma_f32_16x16x32_bf16 v[84:87], a[164:167], v[216:219], v[84:87]
    ds_read_b64_tr_b16 a[206:207], v8 offset:22528
    v_mfma_f32_16x16x32_bf16 v[84:87], a[168:171], v[224:227], v[84:87]
    ds_read_b64_tr_b16 a[208:209], v8 offset:24576
    v_mfma_f32_16x16x32_bf16 v[84:87], a[172:175], v[232:235], v[84:87]
    ds_read_b64_tr_b16 a[210:211], v8 offset:26624
    v_mfma_f32_16x16x32_bf16 v[84:87], a[176:179], v[240:243], v[84:87]
    ds_read_b64_tr_b16 a[212:213], v8 offset:28672
    v_mfma_f32_16x16x32_bf16 v[84:87], a[180:183], v[248:251], v[84:87]
    ds_read_b64_tr_b16 a[214:215], v8 offset:30720
    v_mfma_f32_16x16x32_bf16 v[100:103], a[152:155], v[164:167], v[100:103]
    buffer_store_dwordx4 v[244:247], v10, s[32:35], s95 offen offset:0 sc1 nt
    v_mfma_f32_16x16x32_bf16 v[100:103], a[156:159], v[196:199], v[100:103]
    v_mul_f32 v212, v14, v212
    v_mul_f32 v213, v14, v213
    v_mfma_f32_16x16x32_bf16 v[100:103], a[160:163], v[60:63], v[100:103]
    v_mul_f32 v214, v14, v214
    v_mul_f32 v215, v14, v215
    v_mfma_f32_16x16x32_bf16 v[100:103], a[164:167], v[76:79], v[100:103]
    v_cvt_pk_bf16_f32 v22, v212, v213
    v_cvt_pk_bf16_f32 v23, v214, v215
    v_mfma_f32_16x16x32_bf16 v[100:103], a[168:171], v[92:95], v[100:103]
    v_permlane16_swap_b32 v20, v22
    v_permlane16_swap_b32 v21, v23
    v_mfma_f32_16x16x32_bf16 v[100:103], a[172:175], v[108:111], v[100:103]
    buffer_store_dwordx4 v[20:23], v11, s[32:35], s95 offen offset:0 sc1 nt
    v_mfma_f32_16x16x32_bf16 v[100:103], a[176:179], v[124:127], v[100:103]
    v_mul_f32 v68, v12, v68
    v_mul_f32 v69, v12, v69
    v_mfma_f32_16x16x32_bf16 v[100:103], a[180:183], v[140:143], v[100:103]
    v_mul_f32 v70, v12, v70
    s_waitcnt lgkmcnt(8)
    v_mfma_f32_16x16x32_bf16 v[116:119], a[184:187], v[88:91], v[116:119]
    v_mul_f32 v71, v12, v71
    v_cvt_pk_bf16_f32 v68, v68, v69
    v_mfma_f32_16x16x32_bf16 v[116:119], a[188:191], v[96:99], v[116:119]
    v_cvt_pk_bf16_f32 v69, v70, v71
    v_mul_f32 v84, v13, v84
    v_mfma_f32_16x16x32_bf16 v[116:119], a[192:195], v[104:107], v[116:119]
    v_mul_f32 v85, v13, v85
    v_mul_f32 v86, v13, v86
    v_mfma_f32_16x16x32_bf16 v[116:119], a[196:199], v[112:115], v[116:119]
    v_mul_f32 v87, v13, v87
    s_waitcnt lgkmcnt(0)
    v_mfma_f32_16x16x32_bf16 v[116:119], a[200:203], v[120:123], v[116:119]
    v_cvt_pk_bf16_f32 v84, v84, v85
    v_cvt_pk_bf16_f32 v85, v86, v87
    v_mfma_f32_16x16x32_bf16 v[116:119], a[204:207], v[128:131], v[116:119]
    v_mul_f32 v100, v14, v100
    v_mul_f32 v101, v14, v101
    v_mfma_f32_16x16x32_bf16 v[116:119], a[208:211], v[136:139], v[116:119]
    v_mul_f32 v102, v14, v102
    v_mul_f32 v103, v14, v103
    v_mfma_f32_16x16x32_bf16 v[116:119], a[212:215], v[144:147], v[116:119]
    v_cvt_pk_bf16_f32 v100, v100, v101
    v_cvt_pk_bf16_f32 v101, v102, v103
    v_mfma_f32_16x16x32_bf16 v[132:135], a[184:187], v[192:195], v[132:135]
    v_mfma_f32_16x16x32_bf16 v[132:135], a[188:191], v[200:203], v[132:135]
    v_mfma_f32_16x16x32_bf16 v[132:135], a[192:195], v[208:211], v[132:135]
    v_mfma_f32_16x16x32_bf16 v[132:135], a[196:199], v[216:219], v[132:135]
    v_mfma_f32_16x16x32_bf16 v[132:135], a[200:203], v[224:227], v[132:135]
    s_nop 0
    v_mul_f32 v116, v12, v116
    v_mul_f32 v117, v12, v117
    v_mfma_f32_16x16x32_bf16 v[132:135], a[204:207], v[232:235], v[132:135]
    v_mul_f32 v118, v12, v118
    v_mul_f32 v119, v12, v119
    v_mfma_f32_16x16x32_bf16 v[132:135], a[208:211], v[240:243], v[132:135]
    v_cvt_pk_bf16_f32 v70, v116, v117
    v_cvt_pk_bf16_f32 v71, v118, v119
    v_mfma_f32_16x16x32_bf16 v[132:135], a[212:215], v[248:251], v[132:135]
    v_permlane16_swap_b32 v68, v70
    v_permlane16_swap_b32 v69, v71
    v_mfma_f32_16x16x32_bf16 v[148:151], a[184:187], v[164:167], v[148:151]
    buffer_store_dwordx4 v[68:71], v9, s[32:35], s95 offen offset:64 sc1 nt
    v_mfma_f32_16x16x32_bf16 v[148:151], a[188:191], v[196:199], v[148:151]
    v_mfma_f32_16x16x32_bf16 v[148:151], a[192:195], v[60:63], v[148:151]
    v_mfma_f32_16x16x32_bf16 v[148:151], a[196:199], v[76:79], v[148:151]
    v_mfma_f32_16x16x32_bf16 v[148:151], a[200:203], v[92:95], v[148:151]
    v_mul_f32 v132, v13, v132
    v_mul_f32 v133, v13, v133
    v_mfma_f32_16x16x32_bf16 v[148:151], a[204:207], v[108:111], v[148:151]
    v_mul_f32 v134, v13, v134
    v_mul_f32 v135, v13, v135
    v_mfma_f32_16x16x32_bf16 v[148:151], a[208:211], v[124:127], v[148:151]
    v_cvt_pk_bf16_f32 v86, v132, v133
    v_cvt_pk_bf16_f32 v87, v134, v135
    v_mfma_f32_16x16x32_bf16 v[148:151], a[212:215], v[140:143], v[148:151]
    v_permlane16_swap_b32 v84, v86
    v_permlane16_swap_b32 v85, v87
    buffer_store_dwordx4 v[84:87], v10, s[32:35], s95 offen offset:64 sc1 nt
    s_nop 4
    v_mul_f32 v148, v14, v148
    v_mul_f32 v149, v14, v149
    v_mul_f32 v150, v14, v150
    v_mul_f32 v151, v14, v151
    v_cvt_pk_bf16_f32 v102, v148, v149
    v_cvt_pk_bf16_f32 v103, v150, v151
    s_nop 0
    v_permlane16_swap_b32 v100, v102
    v_permlane16_swap_b32 v101, v103
    buffer_store_dwordx4 v[100:103], v11, s[32:35], s95 offen offset:64 sc1 nt
    s_waitcnt vmcnt(0)
    s_endpgm

.section .rodata,"a"
.p2align 6
.amdhsa_kernel standalone__gqa_softmax__near_ridge_kernel
  .amdhsa_next_free_vgpr 512
  .amdhsa_next_free_sgpr 102
  .amdhsa_accum_offset 256
  .amdhsa_group_segment_fixed_size 0
  .amdhsa_kernarg_size 48
  .amdhsa_user_sgpr_count 2
  .amdhsa_user_sgpr_kernarg_segment_ptr 1
  .amdhsa_system_sgpr_workgroup_id_x 1
.end_amdhsa_kernel
```
